```python
import torch

def _softmax(x, axis=-1):
    return torch.softmax(x, dim=axis)

def _gelu(x):
    return torch.nn.functional.gelu(x, approximate='tanh')

def _silu(x):
    return torch.nn.functional.silu(x)

def _sigmoid(x):
    return torch.sigmoid(x)

def _layernorm(x, axis=-1, eps=1e-05):
    m = x.mean(dim=axis, keepdim=True)
    v = x.var(dim=axis, keepdim=True, unbiased=False)
    return (x - m) / torch.sqrt(v + eps)

def _scatter_add(tgt, idx, src, axis=0):
    return tgt.clone().index_add_(axis, idx, src)

def _segment_sum(src, seg, n):
    out = torch.zeros((n,) + src.shape[1:], dtype=src.dtype)
    return out.index_add_(0, seg, src)

def _pad(x, pw):
    flat = tuple((v for pair in reversed(pw) for v in pair))
    return torch.nn.functional.pad(x, flat)
kernel_name = 'recurrent_scan__memory_aug_recurrent_mem_tr__glu_gated_bilinear__prompt'

def setup_inputs():

    _w = lambda a: (lambda t: t.to(torch.bfloat16) if t.is_floating_point() else t)(torch.as_tensor(a))

    def _A_setup():
        B, S, Dm = (1, 2048, 512)
        H, Dh = (32, 128)
        M, seg = (8, 32)
        seg = min(seg, S)
        S = S // seg * seg
        return {'x': _w((lambda *s: torch.randn(*s, dtype=torch.bfloat16) * 0.1)(B, S, Dm)), 'mem0': _w((lambda *s: torch.randn(*s, dtype=torch.bfloat16) * 1.6)(B, M, Dm)), 'Wq': _w((lambda *s: torch.randn(*s, dtype=torch.bfloat16) * 0.8)(Dm, H, Dh) * Dm ** (-0.5)), 'Wk': _w((lambda *s: torch.randn(*s, dtype=torch.bfloat16) * 0.8)(Dm, H, Dh) * Dm ** (-0.5)), 'Wv': _w((lambda *s: torch.randn(*s, dtype=torch.bfloat16) * 1.6)(Dm, H, Dh) * Dm ** (-0.5)), 'Wo': _w((lambda *s: torch.randn(*s, dtype=torch.bfloat16) * 1.6)(H, Dh, Dm) * (H * Dh) ** (-0.5)), 'seg_len': seg}
    _A_in = _A_setup()

    def _B_setup():
        B, S, D, F = (1, 2048, 512, 1376)
        return {'x': _w((lambda *s: torch.randn(*s, dtype=torch.bfloat16) * 0.1)(B, S, D)), 'w_gate': _w((lambda *s: torch.randn(*s, dtype=torch.bfloat16) * 0.4)(D, F) * D ** (-0.5)), 'w_up': _w((lambda *s: torch.randn(*s, dtype=torch.bfloat16) * 0.4)(D, F) * D ** (-0.5)), 'w_down': _w((lambda *s: torch.randn(*s, dtype=torch.bfloat16) * 0.4)(F, D) * F ** (-0.5))}
    _B_in = _B_setup()
    return {'A_x': _A_in['x'], 'A_mem0': _A_in['mem0'], 'A_Wq': _A_in['Wq'], 'A_Wk': _A_in['Wk'], 'A_Wv': _A_in['Wv'], 'A_Wo': _A_in['Wo'], 'A_seg_len': _A_in['seg_len'], 'B_x': _B_in['x'], 'B_w_gate': _B_in['w_gate'], 'B_w_up': _B_in['w_up'], 'B_w_down': _B_in['w_down']}

def reference(A_x, A_mem0, A_Wq, A_Wk, A_Wv, A_Wo, A_seg_len, B_x, B_w_gate, B_w_up, B_w_down):

    def _A_ref(x, mem0, Wq, Wk, Wv, Wo, seg_len):
        B, S, Dm = x.shape
        H, Dh = (Wq.shape[1], Wq.shape[2])
        M = mem0.shape[1]
        scale = Dh ** (-0.5)
        n_seg = S // seg_len
        L = M + seg_len
        idx = torch.arange(L)
        mask = (idx[:, None] < M) | (idx[:, None] >= idx[None, :])
        mem = mem0
        outs = []
        for s in range(n_seg):
            xs = x[:, s * seg_len:(s + 1) * seg_len, :].clone()
            h = torch.concatenate([mem, xs], axis=1)
            q = torch.einsum('btd,dhe->bhte', h, Wq)
            k = torch.einsum('btd,dhe->bhte', h, Wk)
            v = torch.einsum('btd,dhe->bhte', h, Wv)
            scores = torch.einsum('bhqe,bhke->bhqk', q, k) * scale
            scores = torch.where(mask[None, None], scores, -1000000000.0)
            p = _softmax(scores, axis=-1)
            o = torch.einsum('bhqk,bhke->bhqe', p, v)
            o = torch.einsum('bhte,hed->btd', o, Wo)
            mem = o[:, :M, :].clone()
            outs.append(o[:, M:, :])
        return torch.concatenate(outs, axis=1)

    def _B_ref(x, w_gate, w_up, w_down):
        g = torch.einsum('bsd,df->bsf', x, w_gate)
        u = torch.einsum('bsd,df->bsf', x, w_up)
        h = g * u
        return torch.einsum('bsf,fd->bsd', h, w_down)
    x = A_x
    xn = _layernorm(x, axis=-1)
    s = _A_ref(xn, A_mem0, A_Wq, A_Wk, A_Wv, A_Wo, A_seg_len)
    g = _silu(_B_ref(xn, B_w_gate, B_w_up, B_w_down))
    return x + s * g
```

```asm
; @launch grid=(256,1,1) block=(256,1,1) lds=163840
.amdgcn_target "amdgcn-amd-amdhsa--gfx950"
.text
.globl recurrent_scan__memory_aug_recurrent_mem_tr__glu_gated_bilinear__prompt_kernel
.p2align 8
.type recurrent_scan__memory_aug_recurrent_mem_tr__glu_gated_bilinear__prompt_kernel,@function
recurrent_scan__memory_aug_recurrent_mem_tr__glu_gated_bilinear__prompt_kernel:
    s_cmp_ge_u32 s2, 256
    s_cbranch_scc1 L_exit
    s_load_dwordx2 s[4:5], s[0:1], 104
    s_load_dwordx2 s[8:9], s[0:1], 96
    s_waitcnt lgkmcnt(0)
    s_mov_b32 s6, 0x10000000
    s_mov_b32 s7, 0x20000
    s_mov_b32 s10, 0x100
    s_mov_b32 s11, 0x20000
    v_lshrrev_b32 v1, 6, v0
    s_nop 0
    v_readfirstlane_b32 s32, v1
    v_and_b32 v0, 63, v0
    s_mov_b32 s35, 0
    s_getreg_b32 s34, hwreg(HW_REG_XCC_ID)
    s_and_b32 s34, s34, 7
    s_lshl_b32 s34, s34, 2
    s_lshr_b32 s34, 0x63520741, s34
    s_and_b32 s34, s34, 7
    v_mov_b32 v2, 0
    s_cmp_lg_u32 s32, 0
    s_cbranch_scc1 L_code
    v_lshlrev_b32 v1, 2, v0
    s_lshl_b32 s36, s2, 8
    s_add_u32 s36, s36, 11796480
    buffer_store_dword v2, v1, s[4:7], s36 offen sc1
    v_mov_b32 v1, 1
    s_lshl_b32 s36, s34, 5
    v_mov_b32 v3, s36
    s_waitcnt vmcnt(0)
    s_mov_b64 exec, 1
    buffer_atomic_add v1, v3, s[8:11], 0 offen sc0 sc1
    s_waitcnt vmcnt(0)
    ds_write_b32 v2, v1
    s_mov_b64 exec, -1
    s_waitcnt lgkmcnt(0)
    s_branch L_tk
L_code:
L_pfw:
    s_waitcnt vmcnt(0)
L_tk:
    s_barrier
    ds_read_b32 v1, v2
    s_waitcnt lgkmcnt(0)
    v_readfirstlane_b32 s33, v1
    s_barrier
    s_cmp_lt_u32 s33, 32
    s_cbranch_scc1 L_role
    v_mbcnt_lo_u32_b32 v2, -1, 0
    v_mbcnt_hi_u32_b32 v2, -1, v2
    v_lshlrev_b32 v2, 5, v2
wt_1:
    buffer_load_dword v1, v2, s[8:11], 0 offen sc1
    s_waitcnt vmcnt(0)
    v_readlane_b32 s36, v1, 0
    v_readlane_b32 s37, v1, 1
    s_nop 0
    s_add_u32 s36, s36, s37
    v_readlane_b32 s37, v1, 2
    s_nop 0
    s_add_u32 s36, s36, s37
    v_readlane_b32 s37, v1, 3
    s_nop 0
    s_add_u32 s36, s36, s37
    v_readlane_b32 s37, v1, 4
    s_nop 0
    s_add_u32 s36, s36, s37
    v_readlane_b32 s37, v1, 5
    s_nop 0
    s_add_u32 s36, s36, s37
    v_readlane_b32 s37, v1, 6
    s_nop 0
    s_add_u32 s36, s36, s37
    v_readlane_b32 s37, v1, 7
    s_nop 0
    s_add_u32 s36, s36, s37
    s_cmp_ge_u32 s36, 256
    s_cbranch_scc1 wtd_2
    s_sleep 2
    s_add_u32 s35, s35, 1
    s_cmp_lt_u32 s35, 524288
    s_cbranch_scc1 wt_1
wtd_2:
    s_sub_u32 s40, s33, 32
    v_readlane_b32 s42, v1, 0
    s_nop 0
    s_max_u32 s42, s42, 32
    s_sub_u32 s42, s42, 32
    s_cmp_gt_u32 s34, 0
    s_cselect_b32 s42, s42, 0
    s_add_u32 s40, s40, s42
    v_readlane_b32 s42, v1, 1
    s_nop 0
    s_max_u32 s42, s42, 32
    s_sub_u32 s42, s42, 32
    s_cmp_gt_u32 s34, 1
    s_cselect_b32 s42, s42, 0
    s_add_u32 s40, s40, s42
    v_readlane_b32 s42, v1, 2
    s_nop 0
    s_max_u32 s42, s42, 32
    s_sub_u32 s42, s42, 32
    s_cmp_gt_u32 s34, 2
    s_cselect_b32 s42, s42, 0
    s_add_u32 s40, s40, s42
    v_readlane_b32 s42, v1, 3
    s_nop 0
    s_max_u32 s42, s42, 32
    s_sub_u32 s42, s42, 32
    s_cmp_gt_u32 s34, 3
    s_cselect_b32 s42, s42, 0
    s_add_u32 s40, s40, s42
    v_readlane_b32 s42, v1, 4
    s_nop 0
    s_max_u32 s42, s42, 32
    s_sub_u32 s42, s42, 32
    s_cmp_gt_u32 s34, 4
    s_cselect_b32 s42, s42, 0
    s_add_u32 s40, s40, s42
    v_readlane_b32 s42, v1, 5
    s_nop 0
    s_max_u32 s42, s42, 32
    s_sub_u32 s42, s42, 32
    s_cmp_gt_u32 s34, 5
    s_cselect_b32 s42, s42, 0
    s_add_u32 s40, s40, s42
    v_readlane_b32 s42, v1, 6
    s_nop 0
    s_max_u32 s42, s42, 32
    s_sub_u32 s42, s42, 32
    s_cmp_gt_u32 s34, 6
    s_cselect_b32 s42, s42, 0
    s_add_u32 s40, s40, s42
    v_readlane_b32 s42, v1, 0
    s_nop 0
    s_min_u32 s42, s42, 32
    s_mov_b32 s34, 0
    s_add_u32 s33, s42, s40
    s_cmp_lt_u32 s33, 32
    s_cbranch_scc1 L_role
    s_sub_u32 s40, s33, 32
    v_readlane_b32 s42, v1, 1
    s_nop 0
    s_min_u32 s42, s42, 32
    s_mov_b32 s34, 1
    s_add_u32 s33, s42, s40
    s_cmp_lt_u32 s33, 32
    s_cbranch_scc1 L_role
    s_sub_u32 s40, s33, 32
    v_readlane_b32 s42, v1, 2
    s_nop 0
    s_min_u32 s42, s42, 32
    s_mov_b32 s34, 2
    s_add_u32 s33, s42, s40
    s_cmp_lt_u32 s33, 32
    s_cbranch_scc1 L_role
    s_sub_u32 s40, s33, 32
    v_readlane_b32 s42, v1, 3
    s_nop 0
    s_min_u32 s42, s42, 32
    s_mov_b32 s34, 3
    s_add_u32 s33, s42, s40
    s_cmp_lt_u32 s33, 32
    s_cbranch_scc1 L_role
    s_sub_u32 s40, s33, 32
    v_readlane_b32 s42, v1, 4
    s_nop 0
    s_min_u32 s42, s42, 32
    s_mov_b32 s34, 4
    s_add_u32 s33, s42, s40
    s_cmp_lt_u32 s33, 32
    s_cbranch_scc1 L_role
    s_sub_u32 s40, s33, 32
    v_readlane_b32 s42, v1, 5
    s_nop 0
    s_min_u32 s42, s42, 32
    s_mov_b32 s34, 5
    s_add_u32 s33, s42, s40
    s_cmp_lt_u32 s33, 32
    s_cbranch_scc1 L_role
    s_sub_u32 s40, s33, 32
    v_readlane_b32 s42, v1, 6
    s_nop 0
    s_min_u32 s42, s42, 32
    s_mov_b32 s34, 6
    s_add_u32 s33, s42, s40
    s_cmp_lt_u32 s33, 32
    s_cbranch_scc1 L_role
    s_sub_u32 s40, s33, 32
    v_readlane_b32 s42, v1, 7
    s_nop 0
    s_min_u32 s42, s42, 32
    s_mov_b32 s34, 7
    s_add_u32 s33, s42, s40
    s_cmp_lt_u32 s33, 32
    s_cbranch_scc1 L_role
    s_sub_u32 s40, s33, 32
    s_branch L_exit
L_role:
    s_cmp_ge_u32 s34, 4
    s_cbranch_scc1 L_p3
    s_cmp_eq_u32 s34, 3
    s_cbranch_scc1 L_glu
    s_cmp_lg_u32 s34, 0
    s_cbranch_scc1 L_t1
    s_load_dwordx2 s[12:13], s[0:1], 16
    s_load_dwordx2 s[16:17], s[0:1], 24
    s_load_dwordx2 s[20:21], s[0:1], 32
    s_load_dwordx2 s[24:25], s[0:1], 40
    s_load_dwordx2 s[28:29], s[0:1], 8
    s_waitcnt lgkmcnt(0)
    s_mov_b32 s14, 0x400000
    s_mov_b32 s15, 0x20000
    s_mov_b32 s18, 0x400000
    s_mov_b32 s19, 0x20000
    s_mov_b32 s22, 0x400000
    s_mov_b32 s23, 0x20000
    s_mov_b32 s26, 0x400000
    s_mov_b32 s27, 0x20000
    s_mov_b32 s30, 0x2000
    s_mov_b32 s31, 0x20000
    v_mov_b32 v38, v0
    v_lshlrev_b32 v1, 4, v0
    v_lshrrev_b32 v32, 4, v0
    v_and_b32 v33, 15, v0
    s_mov_b32 s54, 0xcccccccc
    s_mov_b32 s55, 0xcccccccc
    s_mov_b32 s64, 0xaaaaaaaa
    s_mov_b32 s65, 0xaaaaaaaa
    s_mov_b32 s66, 0xf0f0f0f0
    s_mov_b32 s67, 0xf0f0f0f0
    v_mov_b32 v34, 0x44444444
    v_mov_b32 v35, 0xe4e4eeee
    v_cndmask_b32 v2, v34, v35, s[54:55]
    s_lshl_b32 s36, s32, 11
    s_add_u32 s37, s36, 139264
    v_add_u32 v3, s37, v1
    s_add_u32 s58, s36, 0
    s_add_u32 s59, s36, 147456
    s_lshl_b32 s37, s32, 14
    s_add_u32 s37, s37, 8192
    v_add_u32 v10, s37, v1
    s_lshl_b32 s37, s32, 6
    s_add_u32 s37, s37, 155648
    v_mul_u32_u24 v34, 576, v32
    v_lshl_add_u32 v34, v33, 2, v34
    v_add_u32 v4, s37, v34
    v_lshrrev_b32 v34, 2, v33
    v_and_b32 v35, 1, v33
    v_lshl_add_u32 v35, v34, 1, v35
    v_mul_u32_u24 v35, 288, v35
    v_lshl_add_u32 v36, v32, 4, v35
    v_add_u32 v5, 155648, v36
    v_and_b32 v35, 2, v34
    v_add_u32 v35, v35, v33
    v_and_b32 v35, 3, v35
    v_and_b32 v36, 1, v34
    v_lshl_add_u32 v35, v36, 2, v35
    v_mul_u32_u24 v35, 288, v35
    v_lshl_add_u32 v35, v32, 4, v35
    v_add_u32 v6, 157952, v35
    v_lshrrev_b32 v34, 5, v38
    v_mul_u32_u24 v34, 9472, v34
    v_and_b32 v35, 31, v38
    v_lshl_add_u32 v8, v35, 3, v34
    s_add_u32 s36, s33, 0
    s_and_b32 s36, s36, 3
    s_lshl_b32 s37, s32, 2
    s_add_u32 s36, s36, s37
    s_mul_i32 s36, s36, 18944
    s_lshr_b32 s37, s33, 2
    s_lshl_b32 s37, s37, 8
    s_add_u32 s36, s36, s37
    s_add_u32 s44, s36, 10485760
    s_add_u32 s36, s33, 1
    s_and_b32 s36, s36, 3
    s_lshl_b32 s37, s32, 2
    s_add_u32 s36, s36, s37
    s_mul_i32 s36, s36, 18944
    s_lshr_b32 s37, s33, 2
    s_lshl_b32 s37, s37, 8
    s_add_u32 s36, s36, s37
    s_add_u32 s45, s36, 10487808
    s_add_u32 s36, s33, 2
    s_and_b32 s36, s36, 3
    s_lshl_b32 s37, s32, 2
    s_add_u32 s36, s36, s37
    s_mul_i32 s36, s36, 18944
    s_lshr_b32 s37, s33, 2
    s_lshl_b32 s37, s37, 8
    s_add_u32 s36, s36, s37
    s_add_u32 s46, s36, 10489856
    s_add_u32 s36, s33, 3
    s_and_b32 s36, s36, 3
    s_lshl_b32 s37, s32, 2
    s_add_u32 s36, s36, s37
    s_mul_i32 s36, s36, 18944
    s_lshr_b32 s37, s33, 2
    s_lshl_b32 s37, s37, 8
    s_add_u32 s36, s36, s37
    s_add_u32 s47, s36, 10491904
    s_mul_i32 s36, s33, 9472
    s_add_u32 s48, s36, 10485760
    s_lshr_b32 s36, s33, 1
    s_and_b32 s36, s36, 3
    s_lshl_b32 s38, s36, 11
    s_lshr_b32 s37, s33, 4
    s_lshl_b32 s37, s37, 10
    s_add_u32 s38, s38, s37
    s_and_b32 s37, s33, 0
    s_lshl_b32 s37, s37, 10
    s_lshl_b32 s70, s32, 11
    s_add_u32 s70, s70, s37
    s_bfe_u32 s37, s33, 0x10003
    s_lshl_b32 s37, s37, 9
    s_add_u32 s38, s38, s37
    s_and_b32 s37, s33, 1
    s_lshl_b32 s37, s37, 7
    s_add_u32 s38, s38, s37
    v_and_b32 v36, 1, v32
    v_lshlrev_b32 v34, 8, v36
    v_lshrrev_b32 v35, 1, v32
    v_lshl_add_u32 v34, v35, 4, v34
    v_lshrrev_b32 v37, 2, v33
    v_lshl_add_u32 v34, v37, 5, v34
    v_and_b32 v37, 3, v33
    v_lshl_add_u32 v34, v37, 2, v34
    s_cmp_eq_u32 s32, 0
    s_cselect_b32 s38, s38, 0x80000000
    v_add_u32 v9, s38, v34
    s_lshl_b32 s38, s36, 8
    s_lshr_b32 s37, s33, 3
    s_lshl_b32 s37, s37, 6
    s_add_u32 s38, s38, s37
    s_and_b32 s37, s33, 1
    s_lshl_b32 s37, s37, 12
    s_add_u32 s38, s38, s37
    v_lshlrev_b32 v34, 5, v36
    v_lshl_add_u32 v34, v35, 10, v34
    v_lshrrev_b32 v37, 3, v33
    v_lshl_add_u32 v34, v37, 11, v34
    v_and_b32 v35, 7, v33
    v_lshl_add_u32 v34, v35, 2, v34
    v_mov_b32 v24, 0x3f803f80
    v_mov_b32 v26, 0x3f803f80
    v_mov_b32 v27, 0x3f803f80
    v_mov_b32 v28, 0x3f803f80
    v_mov_b32 v30, 0x3f803f80
    v_mov_b32 v31, 0x3f803f80
    v_lshlrev_b32 v35, 4, v37
    v_mov_b32 v36, 0x3f80
    v_lshlrev_b32 v25, v35, v36
    v_bfe_u32 v35, v33, 2, 1
    v_mul_u32_u24 v35, 0xaaaa, v35
    v_add_u32 v29, 0x4444, v35
    s_cmp_eq_u32 s32, 1
    s_cselect_b32 s37, 4, 7
    v_lshlrev_b32 v7, s37, v38
    s_cmp_lg_u32 s32, 1
    s_cselect_b32 s37, 0x80000000, 0
    v_or_b32 v7, s37, v7
    s_lshl_b32 s37, s33, 8
    s_add_u32 s53, s37, 11804672
    buffer_load_dword v37, v34, s[28:31], s38 offen
    s_mov_b32 s52, 0x3e0293ee
    s_mov_b32 s61, 0
    s_mov_b32 s62, 0
    s_mul_i32 s36, s33, 2097152
    s_lshl_b32 s37, s32, 10
    s_add_u32 s36, s36, s37
    s_add_u32 s51, s36, 33579008
    s_add_u32 s36, s36, s37
    s_add_u32 s50, s36, 33554432
    v_mov_b32 v64, 0
    v_mov_b32 v65, 0
    v_mov_b32 v66, 0
    v_mov_b32 v67, 0
    s_lshl_b32 s38, s32, 11
    s_add_u32 s38, s38, s48
    s_add_u32 s37, s38, 524288
    buffer_store_dwordx4 v[64:67], v1, s[4:7], s38 offen offset:0 sc1
    buffer_store_dwordx4 v[64:67], v1, s[4:7], s38 offen offset:1024 sc1
    buffer_store_dwordx4 v[64:67], v1, s[4:7], s37 offen offset:0 sc1
    buffer_store_dwordx4 v[64:67], v1, s[4:7], s37 offen offset:1024 sc1
    v_mov_b32 v68, -1
    s_mov_b32 s36, 11542528
    buffer_store_dword v68, v9, s[4:7], s36 offen offset:0 sc1
    s_mov_b32 s36, 11550720
    buffer_store_dword v68, v9, s[4:7], s36 offen offset:0 sc1
    s_mov_b32 s36, 11558912
    buffer_store_dword v68, v9, s[4:7], s36 offen offset:0 sc1
    s_waitcnt vmcnt(7)
    v_min_u32 v37, 0xfffffffe, v37
    s_mov_b32 s36, 11534336
    buffer_store_dword v37, v9, s[4:7], s36 offen offset:0 sc1
    v_lshrrev_b32 v72, 4, v38
    v_lshlrev_b32 v73, 1, v72
    v_and_b32 v74, 15, v38
    v_xor_b32 v73, v73, v74
    v_lshlrev_b32 v73, 4, v73
    v_lshrrev_b32 v74, 1, v72
    v_and_b32 v75, 1, v72
    s_lshl_b32 s36, s32, 17
    s_lshl_b32 s37, s33, 8
    s_add_u32 s36, s36, s37
    v_lshlrev_b32 v72, 16, v74
    v_lshl_add_u32 v72, v75, 13, v72
    v_add_u32 v72, s36, v72
    v_add_u32 v12, v72, v73
    v_xor_b32 v13, 128, v12
    s_lshr_b32 s36, s32, 1
    s_lshl_b32 s36, s36, 15
    s_and_b32 s37, s32, 1
    s_lshl_b32 s37, s37, 13
    s_add_u32 s36, s36, s37
    s_lshl_b32 s37, s33, 17
    s_add_u32 s36, s36, s37
    v_lshlrev_b32 v72, 14, v74
    v_lshl_add_u32 v72, v75, 10, v72
    v_add_u32 v72, s36, v72
    v_add_u32 v14, v72, v73
    v_xor_b32 v15, 128, v14
    v_lshrrev_b32 v72, 4, v38
    v_bfe_u32 v73, v38, 2, 2
    v_lshl_add_u32 v74, v72, 3, v73
    v_lshlrev_b32 v74, 8, v74
    v_and_b32 v72, 1, v72
    v_lshl_add_u32 v72, v72, 2, v73
    s_lshl_b32 s36, s32, 1
    v_xor_b32 v72, s36, v72
    v_lshl_add_u32 v74, v72, 5, v74
    v_and_b32 v73, 3, v38
    v_lshl_add_u32 v74, v73, 3, v74
    v_add_u32 v16, 73728, v74
    v_xor_b32 v17, 32, v16
    v_add_u32 v18, 49152, v16
    v_add_u32 v19, 49152, v17
    v_bfe_u32 v72, v38, 4, 1
    v_bfe_u32 v73, v38, 2, 1
    v_lshl_add_u32 v75, v72, 1, v73
    v_lshlrev_b32 v75, 1, v75
    v_lshlrev_b32 v74, 11, v72
    v_lshl_add_u32 v74, v73, 9, v74
    v_lshrrev_b32 v72, 5, v38
    v_lshl_add_u32 v74, v72, 10, v74
    v_bfe_u32 v72, v38, 3, 1
    v_add_u32 v72, s36, v72
    v_xor_b32 v72, v72, v75
    v_lshl_add_u32 v74, v72, 5, v74
    v_and_b32 v73, 3, v38
    v_lshl_add_u32 v74, v73, 3, v74
    v_add_u32 v20, 73728, v74
    v_xor_b32 v21, 288, v20
    v_add_u32 v22, 49152, v20
    v_add_u32 v23, 49152, v21
    s_add_u32 s36, s33, 0
    s_and_b32 s36, s36, 3
    s_lshl_b32 s72, s36, 8
    s_add_u32 s36, s33, 1
    s_and_b32 s36, s36, 3
    s_lshl_b32 s73, s36, 8
    s_add_u32 s36, s33, 2
    s_and_b32 s36, s36, 3
    s_lshl_b32 s74, s36, 8
    s_add_u32 s36, s33, 3
    s_and_b32 s36, s36, 3
    s_lshl_b32 s75, s36, 8
    s_lshl_b32 s76, s32, 12
    s_add_u32 s76, s76, 73728
    s_add_u32 m0, s76, 0
    s_mov_b32 s36, 0
    buffer_load_dwordx4 v12, s[16:19], s36 offen nt lds
    s_add_u32 m0, s76, 1024
    s_mov_b32 s36, 16384
    buffer_load_dwordx4 v12, s[16:19], s36 offen nt lds
    s_add_u32 m0, s76, 2048
    s_mov_b32 s36, 32768
    buffer_load_dwordx4 v13, s[16:19], s36 offen nt lds
    s_add_u32 m0, s76, 3072
    s_mov_b32 s36, 49152
    buffer_load_dwordx4 v13, s[16:19], s36 offen nt lds
    s_add_u32 m0, s76, 16384
    s_mov_b32 s36, 524288
    buffer_load_dwordx4 v12, s[16:19], s36 offen nt lds
    s_add_u32 m0, s76, 17408
    s_mov_b32 s36, 540672
    buffer_load_dwordx4 v12, s[16:19], s36 offen nt lds
    s_add_u32 m0, s76, 18432
    s_mov_b32 s36, 557056
    buffer_load_dwordx4 v13, s[16:19], s36 offen nt lds
    s_add_u32 m0, s76, 19456
    s_mov_b32 s36, 573440
    buffer_load_dwordx4 v13, s[16:19], s36 offen nt lds
    s_add_u32 m0, s76, 32768
    s_mov_b32 s36, 1048576
    buffer_load_dwordx4 v12, s[16:19], s36 offen nt lds
    s_add_u32 m0, s76, 33792
    s_mov_b32 s36, 1064960
    buffer_load_dwordx4 v12, s[16:19], s36 offen nt lds
    s_add_u32 m0, s76, 34816
    s_mov_b32 s36, 1081344
    buffer_load_dwordx4 v13, s[16:19], s36 offen nt lds
    s_add_u32 m0, s76, 35840
    s_mov_b32 s36, 1097728
    buffer_load_dwordx4 v13, s[16:19], s36 offen nt lds
    s_add_u32 m0, s76, 49152
    s_mov_b32 s36, 1572864
    buffer_load_dwordx4 v12, s[16:19], s36 offen nt lds
    s_add_u32 m0, s76, 50176
    s_mov_b32 s36, 1589248
    buffer_load_dwordx4 v12, s[16:19], s36 offen nt lds
    s_add_u32 m0, s76, 51200
    s_mov_b32 s36, 1605632
    buffer_load_dwordx4 v13, s[16:19], s36 offen nt lds
    s_add_u32 m0, s76, 52224
    s_mov_b32 s36, 1622016
    buffer_load_dwordx4 v13, s[16:19], s36 offen nt lds
    s_cmp_eq_u32 s32, 1
    s_cbranch_scc1 cw1_5
    s_cmp_eq_u32 s32, 2
    s_cbranch_scc1 cw2_6
    s_cmp_eq_u32 s32, 3
    s_cbranch_scc1 cw3_7
cw0_4:
    s_waitcnt vmcnt(12) lgkmcnt(0)
    s_barrier
    s_add_u32 m0, s76, 65536
    s_mov_b32 s36, 2097152
    buffer_load_dwordx4 v12, s[16:19], s36 offen nt lds
    s_add_u32 m0, s76, 66560
    s_mov_b32 s36, 2113536
    buffer_load_dwordx4 v12, s[16:19], s36 offen nt lds
    s_add_u32 m0, s76, 67584
    s_mov_b32 s36, 2129920
    buffer_load_dwordx4 v13, s[16:19], s36 offen nt lds
    s_add_u32 m0, s76, 68608
    s_mov_b32 s36, 2146304
    buffer_load_dwordx4 v13, s[16:19], s36 offen nt lds
    ds_read_b64_tr_b16 v[56:57], v16 offset:0
    ds_read_b64_tr_b16 v[58:59], v16 offset:1024
    ds_read_b64_tr_b16 v[60:61], v16 offset:8192
    ds_read_b64_tr_b16 v[62:63], v16 offset:9216
    ds_read_b64_tr_b16 v[88:89], v17 offset:0
    ds_read_b64_tr_b16 v[90:91], v17 offset:1024
    ds_read_b64_tr_b16 v[92:93], v17 offset:8192
    ds_read_b64_tr_b16 v[94:95], v17 offset:9216
    s_waitcnt vmcnt(12) lgkmcnt(0)
    s_barrier
    s_add_u32 m0, s76, 0
    s_mov_b32 s36, 2621440
    buffer_load_dwordx4 v12, s[16:19], s36 offen nt lds
    s_add_u32 m0, s76, 1024
    s_mov_b32 s36, 2637824
    buffer_load_dwordx4 v12, s[16:19], s36 offen nt lds
    s_add_u32 m0, s76, 2048
    s_mov_b32 s36, 2654208
    buffer_load_dwordx4 v13, s[16:19], s36 offen nt lds
    s_add_u32 m0, s76, 3072
    s_mov_b32 s36, 2670592
    buffer_load_dwordx4 v13, s[16:19], s36 offen nt lds
    ds_read_b64_tr_b16 v[128:129], v16 offset:16384
    ds_read_b64_tr_b16 v[130:131], v16 offset:17408
    ds_read_b64_tr_b16 v[132:133], v16 offset:24576
    ds_read_b64_tr_b16 v[134:135], v16 offset:25600
    ds_read_b64_tr_b16 v[136:137], v17 offset:16384
    ds_read_b64_tr_b16 v[138:139], v17 offset:17408
    ds_read_b64_tr_b16 v[140:141], v17 offset:24576
    ds_read_b64_tr_b16 v[142:143], v17 offset:25600
    s_waitcnt vmcnt(12) lgkmcnt(0)
    s_barrier
    s_add_u32 m0, s76, 16384
    s_mov_b32 s36, 3145728
    buffer_load_dwordx4 v12, s[16:19], s36 offen nt lds
    s_add_u32 m0, s76, 17408
    s_mov_b32 s36, 3162112
    buffer_load_dwordx4 v12, s[16:19], s36 offen nt lds
    s_add_u32 m0, s76, 18432
    s_mov_b32 s36, 3178496
    buffer_load_dwordx4 v13, s[16:19], s36 offen nt lds
    s_add_u32 m0, s76, 19456
    s_mov_b32 s36, 3194880
    buffer_load_dwordx4 v13, s[16:19], s36 offen nt lds
    ds_read_b64_tr_b16 a[0:1], v16 offset:32768
    ds_read_b64_tr_b16 a[2:3], v16 offset:33792
    ds_read_b64_tr_b16 a[4:5], v16 offset:40960
    ds_read_b64_tr_b16 a[6:7], v16 offset:41984
    ds_read_b64_tr_b16 a[8:9], v17 offset:32768
    ds_read_b64_tr_b16 a[10:11], v17 offset:33792
    ds_read_b64_tr_b16 a[12:13], v17 offset:40960
    ds_read_b64_tr_b16 a[14:15], v17 offset:41984
    s_waitcnt vmcnt(12) lgkmcnt(0)
    s_barrier
    s_add_u32 m0, s76, 32768
    s_mov_b32 s36, 3670016
    buffer_load_dwordx4 v12, s[16:19], s36 offen nt lds
    s_add_u32 m0, s76, 33792
    s_mov_b32 s36, 3686400
    buffer_load_dwordx4 v12, s[16:19], s36 offen nt lds
    s_add_u32 m0, s76, 34816
    s_mov_b32 s36, 3702784
    buffer_load_dwordx4 v13, s[16:19], s36 offen nt lds
    s_add_u32 m0, s76, 35840
    s_mov_b32 s36, 3719168
    buffer_load_dwordx4 v13, s[16:19], s36 offen nt lds
    ds_read_b64_tr_b16 a[16:17], v18 offset:0
    ds_read_b64_tr_b16 a[18:19], v18 offset:1024
    ds_read_b64_tr_b16 a[20:21], v18 offset:8192
    ds_read_b64_tr_b16 a[22:23], v18 offset:9216
    ds_read_b64_tr_b16 a[24:25], v19 offset:0
    ds_read_b64_tr_b16 a[26:27], v19 offset:1024
    ds_read_b64_tr_b16 a[28:29], v19 offset:8192
    ds_read_b64_tr_b16 a[30:31], v19 offset:9216
    s_waitcnt vmcnt(12) lgkmcnt(0)
    s_barrier
    s_add_u32 m0, s76, 49152
    s_mov_b32 s36, 0
    buffer_load_dwordx4 v12, s[20:23], s36 offen nt lds
    s_add_u32 m0, s76, 50176
    s_mov_b32 s36, 16384
    buffer_load_dwordx4 v12, s[20:23], s36 offen nt lds
    s_add_u32 m0, s76, 51200
    s_mov_b32 s36, 32768
    buffer_load_dwordx4 v13, s[20:23], s36 offen nt lds
    s_add_u32 m0, s76, 52224
    s_mov_b32 s36, 49152
    buffer_load_dwordx4 v13, s[20:23], s36 offen nt lds
    ds_read_b64_tr_b16 a[32:33], v18 offset:16384
    ds_read_b64_tr_b16 a[34:35], v18 offset:17408
    ds_read_b64_tr_b16 a[36:37], v18 offset:24576
    ds_read_b64_tr_b16 a[38:39], v18 offset:25600
    ds_read_b64_tr_b16 a[40:41], v19 offset:16384
    ds_read_b64_tr_b16 a[42:43], v19 offset:17408
    ds_read_b64_tr_b16 a[44:45], v19 offset:24576
    ds_read_b64_tr_b16 a[46:47], v19 offset:25600
    s_waitcnt vmcnt(12) lgkmcnt(0)
    s_barrier
    s_add_u32 m0, s76, 65536
    s_mov_b32 s36, 524288
    buffer_load_dwordx4 v12, s[20:23], s36 offen nt lds
    s_add_u32 m0, s76, 66560
    s_mov_b32 s36, 540672
    buffer_load_dwordx4 v12, s[20:23], s36 offen nt lds
    s_add_u32 m0, s76, 67584
    s_mov_b32 s36, 557056
    buffer_load_dwordx4 v13, s[20:23], s36 offen nt lds
    s_add_u32 m0, s76, 68608
    s_mov_b32 s36, 573440
    buffer_load_dwordx4 v13, s[20:23], s36 offen nt lds
    ds_read_b64_tr_b16 a[48:49], v16 offset:0
    ds_read_b64_tr_b16 a[50:51], v16 offset:1024
    ds_read_b64_tr_b16 a[52:53], v16 offset:8192
    ds_read_b64_tr_b16 a[54:55], v16 offset:9216
    ds_read_b64_tr_b16 a[56:57], v17 offset:0
    ds_read_b64_tr_b16 a[58:59], v17 offset:1024
    ds_read_b64_tr_b16 a[60:61], v17 offset:8192
    ds_read_b64_tr_b16 a[62:63], v17 offset:9216
    s_waitcnt vmcnt(12) lgkmcnt(0)
    s_barrier
    s_add_u32 m0, s76, 0
    s_mov_b32 s36, 1048576
    buffer_load_dwordx4 v12, s[20:23], s36 offen nt lds
    s_add_u32 m0, s76, 1024
    s_mov_b32 s36, 1064960
    buffer_load_dwordx4 v12, s[20:23], s36 offen nt lds
    s_add_u32 m0, s76, 2048
    s_mov_b32 s36, 1081344
    buffer_load_dwordx4 v13, s[20:23], s36 offen nt lds
    s_add_u32 m0, s76, 3072
    s_mov_b32 s36, 1097728
    buffer_load_dwordx4 v13, s[20:23], s36 offen nt lds
    ds_read_b64_tr_b16 a[64:65], v16 offset:16384
    ds_read_b64_tr_b16 a[66:67], v16 offset:17408
    ds_read_b64_tr_b16 a[68:69], v16 offset:24576
    ds_read_b64_tr_b16 a[70:71], v16 offset:25600
    ds_read_b64_tr_b16 a[72:73], v17 offset:16384
    ds_read_b64_tr_b16 a[74:75], v17 offset:17408
    ds_read_b64_tr_b16 a[76:77], v17 offset:24576
    ds_read_b64_tr_b16 a[78:79], v17 offset:25600
    s_waitcnt vmcnt(12) lgkmcnt(0)
    s_barrier
    s_add_u32 m0, s76, 16384
    s_mov_b32 s36, 1572864
    buffer_load_dwordx4 v12, s[20:23], s36 offen nt lds
    s_add_u32 m0, s76, 17408
    s_mov_b32 s36, 1589248
    buffer_load_dwordx4 v12, s[20:23], s36 offen nt lds
    s_add_u32 m0, s76, 18432
    s_mov_b32 s36, 1605632
    buffer_load_dwordx4 v13, s[20:23], s36 offen nt lds
    s_add_u32 m0, s76, 19456
    s_mov_b32 s36, 1622016
    buffer_load_dwordx4 v13, s[20:23], s36 offen nt lds
    ds_read_b64_tr_b16 a[80:81], v16 offset:32768
    ds_read_b64_tr_b16 a[82:83], v16 offset:33792
    ds_read_b64_tr_b16 a[84:85], v16 offset:40960
    ds_read_b64_tr_b16 a[86:87], v16 offset:41984
    ds_read_b64_tr_b16 a[88:89], v17 offset:32768
    ds_read_b64_tr_b16 a[90:91], v17 offset:33792
    ds_read_b64_tr_b16 a[92:93], v17 offset:40960
    ds_read_b64_tr_b16 a[94:95], v17 offset:41984
    s_waitcnt vmcnt(12) lgkmcnt(0)
    s_barrier
    s_add_u32 m0, s76, 32768
    s_mov_b32 s36, 2097152
    buffer_load_dwordx4 v12, s[20:23], s36 offen nt lds
    s_add_u32 m0, s76, 33792
    s_mov_b32 s36, 2113536
    buffer_load_dwordx4 v12, s[20:23], s36 offen nt lds
    s_add_u32 m0, s76, 34816
    s_mov_b32 s36, 2129920
    buffer_load_dwordx4 v13, s[20:23], s36 offen nt lds
    s_add_u32 m0, s76, 35840
    s_mov_b32 s36, 2146304
    buffer_load_dwordx4 v13, s[20:23], s36 offen nt lds
    v_mbcnt_lo_u32_b32 v81, -1, 0
    v_mbcnt_hi_u32_b32 v81, -1, v81
    v_lshlrev_b32 v81, 5, v81
wt_8:
    buffer_load_dword v80, v81, s[8:11], 0 offen sc1
    s_waitcnt vmcnt(0)
    v_readlane_b32 s36, v80, 0
    v_readlane_b32 s37, v80, 1
    s_nop 0
    s_add_u32 s36, s36, s37
    v_readlane_b32 s37, v80, 2
    s_nop 0
    s_add_u32 s36, s36, s37
    v_readlane_b32 s37, v80, 3
    s_nop 0
    s_add_u32 s36, s36, s37
    v_readlane_b32 s37, v80, 4
    s_nop 0
    s_add_u32 s36, s36, s37
    v_readlane_b32 s37, v80, 5
    s_nop 0
    s_add_u32 s36, s36, s37
    v_readlane_b32 s37, v80, 6
    s_nop 0
    s_add_u32 s36, s36, s37
    v_readlane_b32 s37, v80, 7
    s_nop 0
    s_add_u32 s36, s36, s37
    s_cmp_ge_u32 s36, 256
    s_cbranch_scc1 wtd_9
    s_sleep 2
    s_add_u32 s35, s35, 1
    s_cmp_lt_u32 s35, 524288
    s_cbranch_scc1 wt_8
wtd_9:
    v_readlane_b32 s57, v80, 0
    v_mov_b32 v81, 0
    v_mov_b32 v80, 1
    s_lshl_b32 s36, s33, 2
    s_add_u32 s36, s36, 11796480
    s_mov_b64 exec, 1
    buffer_store_dword v80, v81, s[4:7], s36 offen sc1
    s_mov_b64 exec, -1
    ds_read_b64_tr_b16 v[96:97], v18 offset:0
    ds_read_b64_tr_b16 v[98:99], v18 offset:1024
    ds_read_b64_tr_b16 v[100:101], v18 offset:8192
    ds_read_b64_tr_b16 v[102:103], v18 offset:9216
    ds_read_b64_tr_b16 v[104:105], v19 offset:0
    ds_read_b64_tr_b16 v[106:107], v19 offset:1024
    ds_read_b64_tr_b16 v[108:109], v19 offset:8192
    ds_read_b64_tr_b16 v[110:111], v19 offset:9216
    s_waitcnt vmcnt(12) lgkmcnt(0)
    s_barrier
    s_add_u32 m0, s76, 49152
    s_mov_b32 s36, 2621440
    buffer_load_dwordx4 v12, s[20:23], s36 offen nt lds
    s_add_u32 m0, s76, 50176
    s_mov_b32 s36, 2637824
    buffer_load_dwordx4 v12, s[20:23], s36 offen nt lds
    s_add_u32 m0, s76, 51200
    s_mov_b32 s36, 2654208
    buffer_load_dwordx4 v13, s[20:23], s36 offen nt lds
    s_add_u32 m0, s76, 52224
    s_mov_b32 s36, 2670592
    buffer_load_dwordx4 v13, s[20:23], s36 offen nt lds
    ds_read_b64_tr_b16 v[144:145], v18 offset:16384
    ds_read_b64_tr_b16 v[146:147], v18 offset:17408
    ds_read_b64_tr_b16 v[148:149], v18 offset:24576
    ds_read_b64_tr_b16 v[150:151], v18 offset:25600
    ds_read_b64_tr_b16 v[152:153], v19 offset:16384
    ds_read_b64_tr_b16 v[154:155], v19 offset:17408
    ds_read_b64_tr_b16 v[156:157], v19 offset:24576
    ds_read_b64_tr_b16 v[158:159], v19 offset:25600
    s_waitcnt vmcnt(12) lgkmcnt(0)
    s_barrier
    s_add_u32 m0, s76, 65536
    s_mov_b32 s36, 3145728
    buffer_load_dwordx4 v12, s[20:23], s36 offen nt lds
    s_add_u32 m0, s76, 66560
    s_mov_b32 s36, 3162112
    buffer_load_dwordx4 v12, s[20:23], s36 offen nt lds
    s_add_u32 m0, s76, 67584
    s_mov_b32 s36, 3178496
    buffer_load_dwordx4 v13, s[20:23], s36 offen nt lds
    s_add_u32 m0, s76, 68608
    s_mov_b32 s36, 3194880
    buffer_load_dwordx4 v13, s[20:23], s36 offen nt lds
    ds_read_b64_tr_b16 a[96:97], v16 offset:0
    ds_read_b64_tr_b16 a[98:99], v16 offset:1024
    ds_read_b64_tr_b16 a[100:101], v16 offset:8192
    ds_read_b64_tr_b16 a[102:103], v16 offset:9216
    ds_read_b64_tr_b16 a[104:105], v17 offset:0
    ds_read_b64_tr_b16 a[106:107], v17 offset:1024
    ds_read_b64_tr_b16 a[108:109], v17 offset:8192
    ds_read_b64_tr_b16 a[110:111], v17 offset:9216
    s_waitcnt vmcnt(12) lgkmcnt(0)
    s_barrier
    s_add_u32 m0, s76, 0
    s_mov_b32 s36, 3670016
    buffer_load_dwordx4 v12, s[20:23], s36 offen nt lds
    s_add_u32 m0, s76, 1024
    s_mov_b32 s36, 3686400
    buffer_load_dwordx4 v12, s[20:23], s36 offen nt lds
    s_add_u32 m0, s76, 2048
    s_mov_b32 s36, 3702784
    buffer_load_dwordx4 v13, s[20:23], s36 offen nt lds
    s_add_u32 m0, s76, 3072
    s_mov_b32 s36, 3719168
    buffer_load_dwordx4 v13, s[20:23], s36 offen nt lds
    ds_read_b64_tr_b16 a[112:113], v16 offset:16384
    ds_read_b64_tr_b16 a[114:115], v16 offset:17408
    ds_read_b64_tr_b16 a[116:117], v16 offset:24576
    ds_read_b64_tr_b16 a[118:119], v16 offset:25600
    ds_read_b64_tr_b16 a[120:121], v17 offset:16384
    ds_read_b64_tr_b16 a[122:123], v17 offset:17408
    ds_read_b64_tr_b16 a[124:125], v17 offset:24576
    ds_read_b64_tr_b16 a[126:127], v17 offset:25600
    s_waitcnt vmcnt(12) lgkmcnt(0)
    s_barrier
    s_add_u32 m0, s76, 16384
    s_add_u32 s36, s74, 0
    buffer_load_dwordx4 v14, s[24:27], s36 offen nt lds
    s_add_u32 m0, s76, 17408
    s_add_u32 s36, s74, 4096
    buffer_load_dwordx4 v14, s[24:27], s36 offen nt lds
    s_add_u32 m0, s76, 18432
    s_add_u32 s36, s74, 2048
    buffer_load_dwordx4 v15, s[24:27], s36 offen nt lds
    s_add_u32 m0, s76, 19456
    s_add_u32 s36, s74, 6144
    buffer_load_dwordx4 v15, s[24:27], s36 offen nt lds
    ds_read_b64_tr_b16 a[128:129], v16 offset:32768
    ds_read_b64_tr_b16 a[130:131], v16 offset:33792
    ds_read_b64_tr_b16 a[132:133], v16 offset:40960
    ds_read_b64_tr_b16 a[134:135], v16 offset:41984
    ds_read_b64_tr_b16 a[136:137], v17 offset:32768
    ds_read_b64_tr_b16 a[138:139], v17 offset:33792
    ds_read_b64_tr_b16 a[140:141], v17 offset:40960
    ds_read_b64_tr_b16 a[142:143], v17 offset:41984
    s_waitcnt vmcnt(12) lgkmcnt(0)
    s_barrier
    s_add_u32 m0, s76, 32768
    s_add_u32 s36, s74, 65536
    buffer_load_dwordx4 v14, s[24:27], s36 offen nt lds
    s_add_u32 m0, s76, 33792
    s_add_u32 s36, s74, 69632
    buffer_load_dwordx4 v14, s[24:27], s36 offen nt lds
    s_add_u32 m0, s76, 34816
    s_add_u32 s36, s74, 67584
    buffer_load_dwordx4 v15, s[24:27], s36 offen nt lds
    s_add_u32 m0, s76, 35840
    s_add_u32 s36, s74, 71680
    buffer_load_dwordx4 v15, s[24:27], s36 offen nt lds
    ds_read_b64_tr_b16 a[144:145], v18 offset:0
    ds_read_b64_tr_b16 a[146:147], v18 offset:1024
    ds_read_b64_tr_b16 a[148:149], v18 offset:8192
    ds_read_b64_tr_b16 a[150:151], v18 offset:9216
    ds_read_b64_tr_b16 a[152:153], v19 offset:0
    ds_read_b64_tr_b16 a[154:155], v19 offset:1024
    ds_read_b64_tr_b16 a[156:157], v19 offset:8192
    ds_read_b64_tr_b16 a[158:159], v19 offset:9216
    s_waitcnt vmcnt(12) lgkmcnt(0)
    s_barrier
    s_add_u32 m0, s76, 49152
    s_add_u32 s36, s75, 0
    buffer_load_dwordx4 v14, s[24:27], s36 offen nt lds
    s_add_u32 m0, s76, 50176
    s_add_u32 s36, s75, 4096
    buffer_load_dwordx4 v14, s[24:27], s36 offen nt lds
    s_add_u32 m0, s76, 51200
    s_add_u32 s36, s75, 2048
    buffer_load_dwordx4 v15, s[24:27], s36 offen nt lds
    s_add_u32 m0, s76, 52224
    s_add_u32 s36, s75, 6144
    buffer_load_dwordx4 v15, s[24:27], s36 offen nt lds
    ds_read_b64_tr_b16 a[160:161], v18 offset:16384
    ds_read_b64_tr_b16 a[162:163], v18 offset:17408
    ds_read_b64_tr_b16 a[164:165], v18 offset:24576
    ds_read_b64_tr_b16 a[166:167], v18 offset:25600
    ds_read_b64_tr_b16 a[168:169], v19 offset:16384
    ds_read_b64_tr_b16 a[170:171], v19 offset:17408
    ds_read_b64_tr_b16 a[172:173], v19 offset:24576
    ds_read_b64_tr_b16 a[174:175], v19 offset:25600
    s_waitcnt vmcnt(12) lgkmcnt(0)
    s_barrier
    s_add_u32 m0, s76, 65536
    s_add_u32 s36, s75, 65536
    buffer_load_dwordx4 v14, s[24:27], s36 offen nt lds
    s_add_u32 m0, s76, 66560
    s_add_u32 s36, s75, 69632
    buffer_load_dwordx4 v14, s[24:27], s36 offen nt lds
    s_add_u32 m0, s76, 67584
    s_add_u32 s36, s75, 67584
    buffer_load_dwordx4 v15, s[24:27], s36 offen nt lds
    s_add_u32 m0, s76, 68608
    s_add_u32 s36, s75, 71680
    buffer_load_dwordx4 v15, s[24:27], s36 offen nt lds
    ds_read_b64_tr_b16 a[176:177], v16 offset:0
    ds_read_b64_tr_b16 a[178:179], v16 offset:1024
    ds_read_b64_tr_b16 a[180:181], v16 offset:8192
    ds_read_b64_tr_b16 a[182:183], v16 offset:9216
    ds_read_b64_tr_b16 a[184:185], v17 offset:0
    ds_read_b64_tr_b16 a[186:187], v17 offset:1024
    ds_read_b64_tr_b16 a[188:189], v17 offset:8192
    ds_read_b64_tr_b16 a[190:191], v17 offset:9216
    s_waitcnt vmcnt(12) lgkmcnt(0)
    s_barrier
    s_add_u32 m0, s76, 0
    s_mov_b32 s36, 0
    buffer_load_dwordx4 v12, s[12:15], s36 offen nt lds
    s_add_u32 m0, s76, 1024
    s_mov_b32 s36, 16384
    buffer_load_dwordx4 v12, s[12:15], s36 offen nt lds
    s_add_u32 m0, s76, 2048
    s_mov_b32 s36, 32768
    buffer_load_dwordx4 v13, s[12:15], s36 offen nt lds
    s_add_u32 m0, s76, 3072
    s_mov_b32 s36, 49152
    buffer_load_dwordx4 v13, s[12:15], s36 offen nt lds
    ds_read_b64_tr_b16 v[64:65], v20 offset:16384
    ds_read_b64_tr_b16 v[66:67], v21 offset:16384
    ds_read_b64_tr_b16 v[68:69], v20 offset:20480
    ds_read_b64_tr_b16 v[70:71], v21 offset:20480
    ds_read_b64_tr_b16 v[72:73], v20 offset:24576
    ds_read_b64_tr_b16 v[74:75], v21 offset:24576
    ds_read_b64_tr_b16 v[76:77], v20 offset:28672
    ds_read_b64_tr_b16 v[78:79], v21 offset:28672
    s_waitcnt vmcnt(12) lgkmcnt(0)
    s_barrier
    s_add_u32 m0, s76, 16384
    s_mov_b32 s36, 524288
    buffer_load_dwordx4 v12, s[12:15], s36 offen nt lds
    s_add_u32 m0, s76, 17408
    s_mov_b32 s36, 540672
    buffer_load_dwordx4 v12, s[12:15], s36 offen nt lds
    s_add_u32 m0, s76, 18432
    s_mov_b32 s36, 557056
    buffer_load_dwordx4 v13, s[12:15], s36 offen nt lds
    s_add_u32 m0, s76, 19456
    s_mov_b32 s36, 573440
    buffer_load_dwordx4 v13, s[12:15], s36 offen nt lds
    ds_write_b128 v10, v[64:67] offset:0
    ds_write_b128 v10, v[68:71] offset:1024
    ds_write_b128 v10, v[72:75] offset:2048
    ds_write_b128 v10, v[76:79] offset:3072
    ds_read_b64_tr_b16 v[80:81], v20 offset:32768
    ds_read_b64_tr_b16 v[82:83], v21 offset:32768
    ds_read_b64_tr_b16 v[84:85], v20 offset:36864
    ds_read_b64_tr_b16 v[86:87], v21 offset:36864
    ds_read_b64_tr_b16 v[32:33], v20 offset:40960
    ds_read_b64_tr_b16 v[34:35], v21 offset:40960
    ds_read_b64_tr_b16 v[36:37], v20 offset:45056
    ds_read_b64_tr_b16 v[38:39], v21 offset:45056
    s_waitcnt vmcnt(12) lgkmcnt(0)
    s_barrier
    s_add_u32 m0, s76, 32768
    s_mov_b32 s36, 1048576
    buffer_load_dwordx4 v12, s[12:15], s36 offen nt lds
    s_add_u32 m0, s76, 33792
    s_mov_b32 s36, 1064960
    buffer_load_dwordx4 v12, s[12:15], s36 offen nt lds
    s_add_u32 m0, s76, 34816
    s_mov_b32 s36, 1081344
    buffer_load_dwordx4 v13, s[12:15], s36 offen nt lds
    s_add_u32 m0, s76, 35840
    s_mov_b32 s36, 1097728
    buffer_load_dwordx4 v13, s[12:15], s36 offen nt lds
    ds_write_b128 v10, v[80:83] offset:4096
    ds_write_b128 v10, v[84:87] offset:5120
    ds_write_b128 v10, v[32:35] offset:6144
    ds_write_b128 v10, v[36:39] offset:7168
    ds_read_b64_tr_b16 v[64:65], v22 offset:0
    ds_read_b64_tr_b16 v[66:67], v23 offset:0
    ds_read_b64_tr_b16 v[68:69], v22 offset:4096
    ds_read_b64_tr_b16 v[70:71], v23 offset:4096
    ds_read_b64_tr_b16 v[72:73], v22 offset:8192
    ds_read_b64_tr_b16 v[74:75], v23 offset:8192
    ds_read_b64_tr_b16 v[76:77], v22 offset:12288
    ds_read_b64_tr_b16 v[78:79], v23 offset:12288
    s_waitcnt vmcnt(12) lgkmcnt(0)
    s_barrier
    s_add_u32 m0, s76, 49152
    s_mov_b32 s36, 1572864
    buffer_load_dwordx4 v12, s[12:15], s36 offen nt lds
    s_add_u32 m0, s76, 50176
    s_mov_b32 s36, 1589248
    buffer_load_dwordx4 v12, s[12:15], s36 offen nt lds
    s_add_u32 m0, s76, 51200
    s_mov_b32 s36, 1605632
    buffer_load_dwordx4 v13, s[12:15], s36 offen nt lds
    s_add_u32 m0, s76, 52224
    s_mov_b32 s36, 1622016
    buffer_load_dwordx4 v13, s[12:15], s36 offen nt lds
    ds_write_b128 v10, v[64:67] offset:8192
    ds_write_b128 v10, v[68:71] offset:9216
    ds_write_b128 v10, v[72:75] offset:10240
    ds_write_b128 v10, v[76:79] offset:11264
    ds_read_b64_tr_b16 v[80:81], v22 offset:16384
    ds_read_b64_tr_b16 v[82:83], v23 offset:16384
    ds_read_b64_tr_b16 v[84:85], v22 offset:20480
    ds_read_b64_tr_b16 v[86:87], v23 offset:20480
    ds_read_b64_tr_b16 v[32:33], v22 offset:24576
    ds_read_b64_tr_b16 v[34:35], v23 offset:24576
    ds_read_b64_tr_b16 v[36:37], v22 offset:28672
    ds_read_b64_tr_b16 v[38:39], v23 offset:28672
    s_waitcnt vmcnt(12) lgkmcnt(0)
    s_barrier
    s_add_u32 m0, s76, 65536
    s_mov_b32 s36, 2097152
    buffer_load_dwordx4 v12, s[12:15], s36 offen nt lds
    s_add_u32 m0, s76, 66560
    s_mov_b32 s36, 2113536
    buffer_load_dwordx4 v12, s[12:15], s36 offen nt lds
    s_add_u32 m0, s76, 67584
    s_mov_b32 s36, 2129920
    buffer_load_dwordx4 v13, s[12:15], s36 offen nt lds
    s_add_u32 m0, s76, 68608
    s_mov_b32 s36, 2146304
    buffer_load_dwordx4 v13, s[12:15], s36 offen nt lds
    ds_write_b128 v10, v[80:83] offset:12288
    ds_write_b128 v10, v[84:87] offset:13312
    ds_write_b128 v10, v[32:35] offset:14336
    ds_write_b128 v10, v[36:39] offset:15360
    ds_read_b64_tr_b16 v[40:41], v16 offset:0
    ds_read_b64_tr_b16 v[42:43], v16 offset:1024
    ds_read_b64_tr_b16 v[44:45], v16 offset:8192
    ds_read_b64_tr_b16 v[46:47], v16 offset:9216
    ds_read_b64_tr_b16 v[48:49], v17 offset:0
    ds_read_b64_tr_b16 v[50:51], v17 offset:1024
    ds_read_b64_tr_b16 v[52:53], v17 offset:8192
    ds_read_b64_tr_b16 v[54:55], v17 offset:9216
    s_waitcnt vmcnt(12) lgkmcnt(0)
    s_barrier
    s_add_u32 m0, s76, 0
    s_mov_b32 s36, 2621440
    buffer_load_dwordx4 v12, s[12:15], s36 offen nt lds
    s_add_u32 m0, s76, 1024
    s_mov_b32 s36, 2637824
    buffer_load_dwordx4 v12, s[12:15], s36 offen nt lds
    s_add_u32 m0, s76, 2048
    s_mov_b32 s36, 2654208
    buffer_load_dwordx4 v13, s[12:15], s36 offen nt lds
    s_add_u32 m0, s76, 3072
    s_mov_b32 s36, 2670592
    buffer_load_dwordx4 v13, s[12:15], s36 offen nt lds
    ds_read_b64_tr_b16 v[112:113], v16 offset:16384
    ds_read_b64_tr_b16 v[114:115], v16 offset:17408
    ds_read_b64_tr_b16 v[116:117], v16 offset:24576
    ds_read_b64_tr_b16 v[118:119], v16 offset:25600
    ds_read_b64_tr_b16 v[120:121], v17 offset:16384
    ds_read_b64_tr_b16 v[122:123], v17 offset:17408
    ds_read_b64_tr_b16 v[124:125], v17 offset:24576
    ds_read_b64_tr_b16 v[126:127], v17 offset:25600
    s_waitcnt vmcnt(12) lgkmcnt(0)
    s_barrier
    s_add_u32 m0, s76, 16384
    s_mov_b32 s36, 3145728
    buffer_load_dwordx4 v12, s[12:15], s36 offen nt lds
    s_add_u32 m0, s76, 17408
    s_mov_b32 s36, 3162112
    buffer_load_dwordx4 v12, s[12:15], s36 offen nt lds
    s_add_u32 m0, s76, 18432
    s_mov_b32 s36, 3178496
    buffer_load_dwordx4 v13, s[12:15], s36 offen nt lds
    s_add_u32 m0, s76, 19456
    s_mov_b32 s36, 3194880
    buffer_load_dwordx4 v13, s[12:15], s36 offen nt lds
    ds_read_b64_tr_b16 v[160:161], v16 offset:32768
    ds_read_b64_tr_b16 v[162:163], v16 offset:33792
    ds_read_b64_tr_b16 v[164:165], v16 offset:40960
    ds_read_b64_tr_b16 v[166:167], v16 offset:41984
    ds_read_b64_tr_b16 v[168:169], v17 offset:32768
    ds_read_b64_tr_b16 v[170:171], v17 offset:33792
    ds_read_b64_tr_b16 v[172:173], v17 offset:40960
    ds_read_b64_tr_b16 v[174:175], v17 offset:41984
    s_waitcnt vmcnt(12) lgkmcnt(0)
    s_barrier
    s_add_u32 m0, s76, 32768
    s_mov_b32 s36, 3670016
    buffer_load_dwordx4 v12, s[12:15], s36 offen nt lds
    s_add_u32 m0, s76, 33792
    s_mov_b32 s36, 3686400
    buffer_load_dwordx4 v12, s[12:15], s36 offen nt lds
    s_add_u32 m0, s76, 34816
    s_mov_b32 s36, 3702784
    buffer_load_dwordx4 v13, s[12:15], s36 offen nt lds
    s_add_u32 m0, s76, 35840
    s_mov_b32 s36, 3719168
    buffer_load_dwordx4 v13, s[12:15], s36 offen nt lds
    s_lshl_b32 s38, s32, 11
    s_add_u32 s37, s38, s48
    s_add_u32 s39, s37, 524288
    buffer_load_dwordx4 v[80:83], v1, s[4:7], s37 offen offset:0 sc1
    buffer_load_dwordx4 v[80:83], v1, s[4:7], s37 offen offset:1024 sc1
    buffer_load_dwordx4 v[80:83], v1, s[4:7], s39 offen offset:0 sc1
    buffer_load_dwordx4 v[80:83], v1, s[4:7], s39 offen offset:1024 sc1
    s_lshl_b32 s37, s33, 2
    s_add_u32 s37, s37, s32
    s_lshl_b32 s37, s37, 10
    s_add_u32 s37, s37, 11534336
    buffer_load_dwordx4 v[80:83], v1, s[4:7], s37 offen sc1
    ds_read_b64_tr_b16 v[176:177], v18 offset:0
    ds_read_b64_tr_b16 v[178:179], v18 offset:1024
    ds_read_b64_tr_b16 v[180:181], v18 offset:8192
    ds_read_b64_tr_b16 v[182:183], v18 offset:9216
    ds_read_b64_tr_b16 v[184:185], v19 offset:0
    ds_read_b64_tr_b16 v[186:187], v19 offset:1024
    ds_read_b64_tr_b16 v[188:189], v19 offset:8192
    ds_read_b64_tr_b16 v[190:191], v19 offset:9216
    s_waitcnt vmcnt(12) lgkmcnt(0)
    s_barrier
    s_add_u32 m0, s76, 49152
    s_add_u32 s36, s72, 0
    buffer_load_dwordx4 v14, s[24:27], s36 offen nt lds
    s_add_u32 m0, s76, 50176
    s_add_u32 s36, s72, 4096
    buffer_load_dwordx4 v14, s[24:27], s36 offen nt lds
    s_add_u32 m0, s76, 51200
    s_add_u32 s36, s72, 2048
    buffer_load_dwordx4 v15, s[24:27], s36 offen nt lds
    s_add_u32 m0, s76, 52224
    s_add_u32 s36, s72, 6144
    buffer_load_dwordx4 v15, s[24:27], s36 offen nt lds
    ds_read_b64_tr_b16 v[192:193], v18 offset:16384
    ds_read_b64_tr_b16 v[194:195], v18 offset:17408
    ds_read_b64_tr_b16 v[196:197], v18 offset:24576
    ds_read_b64_tr_b16 v[198:199], v18 offset:25600
    ds_read_b64_tr_b16 v[200:201], v19 offset:16384
    ds_read_b64_tr_b16 v[202:203], v19 offset:17408
    ds_read_b64_tr_b16 v[204:205], v19 offset:24576
    ds_read_b64_tr_b16 v[206:207], v19 offset:25600
    s_waitcnt vmcnt(12) lgkmcnt(0)
    s_barrier
    s_add_u32 m0, s76, 65536
    s_add_u32 s36, s72, 65536
    buffer_load_dwordx4 v14, s[24:27], s36 offen nt lds
    s_add_u32 m0, s76, 66560
    s_add_u32 s36, s72, 69632
    buffer_load_dwordx4 v14, s[24:27], s36 offen nt lds
    s_add_u32 m0, s76, 67584
    s_add_u32 s36, s72, 67584
    buffer_load_dwordx4 v15, s[24:27], s36 offen nt lds
    s_add_u32 m0, s76, 68608
    s_add_u32 s36, s72, 71680
    buffer_load_dwordx4 v15, s[24:27], s36 offen nt lds
    ds_read_b64_tr_b16 v[208:209], v16 offset:0
    ds_read_b64_tr_b16 v[210:211], v16 offset:1024
    ds_read_b64_tr_b16 v[212:213], v16 offset:8192
    ds_read_b64_tr_b16 v[214:215], v16 offset:9216
    ds_read_b64_tr_b16 v[216:217], v17 offset:0
    ds_read_b64_tr_b16 v[218:219], v17 offset:1024
    ds_read_b64_tr_b16 v[220:221], v17 offset:8192
    ds_read_b64_tr_b16 v[222:223], v17 offset:9216
    s_waitcnt vmcnt(12) lgkmcnt(0)
    s_barrier
    s_add_u32 m0, s76, 0
    s_add_u32 s36, s73, 0
    buffer_load_dwordx4 v14, s[24:27], s36 offen nt lds
    s_add_u32 m0, s76, 1024
    s_add_u32 s36, s73, 4096
    buffer_load_dwordx4 v14, s[24:27], s36 offen nt lds
    s_add_u32 m0, s76, 2048
    s_add_u32 s36, s73, 2048
    buffer_load_dwordx4 v15, s[24:27], s36 offen nt lds
    s_add_u32 m0, s76, 3072
    s_add_u32 s36, s73, 6144
    buffer_load_dwordx4 v15, s[24:27], s36 offen nt lds
    ds_read_b64_tr_b16 v[224:225], v16 offset:16384
    ds_read_b64_tr_b16 v[226:227], v16 offset:17408
    ds_read_b64_tr_b16 v[228:229], v16 offset:24576
    ds_read_b64_tr_b16 v[230:231], v16 offset:25600
    ds_read_b64_tr_b16 v[232:233], v17 offset:16384
    ds_read_b64_tr_b16 v[234:235], v17 offset:17408
    ds_read_b64_tr_b16 v[236:237], v17 offset:24576
    ds_read_b64_tr_b16 v[238:239], v17 offset:25600
    s_waitcnt vmcnt(12) lgkmcnt(0)
    s_barrier
    s_add_u32 m0, s76, 16384
    s_add_u32 s36, s73, 65536
    buffer_load_dwordx4 v14, s[24:27], s36 offen nt lds
    s_add_u32 m0, s76, 17408
    s_add_u32 s36, s73, 69632
    buffer_load_dwordx4 v14, s[24:27], s36 offen nt lds
    s_add_u32 m0, s76, 18432
    s_add_u32 s36, s73, 67584
    buffer_load_dwordx4 v15, s[24:27], s36 offen nt lds
    s_add_u32 m0, s76, 19456
    s_add_u32 s36, s73, 71680
    buffer_load_dwordx4 v15, s[24:27], s36 offen nt lds
    ds_read_b64_tr_b16 v[240:241], v16 offset:32768
    ds_read_b64_tr_b16 v[242:243], v16 offset:33792
    ds_read_b64_tr_b16 v[244:245], v16 offset:40960
    ds_read_b64_tr_b16 v[246:247], v16 offset:41984
    ds_read_b64_tr_b16 v[248:249], v17 offset:32768
    ds_read_b64_tr_b16 v[250:251], v17 offset:33792
    ds_read_b64_tr_b16 v[252:253], v17 offset:40960
    ds_read_b64_tr_b16 v[254:255], v17 offset:41984
    s_waitcnt vmcnt(12) lgkmcnt(0)
    s_barrier
    ds_read_b64_tr_b16 a[192:193], v22 offset:0
    ds_read_b64_tr_b16 a[194:195], v23 offset:0
    ds_read_b64_tr_b16 a[196:197], v22 offset:4096
    ds_read_b64_tr_b16 a[198:199], v23 offset:4096
    ds_read_b64_tr_b16 a[200:201], v22 offset:8192
    ds_read_b64_tr_b16 a[202:203], v23 offset:8192
    ds_read_b64_tr_b16 a[204:205], v22 offset:12288
    ds_read_b64_tr_b16 a[206:207], v23 offset:12288
    s_waitcnt vmcnt(8) lgkmcnt(0)
    s_barrier
    s_mov_b32 m0, s58
    s_nop 0
    buffer_load_dwordx4 v1, s[4:7], s50 offen sc1 lds
    buffer_load_dwordx4 v1, s[4:7], s50 offen offset:1024 sc1 lds
    ds_read_b64_tr_b16 a[208:209], v22 offset:16384
    ds_read_b64_tr_b16 a[210:211], v23 offset:16384
    ds_read_b64_tr_b16 a[212:213], v22 offset:20480
    ds_read_b64_tr_b16 a[214:215], v23 offset:20480
    ds_read_b64_tr_b16 a[216:217], v22 offset:24576
    ds_read_b64_tr_b16 a[218:219], v23 offset:24576
    ds_read_b64_tr_b16 a[220:221], v22 offset:28672
    ds_read_b64_tr_b16 a[222:223], v23 offset:28672
    s_waitcnt vmcnt(6) lgkmcnt(0)
    s_barrier
    s_mov_b32 m0, s59
    s_add_u32 s36, s50, 8192
    buffer_load_dwordx4 v1, s[4:7], s36 offen sc1 lds
    buffer_load_dwordx4 v1, s[4:7], s36 offen offset:1024 sc1 lds
    ds_read_b64_tr_b16 a[224:225], v20 offset:0
    ds_read_b64_tr_b16 a[226:227], v21 offset:0
    ds_read_b64_tr_b16 a[228:229], v20 offset:4096
    ds_read_b64_tr_b16 a[230:231], v21 offset:4096
    ds_read_b64_tr_b16 a[232:233], v20 offset:8192
    ds_read_b64_tr_b16 a[234:235], v21 offset:8192
    ds_read_b64_tr_b16 a[236:237], v20 offset:12288
    ds_read_b64_tr_b16 a[238:239], v21 offset:12288
    s_waitcnt vmcnt(4) lgkmcnt(0)
    s_barrier
    v_add_u32 v0, 65536, v10
    ds_write_b128 v0, v[40:43] offset:0
    ds_write_b128 v0, v[44:47] offset:1024
    ds_write_b128 v0, v[48:51] offset:2048
    ds_write_b128 v0, v[52:55] offset:3072
    ds_write_b128 v0, v[56:59] offset:4096
    ds_write_b128 v0, v[60:63] offset:5120
    ds_write_b128 v0, v[88:91] offset:6144
    ds_write_b128 v0, v[92:95] offset:7168
    ds_write_b128 v0, v[96:99] offset:8192
    ds_write_b128 v0, v[100:103] offset:9216
    ds_write_b128 v0, v[104:107] offset:10240
    ds_write_b128 v0, v[108:111] offset:11264
    ds_write_b128 v0, v[112:115] offset:12288
    ds_write_b128 v0, v[116:119] offset:13312
    ds_write_b128 v0, v[120:123] offset:14336
    ds_write_b128 v0, v[124:127] offset:15360
    ds_read_b64_tr_b16 a[240:241], v20 offset:16384
    ds_read_b64_tr_b16 a[242:243], v21 offset:16384
    ds_read_b64_tr_b16 a[244:245], v20 offset:20480
    ds_read_b64_tr_b16 a[246:247], v21 offset:20480
    ds_read_b64_tr_b16 a[248:249], v20 offset:24576
    ds_read_b64_tr_b16 a[250:251], v21 offset:24576
    ds_read_b64_tr_b16 a[252:253], v20 offset:28672
    ds_read_b64_tr_b16 a[254:255], v21 offset:28672
    s_waitcnt lgkmcnt(0)
    s_branch cw_done_3
cw1_5:
    s_waitcnt vmcnt(12) lgkmcnt(0)
    s_barrier
    s_add_u32 m0, s76, 65536
    s_mov_b32 s36, 2097152
    buffer_load_dwordx4 v12, s[16:19], s36 offen nt lds
    s_add_u32 m0, s76, 66560
    s_mov_b32 s36, 2113536
    buffer_load_dwordx4 v12, s[16:19], s36 offen nt lds
    s_add_u32 m0, s76, 67584
    s_mov_b32 s36, 2129920
    buffer_load_dwordx4 v13, s[16:19], s36 offen nt lds
    s_add_u32 m0, s76, 68608
    s_mov_b32 s36, 2146304
    buffer_load_dwordx4 v13, s[16:19], s36 offen nt lds
    ds_read_b64_tr_b16 a[0:1], v16 offset:0
    ds_read_b64_tr_b16 a[2:3], v16 offset:1024
    ds_read_b64_tr_b16 a[4:5], v16 offset:8192
    ds_read_b64_tr_b16 a[6:7], v16 offset:9216
    ds_read_b64_tr_b16 a[8:9], v17 offset:0
    ds_read_b64_tr_b16 a[10:11], v17 offset:1024
    ds_read_b64_tr_b16 a[12:13], v17 offset:8192
    ds_read_b64_tr_b16 a[14:15], v17 offset:9216
    s_waitcnt vmcnt(12) lgkmcnt(0)
    s_barrier
    s_add_u32 m0, s76, 0
    s_mov_b32 s36, 2621440
    buffer_load_dwordx4 v12, s[16:19], s36 offen nt lds
    s_add_u32 m0, s76, 1024
    s_mov_b32 s36, 2637824
    buffer_load_dwordx4 v12, s[16:19], s36 offen nt lds
    s_add_u32 m0, s76, 2048
    s_mov_b32 s36, 2654208
    buffer_load_dwordx4 v13, s[16:19], s36 offen nt lds
    s_add_u32 m0, s76, 3072
    s_mov_b32 s36, 2670592
    buffer_load_dwordx4 v13, s[16:19], s36 offen nt lds
    ds_read_b64_tr_b16 a[16:17], v16 offset:16384
    ds_read_b64_tr_b16 a[18:19], v16 offset:17408
    ds_read_b64_tr_b16 a[20:21], v16 offset:24576
    ds_read_b64_tr_b16 a[22:23], v16 offset:25600
    ds_read_b64_tr_b16 a[24:25], v17 offset:16384
    ds_read_b64_tr_b16 a[26:27], v17 offset:17408
    ds_read_b64_tr_b16 a[28:29], v17 offset:24576
    ds_read_b64_tr_b16 a[30:31], v17 offset:25600
    s_waitcnt vmcnt(12) lgkmcnt(0)
    s_barrier
    s_add_u32 m0, s76, 16384
    s_mov_b32 s36, 3145728
    buffer_load_dwordx4 v12, s[16:19], s36 offen nt lds
    s_add_u32 m0, s76, 17408
    s_mov_b32 s36, 3162112
    buffer_load_dwordx4 v12, s[16:19], s36 offen nt lds
    s_add_u32 m0, s76, 18432
    s_mov_b32 s36, 3178496
    buffer_load_dwordx4 v13, s[16:19], s36 offen nt lds
    s_add_u32 m0, s76, 19456
    s_mov_b32 s36, 3194880
    buffer_load_dwordx4 v13, s[16:19], s36 offen nt lds
    ds_read_b64_tr_b16 v[56:57], v16 offset:32768
    ds_read_b64_tr_b16 v[58:59], v16 offset:33792
    ds_read_b64_tr_b16 v[60:61], v16 offset:40960
    ds_read_b64_tr_b16 v[62:63], v16 offset:41984
    ds_read_b64_tr_b16 v[88:89], v17 offset:32768
    ds_read_b64_tr_b16 v[90:91], v17 offset:33792
    ds_read_b64_tr_b16 v[92:93], v17 offset:40960
    ds_read_b64_tr_b16 v[94:95], v17 offset:41984
    s_waitcnt vmcnt(12) lgkmcnt(0)
    s_barrier
    s_add_u32 m0, s76, 32768
    s_mov_b32 s36, 3670016
    buffer_load_dwordx4 v12, s[16:19], s36 offen nt lds
    s_add_u32 m0, s76, 33792
    s_mov_b32 s36, 3686400
    buffer_load_dwordx4 v12, s[16:19], s36 offen nt lds
    s_add_u32 m0, s76, 34816
    s_mov_b32 s36, 3702784
    buffer_load_dwordx4 v13, s[16:19], s36 offen nt lds
    s_add_u32 m0, s76, 35840
    s_mov_b32 s36, 3719168
    buffer_load_dwordx4 v13, s[16:19], s36 offen nt lds
    ds_read_b64_tr_b16 v[128:129], v18 offset:0
    ds_read_b64_tr_b16 v[130:131], v18 offset:1024
    ds_read_b64_tr_b16 v[132:133], v18 offset:8192
    ds_read_b64_tr_b16 v[134:135], v18 offset:9216
    ds_read_b64_tr_b16 v[136:137], v19 offset:0
    ds_read_b64_tr_b16 v[138:139], v19 offset:1024
    ds_read_b64_tr_b16 v[140:141], v19 offset:8192
    ds_read_b64_tr_b16 v[142:143], v19 offset:9216
    s_waitcnt vmcnt(12) lgkmcnt(0)
    s_barrier
    s_add_u32 m0, s76, 49152
    s_mov_b32 s36, 0
    buffer_load_dwordx4 v12, s[20:23], s36 offen nt lds
    s_add_u32 m0, s76, 50176
    s_mov_b32 s36, 16384
    buffer_load_dwordx4 v12, s[20:23], s36 offen nt lds
    s_add_u32 m0, s76, 51200
    s_mov_b32 s36, 32768
    buffer_load_dwordx4 v13, s[20:23], s36 offen nt lds
    s_add_u32 m0, s76, 52224
    s_mov_b32 s36, 49152
    buffer_load_dwordx4 v13, s[20:23], s36 offen nt lds
    ds_read_b64_tr_b16 a[64:65], v18 offset:16384
    ds_read_b64_tr_b16 a[66:67], v18 offset:17408
    ds_read_b64_tr_b16 a[68:69], v18 offset:24576
    ds_read_b64_tr_b16 a[70:71], v18 offset:25600
    ds_read_b64_tr_b16 a[72:73], v19 offset:16384
    ds_read_b64_tr_b16 a[74:75], v19 offset:17408
    ds_read_b64_tr_b16 a[76:77], v19 offset:24576
    ds_read_b64_tr_b16 a[78:79], v19 offset:25600
    s_waitcnt vmcnt(12) lgkmcnt(0)
    s_barrier
    s_add_u32 m0, s76, 65536
    s_mov_b32 s36, 524288
    buffer_load_dwordx4 v12, s[20:23], s36 offen nt lds
    s_add_u32 m0, s76, 66560
    s_mov_b32 s36, 540672
    buffer_load_dwordx4 v12, s[20:23], s36 offen nt lds
    s_add_u32 m0, s76, 67584
    s_mov_b32 s36, 557056
    buffer_load_dwordx4 v13, s[20:23], s36 offen nt lds
    s_add_u32 m0, s76, 68608
    s_mov_b32 s36, 573440
    buffer_load_dwordx4 v13, s[20:23], s36 offen nt lds
    ds_read_b64_tr_b16 a[80:81], v16 offset:0
    ds_read_b64_tr_b16 a[82:83], v16 offset:1024
    ds_read_b64_tr_b16 a[84:85], v16 offset:8192
    ds_read_b64_tr_b16 a[86:87], v16 offset:9216
    ds_read_b64_tr_b16 a[88:89], v17 offset:0
    ds_read_b64_tr_b16 a[90:91], v17 offset:1024
    ds_read_b64_tr_b16 a[92:93], v17 offset:8192
    ds_read_b64_tr_b16 a[94:95], v17 offset:9216
    s_waitcnt vmcnt(12) lgkmcnt(0)
    s_barrier
    s_add_u32 m0, s76, 0
    s_mov_b32 s36, 1048576
    buffer_load_dwordx4 v12, s[20:23], s36 offen nt lds
    s_add_u32 m0, s76, 1024
    s_mov_b32 s36, 1064960
    buffer_load_dwordx4 v12, s[20:23], s36 offen nt lds
    s_add_u32 m0, s76, 2048
    s_mov_b32 s36, 1081344
    buffer_load_dwordx4 v13, s[20:23], s36 offen nt lds
    s_add_u32 m0, s76, 3072
    s_mov_b32 s36, 1097728
    buffer_load_dwordx4 v13, s[20:23], s36 offen nt lds
    ds_read_b64_tr_b16 a[32:33], v16 offset:16384
    ds_read_b64_tr_b16 a[34:35], v16 offset:17408
    ds_read_b64_tr_b16 a[36:37], v16 offset:24576
    ds_read_b64_tr_b16 a[38:39], v16 offset:25600
    ds_read_b64_tr_b16 a[40:41], v17 offset:16384
    ds_read_b64_tr_b16 a[42:43], v17 offset:17408
    ds_read_b64_tr_b16 a[44:45], v17 offset:24576
    ds_read_b64_tr_b16 a[46:47], v17 offset:25600
    s_waitcnt vmcnt(12) lgkmcnt(0)
    s_barrier
    s_add_u32 m0, s76, 16384
    s_mov_b32 s36, 1572864
    buffer_load_dwordx4 v12, s[20:23], s36 offen nt lds
    s_add_u32 m0, s76, 17408
    s_mov_b32 s36, 1589248
    buffer_load_dwordx4 v12, s[20:23], s36 offen nt lds
    s_add_u32 m0, s76, 18432
    s_mov_b32 s36, 1605632
    buffer_load_dwordx4 v13, s[20:23], s36 offen nt lds
    s_add_u32 m0, s76, 19456
    s_mov_b32 s36, 1622016
    buffer_load_dwordx4 v13, s[20:23], s36 offen nt lds
    ds_read_b64_tr_b16 a[48:49], v16 offset:32768
    ds_read_b64_tr_b16 a[50:51], v16 offset:33792
    ds_read_b64_tr_b16 a[52:53], v16 offset:40960
    ds_read_b64_tr_b16 a[54:55], v16 offset:41984
    ds_read_b64_tr_b16 a[56:57], v17 offset:32768
    ds_read_b64_tr_b16 a[58:59], v17 offset:33792
    ds_read_b64_tr_b16 a[60:61], v17 offset:40960
    ds_read_b64_tr_b16 a[62:63], v17 offset:41984
    s_waitcnt vmcnt(12) lgkmcnt(0)
    s_barrier
    s_add_u32 m0, s76, 32768
    s_mov_b32 s36, 2097152
    buffer_load_dwordx4 v12, s[20:23], s36 offen nt lds
    s_add_u32 m0, s76, 33792
    s_mov_b32 s36, 2113536
    buffer_load_dwordx4 v12, s[20:23], s36 offen nt lds
    s_add_u32 m0, s76, 34816
    s_mov_b32 s36, 2129920
    buffer_load_dwordx4 v13, s[20:23], s36 offen nt lds
    s_add_u32 m0, s76, 35840
    s_mov_b32 s36, 2146304
    buffer_load_dwordx4 v13, s[20:23], s36 offen nt lds
    ds_read_b64_tr_b16 a[96:97], v18 offset:0
    ds_read_b64_tr_b16 a[98:99], v18 offset:1024
    ds_read_b64_tr_b16 a[100:101], v18 offset:8192
    ds_read_b64_tr_b16 a[102:103], v18 offset:9216
    ds_read_b64_tr_b16 a[104:105], v19 offset:0
    ds_read_b64_tr_b16 a[106:107], v19 offset:1024
    ds_read_b64_tr_b16 a[108:109], v19 offset:8192
    ds_read_b64_tr_b16 a[110:111], v19 offset:9216
    s_waitcnt vmcnt(12) lgkmcnt(0)
    s_barrier
    s_add_u32 m0, s76, 49152
    s_mov_b32 s36, 2621440
    buffer_load_dwordx4 v12, s[20:23], s36 offen nt lds
    s_add_u32 m0, s76, 50176
    s_mov_b32 s36, 2637824
    buffer_load_dwordx4 v12, s[20:23], s36 offen nt lds
    s_add_u32 m0, s76, 51200
    s_mov_b32 s36, 2654208
    buffer_load_dwordx4 v13, s[20:23], s36 offen nt lds
    s_add_u32 m0, s76, 52224
    s_mov_b32 s36, 2670592
    buffer_load_dwordx4 v13, s[20:23], s36 offen nt lds
    v_mbcnt_lo_u32_b32 v81, -1, 0
    v_mbcnt_hi_u32_b32 v81, -1, v81
    v_lshlrev_b32 v81, 5, v81
wt_10:
    buffer_load_dword v80, v81, s[8:11], 0 offen sc1
    s_waitcnt vmcnt(0)
    v_readlane_b32 s36, v80, 0
    v_readlane_b32 s37, v80, 1
    s_nop 0
    s_add_u32 s36, s36, s37
    v_readlane_b32 s37, v80, 2
    s_nop 0
    s_add_u32 s36, s36, s37
    v_readlane_b32 s37, v80, 3
    s_nop 0
    s_add_u32 s36, s36, s37
    v_readlane_b32 s37, v80, 4
    s_nop 0
    s_add_u32 s36, s36, s37
    v_readlane_b32 s37, v80, 5
    s_nop 0
    s_add_u32 s36, s36, s37
    v_readlane_b32 s37, v80, 6
    s_nop 0
    s_add_u32 s36, s36, s37
    v_readlane_b32 s37, v80, 7
    s_nop 0
    s_add_u32 s36, s36, s37
    s_cmp_ge_u32 s36, 256
    s_cbranch_scc1 wtd_11
    s_sleep 2
    s_add_u32 s35, s35, 1
    s_cmp_lt_u32 s35, 524288
    s_cbranch_scc1 wt_10
wtd_11:
    v_readlane_b32 s57, v80, 0
    ds_read_b64_tr_b16 a[112:113], v18 offset:16384
    ds_read_b64_tr_b16 a[114:115], v18 offset:17408
    ds_read_b64_tr_b16 a[116:117], v18 offset:24576
    ds_read_b64_tr_b16 a[118:119], v18 offset:25600
    ds_read_b64_tr_b16 a[120:121], v19 offset:16384
    ds_read_b64_tr_b16 a[122:123], v19 offset:17408
    ds_read_b64_tr_b16 a[124:125], v19 offset:24576
    ds_read_b64_tr_b16 a[126:127], v19 offset:25600
    s_waitcnt vmcnt(12) lgkmcnt(0)
    s_barrier
    s_add_u32 m0, s76, 65536
    s_mov_b32 s36, 3145728
    buffer_load_dwordx4 v12, s[20:23], s36 offen nt lds
    s_add_u32 m0, s76, 66560
    s_mov_b32 s36, 3162112
    buffer_load_dwordx4 v12, s[20:23], s36 offen nt lds
    s_add_u32 m0, s76, 67584
    s_mov_b32 s36, 3178496
    buffer_load_dwordx4 v13, s[20:23], s36 offen nt lds
    s_add_u32 m0, s76, 68608
    s_mov_b32 s36, 3194880
    buffer_load_dwordx4 v13, s[20:23], s36 offen nt lds
    ds_read_b64_tr_b16 v[96:97], v16 offset:0
    ds_read_b64_tr_b16 v[98:99], v16 offset:1024
    ds_read_b64_tr_b16 v[100:101], v16 offset:8192
    ds_read_b64_tr_b16 v[102:103], v16 offset:9216
    ds_read_b64_tr_b16 v[104:105], v17 offset:0
    ds_read_b64_tr_b16 v[106:107], v17 offset:1024
    ds_read_b64_tr_b16 v[108:109], v17 offset:8192
    ds_read_b64_tr_b16 v[110:111], v17 offset:9216
    s_waitcnt vmcnt(12) lgkmcnt(0)
    s_barrier
    s_add_u32 m0, s76, 0
    s_mov_b32 s36, 3670016
    buffer_load_dwordx4 v12, s[20:23], s36 offen nt lds
    s_add_u32 m0, s76, 1024
    s_mov_b32 s36, 3686400
    buffer_load_dwordx4 v12, s[20:23], s36 offen nt lds
    s_add_u32 m0, s76, 2048
    s_mov_b32 s36, 3702784
    buffer_load_dwordx4 v13, s[20:23], s36 offen nt lds
    s_add_u32 m0, s76, 3072
    s_mov_b32 s36, 3719168
    buffer_load_dwordx4 v13, s[20:23], s36 offen nt lds
    ds_read_b64_tr_b16 v[144:145], v16 offset:16384
    ds_read_b64_tr_b16 v[146:147], v16 offset:17408
    ds_read_b64_tr_b16 v[148:149], v16 offset:24576
    ds_read_b64_tr_b16 v[150:151], v16 offset:25600
    ds_read_b64_tr_b16 v[152:153], v17 offset:16384
    ds_read_b64_tr_b16 v[154:155], v17 offset:17408
    ds_read_b64_tr_b16 v[156:157], v17 offset:24576
    ds_read_b64_tr_b16 v[158:159], v17 offset:25600
    s_waitcnt vmcnt(12) lgkmcnt(0)
    s_barrier
    s_add_u32 m0, s76, 16384
    s_add_u32 s36, s74, 0
    buffer_load_dwordx4 v14, s[24:27], s36 offen nt lds
    s_add_u32 m0, s76, 17408
    s_add_u32 s36, s74, 4096
    buffer_load_dwordx4 v14, s[24:27], s36 offen nt lds
    s_add_u32 m0, s76, 18432
    s_add_u32 s36, s74, 2048
    buffer_load_dwordx4 v15, s[24:27], s36 offen nt lds
    s_add_u32 m0, s76, 19456
    s_add_u32 s36, s74, 6144
    buffer_load_dwordx4 v15, s[24:27], s36 offen nt lds
    ds_read_b64_tr_b16 a[160:161], v16 offset:32768
    ds_read_b64_tr_b16 a[162:163], v16 offset:33792
    ds_read_b64_tr_b16 a[164:165], v16 offset:40960
    ds_read_b64_tr_b16 a[166:167], v16 offset:41984
    ds_read_b64_tr_b16 a[168:169], v17 offset:32768
    ds_read_b64_tr_b16 a[170:171], v17 offset:33792
    ds_read_b64_tr_b16 a[172:173], v17 offset:40960
    ds_read_b64_tr_b16 a[174:175], v17 offset:41984
    s_waitcnt vmcnt(12) lgkmcnt(0)
    s_barrier
    s_add_u32 m0, s76, 32768
    s_add_u32 s36, s74, 65536
    buffer_load_dwordx4 v14, s[24:27], s36 offen nt lds
    s_add_u32 m0, s76, 33792
    s_add_u32 s36, s74, 69632
    buffer_load_dwordx4 v14, s[24:27], s36 offen nt lds
    s_add_u32 m0, s76, 34816
    s_add_u32 s36, s74, 67584
    buffer_load_dwordx4 v15, s[24:27], s36 offen nt lds
    s_add_u32 m0, s76, 35840
    s_add_u32 s36, s74, 71680
    buffer_load_dwordx4 v15, s[24:27], s36 offen nt lds
    ds_read_b64_tr_b16 a[176:177], v18 offset:0
    ds_read_b64_tr_b16 a[178:179], v18 offset:1024
    ds_read_b64_tr_b16 a[180:181], v18 offset:8192
    ds_read_b64_tr_b16 a[182:183], v18 offset:9216
    ds_read_b64_tr_b16 a[184:185], v19 offset:0
    ds_read_b64_tr_b16 a[186:187], v19 offset:1024
    ds_read_b64_tr_b16 a[188:189], v19 offset:8192
    ds_read_b64_tr_b16 a[190:191], v19 offset:9216
    s_waitcnt vmcnt(12) lgkmcnt(0)
    s_barrier
    s_add_u32 m0, s76, 49152
    s_add_u32 s36, s75, 0
    buffer_load_dwordx4 v14, s[24:27], s36 offen nt lds
    s_add_u32 m0, s76, 50176
    s_add_u32 s36, s75, 4096
    buffer_load_dwordx4 v14, s[24:27], s36 offen nt lds
    s_add_u32 m0, s76, 51200
    s_add_u32 s36, s75, 2048
    buffer_load_dwordx4 v15, s[24:27], s36 offen nt lds
    s_add_u32 m0, s76, 52224
    s_add_u32 s36, s75, 6144
    buffer_load_dwordx4 v15, s[24:27], s36 offen nt lds
    ds_read_b64_tr_b16 a[128:129], v18 offset:16384
    ds_read_b64_tr_b16 a[130:131], v18 offset:17408
    ds_read_b64_tr_b16 a[132:133], v18 offset:24576
    ds_read_b64_tr_b16 a[134:135], v18 offset:25600
    ds_read_b64_tr_b16 a[136:137], v19 offset:16384
    ds_read_b64_tr_b16 a[138:139], v19 offset:17408
    ds_read_b64_tr_b16 a[140:141], v19 offset:24576
    ds_read_b64_tr_b16 a[142:143], v19 offset:25600
    s_waitcnt vmcnt(12) lgkmcnt(0)
    s_barrier
    s_add_u32 m0, s76, 65536
    s_add_u32 s36, s75, 65536
    buffer_load_dwordx4 v14, s[24:27], s36 offen nt lds
    s_add_u32 m0, s76, 66560
    s_add_u32 s36, s75, 69632
    buffer_load_dwordx4 v14, s[24:27], s36 offen nt lds
    s_add_u32 m0, s76, 67584
    s_add_u32 s36, s75, 67584
    buffer_load_dwordx4 v15, s[24:27], s36 offen nt lds
    s_add_u32 m0, s76, 68608
    s_add_u32 s36, s75, 71680
    buffer_load_dwordx4 v15, s[24:27], s36 offen nt lds
    ds_read_b64_tr_b16 a[144:145], v16 offset:0
    ds_read_b64_tr_b16 a[146:147], v16 offset:1024
    ds_read_b64_tr_b16 a[148:149], v16 offset:8192
    ds_read_b64_tr_b16 a[150:151], v16 offset:9216
    ds_read_b64_tr_b16 a[152:153], v17 offset:0
    ds_read_b64_tr_b16 a[154:155], v17 offset:1024
    ds_read_b64_tr_b16 a[156:157], v17 offset:8192
    ds_read_b64_tr_b16 a[158:159], v17 offset:9216
    s_waitcnt vmcnt(12) lgkmcnt(0)
    s_barrier
    s_add_u32 m0, s76, 0
    s_mov_b32 s36, 0
    buffer_load_dwordx4 v12, s[12:15], s36 offen nt lds
    s_add_u32 m0, s76, 1024
    s_mov_b32 s36, 16384
    buffer_load_dwordx4 v12, s[12:15], s36 offen nt lds
    s_add_u32 m0, s76, 2048
    s_mov_b32 s36, 32768
    buffer_load_dwordx4 v13, s[12:15], s36 offen nt lds
    s_add_u32 m0, s76, 3072
    s_mov_b32 s36, 49152
    buffer_load_dwordx4 v13, s[12:15], s36 offen nt lds
    ds_read_b64_tr_b16 v[64:65], v20 offset:16384
    ds_read_b64_tr_b16 v[66:67], v21 offset:16384
    ds_read_b64_tr_b16 v[68:69], v20 offset:20480
    ds_read_b64_tr_b16 v[70:71], v21 offset:20480
    ds_read_b64_tr_b16 v[72:73], v20 offset:24576
    ds_read_b64_tr_b16 v[74:75], v21 offset:24576
    ds_read_b64_tr_b16 v[76:77], v20 offset:28672
    ds_read_b64_tr_b16 v[78:79], v21 offset:28672
    s_waitcnt vmcnt(12) lgkmcnt(0)
    s_barrier
    s_add_u32 m0, s76, 16384
    s_mov_b32 s36, 524288
    buffer_load_dwordx4 v12, s[12:15], s36 offen nt lds
    s_add_u32 m0, s76, 17408
    s_mov_b32 s36, 540672
    buffer_load_dwordx4 v12, s[12:15], s36 offen nt lds
    s_add_u32 m0, s76, 18432
    s_mov_b32 s36, 557056
    buffer_load_dwordx4 v13, s[12:15], s36 offen nt lds
    s_add_u32 m0, s76, 19456
    s_mov_b32 s36, 573440
    buffer_load_dwordx4 v13, s[12:15], s36 offen nt lds
    ds_write_b128 v10, v[64:67] offset:0
    ds_write_b128 v10, v[68:71] offset:1024
    ds_write_b128 v10, v[72:75] offset:2048
    ds_write_b128 v10, v[76:79] offset:3072
    ds_read_b64_tr_b16 v[80:81], v20 offset:32768
    ds_read_b64_tr_b16 v[82:83], v21 offset:32768
    ds_read_b64_tr_b16 v[84:85], v20 offset:36864
    ds_read_b64_tr_b16 v[86:87], v21 offset:36864
    ds_read_b64_tr_b16 v[32:33], v20 offset:40960
    ds_read_b64_tr_b16 v[34:35], v21 offset:40960
    ds_read_b64_tr_b16 v[36:37], v20 offset:45056
    ds_read_b64_tr_b16 v[38:39], v21 offset:45056
    s_waitcnt vmcnt(12) lgkmcnt(0)
    s_barrier
    s_add_u32 m0, s76, 32768
    s_mov_b32 s36, 1048576
    buffer_load_dwordx4 v12, s[12:15], s36 offen nt lds
    s_add_u32 m0, s76, 33792
    s_mov_b32 s36, 1064960
    buffer_load_dwordx4 v12, s[12:15], s36 offen nt lds
    s_add_u32 m0, s76, 34816
    s_mov_b32 s36, 1081344
    buffer_load_dwordx4 v13, s[12:15], s36 offen nt lds
    s_add_u32 m0, s76, 35840
    s_mov_b32 s36, 1097728
    buffer_load_dwordx4 v13, s[12:15], s36 offen nt lds
    ds_write_b128 v10, v[80:83] offset:4096
    ds_write_b128 v10, v[84:87] offset:5120
    ds_write_b128 v10, v[32:35] offset:6144
    ds_write_b128 v10, v[36:39] offset:7168
    ds_read_b64_tr_b16 v[64:65], v22 offset:0
    ds_read_b64_tr_b16 v[66:67], v23 offset:0
    ds_read_b64_tr_b16 v[68:69], v22 offset:4096
    ds_read_b64_tr_b16 v[70:71], v23 offset:4096
    ds_read_b64_tr_b16 v[72:73], v22 offset:8192
    ds_read_b64_tr_b16 v[74:75], v23 offset:8192
    ds_read_b64_tr_b16 v[76:77], v22 offset:12288
    ds_read_b64_tr_b16 v[78:79], v23 offset:12288
    s_waitcnt vmcnt(12) lgkmcnt(0)
    s_barrier
    s_add_u32 m0, s76, 49152
    s_mov_b32 s36, 1572864
    buffer_load_dwordx4 v12, s[12:15], s36 offen nt lds
    s_add_u32 m0, s76, 50176
    s_mov_b32 s36, 1589248
    buffer_load_dwordx4 v12, s[12:15], s36 offen nt lds
    s_add_u32 m0, s76, 51200
    s_mov_b32 s36, 1605632
    buffer_load_dwordx4 v13, s[12:15], s36 offen nt lds
    s_add_u32 m0, s76, 52224
    s_mov_b32 s36, 1622016
    buffer_load_dwordx4 v13, s[12:15], s36 offen nt lds
    ds_write_b128 v10, v[64:67] offset:8192
    ds_write_b128 v10, v[68:71] offset:9216
    ds_write_b128 v10, v[72:75] offset:10240
    ds_write_b128 v10, v[76:79] offset:11264
    ds_read_b64_tr_b16 v[80:81], v22 offset:16384
    ds_read_b64_tr_b16 v[82:83], v23 offset:16384
    ds_read_b64_tr_b16 v[84:85], v22 offset:20480
    ds_read_b64_tr_b16 v[86:87], v23 offset:20480
    ds_read_b64_tr_b16 v[32:33], v22 offset:24576
    ds_read_b64_tr_b16 v[34:35], v23 offset:24576
    ds_read_b64_tr_b16 v[36:37], v22 offset:28672
    ds_read_b64_tr_b16 v[38:39], v23 offset:28672
    s_waitcnt vmcnt(12) lgkmcnt(0)
    s_barrier
    s_add_u32 m0, s76, 65536
    s_mov_b32 s36, 2097152
    buffer_load_dwordx4 v12, s[12:15], s36 offen nt lds
    s_add_u32 m0, s76, 66560
    s_mov_b32 s36, 2113536
    buffer_load_dwordx4 v12, s[12:15], s36 offen nt lds
    s_add_u32 m0, s76, 67584
    s_mov_b32 s36, 2129920
    buffer_load_dwordx4 v13, s[12:15], s36 offen nt lds
    s_add_u32 m0, s76, 68608
    s_mov_b32 s36, 2146304
    buffer_load_dwordx4 v13, s[12:15], s36 offen nt lds
    ds_write_b128 v10, v[80:83] offset:12288
    ds_write_b128 v10, v[84:87] offset:13312
    ds_write_b128 v10, v[32:35] offset:14336
    ds_write_b128 v10, v[36:39] offset:15360
    ds_read_b64_tr_b16 v[160:161], v16 offset:0
    ds_read_b64_tr_b16 v[162:163], v16 offset:1024
    ds_read_b64_tr_b16 v[164:165], v16 offset:8192
    ds_read_b64_tr_b16 v[166:167], v16 offset:9216
    ds_read_b64_tr_b16 v[168:169], v17 offset:0
    ds_read_b64_tr_b16 v[170:171], v17 offset:1024
    ds_read_b64_tr_b16 v[172:173], v17 offset:8192
    ds_read_b64_tr_b16 v[174:175], v17 offset:9216
    s_waitcnt vmcnt(12) lgkmcnt(0)
    s_barrier
    s_add_u32 m0, s76, 0
    s_mov_b32 s36, 2621440
    buffer_load_dwordx4 v12, s[12:15], s36 offen nt lds
    s_add_u32 m0, s76, 1024
    s_mov_b32 s36, 2637824
    buffer_load_dwordx4 v12, s[12:15], s36 offen nt lds
    s_add_u32 m0, s76, 2048
    s_mov_b32 s36, 2654208
    buffer_load_dwordx4 v13, s[12:15], s36 offen nt lds
    s_add_u32 m0, s76, 3072
    s_mov_b32 s36, 2670592
    buffer_load_dwordx4 v13, s[12:15], s36 offen nt lds
    ds_read_b64_tr_b16 v[176:177], v16 offset:16384
    ds_read_b64_tr_b16 v[178:179], v16 offset:17408
    ds_read_b64_tr_b16 v[180:181], v16 offset:24576
    ds_read_b64_tr_b16 v[182:183], v16 offset:25600
    ds_read_b64_tr_b16 v[184:185], v17 offset:16384
    ds_read_b64_tr_b16 v[186:187], v17 offset:17408
    ds_read_b64_tr_b16 v[188:189], v17 offset:24576
    ds_read_b64_tr_b16 v[190:191], v17 offset:25600
    s_waitcnt vmcnt(12) lgkmcnt(0)
    s_barrier
    s_add_u32 m0, s76, 16384
    s_mov_b32 s36, 3145728
    buffer_load_dwordx4 v12, s[12:15], s36 offen nt lds
    s_add_u32 m0, s76, 17408
    s_mov_b32 s36, 3162112
    buffer_load_dwordx4 v12, s[12:15], s36 offen nt lds
    s_add_u32 m0, s76, 18432
    s_mov_b32 s36, 3178496
    buffer_load_dwordx4 v13, s[12:15], s36 offen nt lds
    s_add_u32 m0, s76, 19456
    s_mov_b32 s36, 3194880
    buffer_load_dwordx4 v13, s[12:15], s36 offen nt lds
    v_and_b32 v84, 0x70, v1
    s_mov_b32 s38, 11796480
wf_12:
    buffer_load_dwordx4 v[80:83], v84, s[4:7], s38 offen sc1
    s_waitcnt vmcnt(0)
    v_min_u32 v80, v80, v81
    v_min_u32 v80, v80, v82
    v_min_u32 v80, v80, v83
    v_cmp_gt_u32 vcc, 1, v80
    s_cbranch_vccz wfd_13
    s_sleep 2
    s_add_u32 s35, s35, 1
    s_cmp_lt_u32 s35, 524288
    s_cbranch_scc1 wf_12
wfd_13:
    ds_read_b64_tr_b16 v[40:41], v16 offset:32768
    ds_read_b64_tr_b16 v[42:43], v16 offset:33792
    ds_read_b64_tr_b16 v[44:45], v16 offset:40960
    ds_read_b64_tr_b16 v[46:47], v16 offset:41984
    ds_read_b64_tr_b16 v[48:49], v17 offset:32768
    ds_read_b64_tr_b16 v[50:51], v17 offset:33792
    ds_read_b64_tr_b16 v[52:53], v17 offset:40960
    ds_read_b64_tr_b16 v[54:55], v17 offset:41984
    s_waitcnt vmcnt(12) lgkmcnt(0)
    s_barrier
    s_add_u32 m0, s76, 32768
    s_mov_b32 s36, 3670016
    buffer_load_dwordx4 v12, s[12:15], s36 offen nt lds
    s_add_u32 m0, s76, 33792
    s_mov_b32 s36, 3686400
    buffer_load_dwordx4 v12, s[12:15], s36 offen nt lds
    s_add_u32 m0, s76, 34816
    s_mov_b32 s36, 3702784
    buffer_load_dwordx4 v13, s[12:15], s36 offen nt lds
    s_add_u32 m0, s76, 35840
    s_mov_b32 s36, 3719168
    buffer_load_dwordx4 v13, s[12:15], s36 offen nt lds
    s_lshl_b32 s38, s32, 11
    s_add_u32 s37, s38, s48
    s_add_u32 s39, s37, 524288
    buffer_load_dwordx4 v[80:83], v1, s[4:7], s37 offen offset:0 sc1
    buffer_load_dwordx4 v[80:83], v1, s[4:7], s37 offen offset:1024 sc1
    buffer_load_dwordx4 v[80:83], v1, s[4:7], s39 offen offset:0 sc1
    buffer_load_dwordx4 v[80:83], v1, s[4:7], s39 offen offset:1024 sc1
    s_lshl_b32 s37, s33, 2
    s_add_u32 s37, s37, s32
    s_lshl_b32 s37, s37, 10
    s_add_u32 s37, s37, 11534336
    buffer_load_dwordx4 v[80:83], v1, s[4:7], s37 offen sc1
    ds_read_b64_tr_b16 v[112:113], v18 offset:0
    ds_read_b64_tr_b16 v[114:115], v18 offset:1024
    ds_read_b64_tr_b16 v[116:117], v18 offset:8192
    ds_read_b64_tr_b16 v[118:119], v18 offset:9216
    ds_read_b64_tr_b16 v[120:121], v19 offset:0
    ds_read_b64_tr_b16 v[122:123], v19 offset:1024
    ds_read_b64_tr_b16 v[124:125], v19 offset:8192
    ds_read_b64_tr_b16 v[126:127], v19 offset:9216
    s_waitcnt vmcnt(12) lgkmcnt(0)
    s_barrier
    s_add_u32 m0, s76, 49152
    s_add_u32 s36, s72, 0
    buffer_load_dwordx4 v14, s[24:27], s36 offen nt lds
    s_add_u32 m0, s76, 50176
    s_add_u32 s36, s72, 4096
    buffer_load_dwordx4 v14, s[24:27], s36 offen nt lds
    s_add_u32 m0, s76, 51200
    s_add_u32 s36, s72, 2048
    buffer_load_dwordx4 v15, s[24:27], s36 offen nt lds
    s_add_u32 m0, s76, 52224
    s_add_u32 s36, s72, 6144
    buffer_load_dwordx4 v15, s[24:27], s36 offen nt lds
    ds_read_b64_tr_b16 v[224:225], v18 offset:16384
    ds_read_b64_tr_b16 v[226:227], v18 offset:17408
    ds_read_b64_tr_b16 v[228:229], v18 offset:24576
    ds_read_b64_tr_b16 v[230:231], v18 offset:25600
    ds_read_b64_tr_b16 v[232:233], v19 offset:16384
    ds_read_b64_tr_b16 v[234:235], v19 offset:17408
    ds_read_b64_tr_b16 v[236:237], v19 offset:24576
    ds_read_b64_tr_b16 v[238:239], v19 offset:25600
    s_waitcnt vmcnt(12) lgkmcnt(0)
    s_barrier
    s_add_u32 m0, s76, 65536
    s_add_u32 s36, s72, 65536
    buffer_load_dwordx4 v14, s[24:27], s36 offen nt lds
    s_add_u32 m0, s76, 66560
    s_add_u32 s36, s72, 69632
    buffer_load_dwordx4 v14, s[24:27], s36 offen nt lds
    s_add_u32 m0, s76, 67584
    s_add_u32 s36, s72, 67584
    buffer_load_dwordx4 v15, s[24:27], s36 offen nt lds
    s_add_u32 m0, s76, 68608
    s_add_u32 s36, s72, 71680
    buffer_load_dwordx4 v15, s[24:27], s36 offen nt lds
    ds_read_b64_tr_b16 v[240:241], v16 offset:0
    ds_read_b64_tr_b16 v[242:243], v16 offset:1024
    ds_read_b64_tr_b16 v[244:245], v16 offset:8192
    ds_read_b64_tr_b16 v[246:247], v16 offset:9216
    ds_read_b64_tr_b16 v[248:249], v17 offset:0
    ds_read_b64_tr_b16 v[250:251], v17 offset:1024
    ds_read_b64_tr_b16 v[252:253], v17 offset:8192
    ds_read_b64_tr_b16 v[254:255], v17 offset:9216
    s_waitcnt vmcnt(12) lgkmcnt(0)
    s_barrier
    s_add_u32 m0, s76, 0
    s_add_u32 s36, s73, 0
    buffer_load_dwordx4 v14, s[24:27], s36 offen nt lds
    s_add_u32 m0, s76, 1024
    s_add_u32 s36, s73, 4096
    buffer_load_dwordx4 v14, s[24:27], s36 offen nt lds
    s_add_u32 m0, s76, 2048
    s_add_u32 s36, s73, 2048
    buffer_load_dwordx4 v15, s[24:27], s36 offen nt lds
    s_add_u32 m0, s76, 3072
    s_add_u32 s36, s73, 6144
    buffer_load_dwordx4 v15, s[24:27], s36 offen nt lds
    ds_read_b64_tr_b16 v[192:193], v16 offset:16384
    ds_read_b64_tr_b16 v[194:195], v16 offset:17408
    ds_read_b64_tr_b16 v[196:197], v16 offset:24576
    ds_read_b64_tr_b16 v[198:199], v16 offset:25600
    ds_read_b64_tr_b16 v[200:201], v17 offset:16384
    ds_read_b64_tr_b16 v[202:203], v17 offset:17408
    ds_read_b64_tr_b16 v[204:205], v17 offset:24576
    ds_read_b64_tr_b16 v[206:207], v17 offset:25600
    s_waitcnt vmcnt(12) lgkmcnt(0)
    s_barrier
    s_add_u32 m0, s76, 16384
    s_add_u32 s36, s73, 65536
    buffer_load_dwordx4 v14, s[24:27], s36 offen nt lds
    s_add_u32 m0, s76, 17408
    s_add_u32 s36, s73, 69632
    buffer_load_dwordx4 v14, s[24:27], s36 offen nt lds
    s_add_u32 m0, s76, 18432
    s_add_u32 s36, s73, 67584
    buffer_load_dwordx4 v15, s[24:27], s36 offen nt lds
    s_add_u32 m0, s76, 19456
    s_add_u32 s36, s73, 71680
    buffer_load_dwordx4 v15, s[24:27], s36 offen nt lds
    ds_read_b64_tr_b16 v[208:209], v16 offset:32768
    ds_read_b64_tr_b16 v[210:211], v16 offset:33792
    ds_read_b64_tr_b16 v[212:213], v16 offset:40960
    ds_read_b64_tr_b16 v[214:215], v16 offset:41984
    ds_read_b64_tr_b16 v[216:217], v17 offset:32768
    ds_read_b64_tr_b16 v[218:219], v17 offset:33792
    ds_read_b64_tr_b16 v[220:221], v17 offset:40960
    ds_read_b64_tr_b16 v[222:223], v17 offset:41984
    s_waitcnt vmcnt(12) lgkmcnt(0)
    s_barrier
    ds_read_b64_tr_b16 a[192:193], v22 offset:0
    ds_read_b64_tr_b16 a[194:195], v23 offset:0
    ds_read_b64_tr_b16 a[196:197], v22 offset:4096
    ds_read_b64_tr_b16 a[198:199], v23 offset:4096
    ds_read_b64_tr_b16 a[200:201], v22 offset:8192
    ds_read_b64_tr_b16 a[202:203], v23 offset:8192
    ds_read_b64_tr_b16 a[204:205], v22 offset:12288
    ds_read_b64_tr_b16 a[206:207], v23 offset:12288
    s_waitcnt vmcnt(8) lgkmcnt(0)
    s_barrier
    s_mov_b32 m0, s58
    s_nop 0
    buffer_load_dwordx4 v1, s[4:7], s50 offen sc1 lds
    buffer_load_dwordx4 v1, s[4:7], s50 offen offset:1024 sc1 lds
    ds_read_b64_tr_b16 a[208:209], v22 offset:16384
    ds_read_b64_tr_b16 a[210:211], v23 offset:16384
    ds_read_b64_tr_b16 a[212:213], v22 offset:20480
    ds_read_b64_tr_b16 a[214:215], v23 offset:20480
    ds_read_b64_tr_b16 a[216:217], v22 offset:24576
    ds_read_b64_tr_b16 a[218:219], v23 offset:24576
    ds_read_b64_tr_b16 a[220:221], v22 offset:28672
    ds_read_b64_tr_b16 a[222:223], v23 offset:28672
    s_waitcnt vmcnt(6) lgkmcnt(0)
    s_barrier
    s_mov_b32 m0, s59
    s_add_u32 s36, s50, 8192
    buffer_load_dwordx4 v1, s[4:7], s36 offen sc1 lds
    buffer_load_dwordx4 v1, s[4:7], s36 offen offset:1024 sc1 lds
    ds_read_b64_tr_b16 a[224:225], v20 offset:0
    ds_read_b64_tr_b16 a[226:227], v21 offset:0
    ds_read_b64_tr_b16 a[228:229], v20 offset:4096
    ds_read_b64_tr_b16 a[230:231], v21 offset:4096
    ds_read_b64_tr_b16 a[232:233], v20 offset:8192
    ds_read_b64_tr_b16 a[234:235], v21 offset:8192
    ds_read_b64_tr_b16 a[236:237], v20 offset:12288
    ds_read_b64_tr_b16 a[238:239], v21 offset:12288
    s_waitcnt vmcnt(4) lgkmcnt(0)
    s_barrier
    ds_read_b64_tr_b16 a[240:241], v20 offset:16384
    ds_read_b64_tr_b16 a[242:243], v21 offset:16384
    ds_read_b64_tr_b16 a[244:245], v20 offset:20480
    ds_read_b64_tr_b16 a[246:247], v21 offset:20480
    ds_read_b64_tr_b16 a[248:249], v20 offset:24576
    ds_read_b64_tr_b16 a[250:251], v21 offset:24576
    ds_read_b64_tr_b16 a[252:253], v20 offset:28672
    ds_read_b64_tr_b16 a[254:255], v21 offset:28672
    s_waitcnt lgkmcnt(0)
    s_branch cw_done_3
cw2_6:
    s_waitcnt vmcnt(12) lgkmcnt(0)
    s_barrier
    s_add_u32 m0, s76, 65536
    s_mov_b32 s36, 2097152
    buffer_load_dwordx4 v12, s[16:19], s36 offen nt lds
    s_add_u32 m0, s76, 66560
    s_mov_b32 s36, 2113536
    buffer_load_dwordx4 v12, s[16:19], s36 offen nt lds
    s_add_u32 m0, s76, 67584
    s_mov_b32 s36, 2129920
    buffer_load_dwordx4 v13, s[16:19], s36 offen nt lds
    s_add_u32 m0, s76, 68608
    s_mov_b32 s36, 2146304
    buffer_load_dwordx4 v13, s[16:19], s36 offen nt lds
    ds_read_b64_tr_b16 a[32:33], v16 offset:0
    ds_read_b64_tr_b16 a[34:35], v16 offset:1024
    ds_read_b64_tr_b16 a[36:37], v16 offset:8192
    ds_read_b64_tr_b16 a[38:39], v16 offset:9216
    ds_read_b64_tr_b16 a[40:41], v17 offset:0
    ds_read_b64_tr_b16 a[42:43], v17 offset:1024
    ds_read_b64_tr_b16 a[44:45], v17 offset:8192
    ds_read_b64_tr_b16 a[46:47], v17 offset:9216
    s_waitcnt vmcnt(12) lgkmcnt(0)
    s_barrier
    s_add_u32 m0, s76, 0
    s_mov_b32 s36, 2621440
    buffer_load_dwordx4 v12, s[16:19], s36 offen nt lds
    s_add_u32 m0, s76, 1024
    s_mov_b32 s36, 2637824
    buffer_load_dwordx4 v12, s[16:19], s36 offen nt lds
    s_add_u32 m0, s76, 2048
    s_mov_b32 s36, 2654208
    buffer_load_dwordx4 v13, s[16:19], s36 offen nt lds
    s_add_u32 m0, s76, 3072
    s_mov_b32 s36, 2670592
    buffer_load_dwordx4 v13, s[16:19], s36 offen nt lds
    ds_read_b64_tr_b16 a[48:49], v16 offset:16384
    ds_read_b64_tr_b16 a[50:51], v16 offset:17408
    ds_read_b64_tr_b16 a[52:53], v16 offset:24576
    ds_read_b64_tr_b16 a[54:55], v16 offset:25600
    ds_read_b64_tr_b16 a[56:57], v17 offset:16384
    ds_read_b64_tr_b16 a[58:59], v17 offset:17408
    ds_read_b64_tr_b16 a[60:61], v17 offset:24576
    ds_read_b64_tr_b16 a[62:63], v17 offset:25600
    s_waitcnt vmcnt(12) lgkmcnt(0)
    s_barrier
    s_add_u32 m0, s76, 16384
    s_mov_b32 s36, 3145728
    buffer_load_dwordx4 v12, s[16:19], s36 offen nt lds
    s_add_u32 m0, s76, 17408
    s_mov_b32 s36, 3162112
    buffer_load_dwordx4 v12, s[16:19], s36 offen nt lds
    s_add_u32 m0, s76, 18432
    s_mov_b32 s36, 3178496
    buffer_load_dwordx4 v13, s[16:19], s36 offen nt lds
    s_add_u32 m0, s76, 19456
    s_mov_b32 s36, 3194880
    buffer_load_dwordx4 v13, s[16:19], s36 offen nt lds
    ds_read_b64_tr_b16 a[64:65], v16 offset:32768
    ds_read_b64_tr_b16 a[66:67], v16 offset:33792
    ds_read_b64_tr_b16 a[68:69], v16 offset:40960
    ds_read_b64_tr_b16 a[70:71], v16 offset:41984
    ds_read_b64_tr_b16 a[72:73], v17 offset:32768
    ds_read_b64_tr_b16 a[74:75], v17 offset:33792
    ds_read_b64_tr_b16 a[76:77], v17 offset:40960
    ds_read_b64_tr_b16 a[78:79], v17 offset:41984
    s_waitcnt vmcnt(12) lgkmcnt(0)
    s_barrier
    s_add_u32 m0, s76, 32768
    s_mov_b32 s36, 3670016
    buffer_load_dwordx4 v12, s[16:19], s36 offen nt lds
    s_add_u32 m0, s76, 33792
    s_mov_b32 s36, 3686400
    buffer_load_dwordx4 v12, s[16:19], s36 offen nt lds
    s_add_u32 m0, s76, 34816
    s_mov_b32 s36, 3702784
    buffer_load_dwordx4 v13, s[16:19], s36 offen nt lds
    s_add_u32 m0, s76, 35840
    s_mov_b32 s36, 3719168
    buffer_load_dwordx4 v13, s[16:19], s36 offen nt lds
    ds_read_b64_tr_b16 a[80:81], v18 offset:0
    ds_read_b64_tr_b16 a[82:83], v18 offset:1024
    ds_read_b64_tr_b16 a[84:85], v18 offset:8192
    ds_read_b64_tr_b16 a[86:87], v18 offset:9216
    ds_read_b64_tr_b16 a[88:89], v19 offset:0
    ds_read_b64_tr_b16 a[90:91], v19 offset:1024
    ds_read_b64_tr_b16 a[92:93], v19 offset:8192
    ds_read_b64_tr_b16 a[94:95], v19 offset:9216
    s_waitcnt vmcnt(12) lgkmcnt(0)
    s_barrier
    s_add_u32 m0, s76, 49152
    s_mov_b32 s36, 0
    buffer_load_dwordx4 v12, s[20:23], s36 offen nt lds
    s_add_u32 m0, s76, 50176
    s_mov_b32 s36, 16384
    buffer_load_dwordx4 v12, s[20:23], s36 offen nt lds
    s_add_u32 m0, s76, 51200
    s_mov_b32 s36, 32768
    buffer_load_dwordx4 v13, s[20:23], s36 offen nt lds
    s_add_u32 m0, s76, 52224
    s_mov_b32 s36, 49152
    buffer_load_dwordx4 v13, s[20:23], s36 offen nt lds
    ds_read_b64_tr_b16 v[56:57], v18 offset:16384
    ds_read_b64_tr_b16 v[58:59], v18 offset:17408
    ds_read_b64_tr_b16 v[60:61], v18 offset:24576
    ds_read_b64_tr_b16 v[62:63], v18 offset:25600
    ds_read_b64_tr_b16 v[88:89], v19 offset:16384
    ds_read_b64_tr_b16 v[90:91], v19 offset:17408
    ds_read_b64_tr_b16 v[92:93], v19 offset:24576
    ds_read_b64_tr_b16 v[94:95], v19 offset:25600
    s_waitcnt vmcnt(12) lgkmcnt(0)
    s_barrier
    s_add_u32 m0, s76, 65536
    s_mov_b32 s36, 524288
    buffer_load_dwordx4 v12, s[20:23], s36 offen nt lds
    s_add_u32 m0, s76, 66560
    s_mov_b32 s36, 540672
    buffer_load_dwordx4 v12, s[20:23], s36 offen nt lds
    s_add_u32 m0, s76, 67584
    s_mov_b32 s36, 557056
    buffer_load_dwordx4 v13, s[20:23], s36 offen nt lds
    s_add_u32 m0, s76, 68608
    s_mov_b32 s36, 573440
    buffer_load_dwordx4 v13, s[20:23], s36 offen nt lds
    ds_read_b64_tr_b16 v[128:129], v16 offset:0
    ds_read_b64_tr_b16 v[130:131], v16 offset:1024
    ds_read_b64_tr_b16 v[132:133], v16 offset:8192
    ds_read_b64_tr_b16 v[134:135], v16 offset:9216
    ds_read_b64_tr_b16 v[136:137], v17 offset:0
    ds_read_b64_tr_b16 v[138:139], v17 offset:1024
    ds_read_b64_tr_b16 v[140:141], v17 offset:8192
    ds_read_b64_tr_b16 v[142:143], v17 offset:9216
    s_waitcnt vmcnt(12) lgkmcnt(0)
    s_barrier
    s_add_u32 m0, s76, 0
    s_mov_b32 s36, 1048576
    buffer_load_dwordx4 v12, s[20:23], s36 offen nt lds
    s_add_u32 m0, s76, 1024
    s_mov_b32 s36, 1064960
    buffer_load_dwordx4 v12, s[20:23], s36 offen nt lds
    s_add_u32 m0, s76, 2048
    s_mov_b32 s36, 1081344
    buffer_load_dwordx4 v13, s[20:23], s36 offen nt lds
    s_add_u32 m0, s76, 3072
    s_mov_b32 s36, 1097728
    buffer_load_dwordx4 v13, s[20:23], s36 offen nt lds
    ds_read_b64_tr_b16 a[0:1], v16 offset:16384
    ds_read_b64_tr_b16 a[2:3], v16 offset:17408
    ds_read_b64_tr_b16 a[4:5], v16 offset:24576
    ds_read_b64_tr_b16 a[6:7], v16 offset:25600
    ds_read_b64_tr_b16 a[8:9], v17 offset:16384
    ds_read_b64_tr_b16 a[10:11], v17 offset:17408
    ds_read_b64_tr_b16 a[12:13], v17 offset:24576
    ds_read_b64_tr_b16 a[14:15], v17 offset:25600
    s_waitcnt vmcnt(12) lgkmcnt(0)
    s_barrier
    s_add_u32 m0, s76, 16384
    s_mov_b32 s36, 1572864
    buffer_load_dwordx4 v12, s[20:23], s36 offen nt lds
    s_add_u32 m0, s76, 17408
    s_mov_b32 s36, 1589248
    buffer_load_dwordx4 v12, s[20:23], s36 offen nt lds
    s_add_u32 m0, s76, 18432
    s_mov_b32 s36, 1605632
    buffer_load_dwordx4 v13, s[20:23], s36 offen nt lds
    s_add_u32 m0, s76, 19456
    s_mov_b32 s36, 1622016
    buffer_load_dwordx4 v13, s[20:23], s36 offen nt lds
    ds_read_b64_tr_b16 a[16:17], v16 offset:32768
    ds_read_b64_tr_b16 a[18:19], v16 offset:33792
    ds_read_b64_tr_b16 a[20:21], v16 offset:40960
    ds_read_b64_tr_b16 a[22:23], v16 offset:41984
    ds_read_b64_tr_b16 a[24:25], v17 offset:32768
    ds_read_b64_tr_b16 a[26:27], v17 offset:33792
    ds_read_b64_tr_b16 a[28:29], v17 offset:40960
    ds_read_b64_tr_b16 a[30:31], v17 offset:41984
    s_waitcnt vmcnt(12) lgkmcnt(0)
    s_barrier
    s_add_u32 m0, s76, 32768
    s_mov_b32 s36, 2097152
    buffer_load_dwordx4 v12, s[20:23], s36 offen nt lds
    s_add_u32 m0, s76, 33792
    s_mov_b32 s36, 2113536
    buffer_load_dwordx4 v12, s[20:23], s36 offen nt lds
    s_add_u32 m0, s76, 34816
    s_mov_b32 s36, 2129920
    buffer_load_dwordx4 v13, s[20:23], s36 offen nt lds
    s_add_u32 m0, s76, 35840
    s_mov_b32 s36, 2146304
    buffer_load_dwordx4 v13, s[20:23], s36 offen nt lds
    ds_read_b64_tr_b16 a[128:129], v18 offset:0
    ds_read_b64_tr_b16 a[130:131], v18 offset:1024
    ds_read_b64_tr_b16 a[132:133], v18 offset:8192
    ds_read_b64_tr_b16 a[134:135], v18 offset:9216
    ds_read_b64_tr_b16 a[136:137], v19 offset:0
    ds_read_b64_tr_b16 a[138:139], v19 offset:1024
    ds_read_b64_tr_b16 a[140:141], v19 offset:8192
    ds_read_b64_tr_b16 a[142:143], v19 offset:9216
    s_waitcnt vmcnt(12) lgkmcnt(0)
    s_barrier
    s_add_u32 m0, s76, 49152
    s_mov_b32 s36, 2621440
    buffer_load_dwordx4 v12, s[20:23], s36 offen nt lds
    s_add_u32 m0, s76, 50176
    s_mov_b32 s36, 2637824
    buffer_load_dwordx4 v12, s[20:23], s36 offen nt lds
    s_add_u32 m0, s76, 51200
    s_mov_b32 s36, 2654208
    buffer_load_dwordx4 v13, s[20:23], s36 offen nt lds
    s_add_u32 m0, s76, 52224
    s_mov_b32 s36, 2670592
    buffer_load_dwordx4 v13, s[20:23], s36 offen nt lds
    ds_read_b64_tr_b16 a[144:145], v18 offset:16384
    ds_read_b64_tr_b16 a[146:147], v18 offset:17408
    ds_read_b64_tr_b16 a[148:149], v18 offset:24576
    ds_read_b64_tr_b16 a[150:151], v18 offset:25600
    ds_read_b64_tr_b16 a[152:153], v19 offset:16384
    ds_read_b64_tr_b16 a[154:155], v19 offset:17408
    ds_read_b64_tr_b16 a[156:157], v19 offset:24576
    ds_read_b64_tr_b16 a[158:159], v19 offset:25600
    s_waitcnt vmcnt(12) lgkmcnt(0)
    s_barrier
    s_add_u32 m0, s76, 65536
    s_mov_b32 s36, 3145728
    buffer_load_dwordx4 v12, s[20:23], s36 offen nt lds
    s_add_u32 m0, s76, 66560
    s_mov_b32 s36, 3162112
    buffer_load_dwordx4 v12, s[20:23], s36 offen nt lds
    s_add_u32 m0, s76, 67584
    s_mov_b32 s36, 3178496
    buffer_load_dwordx4 v13, s[20:23], s36 offen nt lds
    s_add_u32 m0, s76, 68608
    s_mov_b32 s36, 3194880
    buffer_load_dwordx4 v13, s[20:23], s36 offen nt lds
    v_mbcnt_lo_u32_b32 v81, -1, 0
    v_mbcnt_hi_u32_b32 v81, -1, v81
    v_lshlrev_b32 v81, 5, v81
wt_14:
    buffer_load_dword v80, v81, s[8:11], 0 offen sc1
    s_waitcnt vmcnt(0)
    v_readlane_b32 s36, v80, 0
    v_readlane_b32 s37, v80, 1
    s_nop 0
    s_add_u32 s36, s36, s37
    v_readlane_b32 s37, v80, 2
    s_nop 0
    s_add_u32 s36, s36, s37
    v_readlane_b32 s37, v80, 3
    s_nop 0
    s_add_u32 s36, s36, s37
    v_readlane_b32 s37, v80, 4
    s_nop 0
    s_add_u32 s36, s36, s37
    v_readlane_b32 s37, v80, 5
    s_nop 0
    s_add_u32 s36, s36, s37
    v_readlane_b32 s37, v80, 6
    s_nop 0
    s_add_u32 s36, s36, s37
    v_readlane_b32 s37, v80, 7
    s_nop 0
    s_add_u32 s36, s36, s37
    s_cmp_ge_u32 s36, 256
    s_cbranch_scc1 wtd_15
    s_sleep 2
    s_add_u32 s35, s35, 1
    s_cmp_lt_u32 s35, 524288
    s_cbranch_scc1 wt_14
wtd_15:
    v_readlane_b32 s57, v80, 0
    ds_read_b64_tr_b16 a[160:161], v16 offset:0
    ds_read_b64_tr_b16 a[162:163], v16 offset:1024
    ds_read_b64_tr_b16 a[164:165], v16 offset:8192
    ds_read_b64_tr_b16 a[166:167], v16 offset:9216
    ds_read_b64_tr_b16 a[168:169], v17 offset:0
    ds_read_b64_tr_b16 a[170:171], v17 offset:1024
    ds_read_b64_tr_b16 a[172:173], v17 offset:8192
    ds_read_b64_tr_b16 a[174:175], v17 offset:9216
    s_waitcnt vmcnt(12) lgkmcnt(0)
    s_barrier
    s_add_u32 m0, s76, 0
    s_mov_b32 s36, 3670016
    buffer_load_dwordx4 v12, s[20:23], s36 offen nt lds
    s_add_u32 m0, s76, 1024
    s_mov_b32 s36, 3686400
    buffer_load_dwordx4 v12, s[20:23], s36 offen nt lds
    s_add_u32 m0, s76, 2048
    s_mov_b32 s36, 3702784
    buffer_load_dwordx4 v13, s[20:23], s36 offen nt lds
    s_add_u32 m0, s76, 3072
    s_mov_b32 s36, 3719168
    buffer_load_dwordx4 v13, s[20:23], s36 offen nt lds
    ds_read_b64_tr_b16 a[176:177], v16 offset:16384
    ds_read_b64_tr_b16 a[178:179], v16 offset:17408
    ds_read_b64_tr_b16 a[180:181], v16 offset:24576
    ds_read_b64_tr_b16 a[182:183], v16 offset:25600
    ds_read_b64_tr_b16 a[184:185], v17 offset:16384
    ds_read_b64_tr_b16 a[186:187], v17 offset:17408
    ds_read_b64_tr_b16 a[188:189], v17 offset:24576
    ds_read_b64_tr_b16 a[190:191], v17 offset:25600
    s_waitcnt vmcnt(12) lgkmcnt(0)
    s_barrier
    s_add_u32 m0, s76, 16384
    s_add_u32 s36, s74, 0
    buffer_load_dwordx4 v14, s[24:27], s36 offen nt lds
    s_add_u32 m0, s76, 17408
    s_add_u32 s36, s74, 4096
    buffer_load_dwordx4 v14, s[24:27], s36 offen nt lds
    s_add_u32 m0, s76, 18432
    s_add_u32 s36, s74, 2048
    buffer_load_dwordx4 v15, s[24:27], s36 offen nt lds
    s_add_u32 m0, s76, 19456
    s_add_u32 s36, s74, 6144
    buffer_load_dwordx4 v15, s[24:27], s36 offen nt lds
    ds_read_b64_tr_b16 v[96:97], v16 offset:32768
    ds_read_b64_tr_b16 v[98:99], v16 offset:33792
    ds_read_b64_tr_b16 v[100:101], v16 offset:40960
    ds_read_b64_tr_b16 v[102:103], v16 offset:41984
    ds_read_b64_tr_b16 v[104:105], v17 offset:32768
    ds_read_b64_tr_b16 v[106:107], v17 offset:33792
    ds_read_b64_tr_b16 v[108:109], v17 offset:40960
    ds_read_b64_tr_b16 v[110:111], v17 offset:41984
    s_waitcnt vmcnt(12) lgkmcnt(0)
    s_barrier
    s_add_u32 m0, s76, 32768
    s_add_u32 s36, s74, 65536
    buffer_load_dwordx4 v14, s[24:27], s36 offen nt lds
    s_add_u32 m0, s76, 33792
    s_add_u32 s36, s74, 69632
    buffer_load_dwordx4 v14, s[24:27], s36 offen nt lds
    s_add_u32 m0, s76, 34816
    s_add_u32 s36, s74, 67584
    buffer_load_dwordx4 v15, s[24:27], s36 offen nt lds
    s_add_u32 m0, s76, 35840
    s_add_u32 s36, s74, 71680
    buffer_load_dwordx4 v15, s[24:27], s36 offen nt lds
    ds_read_b64_tr_b16 v[144:145], v18 offset:0
    ds_read_b64_tr_b16 v[146:147], v18 offset:1024
    ds_read_b64_tr_b16 v[148:149], v18 offset:8192
    ds_read_b64_tr_b16 v[150:151], v18 offset:9216
    ds_read_b64_tr_b16 v[152:153], v19 offset:0
    ds_read_b64_tr_b16 v[154:155], v19 offset:1024
    ds_read_b64_tr_b16 v[156:157], v19 offset:8192
    ds_read_b64_tr_b16 v[158:159], v19 offset:9216
    s_waitcnt vmcnt(12) lgkmcnt(0)
    s_barrier
    s_add_u32 m0, s76, 49152
    s_add_u32 s36, s75, 0
    buffer_load_dwordx4 v14, s[24:27], s36 offen nt lds
    s_add_u32 m0, s76, 50176
    s_add_u32 s36, s75, 4096
    buffer_load_dwordx4 v14, s[24:27], s36 offen nt lds
    s_add_u32 m0, s76, 51200
    s_add_u32 s36, s75, 2048
    buffer_load_dwordx4 v15, s[24:27], s36 offen nt lds
    s_add_u32 m0, s76, 52224
    s_add_u32 s36, s75, 6144
    buffer_load_dwordx4 v15, s[24:27], s36 offen nt lds
    ds_read_b64_tr_b16 a[96:97], v18 offset:16384
    ds_read_b64_tr_b16 a[98:99], v18 offset:17408
    ds_read_b64_tr_b16 a[100:101], v18 offset:24576
    ds_read_b64_tr_b16 a[102:103], v18 offset:25600
    ds_read_b64_tr_b16 a[104:105], v19 offset:16384
    ds_read_b64_tr_b16 a[106:107], v19 offset:17408
    ds_read_b64_tr_b16 a[108:109], v19 offset:24576
    ds_read_b64_tr_b16 a[110:111], v19 offset:25600
    s_waitcnt vmcnt(12) lgkmcnt(0)
    s_barrier
    s_add_u32 m0, s76, 65536
    s_add_u32 s36, s75, 65536
    buffer_load_dwordx4 v14, s[24:27], s36 offen nt lds
    s_add_u32 m0, s76, 66560
    s_add_u32 s36, s75, 69632
    buffer_load_dwordx4 v14, s[24:27], s36 offen nt lds
    s_add_u32 m0, s76, 67584
    s_add_u32 s36, s75, 67584
    buffer_load_dwordx4 v15, s[24:27], s36 offen nt lds
    s_add_u32 m0, s76, 68608
    s_add_u32 s36, s75, 71680
    buffer_load_dwordx4 v15, s[24:27], s36 offen nt lds
    ds_read_b64_tr_b16 a[112:113], v16 offset:0
    ds_read_b64_tr_b16 a[114:115], v16 offset:1024
    ds_read_b64_tr_b16 a[116:117], v16 offset:8192
    ds_read_b64_tr_b16 a[118:119], v16 offset:9216
    ds_read_b64_tr_b16 a[120:121], v17 offset:0
    ds_read_b64_tr_b16 a[122:123], v17 offset:1024
    ds_read_b64_tr_b16 a[124:125], v17 offset:8192
    ds_read_b64_tr_b16 a[126:127], v17 offset:9216
    s_waitcnt vmcnt(12) lgkmcnt(0)
    s_barrier
    s_add_u32 m0, s76, 0
    s_mov_b32 s36, 0
    buffer_load_dwordx4 v12, s[12:15], s36 offen nt lds
    s_add_u32 m0, s76, 1024
    s_mov_b32 s36, 16384
    buffer_load_dwordx4 v12, s[12:15], s36 offen nt lds
    s_add_u32 m0, s76, 2048
    s_mov_b32 s36, 32768
    buffer_load_dwordx4 v13, s[12:15], s36 offen nt lds
    s_add_u32 m0, s76, 3072
    s_mov_b32 s36, 49152
    buffer_load_dwordx4 v13, s[12:15], s36 offen nt lds
    ds_read_b64_tr_b16 v[64:65], v20 offset:16384
    ds_read_b64_tr_b16 v[66:67], v21 offset:16384
    ds_read_b64_tr_b16 v[68:69], v20 offset:20480
    ds_read_b64_tr_b16 v[70:71], v21 offset:20480
    ds_read_b64_tr_b16 v[72:73], v20 offset:24576
    ds_read_b64_tr_b16 v[74:75], v21 offset:24576
    ds_read_b64_tr_b16 v[76:77], v20 offset:28672
    ds_read_b64_tr_b16 v[78:79], v21 offset:28672
    s_waitcnt vmcnt(12) lgkmcnt(0)
    s_barrier
    s_add_u32 m0, s76, 16384
    s_mov_b32 s36, 524288
    buffer_load_dwordx4 v12, s[12:15], s36 offen nt lds
    s_add_u32 m0, s76, 17408
    s_mov_b32 s36, 540672
    buffer_load_dwordx4 v12, s[12:15], s36 offen nt lds
    s_add_u32 m0, s76, 18432
    s_mov_b32 s36, 557056
    buffer_load_dwordx4 v13, s[12:15], s36 offen nt lds
    s_add_u32 m0, s76, 19456
    s_mov_b32 s36, 573440
    buffer_load_dwordx4 v13, s[12:15], s36 offen nt lds
    ds_write_b128 v10, v[64:67] offset:0
    ds_write_b128 v10, v[68:71] offset:1024
    ds_write_b128 v10, v[72:75] offset:2048
    ds_write_b128 v10, v[76:79] offset:3072
    ds_read_b64_tr_b16 v[80:81], v20 offset:32768
    ds_read_b64_tr_b16 v[82:83], v21 offset:32768
    ds_read_b64_tr_b16 v[84:85], v20 offset:36864
    ds_read_b64_tr_b16 v[86:87], v21 offset:36864
    ds_read_b64_tr_b16 v[32:33], v20 offset:40960
    ds_read_b64_tr_b16 v[34:35], v21 offset:40960
    ds_read_b64_tr_b16 v[36:37], v20 offset:45056
    ds_read_b64_tr_b16 v[38:39], v21 offset:45056
    s_waitcnt vmcnt(12) lgkmcnt(0)
    s_barrier
    s_add_u32 m0, s76, 32768
    s_mov_b32 s36, 1048576
    buffer_load_dwordx4 v12, s[12:15], s36 offen nt lds
    s_add_u32 m0, s76, 33792
    s_mov_b32 s36, 1064960
    buffer_load_dwordx4 v12, s[12:15], s36 offen nt lds
    s_add_u32 m0, s76, 34816
    s_mov_b32 s36, 1081344
    buffer_load_dwordx4 v13, s[12:15], s36 offen nt lds
    s_add_u32 m0, s76, 35840
    s_mov_b32 s36, 1097728
    buffer_load_dwordx4 v13, s[12:15], s36 offen nt lds
    ds_write_b128 v10, v[80:83] offset:4096
    ds_write_b128 v10, v[84:87] offset:5120
    ds_write_b128 v10, v[32:35] offset:6144
    ds_write_b128 v10, v[36:39] offset:7168
    ds_read_b64_tr_b16 v[64:65], v22 offset:0
    ds_read_b64_tr_b16 v[66:67], v23 offset:0
    ds_read_b64_tr_b16 v[68:69], v22 offset:4096
    ds_read_b64_tr_b16 v[70:71], v23 offset:4096
    ds_read_b64_tr_b16 v[72:73], v22 offset:8192
    ds_read_b64_tr_b16 v[74:75], v23 offset:8192
    ds_read_b64_tr_b16 v[76:77], v22 offset:12288
    ds_read_b64_tr_b16 v[78:79], v23 offset:12288
    s_waitcnt vmcnt(12) lgkmcnt(0)
    s_barrier
    s_add_u32 m0, s76, 49152
    s_mov_b32 s36, 1572864
    buffer_load_dwordx4 v12, s[12:15], s36 offen nt lds
    s_add_u32 m0, s76, 50176
    s_mov_b32 s36, 1589248
    buffer_load_dwordx4 v12, s[12:15], s36 offen nt lds
    s_add_u32 m0, s76, 51200
    s_mov_b32 s36, 1605632
    buffer_load_dwordx4 v13, s[12:15], s36 offen nt lds
    s_add_u32 m0, s76, 52224
    s_mov_b32 s36, 1622016
    buffer_load_dwordx4 v13, s[12:15], s36 offen nt lds
    ds_write_b128 v10, v[64:67] offset:8192
    ds_write_b128 v10, v[68:71] offset:9216
    ds_write_b128 v10, v[72:75] offset:10240
    ds_write_b128 v10, v[76:79] offset:11264
    ds_read_b64_tr_b16 v[80:81], v22 offset:16384
    ds_read_b64_tr_b16 v[82:83], v23 offset:16384
    ds_read_b64_tr_b16 v[84:85], v22 offset:20480
    ds_read_b64_tr_b16 v[86:87], v23 offset:20480
    ds_read_b64_tr_b16 v[32:33], v22 offset:24576
    ds_read_b64_tr_b16 v[34:35], v23 offset:24576
    ds_read_b64_tr_b16 v[36:37], v22 offset:28672
    ds_read_b64_tr_b16 v[38:39], v23 offset:28672
    s_waitcnt vmcnt(12) lgkmcnt(0)
    s_barrier
    s_add_u32 m0, s76, 65536
    s_mov_b32 s36, 2097152
    buffer_load_dwordx4 v12, s[12:15], s36 offen nt lds
    s_add_u32 m0, s76, 66560
    s_mov_b32 s36, 2113536
    buffer_load_dwordx4 v12, s[12:15], s36 offen nt lds
    s_add_u32 m0, s76, 67584
    s_mov_b32 s36, 2129920
    buffer_load_dwordx4 v13, s[12:15], s36 offen nt lds
    s_add_u32 m0, s76, 68608
    s_mov_b32 s36, 2146304
    buffer_load_dwordx4 v13, s[12:15], s36 offen nt lds
    ds_write_b128 v10, v[80:83] offset:12288
    ds_write_b128 v10, v[84:87] offset:13312
    ds_write_b128 v10, v[32:35] offset:14336
    ds_write_b128 v10, v[36:39] offset:15360
    ds_read_b64_tr_b16 v[192:193], v16 offset:0
    ds_read_b64_tr_b16 v[194:195], v16 offset:1024
    ds_read_b64_tr_b16 v[196:197], v16 offset:8192
    ds_read_b64_tr_b16 v[198:199], v16 offset:9216
    ds_read_b64_tr_b16 v[200:201], v17 offset:0
    ds_read_b64_tr_b16 v[202:203], v17 offset:1024
    ds_read_b64_tr_b16 v[204:205], v17 offset:8192
    ds_read_b64_tr_b16 v[206:207], v17 offset:9216
    s_waitcnt vmcnt(12) lgkmcnt(0)
    s_barrier
    s_add_u32 m0, s76, 0
    s_mov_b32 s36, 2621440
    buffer_load_dwordx4 v12, s[12:15], s36 offen nt lds
    s_add_u32 m0, s76, 1024
    s_mov_b32 s36, 2637824
    buffer_load_dwordx4 v12, s[12:15], s36 offen nt lds
    s_add_u32 m0, s76, 2048
    s_mov_b32 s36, 2654208
    buffer_load_dwordx4 v13, s[12:15], s36 offen nt lds
    s_add_u32 m0, s76, 3072
    s_mov_b32 s36, 2670592
    buffer_load_dwordx4 v13, s[12:15], s36 offen nt lds
    ds_read_b64_tr_b16 v[208:209], v16 offset:16384
    ds_read_b64_tr_b16 v[210:211], v16 offset:17408
    ds_read_b64_tr_b16 v[212:213], v16 offset:24576
    ds_read_b64_tr_b16 v[214:215], v16 offset:25600
    ds_read_b64_tr_b16 v[216:217], v17 offset:16384
    ds_read_b64_tr_b16 v[218:219], v17 offset:17408
    ds_read_b64_tr_b16 v[220:221], v17 offset:24576
    ds_read_b64_tr_b16 v[222:223], v17 offset:25600
    s_waitcnt vmcnt(12) lgkmcnt(0)
    s_barrier
    s_add_u32 m0, s76, 16384
    s_mov_b32 s36, 3145728
    buffer_load_dwordx4 v12, s[12:15], s36 offen nt lds
    s_add_u32 m0, s76, 17408
    s_mov_b32 s36, 3162112
    buffer_load_dwordx4 v12, s[12:15], s36 offen nt lds
    s_add_u32 m0, s76, 18432
    s_mov_b32 s36, 3178496
    buffer_load_dwordx4 v13, s[12:15], s36 offen nt lds
    s_add_u32 m0, s76, 19456
    s_mov_b32 s36, 3194880
    buffer_load_dwordx4 v13, s[12:15], s36 offen nt lds
    ds_read_b64_tr_b16 v[224:225], v16 offset:32768
    ds_read_b64_tr_b16 v[226:227], v16 offset:33792
    ds_read_b64_tr_b16 v[228:229], v16 offset:40960
    ds_read_b64_tr_b16 v[230:231], v16 offset:41984
    ds_read_b64_tr_b16 v[232:233], v17 offset:32768
    ds_read_b64_tr_b16 v[234:235], v17 offset:33792
    ds_read_b64_tr_b16 v[236:237], v17 offset:40960
    ds_read_b64_tr_b16 v[238:239], v17 offset:41984
    s_waitcnt vmcnt(12) lgkmcnt(0)
    s_barrier
    s_add_u32 m0, s76, 32768
    s_mov_b32 s36, 3670016
    buffer_load_dwordx4 v12, s[12:15], s36 offen nt lds
    s_add_u32 m0, s76, 33792
    s_mov_b32 s36, 3686400
    buffer_load_dwordx4 v12, s[12:15], s36 offen nt lds
    s_add_u32 m0, s76, 34816
    s_mov_b32 s36, 3702784
    buffer_load_dwordx4 v13, s[12:15], s36 offen nt lds
    s_add_u32 m0, s76, 35840
    s_mov_b32 s36, 3719168
    buffer_load_dwordx4 v13, s[12:15], s36 offen nt lds
    s_lshl_b32 s38, s32, 11
    s_add_u32 s37, s38, s48
    s_add_u32 s39, s37, 524288
    buffer_load_dwordx4 v[80:83], v1, s[4:7], s37 offen offset:0 sc1
    buffer_load_dwordx4 v[80:83], v1, s[4:7], s37 offen offset:1024 sc1
    buffer_load_dwordx4 v[80:83], v1, s[4:7], s39 offen offset:0 sc1
    buffer_load_dwordx4 v[80:83], v1, s[4:7], s39 offen offset:1024 sc1
    s_lshl_b32 s37, s33, 2
    s_add_u32 s37, s37, s32
    s_lshl_b32 s37, s37, 10
    s_add_u32 s37, s37, 11534336
    buffer_load_dwordx4 v[80:83], v1, s[4:7], s37 offen sc1
    ds_read_b64_tr_b16 v[240:241], v18 offset:0
    ds_read_b64_tr_b16 v[242:243], v18 offset:1024
    ds_read_b64_tr_b16 v[244:245], v18 offset:8192
    ds_read_b64_tr_b16 v[246:247], v18 offset:9216
    ds_read_b64_tr_b16 v[248:249], v19 offset:0
    ds_read_b64_tr_b16 v[250:251], v19 offset:1024
    ds_read_b64_tr_b16 v[252:253], v19 offset:8192
    ds_read_b64_tr_b16 v[254:255], v19 offset:9216
    s_waitcnt vmcnt(12) lgkmcnt(0)
    s_barrier
    s_add_u32 m0, s76, 49152
    s_add_u32 s36, s72, 0
    buffer_load_dwordx4 v14, s[24:27], s36 offen nt lds
    s_add_u32 m0, s76, 50176
    s_add_u32 s36, s72, 4096
    buffer_load_dwordx4 v14, s[24:27], s36 offen nt lds
    s_add_u32 m0, s76, 51200
    s_add_u32 s36, s72, 2048
    buffer_load_dwordx4 v15, s[24:27], s36 offen nt lds
    s_add_u32 m0, s76, 52224
    s_add_u32 s36, s72, 6144
    buffer_load_dwordx4 v15, s[24:27], s36 offen nt lds
    ds_read_b64_tr_b16 v[40:41], v18 offset:16384
    ds_read_b64_tr_b16 v[42:43], v18 offset:17408
    ds_read_b64_tr_b16 v[44:45], v18 offset:24576
    ds_read_b64_tr_b16 v[46:47], v18 offset:25600
    ds_read_b64_tr_b16 v[48:49], v19 offset:16384
    ds_read_b64_tr_b16 v[50:51], v19 offset:17408
    ds_read_b64_tr_b16 v[52:53], v19 offset:24576
    ds_read_b64_tr_b16 v[54:55], v19 offset:25600
    s_waitcnt vmcnt(12) lgkmcnt(0)
    s_barrier
    s_add_u32 m0, s76, 65536
    s_add_u32 s36, s72, 65536
    buffer_load_dwordx4 v14, s[24:27], s36 offen nt lds
    s_add_u32 m0, s76, 66560
    s_add_u32 s36, s72, 69632
    buffer_load_dwordx4 v14, s[24:27], s36 offen nt lds
    s_add_u32 m0, s76, 67584
    s_add_u32 s36, s72, 67584
    buffer_load_dwordx4 v15, s[24:27], s36 offen nt lds
    s_add_u32 m0, s76, 68608
    s_add_u32 s36, s72, 71680
    buffer_load_dwordx4 v15, s[24:27], s36 offen nt lds
    v_and_b32 v84, 0xb0, v1
    buffer_load_dword v80, v84, s[4:7], s53 offen sc1
    ds_read_b64_tr_b16 v[112:113], v16 offset:0
    ds_read_b64_tr_b16 v[114:115], v16 offset:1024
    ds_read_b64_tr_b16 v[116:117], v16 offset:8192
    ds_read_b64_tr_b16 v[118:119], v16 offset:9216
    ds_read_b64_tr_b16 v[120:121], v17 offset:0
    ds_read_b64_tr_b16 v[122:123], v17 offset:1024
    ds_read_b64_tr_b16 v[124:125], v17 offset:8192
    ds_read_b64_tr_b16 v[126:127], v17 offset:9216
    s_waitcnt vmcnt(12) lgkmcnt(0)
    s_barrier
    s_add_u32 m0, s76, 0
    s_add_u32 s36, s73, 0
    buffer_load_dwordx4 v14, s[24:27], s36 offen nt lds
    s_add_u32 m0, s76, 1024
    s_add_u32 s36, s73, 4096
    buffer_load_dwordx4 v14, s[24:27], s36 offen nt lds
    s_add_u32 m0, s76, 2048
    s_add_u32 s36, s73, 2048
    buffer_load_dwordx4 v15, s[24:27], s36 offen nt lds
    s_add_u32 m0, s76, 3072
    s_add_u32 s36, s73, 6144
    buffer_load_dwordx4 v15, s[24:27], s36 offen nt lds
    ds_read_b64_tr_b16 v[160:161], v16 offset:16384
    ds_read_b64_tr_b16 v[162:163], v16 offset:17408
    ds_read_b64_tr_b16 v[164:165], v16 offset:24576
    ds_read_b64_tr_b16 v[166:167], v16 offset:25600
    ds_read_b64_tr_b16 v[168:169], v17 offset:16384
    ds_read_b64_tr_b16 v[170:171], v17 offset:17408
    ds_read_b64_tr_b16 v[172:173], v17 offset:24576
    ds_read_b64_tr_b16 v[174:175], v17 offset:25600
    s_waitcnt vmcnt(12) lgkmcnt(0)
    s_barrier
    s_add_u32 m0, s76, 16384
    s_add_u32 s36, s73, 65536
    buffer_load_dwordx4 v14, s[24:27], s36 offen nt lds
    s_add_u32 m0, s76, 17408
    s_add_u32 s36, s73, 69632
    buffer_load_dwordx4 v14, s[24:27], s36 offen nt lds
    s_add_u32 m0, s76, 18432
    s_add_u32 s36, s73, 67584
    buffer_load_dwordx4 v15, s[24:27], s36 offen nt lds
    s_add_u32 m0, s76, 19456
    s_add_u32 s36, s73, 71680
    buffer_load_dwordx4 v15, s[24:27], s36 offen nt lds
    ds_read_b64_tr_b16 v[176:177], v16 offset:32768
    ds_read_b64_tr_b16 v[178:179], v16 offset:33792
    ds_read_b64_tr_b16 v[180:181], v16 offset:40960
    ds_read_b64_tr_b16 v[182:183], v16 offset:41984
    ds_read_b64_tr_b16 v[184:185], v17 offset:32768
    ds_read_b64_tr_b16 v[186:187], v17 offset:33792
    ds_read_b64_tr_b16 v[188:189], v17 offset:40960
    ds_read_b64_tr_b16 v[190:191], v17 offset:41984
    s_waitcnt vmcnt(12) lgkmcnt(0)
    s_barrier
    s_waitcnt vmcnt(8)
    v_cmp_gt_u32 vcc, 1, v80
    s_cbranch_vccz kfok_16
wf_17:
    buffer_load_dword v80, v84, s[4:7], s53 offen sc1
    s_waitcnt vmcnt(0)
    v_cmp_gt_u32 vcc, 1, v80
    s_cbranch_vccz wfd_18
    s_sleep 2
    s_add_u32 s35, s35, 1
    s_cmp_lt_u32 s35, 524288
    s_cbranch_scc1 wf_17
wfd_18:
kfok_16:
    v_add_u32 v0, 65536, v10
    ds_write_b128 v0, v[40:43] offset:0
    ds_write_b128 v0, v[44:47] offset:1024
    ds_write_b128 v0, v[48:51] offset:2048
    ds_write_b128 v0, v[52:55] offset:3072
    ds_write_b128 v0, v[56:59] offset:4096
    ds_write_b128 v0, v[60:63] offset:5120
    ds_write_b128 v0, v[88:91] offset:6144
    ds_write_b128 v0, v[92:95] offset:7168
    ds_write_b128 v0, v[96:99] offset:8192
    ds_write_b128 v0, v[100:103] offset:9216
    ds_write_b128 v0, v[104:107] offset:10240
    ds_write_b128 v0, v[108:111] offset:11264
    ds_write_b128 v0, v[112:115] offset:12288
    ds_write_b128 v0, v[116:119] offset:13312
    ds_write_b128 v0, v[120:123] offset:14336
    ds_write_b128 v0, v[124:127] offset:15360
    ds_read_b64_tr_b16 a[192:193], v22 offset:0
    ds_read_b64_tr_b16 a[194:195], v23 offset:0
    ds_read_b64_tr_b16 a[196:197], v22 offset:4096
    ds_read_b64_tr_b16 a[198:199], v23 offset:4096
    ds_read_b64_tr_b16 a[200:201], v22 offset:8192
    ds_read_b64_tr_b16 a[202:203], v23 offset:8192
    ds_read_b64_tr_b16 a[204:205], v22 offset:12288
    ds_read_b64_tr_b16 a[206:207], v23 offset:12288
    s_waitcnt vmcnt(8) lgkmcnt(0)
    s_barrier
    s_mov_b32 m0, s58
    s_nop 0
    buffer_load_dwordx4 v1, s[4:7], s50 offen sc1 lds
    buffer_load_dwordx4 v1, s[4:7], s50 offen offset:1024 sc1 lds
    ds_read_b64_tr_b16 a[208:209], v22 offset:16384
    ds_read_b64_tr_b16 a[210:211], v23 offset:16384
    ds_read_b64_tr_b16 a[212:213], v22 offset:20480
    ds_read_b64_tr_b16 a[214:215], v23 offset:20480
    ds_read_b64_tr_b16 a[216:217], v22 offset:24576
    ds_read_b64_tr_b16 a[218:219], v23 offset:24576
    ds_read_b64_tr_b16 a[220:221], v22 offset:28672
    ds_read_b64_tr_b16 a[222:223], v23 offset:28672
    s_waitcnt vmcnt(6) lgkmcnt(0)
    s_barrier
    s_mov_b32 m0, s59
    s_add_u32 s36, s50, 8192
    buffer_load_dwordx4 v1, s[4:7], s36 offen sc1 lds
    buffer_load_dwordx4 v1, s[4:7], s36 offen offset:1024 sc1 lds
    ds_read_b64_tr_b16 a[224:225], v20 offset:0
    ds_read_b64_tr_b16 a[226:227], v21 offset:0
    ds_read_b64_tr_b16 a[228:229], v20 offset:4096
    ds_read_b64_tr_b16 a[230:231], v21 offset:4096
    ds_read_b64_tr_b16 a[232:233], v20 offset:8192
    ds_read_b64_tr_b16 a[234:235], v21 offset:8192
    ds_read_b64_tr_b16 a[236:237], v20 offset:12288
    ds_read_b64_tr_b16 a[238:239], v21 offset:12288
    s_waitcnt vmcnt(4) lgkmcnt(0)
    s_barrier
    ds_read_b64_tr_b16 a[240:241], v20 offset:16384
    ds_read_b64_tr_b16 a[242:243], v21 offset:16384
    ds_read_b64_tr_b16 a[244:245], v20 offset:20480
    ds_read_b64_tr_b16 a[246:247], v21 offset:20480
    ds_read_b64_tr_b16 a[248:249], v20 offset:24576
    ds_read_b64_tr_b16 a[250:251], v21 offset:24576
    ds_read_b64_tr_b16 a[252:253], v20 offset:28672
    ds_read_b64_tr_b16 a[254:255], v21 offset:28672
    s_waitcnt lgkmcnt(0)
    s_branch cw_done_3
cw3_7:
    s_waitcnt vmcnt(12) lgkmcnt(0)
    s_barrier
    s_add_u32 m0, s76, 65536
    s_mov_b32 s36, 2097152
    buffer_load_dwordx4 v12, s[16:19], s36 offen nt lds
    s_add_u32 m0, s76, 66560
    s_mov_b32 s36, 2113536
    buffer_load_dwordx4 v12, s[16:19], s36 offen nt lds
    s_add_u32 m0, s76, 67584
    s_mov_b32 s36, 2129920
    buffer_load_dwordx4 v13, s[16:19], s36 offen nt lds
    s_add_u32 m0, s76, 68608
    s_mov_b32 s36, 2146304
    buffer_load_dwordx4 v13, s[16:19], s36 offen nt lds
    ds_read_b64_tr_b16 a[64:65], v16 offset:0
    ds_read_b64_tr_b16 a[66:67], v16 offset:1024
    ds_read_b64_tr_b16 a[68:69], v16 offset:8192
    ds_read_b64_tr_b16 a[70:71], v16 offset:9216
    ds_read_b64_tr_b16 a[72:73], v17 offset:0
    ds_read_b64_tr_b16 a[74:75], v17 offset:1024
    ds_read_b64_tr_b16 a[76:77], v17 offset:8192
    ds_read_b64_tr_b16 a[78:79], v17 offset:9216
    s_waitcnt vmcnt(12) lgkmcnt(0)
    s_barrier
    s_add_u32 m0, s76, 0
    s_mov_b32 s36, 2621440
    buffer_load_dwordx4 v12, s[16:19], s36 offen nt lds
    s_add_u32 m0, s76, 1024
    s_mov_b32 s36, 2637824
    buffer_load_dwordx4 v12, s[16:19], s36 offen nt lds
    s_add_u32 m0, s76, 2048
    s_mov_b32 s36, 2654208
    buffer_load_dwordx4 v13, s[16:19], s36 offen nt lds
    s_add_u32 m0, s76, 3072
    s_mov_b32 s36, 2670592
    buffer_load_dwordx4 v13, s[16:19], s36 offen nt lds
    ds_read_b64_tr_b16 a[80:81], v16 offset:16384
    ds_read_b64_tr_b16 a[82:83], v16 offset:17408
    ds_read_b64_tr_b16 a[84:85], v16 offset:24576
    ds_read_b64_tr_b16 a[86:87], v16 offset:25600
    ds_read_b64_tr_b16 a[88:89], v17 offset:16384
    ds_read_b64_tr_b16 a[90:91], v17 offset:17408
    ds_read_b64_tr_b16 a[92:93], v17 offset:24576
    ds_read_b64_tr_b16 a[94:95], v17 offset:25600
    s_waitcnt vmcnt(12) lgkmcnt(0)
    s_barrier
    s_add_u32 m0, s76, 16384
    s_mov_b32 s36, 3145728
    buffer_load_dwordx4 v12, s[16:19], s36 offen nt lds
    s_add_u32 m0, s76, 17408
    s_mov_b32 s36, 3162112
    buffer_load_dwordx4 v12, s[16:19], s36 offen nt lds
    s_add_u32 m0, s76, 18432
    s_mov_b32 s36, 3178496
    buffer_load_dwordx4 v13, s[16:19], s36 offen nt lds
    s_add_u32 m0, s76, 19456
    s_mov_b32 s36, 3194880
    buffer_load_dwordx4 v13, s[16:19], s36 offen nt lds
    ds_read_b64_tr_b16 a[32:33], v16 offset:32768
    ds_read_b64_tr_b16 a[34:35], v16 offset:33792
    ds_read_b64_tr_b16 a[36:37], v16 offset:40960
    ds_read_b64_tr_b16 a[38:39], v16 offset:41984
    ds_read_b64_tr_b16 a[40:41], v17 offset:32768
    ds_read_b64_tr_b16 a[42:43], v17 offset:33792
    ds_read_b64_tr_b16 a[44:45], v17 offset:40960
    ds_read_b64_tr_b16 a[46:47], v17 offset:41984
    s_waitcnt vmcnt(12) lgkmcnt(0)
    s_barrier
    s_add_u32 m0, s76, 32768
    s_mov_b32 s36, 3670016
    buffer_load_dwordx4 v12, s[16:19], s36 offen nt lds
    s_add_u32 m0, s76, 33792
    s_mov_b32 s36, 3686400
    buffer_load_dwordx4 v12, s[16:19], s36 offen nt lds
    s_add_u32 m0, s76, 34816
    s_mov_b32 s36, 3702784
    buffer_load_dwordx4 v13, s[16:19], s36 offen nt lds
    s_add_u32 m0, s76, 35840
    s_mov_b32 s36, 3719168
    buffer_load_dwordx4 v13, s[16:19], s36 offen nt lds
    ds_read_b64_tr_b16 a[48:49], v18 offset:0
    ds_read_b64_tr_b16 a[50:51], v18 offset:1024
    ds_read_b64_tr_b16 a[52:53], v18 offset:8192
    ds_read_b64_tr_b16 a[54:55], v18 offset:9216
    ds_read_b64_tr_b16 a[56:57], v19 offset:0
    ds_read_b64_tr_b16 a[58:59], v19 offset:1024
    ds_read_b64_tr_b16 a[60:61], v19 offset:8192
    ds_read_b64_tr_b16 a[62:63], v19 offset:9216
    s_waitcnt vmcnt(12) lgkmcnt(0)
    s_barrier
    s_add_u32 m0, s76, 49152
    s_mov_b32 s36, 0
    buffer_load_dwordx4 v12, s[20:23], s36 offen nt lds
    s_add_u32 m0, s76, 50176
    s_mov_b32 s36, 16384
    buffer_load_dwordx4 v12, s[20:23], s36 offen nt lds
    s_add_u32 m0, s76, 51200
    s_mov_b32 s36, 32768
    buffer_load_dwordx4 v13, s[20:23], s36 offen nt lds
    s_add_u32 m0, s76, 52224
    s_mov_b32 s36, 49152
    buffer_load_dwordx4 v13, s[20:23], s36 offen nt lds
    ds_read_b64_tr_b16 a[0:1], v18 offset:16384
    ds_read_b64_tr_b16 a[2:3], v18 offset:17408
    ds_read_b64_tr_b16 a[4:5], v18 offset:24576
    ds_read_b64_tr_b16 a[6:7], v18 offset:25600
    ds_read_b64_tr_b16 a[8:9], v19 offset:16384
    ds_read_b64_tr_b16 a[10:11], v19 offset:17408
    ds_read_b64_tr_b16 a[12:13], v19 offset:24576
    ds_read_b64_tr_b16 a[14:15], v19 offset:25600
    s_waitcnt vmcnt(12) lgkmcnt(0)
    s_barrier
    s_add_u32 m0, s76, 65536
    s_mov_b32 s36, 524288
    buffer_load_dwordx4 v12, s[20:23], s36 offen nt lds
    s_add_u32 m0, s76, 66560
    s_mov_b32 s36, 540672
    buffer_load_dwordx4 v12, s[20:23], s36 offen nt lds
    s_add_u32 m0, s76, 67584
    s_mov_b32 s36, 557056
    buffer_load_dwordx4 v13, s[20:23], s36 offen nt lds
    s_add_u32 m0, s76, 68608
    s_mov_b32 s36, 573440
    buffer_load_dwordx4 v13, s[20:23], s36 offen nt lds
    ds_read_b64_tr_b16 a[16:17], v16 offset:0
    ds_read_b64_tr_b16 a[18:19], v16 offset:1024
    ds_read_b64_tr_b16 a[20:21], v16 offset:8192
    ds_read_b64_tr_b16 a[22:23], v16 offset:9216
    ds_read_b64_tr_b16 a[24:25], v17 offset:0
    ds_read_b64_tr_b16 a[26:27], v17 offset:1024
    ds_read_b64_tr_b16 a[28:29], v17 offset:8192
    ds_read_b64_tr_b16 a[30:31], v17 offset:9216
    s_waitcnt vmcnt(12) lgkmcnt(0)
    s_barrier
    s_add_u32 m0, s76, 0
    s_mov_b32 s36, 1048576
    buffer_load_dwordx4 v12, s[20:23], s36 offen nt lds
    s_add_u32 m0, s76, 1024
    s_mov_b32 s36, 1064960
    buffer_load_dwordx4 v12, s[20:23], s36 offen nt lds
    s_add_u32 m0, s76, 2048
    s_mov_b32 s36, 1081344
    buffer_load_dwordx4 v13, s[20:23], s36 offen nt lds
    s_add_u32 m0, s76, 3072
    s_mov_b32 s36, 1097728
    buffer_load_dwordx4 v13, s[20:23], s36 offen nt lds
    ds_read_b64_tr_b16 v[56:57], v16 offset:16384
    ds_read_b64_tr_b16 v[58:59], v16 offset:17408
    ds_read_b64_tr_b16 v[60:61], v16 offset:24576
    ds_read_b64_tr_b16 v[62:63], v16 offset:25600
    ds_read_b64_tr_b16 v[88:89], v17 offset:16384
    ds_read_b64_tr_b16 v[90:91], v17 offset:17408
    ds_read_b64_tr_b16 v[92:93], v17 offset:24576
    ds_read_b64_tr_b16 v[94:95], v17 offset:25600
    s_waitcnt vmcnt(12) lgkmcnt(0)
    s_barrier
    s_add_u32 m0, s76, 16384
    s_mov_b32 s36, 1572864
    buffer_load_dwordx4 v12, s[20:23], s36 offen nt lds
    s_add_u32 m0, s76, 17408
    s_mov_b32 s36, 1589248
    buffer_load_dwordx4 v12, s[20:23], s36 offen nt lds
    s_add_u32 m0, s76, 18432
    s_mov_b32 s36, 1605632
    buffer_load_dwordx4 v13, s[20:23], s36 offen nt lds
    s_add_u32 m0, s76, 19456
    s_mov_b32 s36, 1622016
    buffer_load_dwordx4 v13, s[20:23], s36 offen nt lds
    ds_read_b64_tr_b16 v[128:129], v16 offset:32768
    ds_read_b64_tr_b16 v[130:131], v16 offset:33792
    ds_read_b64_tr_b16 v[132:133], v16 offset:40960
    ds_read_b64_tr_b16 v[134:135], v16 offset:41984
    ds_read_b64_tr_b16 v[136:137], v17 offset:32768
    ds_read_b64_tr_b16 v[138:139], v17 offset:33792
    ds_read_b64_tr_b16 v[140:141], v17 offset:40960
    ds_read_b64_tr_b16 v[142:143], v17 offset:41984
    s_waitcnt vmcnt(12) lgkmcnt(0)
    s_barrier
    s_add_u32 m0, s76, 32768
    s_mov_b32 s36, 2097152
    buffer_load_dwordx4 v12, s[20:23], s36 offen nt lds
    s_add_u32 m0, s76, 33792
    s_mov_b32 s36, 2113536
    buffer_load_dwordx4 v12, s[20:23], s36 offen nt lds
    s_add_u32 m0, s76, 34816
    s_mov_b32 s36, 2129920
    buffer_load_dwordx4 v13, s[20:23], s36 offen nt lds
    s_add_u32 m0, s76, 35840
    s_mov_b32 s36, 2146304
    buffer_load_dwordx4 v13, s[20:23], s36 offen nt lds
    ds_read_b64_tr_b16 a[160:161], v18 offset:0
    ds_read_b64_tr_b16 a[162:163], v18 offset:1024
    ds_read_b64_tr_b16 a[164:165], v18 offset:8192
    ds_read_b64_tr_b16 a[166:167], v18 offset:9216
    ds_read_b64_tr_b16 a[168:169], v19 offset:0
    ds_read_b64_tr_b16 a[170:171], v19 offset:1024
    ds_read_b64_tr_b16 a[172:173], v19 offset:8192
    ds_read_b64_tr_b16 a[174:175], v19 offset:9216
    s_waitcnt vmcnt(12) lgkmcnt(0)
    s_barrier
    s_add_u32 m0, s76, 49152
    s_mov_b32 s36, 2621440
    buffer_load_dwordx4 v12, s[20:23], s36 offen nt lds
    s_add_u32 m0, s76, 50176
    s_mov_b32 s36, 2637824
    buffer_load_dwordx4 v12, s[20:23], s36 offen nt lds
    s_add_u32 m0, s76, 51200
    s_mov_b32 s36, 2654208
    buffer_load_dwordx4 v13, s[20:23], s36 offen nt lds
    s_add_u32 m0, s76, 52224
    s_mov_b32 s36, 2670592
    buffer_load_dwordx4 v13, s[20:23], s36 offen nt lds
    ds_read_b64_tr_b16 a[176:177], v18 offset:16384
    ds_read_b64_tr_b16 a[178:179], v18 offset:17408
    ds_read_b64_tr_b16 a[180:181], v18 offset:24576
    ds_read_b64_tr_b16 a[182:183], v18 offset:25600
    ds_read_b64_tr_b16 a[184:185], v19 offset:16384
    ds_read_b64_tr_b16 a[186:187], v19 offset:17408
    ds_read_b64_tr_b16 a[188:189], v19 offset:24576
    ds_read_b64_tr_b16 a[190:191], v19 offset:25600
    s_waitcnt vmcnt(12) lgkmcnt(0)
    s_barrier
    s_add_u32 m0, s76, 65536
    s_mov_b32 s36, 3145728
    buffer_load_dwordx4 v12, s[20:23], s36 offen nt lds
    s_add_u32 m0, s76, 66560
    s_mov_b32 s36, 3162112
    buffer_load_dwordx4 v12, s[20:23], s36 offen nt lds
    s_add_u32 m0, s76, 67584
    s_mov_b32 s36, 3178496
    buffer_load_dwordx4 v13, s[20:23], s36 offen nt lds
    s_add_u32 m0, s76, 68608
    s_mov_b32 s36, 3194880
    buffer_load_dwordx4 v13, s[20:23], s36 offen nt lds
    ds_read_b64_tr_b16 a[128:129], v16 offset:0
    ds_read_b64_tr_b16 a[130:131], v16 offset:1024
    ds_read_b64_tr_b16 a[132:133], v16 offset:8192
    ds_read_b64_tr_b16 a[134:135], v16 offset:9216
    ds_read_b64_tr_b16 a[136:137], v17 offset:0
    ds_read_b64_tr_b16 a[138:139], v17 offset:1024
    ds_read_b64_tr_b16 a[140:141], v17 offset:8192
    ds_read_b64_tr_b16 a[142:143], v17 offset:9216
    s_waitcnt vmcnt(12) lgkmcnt(0)
    s_barrier
    s_add_u32 m0, s76, 0
    s_mov_b32 s36, 3670016
    buffer_load_dwordx4 v12, s[20:23], s36 offen nt lds
    s_add_u32 m0, s76, 1024
    s_mov_b32 s36, 3686400
    buffer_load_dwordx4 v12, s[20:23], s36 offen nt lds
    s_add_u32 m0, s76, 2048
    s_mov_b32 s36, 3702784
    buffer_load_dwordx4 v13, s[20:23], s36 offen nt lds
    s_add_u32 m0, s76, 3072
    s_mov_b32 s36, 3719168
    buffer_load_dwordx4 v13, s[20:23], s36 offen nt lds
    v_mbcnt_lo_u32_b32 v81, -1, 0
    v_mbcnt_hi_u32_b32 v81, -1, v81
    v_lshlrev_b32 v81, 5, v81
wt_19:
    buffer_load_dword v80, v81, s[8:11], 0 offen sc1
    s_waitcnt vmcnt(0)
    v_readlane_b32 s36, v80, 0
    v_readlane_b32 s37, v80, 1
    s_nop 0
    s_add_u32 s36, s36, s37
    v_readlane_b32 s37, v80, 2
    s_nop 0
    s_add_u32 s36, s36, s37
    v_readlane_b32 s37, v80, 3
    s_nop 0
    s_add_u32 s36, s36, s37
    v_readlane_b32 s37, v80, 4
    s_nop 0
    s_add_u32 s36, s36, s37
    v_readlane_b32 s37, v80, 5
    s_nop 0
    s_add_u32 s36, s36, s37
    v_readlane_b32 s37, v80, 6
    s_nop 0
    s_add_u32 s36, s36, s37
    v_readlane_b32 s37, v80, 7
    s_nop 0
    s_add_u32 s36, s36, s37
    s_cmp_ge_u32 s36, 256
    s_cbranch_scc1 wtd_20
    s_sleep 2
    s_add_u32 s35, s35, 1
    s_cmp_lt_u32 s35, 524288
    s_cbranch_scc1 wt_19
wtd_20:
    v_readlane_b32 s57, v80, 0
    ds_read_b64_tr_b16 a[144:145], v16 offset:16384
    ds_read_b64_tr_b16 a[146:147], v16 offset:17408
    ds_read_b64_tr_b16 a[148:149], v16 offset:24576
    ds_read_b64_tr_b16 a[150:151], v16 offset:25600
    ds_read_b64_tr_b16 a[152:153], v17 offset:16384
    ds_read_b64_tr_b16 a[154:155], v17 offset:17408
    ds_read_b64_tr_b16 a[156:157], v17 offset:24576
    ds_read_b64_tr_b16 a[158:159], v17 offset:25600
    s_waitcnt vmcnt(12) lgkmcnt(0)
    s_barrier
    s_add_u32 m0, s76, 16384
    s_add_u32 s36, s74, 0
    buffer_load_dwordx4 v14, s[24:27], s36 offen nt lds
    s_add_u32 m0, s76, 17408
    s_add_u32 s36, s74, 4096
    buffer_load_dwordx4 v14, s[24:27], s36 offen nt lds
    s_add_u32 m0, s76, 18432
    s_add_u32 s36, s74, 2048
    buffer_load_dwordx4 v15, s[24:27], s36 offen nt lds
    s_add_u32 m0, s76, 19456
    s_add_u32 s36, s74, 6144
    buffer_load_dwordx4 v15, s[24:27], s36 offen nt lds
    ds_read_b64_tr_b16 a[96:97], v16 offset:32768
    ds_read_b64_tr_b16 a[98:99], v16 offset:33792
    ds_read_b64_tr_b16 a[100:101], v16 offset:40960
    ds_read_b64_tr_b16 a[102:103], v16 offset:41984
    ds_read_b64_tr_b16 a[104:105], v17 offset:32768
    ds_read_b64_tr_b16 a[106:107], v17 offset:33792
    ds_read_b64_tr_b16 a[108:109], v17 offset:40960
    ds_read_b64_tr_b16 a[110:111], v17 offset:41984
    s_waitcnt vmcnt(12) lgkmcnt(0)
    s_barrier
    s_add_u32 m0, s76, 32768
    s_add_u32 s36, s74, 65536
    buffer_load_dwordx4 v14, s[24:27], s36 offen nt lds
    s_add_u32 m0, s76, 33792
    s_add_u32 s36, s74, 69632
    buffer_load_dwordx4 v14, s[24:27], s36 offen nt lds
    s_add_u32 m0, s76, 34816
    s_add_u32 s36, s74, 67584
    buffer_load_dwordx4 v15, s[24:27], s36 offen nt lds
    s_add_u32 m0, s76, 35840
    s_add_u32 s36, s74, 71680
    buffer_load_dwordx4 v15, s[24:27], s36 offen nt lds
    ds_read_b64_tr_b16 a[112:113], v18 offset:0
    ds_read_b64_tr_b16 a[114:115], v18 offset:1024
    ds_read_b64_tr_b16 a[116:117], v18 offset:8192
    ds_read_b64_tr_b16 a[118:119], v18 offset:9216
    ds_read_b64_tr_b16 a[120:121], v19 offset:0
    ds_read_b64_tr_b16 a[122:123], v19 offset:1024
    ds_read_b64_tr_b16 a[124:125], v19 offset:8192
    ds_read_b64_tr_b16 a[126:127], v19 offset:9216
    s_waitcnt vmcnt(12) lgkmcnt(0)
    s_barrier
    s_add_u32 m0, s76, 49152
    s_add_u32 s36, s75, 0
    buffer_load_dwordx4 v14, s[24:27], s36 offen nt lds
    s_add_u32 m0, s76, 50176
    s_add_u32 s36, s75, 4096
    buffer_load_dwordx4 v14, s[24:27], s36 offen nt lds
    s_add_u32 m0, s76, 51200
    s_add_u32 s36, s75, 2048
    buffer_load_dwordx4 v15, s[24:27], s36 offen nt lds
    s_add_u32 m0, s76, 52224
    s_add_u32 s36, s75, 6144
    buffer_load_dwordx4 v15, s[24:27], s36 offen nt lds
    ds_read_b64_tr_b16 v[96:97], v18 offset:16384
    ds_read_b64_tr_b16 v[98:99], v18 offset:17408
    ds_read_b64_tr_b16 v[100:101], v18 offset:24576
    ds_read_b64_tr_b16 v[102:103], v18 offset:25600
    ds_read_b64_tr_b16 v[104:105], v19 offset:16384
    ds_read_b64_tr_b16 v[106:107], v19 offset:17408
    ds_read_b64_tr_b16 v[108:109], v19 offset:24576
    ds_read_b64_tr_b16 v[110:111], v19 offset:25600
    s_waitcnt vmcnt(12) lgkmcnt(0)
    s_barrier
    s_add_u32 m0, s76, 65536
    s_add_u32 s36, s75, 65536
    buffer_load_dwordx4 v14, s[24:27], s36 offen nt lds
    s_add_u32 m0, s76, 66560
    s_add_u32 s36, s75, 69632
    buffer_load_dwordx4 v14, s[24:27], s36 offen nt lds
    s_add_u32 m0, s76, 67584
    s_add_u32 s36, s75, 67584
    buffer_load_dwordx4 v15, s[24:27], s36 offen nt lds
    s_add_u32 m0, s76, 68608
    s_add_u32 s36, s75, 71680
    buffer_load_dwordx4 v15, s[24:27], s36 offen nt lds
    ds_read_b64_tr_b16 v[144:145], v16 offset:0
    ds_read_b64_tr_b16 v[146:147], v16 offset:1024
    ds_read_b64_tr_b16 v[148:149], v16 offset:8192
    ds_read_b64_tr_b16 v[150:151], v16 offset:9216
    ds_read_b64_tr_b16 v[152:153], v17 offset:0
    ds_read_b64_tr_b16 v[154:155], v17 offset:1024
    ds_read_b64_tr_b16 v[156:157], v17 offset:8192
    ds_read_b64_tr_b16 v[158:159], v17 offset:9216
    s_waitcnt vmcnt(12) lgkmcnt(0)
    s_barrier
    s_add_u32 m0, s76, 0
    s_mov_b32 s36, 0
    buffer_load_dwordx4 v12, s[12:15], s36 offen nt lds
    s_add_u32 m0, s76, 1024
    s_mov_b32 s36, 16384
    buffer_load_dwordx4 v12, s[12:15], s36 offen nt lds
    s_add_u32 m0, s76, 2048
    s_mov_b32 s36, 32768
    buffer_load_dwordx4 v13, s[12:15], s36 offen nt lds
    s_add_u32 m0, s76, 3072
    s_mov_b32 s36, 49152
    buffer_load_dwordx4 v13, s[12:15], s36 offen nt lds
    ds_read_b64_tr_b16 v[64:65], v20 offset:16384
    ds_read_b64_tr_b16 v[66:67], v21 offset:16384
    ds_read_b64_tr_b16 v[68:69], v20 offset:20480
    ds_read_b64_tr_b16 v[70:71], v21 offset:20480
    ds_read_b64_tr_b16 v[72:73], v20 offset:24576
    ds_read_b64_tr_b16 v[74:75], v21 offset:24576
    ds_read_b64_tr_b16 v[76:77], v20 offset:28672
    ds_read_b64_tr_b16 v[78:79], v21 offset:28672
    s_waitcnt vmcnt(12) lgkmcnt(0)
    s_barrier
    s_add_u32 m0, s76, 16384
    s_mov_b32 s36, 524288
    buffer_load_dwordx4 v12, s[12:15], s36 offen nt lds
    s_add_u32 m0, s76, 17408
    s_mov_b32 s36, 540672
    buffer_load_dwordx4 v12, s[12:15], s36 offen nt lds
    s_add_u32 m0, s76, 18432
    s_mov_b32 s36, 557056
    buffer_load_dwordx4 v13, s[12:15], s36 offen nt lds
    s_add_u32 m0, s76, 19456
    s_mov_b32 s36, 573440
    buffer_load_dwordx4 v13, s[12:15], s36 offen nt lds
    ds_write_b128 v10, v[64:67] offset:0
    ds_write_b128 v10, v[68:71] offset:1024
    ds_write_b128 v10, v[72:75] offset:2048
    ds_write_b128 v10, v[76:79] offset:3072
    ds_read_b64_tr_b16 v[80:81], v20 offset:32768
    ds_read_b64_tr_b16 v[82:83], v21 offset:32768
    ds_read_b64_tr_b16 v[84:85], v20 offset:36864
    ds_read_b64_tr_b16 v[86:87], v21 offset:36864
    ds_read_b64_tr_b16 v[32:33], v20 offset:40960
    ds_read_b64_tr_b16 v[34:35], v21 offset:40960
    ds_read_b64_tr_b16 v[36:37], v20 offset:45056
    ds_read_b64_tr_b16 v[38:39], v21 offset:45056
    s_waitcnt vmcnt(12) lgkmcnt(0)
    s_barrier
    s_add_u32 m0, s76, 32768
    s_mov_b32 s36, 1048576
    buffer_load_dwordx4 v12, s[12:15], s36 offen nt lds
    s_add_u32 m0, s76, 33792
    s_mov_b32 s36, 1064960
    buffer_load_dwordx4 v12, s[12:15], s36 offen nt lds
    s_add_u32 m0, s76, 34816
    s_mov_b32 s36, 1081344
    buffer_load_dwordx4 v13, s[12:15], s36 offen nt lds
    s_add_u32 m0, s76, 35840
    s_mov_b32 s36, 1097728
    buffer_load_dwordx4 v13, s[12:15], s36 offen nt lds
    ds_write_b128 v10, v[80:83] offset:4096
    ds_write_b128 v10, v[84:87] offset:5120
    ds_write_b128 v10, v[32:35] offset:6144
    ds_write_b128 v10, v[36:39] offset:7168
    ds_read_b64_tr_b16 v[64:65], v22 offset:0
    ds_read_b64_tr_b16 v[66:67], v23 offset:0
    ds_read_b64_tr_b16 v[68:69], v22 offset:4096
    ds_read_b64_tr_b16 v[70:71], v23 offset:4096
    ds_read_b64_tr_b16 v[72:73], v22 offset:8192
    ds_read_b64_tr_b16 v[74:75], v23 offset:8192
    ds_read_b64_tr_b16 v[76:77], v22 offset:12288
    ds_read_b64_tr_b16 v[78:79], v23 offset:12288
    s_waitcnt vmcnt(12) lgkmcnt(0)
    s_barrier
    s_add_u32 m0, s76, 49152
    s_mov_b32 s36, 1572864
    buffer_load_dwordx4 v12, s[12:15], s36 offen nt lds
    s_add_u32 m0, s76, 50176
    s_mov_b32 s36, 1589248
    buffer_load_dwordx4 v12, s[12:15], s36 offen nt lds
    s_add_u32 m0, s76, 51200
    s_mov_b32 s36, 1605632
    buffer_load_dwordx4 v13, s[12:15], s36 offen nt lds
    s_add_u32 m0, s76, 52224
    s_mov_b32 s36, 1622016
    buffer_load_dwordx4 v13, s[12:15], s36 offen nt lds
    ds_write_b128 v10, v[64:67] offset:8192
    ds_write_b128 v10, v[68:71] offset:9216
    ds_write_b128 v10, v[72:75] offset:10240
    ds_write_b128 v10, v[76:79] offset:11264
    ds_read_b64_tr_b16 v[80:81], v22 offset:16384
    ds_read_b64_tr_b16 v[82:83], v23 offset:16384
    ds_read_b64_tr_b16 v[84:85], v22 offset:20480
    ds_read_b64_tr_b16 v[86:87], v23 offset:20480
    ds_read_b64_tr_b16 v[32:33], v22 offset:24576
    ds_read_b64_tr_b16 v[34:35], v23 offset:24576
    ds_read_b64_tr_b16 v[36:37], v22 offset:28672
    ds_read_b64_tr_b16 v[38:39], v23 offset:28672
    s_waitcnt vmcnt(12) lgkmcnt(0)
    s_barrier
    s_add_u32 m0, s76, 65536
    s_mov_b32 s36, 2097152
    buffer_load_dwordx4 v12, s[12:15], s36 offen nt lds
    s_add_u32 m0, s76, 66560
    s_mov_b32 s36, 2113536
    buffer_load_dwordx4 v12, s[12:15], s36 offen nt lds
    s_add_u32 m0, s76, 67584
    s_mov_b32 s36, 2129920
    buffer_load_dwordx4 v13, s[12:15], s36 offen nt lds
    s_add_u32 m0, s76, 68608
    s_mov_b32 s36, 2146304
    buffer_load_dwordx4 v13, s[12:15], s36 offen nt lds
    ds_write_b128 v10, v[80:83] offset:12288
    ds_write_b128 v10, v[84:87] offset:13312
    ds_write_b128 v10, v[32:35] offset:14336
    ds_write_b128 v10, v[36:39] offset:15360
    ds_read_b64_tr_b16 v[224:225], v16 offset:0
    ds_read_b64_tr_b16 v[226:227], v16 offset:1024
    ds_read_b64_tr_b16 v[228:229], v16 offset:8192
    ds_read_b64_tr_b16 v[230:231], v16 offset:9216
    ds_read_b64_tr_b16 v[232:233], v17 offset:0
    ds_read_b64_tr_b16 v[234:235], v17 offset:1024
    ds_read_b64_tr_b16 v[236:237], v17 offset:8192
    ds_read_b64_tr_b16 v[238:239], v17 offset:9216
    s_waitcnt vmcnt(12) lgkmcnt(0)
    s_barrier
    s_add_u32 m0, s76, 0
    s_mov_b32 s36, 2621440
    buffer_load_dwordx4 v12, s[12:15], s36 offen nt lds
    s_add_u32 m0, s76, 1024
    s_mov_b32 s36, 2637824
    buffer_load_dwordx4 v12, s[12:15], s36 offen nt lds
    s_add_u32 m0, s76, 2048
    s_mov_b32 s36, 2654208
    buffer_load_dwordx4 v13, s[12:15], s36 offen nt lds
    s_add_u32 m0, s76, 3072
    s_mov_b32 s36, 2670592
    buffer_load_dwordx4 v13, s[12:15], s36 offen nt lds
    ds_read_b64_tr_b16 v[240:241], v16 offset:16384
    ds_read_b64_tr_b16 v[242:243], v16 offset:17408
    ds_read_b64_tr_b16 v[244:245], v16 offset:24576
    ds_read_b64_tr_b16 v[246:247], v16 offset:25600
    ds_read_b64_tr_b16 v[248:249], v17 offset:16384
    ds_read_b64_tr_b16 v[250:251], v17 offset:17408
    ds_read_b64_tr_b16 v[252:253], v17 offset:24576
    ds_read_b64_tr_b16 v[254:255], v17 offset:25600
    s_waitcnt vmcnt(12) lgkmcnt(0)
    s_barrier
    s_add_u32 m0, s76, 16384
    s_mov_b32 s36, 3145728
    buffer_load_dwordx4 v12, s[12:15], s36 offen nt lds
    s_add_u32 m0, s76, 17408
    s_mov_b32 s36, 3162112
    buffer_load_dwordx4 v12, s[12:15], s36 offen nt lds
    s_add_u32 m0, s76, 18432
    s_mov_b32 s36, 3178496
    buffer_load_dwordx4 v13, s[12:15], s36 offen nt lds
    s_add_u32 m0, s76, 19456
    s_mov_b32 s36, 3194880
    buffer_load_dwordx4 v13, s[12:15], s36 offen nt lds
    ds_read_b64_tr_b16 v[192:193], v16 offset:32768
    ds_read_b64_tr_b16 v[194:195], v16 offset:33792
    ds_read_b64_tr_b16 v[196:197], v16 offset:40960
    ds_read_b64_tr_b16 v[198:199], v16 offset:41984
    ds_read_b64_tr_b16 v[200:201], v17 offset:32768
    ds_read_b64_tr_b16 v[202:203], v17 offset:33792
    ds_read_b64_tr_b16 v[204:205], v17 offset:40960
    ds_read_b64_tr_b16 v[206:207], v17 offset:41984
    s_waitcnt vmcnt(12) lgkmcnt(0)
    s_barrier
    s_add_u32 m0, s76, 32768
    s_mov_b32 s36, 3670016
    buffer_load_dwordx4 v12, s[12:15], s36 offen nt lds
    s_add_u32 m0, s76, 33792
    s_mov_b32 s36, 3686400
    buffer_load_dwordx4 v12, s[12:15], s36 offen nt lds
    s_add_u32 m0, s76, 34816
    s_mov_b32 s36, 3702784
    buffer_load_dwordx4 v13, s[12:15], s36 offen nt lds
    s_add_u32 m0, s76, 35840
    s_mov_b32 s36, 3719168
    buffer_load_dwordx4 v13, s[12:15], s36 offen nt lds
    s_lshl_b32 s38, s32, 11
    s_add_u32 s37, s38, s48
    s_add_u32 s39, s37, 524288
    buffer_load_dwordx4 v[80:83], v1, s[4:7], s37 offen offset:0 sc1
    buffer_load_dwordx4 v[80:83], v1, s[4:7], s37 offen offset:1024 sc1
    buffer_load_dwordx4 v[80:83], v1, s[4:7], s39 offen offset:0 sc1
    buffer_load_dwordx4 v[80:83], v1, s[4:7], s39 offen offset:1024 sc1
    s_lshl_b32 s37, s33, 2
    s_add_u32 s37, s37, s32
    s_lshl_b32 s37, s37, 10
    s_add_u32 s37, s37, 11534336
    buffer_load_dwordx4 v[80:83], v1, s[4:7], s37 offen sc1
    ds_read_b64_tr_b16 v[208:209], v18 offset:0
    ds_read_b64_tr_b16 v[210:211], v18 offset:1024
    ds_read_b64_tr_b16 v[212:213], v18 offset:8192
    ds_read_b64_tr_b16 v[214:215], v18 offset:9216
    ds_read_b64_tr_b16 v[216:217], v19 offset:0
    ds_read_b64_tr_b16 v[218:219], v19 offset:1024
    ds_read_b64_tr_b16 v[220:221], v19 offset:8192
    ds_read_b64_tr_b16 v[222:223], v19 offset:9216
    s_waitcnt vmcnt(12) lgkmcnt(0)
    s_barrier
    s_add_u32 m0, s76, 49152
    s_add_u32 s36, s72, 0
    buffer_load_dwordx4 v14, s[24:27], s36 offen nt lds
    s_add_u32 m0, s76, 50176
    s_add_u32 s36, s72, 4096
    buffer_load_dwordx4 v14, s[24:27], s36 offen nt lds
    s_add_u32 m0, s76, 51200
    s_add_u32 s36, s72, 2048
    buffer_load_dwordx4 v15, s[24:27], s36 offen nt lds
    s_add_u32 m0, s76, 52224
    s_add_u32 s36, s72, 6144
    buffer_load_dwordx4 v15, s[24:27], s36 offen nt lds
    ds_read_b64_tr_b16 v[160:161], v18 offset:16384
    ds_read_b64_tr_b16 v[162:163], v18 offset:17408
    ds_read_b64_tr_b16 v[164:165], v18 offset:24576
    ds_read_b64_tr_b16 v[166:167], v18 offset:25600
    ds_read_b64_tr_b16 v[168:169], v19 offset:16384
    ds_read_b64_tr_b16 v[170:171], v19 offset:17408
    ds_read_b64_tr_b16 v[172:173], v19 offset:24576
    ds_read_b64_tr_b16 v[174:175], v19 offset:25600
    s_waitcnt vmcnt(12) lgkmcnt(0)
    s_barrier
    s_add_u32 m0, s76, 65536
    s_add_u32 s36, s72, 65536
    buffer_load_dwordx4 v14, s[24:27], s36 offen nt lds
    s_add_u32 m0, s76, 66560
    s_add_u32 s36, s72, 69632
    buffer_load_dwordx4 v14, s[24:27], s36 offen nt lds
    s_add_u32 m0, s76, 67584
    s_add_u32 s36, s72, 67584
    buffer_load_dwordx4 v15, s[24:27], s36 offen nt lds
    s_add_u32 m0, s76, 68608
    s_add_u32 s36, s72, 71680
    buffer_load_dwordx4 v15, s[24:27], s36 offen nt lds
    ds_read_b64_tr_b16 v[176:177], v16 offset:0
    ds_read_b64_tr_b16 v[178:179], v16 offset:1024
    ds_read_b64_tr_b16 v[180:181], v16 offset:8192
    ds_read_b64_tr_b16 v[182:183], v16 offset:9216
    ds_read_b64_tr_b16 v[184:185], v17 offset:0
    ds_read_b64_tr_b16 v[186:187], v17 offset:1024
    ds_read_b64_tr_b16 v[188:189], v17 offset:8192
    ds_read_b64_tr_b16 v[190:191], v17 offset:9216
    s_waitcnt vmcnt(12) lgkmcnt(0)
    s_barrier
    s_add_u32 m0, s76, 0
    s_add_u32 s36, s73, 0
    buffer_load_dwordx4 v14, s[24:27], s36 offen nt lds
    s_add_u32 m0, s76, 1024
    s_add_u32 s36, s73, 4096
    buffer_load_dwordx4 v14, s[24:27], s36 offen nt lds
    s_add_u32 m0, s76, 2048
    s_add_u32 s36, s73, 2048
    buffer_load_dwordx4 v15, s[24:27], s36 offen nt lds
    s_add_u32 m0, s76, 3072
    s_add_u32 s36, s73, 6144
    buffer_load_dwordx4 v15, s[24:27], s36 offen nt lds
    ds_read_b64_tr_b16 v[40:41], v16 offset:16384
    ds_read_b64_tr_b16 v[42:43], v16 offset:17408
    ds_read_b64_tr_b16 v[44:45], v16 offset:24576
    ds_read_b64_tr_b16 v[46:47], v16 offset:25600
    ds_read_b64_tr_b16 v[48:49], v17 offset:16384
    ds_read_b64_tr_b16 v[50:51], v17 offset:17408
    ds_read_b64_tr_b16 v[52:53], v17 offset:24576
    ds_read_b64_tr_b16 v[54:55], v17 offset:25600
    s_waitcnt vmcnt(12) lgkmcnt(0)
    s_barrier
    s_add_u32 m0, s76, 16384
    s_add_u32 s36, s73, 65536
    buffer_load_dwordx4 v14, s[24:27], s36 offen nt lds
    s_add_u32 m0, s76, 17408
    s_add_u32 s36, s73, 69632
    buffer_load_dwordx4 v14, s[24:27], s36 offen nt lds
    s_add_u32 m0, s76, 18432
    s_add_u32 s36, s73, 67584
    buffer_load_dwordx4 v15, s[24:27], s36 offen nt lds
    s_add_u32 m0, s76, 19456
    s_add_u32 s36, s73, 71680
    buffer_load_dwordx4 v15, s[24:27], s36 offen nt lds
    v_mov_b32 v0, 1
    s_lshl_b32 s36, s33, 7
    s_add_u32 s36, s36, 11800576
    s_mov_b64 exec, 1
    buffer_store_dword v0, v1, s[4:7], s36 offen sc1
    s_mov_b64 exec, -1
    ds_read_b64_tr_b16 v[112:113], v16 offset:32768
    ds_read_b64_tr_b16 v[114:115], v16 offset:33792
    ds_read_b64_tr_b16 v[116:117], v16 offset:40960
    ds_read_b64_tr_b16 v[118:119], v16 offset:41984
    ds_read_b64_tr_b16 v[120:121], v17 offset:32768
    ds_read_b64_tr_b16 v[122:123], v17 offset:33792
    ds_read_b64_tr_b16 v[124:125], v17 offset:40960
    ds_read_b64_tr_b16 v[126:127], v17 offset:41984
    s_waitcnt vmcnt(12) lgkmcnt(0)
    s_barrier
    ds_read_b64_tr_b16 a[192:193], v22 offset:0
    ds_read_b64_tr_b16 a[194:195], v23 offset:0
    ds_read_b64_tr_b16 a[196:197], v22 offset:4096
    ds_read_b64_tr_b16 a[198:199], v23 offset:4096
    ds_read_b64_tr_b16 a[200:201], v22 offset:8192
    ds_read_b64_tr_b16 a[202:203], v23 offset:8192
    ds_read_b64_tr_b16 a[204:205], v22 offset:12288
    ds_read_b64_tr_b16 a[206:207], v23 offset:12288
    s_waitcnt vmcnt(8) lgkmcnt(0)
    s_barrier
    s_mov_b32 m0, s58
    s_nop 0
    buffer_load_dwordx4 v1, s[4:7], s50 offen sc1 lds
    buffer_load_dwordx4 v1, s[4:7], s50 offen offset:1024 sc1 lds
    v_add_u32 v0, 65536, v10
    ds_write_b128 v0, v[40:43] offset:0
    ds_write_b128 v0, v[44:47] offset:1024
    ds_write_b128 v0, v[48:51] offset:2048
    ds_write_b128 v0, v[52:55] offset:3072
    ds_write_b128 v0, v[56:59] offset:4096
    ds_write_b128 v0, v[60:63] offset:5120
    ds_write_b128 v0, v[88:91] offset:6144
    ds_write_b128 v0, v[92:95] offset:7168
    ds_write_b128 v0, v[96:99] offset:8192
    ds_write_b128 v0, v[100:103] offset:9216
    ds_write_b128 v0, v[104:107] offset:10240
    ds_write_b128 v0, v[108:111] offset:11264
    ds_write_b128 v0, v[112:115] offset:12288
    ds_write_b128 v0, v[116:119] offset:13312
    ds_write_b128 v0, v[120:123] offset:14336
    ds_write_b128 v0, v[124:127] offset:15360
    ds_read_b64_tr_b16 a[208:209], v22 offset:16384
    ds_read_b64_tr_b16 a[210:211], v23 offset:16384
    ds_read_b64_tr_b16 a[212:213], v22 offset:20480
    ds_read_b64_tr_b16 a[214:215], v23 offset:20480
    ds_read_b64_tr_b16 a[216:217], v22 offset:24576
    ds_read_b64_tr_b16 a[218:219], v23 offset:24576
    ds_read_b64_tr_b16 a[220:221], v22 offset:28672
    ds_read_b64_tr_b16 a[222:223], v23 offset:28672
    s_waitcnt vmcnt(6) lgkmcnt(0)
    s_barrier
    s_mov_b32 m0, s59
    s_add_u32 s36, s50, 8192
    buffer_load_dwordx4 v1, s[4:7], s36 offen sc1 lds
    buffer_load_dwordx4 v1, s[4:7], s36 offen offset:1024 sc1 lds
    ds_read_b64_tr_b16 a[224:225], v20 offset:0
    ds_read_b64_tr_b16 a[226:227], v21 offset:0
    ds_read_b64_tr_b16 a[228:229], v20 offset:4096
    ds_read_b64_tr_b16 a[230:231], v21 offset:4096
    ds_read_b64_tr_b16 a[232:233], v20 offset:8192
    ds_read_b64_tr_b16 a[234:235], v21 offset:8192
    ds_read_b64_tr_b16 a[236:237], v20 offset:12288
    ds_read_b64_tr_b16 a[238:239], v21 offset:12288
    s_waitcnt vmcnt(4) lgkmcnt(0)
    s_barrier
    ds_read_b64_tr_b16 a[240:241], v20 offset:16384
    ds_read_b64_tr_b16 a[242:243], v21 offset:16384
    ds_read_b64_tr_b16 a[244:245], v20 offset:20480
    ds_read_b64_tr_b16 a[246:247], v21 offset:20480
    ds_read_b64_tr_b16 a[248:249], v20 offset:24576
    ds_read_b64_tr_b16 a[250:251], v21 offset:24576
    ds_read_b64_tr_b16 a[252:253], v20 offset:28672
    ds_read_b64_tr_b16 a[254:255], v21 offset:28672
    s_waitcnt lgkmcnt(0)
cw_done_3:
    s_barrier
    s_cmp_lg_u32 s32, 1
    s_cbranch_scc1 cw_tw_21
    v_add_u32 v0, 65536, v10
    ds_write_b128 v0, v[40:43] offset:0
    ds_write_b128 v0, v[44:47] offset:1024
    ds_write_b128 v0, v[48:51] offset:2048
    ds_write_b128 v0, v[52:55] offset:3072
    ds_write_b128 v0, v[56:59] offset:4096
    ds_write_b128 v0, v[60:63] offset:5120
    ds_write_b128 v0, v[88:91] offset:6144
    ds_write_b128 v0, v[92:95] offset:7168
    ds_write_b128 v0, v[96:99] offset:8192
    ds_write_b128 v0, v[100:103] offset:9216
    ds_write_b128 v0, v[104:107] offset:10240
    ds_write_b128 v0, v[108:111] offset:11264
    ds_write_b128 v0, v[112:115] offset:12288
    ds_write_b128 v0, v[116:119] offset:13312
    ds_write_b128 v0, v[120:123] offset:14336
    ds_write_b128 v0, v[124:127] offset:15360
cw_tw_21:
    s_cmp_lt_u32 s57, 32
    s_cbranch_scc1 L_chain_slow
    s_mov_b64 s[28:29], s[4:5]
    s_xor_b32 s59, s59, 0x6000
    s_mov_b32 s40, 0
    s_mov_b32 s60, 0
    s_mov_b32 s49, 1
    s_add_u32 s41, s70, 11534336
    s_add_u32 s71, s41, 1024
    s_mul_i32 s36, s32, 6144
    s_add_u32 s36, s36, s50
    s_add_u32 s36, s36, 16384
    s_cmp_eq_u32 s32, 1
    s_cselect_b32 s57, s53, s36
    s_cselect_b32 s63, 0, 32768
    s_add_u32 s24, s4, s53
    s_addc_u32 s25, s5, 0
    s_cmp_eq_u32 s32, 1
    s_cselect_b32 s26, 256, 0
    v_mov_b32 v11, 0
    v_mov_b64 v[64:65], 0
    v_mov_b64 v[66:67], 0
    v_mov_b64 v[68:69], 0
    v_mov_b64 v[70:71], 0
    v_mov_b64 v[72:73], 0
    v_mov_b64 v[74:75], 0
    v_mov_b64 v[76:77], 0
    v_mov_b64 v[78:79], 0
    v_mov_b64 v[80:81], 0
    v_mov_b64 v[82:83], 0
    v_mov_b64 v[84:85], 0
    v_mov_b64 v[86:87], 0
    v_xor_b32 v13, 2048, v3
    v_xor_b32 v14, 4096, v3
    v_xor_b32 v15, 6144, v3
    s_add_u32 s50, s50, 32768
    s_add_u32 s36, s60, 8192
    s_and_b32 s36, s36, 0x7fff
    s_add_u32 s42, s36, 11534336
    s_add_u32 s38, s60, 24576
    s_and_b32 s38, s38, 0x7fff
    s_add_u32 s43, s38, 11534336
    s_mov_b32 s60, s36
    s_mov_b32 s53, s51
    s_add_u32 s51, s51, 4096
    s_mov_b64 s[68:69], -1
    buffer_load_dwordx4 v[32:35], v1, s[4:7], s41 offen sc1
    buffer_load_dwordx4 v[36:39], v1, s[4:7], s71 offen sc1
    buffer_load_dwordx4 v[32:35], v1, s[4:7], s41 offen sc1
    buffer_load_dwordx4 v[36:39], v1, s[4:7], s71 offen sc1
.p2align 6
    s_nop 0
    s_nop 0
c_top_22:
    s_waitcnt vmcnt(2) lgkmcnt(0)
c_c2_30:
    v_max3_u32 v12, v32, v33, v34
    v_max3_u32 v0, v35, v36, v37
    v_max3_u32 v12, v12, v38, v39
    v_max_u32 v12, v12, v0
    v_cmp_eq_u32 vcc, -1, v12
c_p2_23:
    v_smfmac_f32_16x16x64_bf16 v[64:67], v[32:35], v[40:47], v2
    ds_write_b128 v3, v[32:35]
    s_cmp_lg_u64 vcc, 0
    v_smfmac_f32_16x16x64_bf16 v[68:71], v[32:35], v[48:55], v2
    s_cbranch_scc1 c_r2_25
    ds_write_b128 v3, v[36:39] offset:1024
    v_smfmac_f32_16x16x64_bf16 v[72:75], v[32:35], v[56:63], v2
c_go2_24:
    v_mov_b32 v12, -1
    v_smfmac_f32_16x16x64_bf16 v[76:79], v[32:35], v[88:95], v2
    v_mov_b32 v18, 0
    v_smfmac_f32_16x16x64_bf16 v[80:83], v[32:35], v[96:103], v2
    v_xor_b32 v3, 0x6000, v3
    v_smfmac_f32_16x16x64_bf16 v[84:87], v[32:35], v[104:111], v2
    s_cmp_eq_u32 s40, 63
    s_waitcnt lgkmcnt(0)
    s_barrier
    ds_read_b128 v[40:43], v13 offset:0
    v_smfmac_f32_16x16x64_bf16 v[64:67], v[36:39], v[112:119], v2
    s_cbranch_scc1 c_fin_31
    ds_read_b128 v[44:47], v13 offset:1024
    v_smfmac_f32_16x16x64_bf16 v[68:71], v[36:39], v[120:127], v2
    ds_read_b128 v[48:51], v14 offset:0
    v_smfmac_f32_16x16x64_bf16 v[72:75], v[36:39], v[128:135], v2
    ds_read_b128 v[52:55], v14 offset:1024
    v_smfmac_f32_16x16x64_bf16 v[76:79], v[36:39], v[136:143], v2
    ds_read_b128 v[56:59], v15 offset:0
    v_smfmac_f32_16x16x64_bf16 v[80:83], v[36:39], v[144:151], v2
    ds_read_b128 v[60:63], v15 offset:1024
    v_smfmac_f32_16x16x64_bf16 v[84:87], v[36:39], v[152:159], v2
    buffer_load_dword v7, v1, s[24:27], 0 offen sc1
    s_waitcnt lgkmcnt(4)
    v_smfmac_f32_16x16x64_bf16 v[64:67], v[40:43], v[160:167], v2
    ds_read_b128 v[88:91], v1 offset:0
    v_smfmac_f32_16x16x64_bf16 v[68:71], v[40:43], v[168:175], v2
    ds_read_b128 v[92:95], v1 offset:4096
    v_smfmac_f32_16x16x64_bf16 v[64:67], v[44:47], v[176:183], v2
    buffer_store_dwordx4 v[20:23], v1, s[4:7], s51 offen sc1
    v_smfmac_f32_16x16x64_bf16 v[68:71], v[44:47], v[184:191], v2
    ds_read_b128 v[96:99], v1 offset:1024
    s_waitcnt lgkmcnt(3)
    v_smfmac_f32_16x16x64_bf16 v[64:67], v[48:51], v[192:199], v2
    ds_read_b128 v[100:103], v1 offset:5120
    v_smfmac_f32_16x16x64_bf16 v[68:71], v[48:51], v[200:207], v2
    s_mov_b32 s51, s53
    s_add_u32 s53, s53, 32768
    v_smfmac_f32_16x16x64_bf16 v[64:67], v[52:55], v[208:215], v2
    ds_read_b128 v[104:107], v1 offset:2048
    v_smfmac_f32_16x16x64_bf16 v[68:71], v[52:55], v[216:223], v2
    ds_read_b128 v[108:111], v1 offset:6144
    v_smfmac_f32_16x16x64_bf16 v[64:67], v[56:59], v[224:231], v2
    buffer_store_dword v12, v9, s[4:7], s43 offen
    v_smfmac_f32_16x16x64_bf16 v[64:67], v[60:63], v[240:247], v2
    ds_read_b128 v[112:115], v1 offset:3072
    v_smfmac_f32_16x16x64_bf16 v[68:71], v[56:59], v[232:239], v2
    ds_read_b128 v[116:119], v1 offset:7168
    v_smfmac_f32_16x16x64_bf16 v[68:71], v[60:63], v[248:255], v2
    s_add_u32 s41, s70, s42
    s_add_u32 s71, s41, 1024
    v_add_f32 v64, v64, v66
    v_smfmac_f32_16x16x64_bf16 v[72:75], v[40:43], a[0:7], v2
    v_add_f32 v65, v65, v67
    v_smfmac_f32_16x16x64_bf16 v[76:79], v[40:43], a[8:15], v2
    v_add_f32 v68, v68, v70
    v_smfmac_f32_16x16x64_bf16 v[72:75], v[44:47], a[16:23], v2
    v_cvt_pk_bf16_f32 v66, v64, v68
    v_smfmac_f32_16x16x64_bf16 v[76:79], v[44:47], a[24:31], v2
    ds_write_b32 v4, v66 offset:0
    v_add_f32 v69, v69, v71
    v_smfmac_f32_16x16x64_bf16 v[72:75], v[48:51], a[32:39], v2
    v_cvt_pk_bf16_f32 v67, v65, v69
    v_smfmac_f32_16x16x64_bf16 v[76:79], v[48:51], a[40:47], v2
    ds_write_b32 v4, v67 offset:288
    v_smfmac_f32_16x16x64_bf16 v[72:75], v[52:55], a[48:55], v2
    s_add_u32 s37, s48, 4096
    s_add_u32 s39, s50, 8192
    v_smfmac_f32_16x16x64_bf16 v[76:79], v[52:55], a[56:63], v2
    s_mov_b32 m0, s58
    v_smfmac_f32_16x16x64_bf16 v[72:75], v[56:59], a[64:71], v2
    v_smfmac_f32_16x16x64_bf16 v[72:75], v[60:63], a[80:87], v2
    s_waitcnt vmcnt(3) lgkmcnt(0)
    s_barrier
    v_smfmac_f32_16x16x64_bf16 v[76:79], v[56:59], a[72:79], v2
    ds_read_b128 v[120:123], v5 offset:0
    buffer_load_dwordx4 v1, s[4:7], s50 offen offset:0 sc1 lds
    v_smfmac_f32_16x16x64_bf16 v[76:79], v[60:63], a[88:95], v2
    ds_read_b128 v[124:127], v5 offset:64
    v_add_f32 v72, v72, v74
    v_smfmac_f32_16x16x64_bf16 v[80:83], v[40:43], a[96:103], v2
    ds_read_b128 v[32:35], v5 offset:128
    v_add_f32 v73, v73, v75
    v_smfmac_f32_16x16x64_bf16 v[84:87], v[40:43], a[104:111], v2
    ds_read_b128 v[36:39], v5 offset:192
    buffer_load_dwordx4 v1, s[4:7], s50 offen offset:1024 sc1 lds
    v_add_f32 v76, v76, v78
    v_add_f32 v77, v77, v79
    v_cvt_pk_bf16_f32 v20, v72, v76
    v_cvt_pk_bf16_f32 v21, v73, v77
    v_smfmac_f32_16x16x64_bf16 v[80:83], v[44:47], a[112:119], v2
    ds_write_b32 v4, v20 offset:2304
    ds_write_b32 v4, v21 offset:2592
    v_smfmac_f32_16x16x64_bf16 v[84:87], v[44:47], a[120:127], v2
    s_waitcnt lgkmcnt(2)
    s_mov_b32 m0, s59
    v_mfma_f32_16x16x32_bf16 v[64:67], v[88:91], v[120:123], 0
    v_mov_b64 v[40:41], 0
    v_mov_b64 v[42:43], 0
    v_mfma_f32_16x16x32_bf16 v[68:71], v[92:95], v[120:123], 0
    buffer_load_dwordx4 v1, s[4:7], s39 offen offset:0 sc1 lds
    v_mov_b64 v[44:45], 0
    v_mfma_f32_16x16x32_bf16 v[64:67], v[96:99], v[124:127], v[64:67]
    v_mov_b64 v[46:47], 0
    v_mfma_f32_16x16x32_bf16 v[68:71], v[100:103], v[124:127], v[68:71]
    s_waitcnt lgkmcnt(0)
    s_barrier
    ds_read_b128 v[88:91], v6 offset:0
    v_mfma_f32_16x16x32_bf16 v[64:67], v[104:107], v[32:35], v[64:67]
    ds_read_b128 v[92:95], v6 offset:64
    v_mfma_f32_16x16x32_bf16 v[68:71], v[108:111], v[32:35], v[68:71]
    buffer_load_dwordx4 v1, s[4:7], s39 offen offset:1024 sc1 lds
    ds_read_b128 v[96:99], v6 offset:128
    v_mfma_f32_16x16x32_bf16 v[64:67], v[112:115], v[36:39], v[64:67]
    ds_read_b128 v[100:103], v6 offset:192
    v_mfma_f32_16x16x32_bf16 v[68:71], v[116:119], v[36:39], v[68:71]
    ds_read_b64 v[106:107], v3 offset:0
    ds_read_b64 v[110:111], v3 offset:8
    v_smfmac_f32_16x16x64_bf16 v[80:83], v[48:51], a[128:135], v2
    ds_read_b64 v[114:115], v3 offset:1024
    ds_read_b64 v[118:119], v3 offset:1032
    v_max3_f32 v12, v64, v65, v66
    v_smfmac_f32_16x16x64_bf16 v[84:87], v[48:51], a[136:143], v2
    s_waitcnt lgkmcnt(4)
    v_max3_f32 v13, v68, v69, v70
    v_mfma_f32_16x16x32_bf16 v[72:75], v[88:91], v[120:123], 0
    v_max3_f32 v12, v12, v67, v71
    v_max_f32 v12, v12, v13
    v_mfma_f32_16x16x32_bf16 v[72:75], v[92:95], v[124:127], v[72:75]
    v_mov_b32 v13, v12
    v_cndmask_b32 v76, v64, v68, s[54:55]
    v_mfma_f32_16x16x32_bf16 v[72:75], v[96:99], v[32:35], v[72:75]
    v_cndmask_b32 v77, v65, v69, s[54:55]
    v_permlane32_swap_b32 v12, v13
    v_mfma_f32_16x16x32_bf16 v[72:75], v[100:103], v[36:39], v[72:75]
    v_cndmask_b32 v78, v66, v70, s[54:55]
    v_cndmask_b32 v79, v67, v71, s[54:55]
    v_smfmac_f32_16x16x64_bf16 v[80:83], v[52:55], a[144:151], v2
    ds_read_b128 v[88:91], v10 offset:0
    v_mov_b64 v[64:65], 0
    v_smfmac_f32_16x16x64_bf16 v[84:87], v[52:55], a[152:159], v2
    ds_read_b128 v[92:95], v10 offset:1024
    v_mov_b64 v[66:67], 0
    v_max3_f32 v12, v12, v13, v75
    v_max3_f32 v13, v72, v73, v74
    v_max_f32 v12, v12, v13
    v_mov_b32 v13, v12
    v_smfmac_f32_16x16x64_bf16 v[80:83], v[56:59], a[160:167], v2
    ds_read_b128 v[96:99], v10 offset:2048
    v_permlane16_swap_b32 v12, v13
    v_smfmac_f32_16x16x64_bf16 v[80:83], v[60:63], a[176:183], v2
    ds_read_b128 v[100:103], v10 offset:3072
    v_max_f32 v12, v12, v13
    v_smfmac_f32_16x16x64_bf16 v[84:87], v[56:59], a[168:175], v2
    ds_read_b128 v[120:123], v10 offset:4096
    v_mul_f32 v14, s52, v12
    v_smfmac_f32_16x16x64_bf16 v[84:87], v[60:63], a[184:191], v2
    s_waitcnt lgkmcnt(5)
    v_fma_f32 v15, v12, s52, 1.0
    v_fma_f32 v76, v76, s52, -v14
    v_fma_f32 v77, v77, s52, -v14
    v_fma_f32 v78, v78, s52, -v14
    v_fma_f32 v79, v79, s52, -v14
    v_fma_f32 v72, v72, s52, -v15
    v_fma_f32 v73, v73, s52, -v15
    v_add_f32 v80, v80, v82
    v_add_f32 v81, v81, v83
    v_add_f32 v84, v84, v86
    v_add_f32 v85, v85, v87
    v_cvt_pk_bf16_f32 v104, v80, v81
    v_cvt_pk_bf16_f32 v112, v84, v85
    v_exp_f32 v76, v76
    v_exp_f32 v77, v77
    v_exp_f32 v78, v78
    v_exp_f32 v79, v79
    v_exp_f32 v72, v72
    v_exp_f32 v73, v73
    v_cvt_pk_bf16_f32 v17, v76, v77
    v_cvt_pk_bf16_f32 v19, v78, v79
    v_cvt_pk_bf16_f32 v16, v72, v73
    v_permlane16_swap_b32 v104, v108
    v_permlane16_swap_b32 v112, v116
    v_smfmac_f32_16x16x64_bf16 v[64:67], v[16:19], v[24:31], v2 abid:1
    ds_read_b128 v[124:127], v10 offset:5120
    v_smfmac_f32_16x16x64_bf16 v[40:43], v[16:19], v[104:111], v2 abid:1
    ds_read_b128 v[32:35], v10 offset:6144
    v_smfmac_f32_16x16x64_bf16 v[44:47], v[16:19], v[112:119], v2 abid:1
    ds_read_b128 v[36:39], v10 offset:7168
    v_add_f32 v64, v64, v66
    v_add_f32 v65, v65, v67
    v_rcp_f32 v64, v64
    v_rcp_f32 v65, v65
    v_add_f32 v40, v40, v42
    v_add_f32 v44, v44, v46
    v_mul_f32 v40, v40, v64
    v_mul_f32 v44, v44, v64
    v_cvt_pk_bf16_f32 v42, v40, v44
    ds_write_b32 v4, v42 offset:4608
    v_add_f32 v41, v41, v43
    v_add_f32 v45, v45, v47
    v_mul_f32 v41, v41, v65
    v_mul_f32 v45, v45, v65
    v_cvt_pk_bf16_f32 v43, v41, v45
    ds_write_b32 v4, v43 offset:4896
    v_cvt_pk_bf16_f32 v22, v80, v81
    v_cvt_pk_bf16_f32 v23, v84, v85
    v_mov_b64 v[72:73], 0
    v_mov_b64 v[74:75], 0
    v_mov_b64 v[76:77], 0
    v_mov_b64 v[78:79], 0
    v_mov_b64 v[64:65], 0
    v_mov_b64 v[66:67], 0
    v_mov_b64 v[68:69], 0
    v_mov_b64 v[70:71], 0
    s_waitcnt lgkmcnt(0)
    s_barrier
    ds_read_b128 v[16:19], v5 offset:4608
    v_min_u32 v20, 0xfffffffe, v20
    v_add_u32 v0, 65536, v10
    s_nop 0
    ds_read_b128 v[12:15], v5 offset:4672
    v_min_u32 v21, 0xfffffffe, v21
    s_cmp_lg_u32 s32, 0
    s_nop 0
    ds_read_b128 v[80:83], v5 offset:4736
    v_min_u32 v22, 0xfffffffe, v22
    s_nop 0
    ds_read_b128 v[84:87], v5 offset:4800
    v_min_u32 v23, 0xfffffffe, v23
    s_waitcnt lgkmcnt(3)
    v_smfmac_f32_16x16x64_bf16 v[72:75], v[16:19], a[192:199], v2
    s_waitcnt lgkmcnt(2)
    v_smfmac_f32_16x16x64_bf16 v[72:75], v[12:15], a[200:207], v2
    ds_read_b128 v[48:51], v10 offset:8192
    s_waitcnt lgkmcnt(2)
    v_smfmac_f32_16x16x64_bf16 v[72:75], v[80:83], a[208:215], v2
    ds_read_b128 v[52:55], v10 offset:9216
    s_waitcnt lgkmcnt(2)
    v_smfmac_f32_16x16x64_bf16 v[72:75], v[84:87], a[216:223], v2
    ds_read_b128 v[56:59], v10 offset:10240
    v_smfmac_f32_16x16x64_bf16 v[76:79], v[16:19], a[224:231], v2
    ds_read_b128 v[60:63], v10 offset:11264
    v_smfmac_f32_16x16x64_bf16 v[76:79], v[12:15], a[232:239], v2
    ds_read_b128 v[104:107], v10 offset:12288
    v_cvt_pk_bf16_f32 v72, v72, v73
    v_smfmac_f32_16x16x64_bf16 v[76:79], v[80:83], a[240:247], v2
    ds_read_b128 v[108:111], v10 offset:13312
    v_cvt_pk_bf16_f32 v73, v74, v75
    v_smfmac_f32_16x16x64_bf16 v[76:79], v[84:87], a[248:255], v2
    ds_read_b128 v[112:115], v10 offset:14336
    v_and_or_b32 v72, v72, -2, s49
    v_smfmac_f32_16x16x64_bf16 v[64:67], v[16:19], v[88:95], v2
    buffer_store_dwordx2 v[72:73], v8, s[4:7], s44 offen
    v_smfmac_f32_16x16x64_bf16 v[64:67], v[12:15], v[96:103], v2
    ds_read_b128 v[116:119], v10 offset:15360
    v_cvt_pk_bf16_f32 v76, v76, v77
    v_smfmac_f32_16x16x64_bf16 v[64:67], v[80:83], v[120:127], v2
    v_cvt_pk_bf16_f32 v77, v78, v79
    v_smfmac_f32_16x16x64_bf16 v[64:67], v[84:87], v[32:39], v2
    v_and_or_b32 v76, v76, -2, s49
    s_waitcnt lgkmcnt(0)
    v_smfmac_f32_16x16x64_bf16 v[68:71], v[16:19], v[48:55], v2
    buffer_store_dwordx2 v[76:77], v8, s[4:7], s45 offen
    v_smfmac_f32_16x16x64_bf16 v[68:71], v[12:15], v[56:63], v2
    v_cvt_pk_bf16_f32 v64, v64, v65
    v_smfmac_f32_16x16x64_bf16 v[68:71], v[80:83], v[104:111], v2
    v_cvt_pk_bf16_f32 v65, v66, v67
    v_smfmac_f32_16x16x64_bf16 v[68:71], v[84:87], v[112:119], v2
    v_and_or_b32 v64, v64, -2, s49
    buffer_store_dwordx2 v[64:65], v8, s[4:7], s46 offen
    s_nop 3
    v_cvt_pk_bf16_f32 v68, v68, v69
    v_and_or_b32 v68, v68, -2, s49
    v_cvt_pk_bf16_f32 v69, v70, v71
    buffer_store_dwordx2 v[68:69], v8, s[4:7], s47 offen
    s_cbranch_scc1 c_oth_27
    ds_read_b128 v[40:43], v0 offset:0
    ds_read_b128 v[44:47], v0 offset:1024
    ds_read_b128 v[48:51], v0 offset:2048
    ds_read_b128 v[52:55], v0 offset:3072
    ds_read_b128 v[56:59], v0 offset:4096
    ds_read_b128 v[60:63], v0 offset:5120
    ds_read_b128 v[88:91], v0 offset:6144
    ds_read_b128 v[92:95], v0 offset:7168
    v_cndmask_b32 v16, v25, 0, s[64:65]
    v_cndmask_b32 v17, 0, v25, s[64:65]
    v_mov_b64 v[18:19], v[16:17]
    v_mov_b64 v[12:13], 0
    s_xor_b32 s44, s44, 524288
    s_xor_b32 s45, s45, 524288
    s_xor_b32 s46, s46, 524288
    s_xor_b32 s47, s47, 524288
    s_add_u32 s50, s50, 32768
    s_xor_b32 s59, s59, 0x6000
    s_add_u32 s57, s57, s63
    s_add_u32 s38, s60, 24576
    s_and_b32 s38, s38, 0x7fff
    s_add_u32 s43, s38, 11534336
    s_add_u32 s36, s60, 8192
    s_and_b32 s60, s36, 0x7fff
    s_and_b32 s56, s40, 1
    s_add_u32 s40, s40, 1
    s_nop 3
    s_nop 3
    s_nop 3
    s_nop 3
    s_nop 3
    s_nop 3
    s_nop 3
    buffer_load_dwordx4 v[72:75], v1, s[4:7], s48 offen offset:0 sc1
    buffer_load_dwordx4 v[76:79], v1, s[4:7], s48 offen offset:1024 sc1
    buffer_load_dwordx4 v[80:83], v1, s[4:7], s48 offen offset:2048 sc1
    buffer_load_dwordx4 v[84:87], v1, s[4:7], s48 offen offset:3072 sc1
    buffer_load_dwordx4 v[32:35], v1, s[4:7], s37 offen offset:0 sc1
    buffer_load_dwordx4 v[36:39], v1, s[4:7], s37 offen offset:1024 sc1
    s_nop 3
    s_nop 3
    buffer_load_dwordx4 v[64:67], v1, s[4:7], s37 offen offset:2048 sc1
    buffer_load_dwordx4 v[68:71], v1, s[4:7], s37 offen offset:3072 sc1
    s_nop 3
    s_nop 3
    s_nop 3
    s_nop 3
    s_nop 3
    buffer_load_dwordx4 v[96:99], v1, s[4:7], s48 offen offset:0 sc1
    buffer_load_dwordx4 v[100:103], v1, s[4:7], s48 offen offset:1024 sc1
    buffer_load_dwordx4 v[104:107], v1, s[4:7], s48 offen offset:2048 sc1
    buffer_load_dwordx4 v[108:111], v1, s[4:7], s48 offen offset:3072 sc1
    buffer_load_dwordx4 v[112:115], v1, s[4:7], s37 offen offset:0 sc1
    buffer_load_dwordx4 v[116:119], v1, s[4:7], s37 offen offset:1024 sc1
    buffer_load_dwordx4 v[120:123], v1, s[4:7], s37 offen offset:2048 sc1
    buffer_load_dwordx4 v[124:127], v1, s[4:7], s37 offen offset:3072 sc1
    s_waitcnt vmcnt(15)
    v_bitop3_b32 v11, v72, v74, s49 bitop3:0x7e
    s_waitcnt vmcnt(14)
    v_smfmac_f32_16x16x64_bf16 v[12:15], v[16:19], v[72:79], v29
    v_bitop3_b32 v11, v11, v76, s49 bitop3:0xf6
    v_bitop3_b32 v11, v11, v78, s49 bitop3:0xf6
    s_waitcnt vmcnt(13)
    v_bitop3_b32 v11, v11, v80, s49 bitop3:0xf6
    v_bitop3_b32 v11, v11, v82, s49 bitop3:0xf6
    s_waitcnt vmcnt(12)
    v_smfmac_f32_16x16x64_bf16 v[12:15], v[16:19], v[80:87], v29
    v_bitop3_b32 v11, v11, v84, s49 bitop3:0xf6
    v_bitop3_b32 v11, v11, v86, s49 bitop3:0xf6
    s_waitcnt vmcnt(11)
    v_bitop3_b32 v11, v11, v32, s49 bitop3:0xf6
    v_bitop3_b32 v11, v11, v34, s49 bitop3:0xf6
    s_waitcnt vmcnt(10)
    v_smfmac_f32_16x16x64_bf16 v[12:15], v[16:19], v[32:39], v29
    v_bitop3_b32 v11, v11, v36, s49 bitop3:0xf6
    v_bitop3_b32 v11, v11, v38, s49 bitop3:0xf6
    s_waitcnt vmcnt(9)
    v_bitop3_b32 v11, v11, v64, s49 bitop3:0xf6
    v_bitop3_b32 v11, v11, v66, s49 bitop3:0xf6
    s_waitcnt vmcnt(8)
    v_smfmac_f32_16x16x64_bf16 v[12:15], v[16:19], v[64:71], v29
    v_bitop3_b32 v11, v11, v68, s49 bitop3:0xf6
    v_bitop3_b32 v11, v11, v70, s49 bitop3:0xf6
    v_and_b32 v11, 1, v11
    v_cmp_ne_u32 vcc, 0, v11
    s_nop 1
    v_cvt_pk_bf16_f32 v14, v12, v13
    v_min_u32 v14, 0xfffffffe, v14
    s_cmp_eq_u64 vcc, 0
    s_cselect_b32 s30, 0x10000000, 0
    buffer_store_dword v14, v9, s[28:31], s42 offen
    s_cbranch_scc0 c_fa_33
    v_mov_b64 v[64:65], 0
    v_mov_b64 v[66:67], 0
    v_mov_b64 v[68:69], 0
    v_mov_b64 v[70:71], 0
    v_mov_b64 v[72:73], 0
    v_mov_b64 v[74:75], 0
    v_mov_b64 v[76:77], 0
    v_mov_b64 v[78:79], 0
    v_mov_b64 v[80:81], 0
    v_mov_b64 v[82:83], 0
    v_mov_b64 v[84:85], 0
    v_mov_b64 v[86:87], 0
    s_nop 3
    s_nop 3
    s_nop 3
    s_nop 3
    s_barrier
    buffer_load_dwordx4 v[32:35], v1, s[4:7], s41 offen sc1
    buffer_load_dwordx4 v[36:39], v1, s[4:7], s71 offen sc1
c_pub_36:
    v_xor_b32 v13, 2048, v3
    v_xor_b32 v14, 4096, v3
    v_xor_b32 v15, 6144, v3
    s_xor_b32 s48, s48, 524288
    s_xor_b32 s49, s49, s56
    s_add_u32 s42, s60, 11534336
    s_waitcnt vmcnt(3)
    ds_read_b128 v[96:99], v0 offset:8192
    ds_read_b128 v[100:103], v0 offset:9216
    ds_read_b128 v[104:107], v0 offset:10240
    ds_read_b128 v[108:111], v0 offset:11264
    ds_read_b128 v[112:115], v0 offset:12288
    ds_read_b128 v[116:119], v0 offset:13312
    ds_read_b128 v[120:123], v0 offset:14336
    ds_read_b128 v[124:127], v0 offset:15360
    s_nop 3
    s_nop 3
    s_nop 3
    s_nop 3
    s_nop 3
    buffer_load_dwordx4 v[32:35], v1, s[4:7], s41 offen sc1
    buffer_load_dwordx4 v[36:39], v1, s[4:7], s71 offen sc1
    s_branch c_top_22
c_fin_31:
    buffer_store_dwordx4 v[20:23], v1, s[4:7], s51 offen sc1
    ds_read_b128 v[40:43], v13 offset:0
    ds_read_b128 v[44:47], v13 offset:1024
    ds_read_b128 v[48:51], v14 offset:0
    ds_read_b128 v[52:55], v14 offset:1024
    ds_read_b128 v[56:59], v15 offset:0
    ds_read_b128 v[60:63], v15 offset:1024
    s_mov_b32 s51, s53
    v_smfmac_f32_16x16x64_bf16 v[72:75], v[36:39], v[128:135], v2
    v_smfmac_f32_16x16x64_bf16 v[76:79], v[36:39], v[136:143], v2
    v_smfmac_f32_16x16x64_bf16 v[80:83], v[36:39], v[144:151], v2
    v_smfmac_f32_16x16x64_bf16 v[84:87], v[36:39], v[152:159], v2
    s_waitcnt lgkmcnt(5)
    v_smfmac_f32_16x16x64_bf16 v[72:75], v[40:43], a[0:7], v2
    v_smfmac_f32_16x16x64_bf16 v[76:79], v[40:43], a[8:15], v2
    v_smfmac_f32_16x16x64_bf16 v[80:83], v[40:43], a[96:103], v2
    v_smfmac_f32_16x16x64_bf16 v[84:87], v[40:43], a[104:111], v2
    s_waitcnt lgkmcnt(4)
    v_smfmac_f32_16x16x64_bf16 v[72:75], v[44:47], a[16:23], v2
    v_smfmac_f32_16x16x64_bf16 v[76:79], v[44:47], a[24:31], v2
    v_smfmac_f32_16x16x64_bf16 v[80:83], v[44:47], a[112:119], v2
    v_smfmac_f32_16x16x64_bf16 v[84:87], v[44:47], a[120:127], v2
    s_waitcnt lgkmcnt(3)
    v_smfmac_f32_16x16x64_bf16 v[72:75], v[48:51], a[32:39], v2
    v_smfmac_f32_16x16x64_bf16 v[76:79], v[48:51], a[40:47], v2
    v_smfmac_f32_16x16x64_bf16 v[80:83], v[48:51], a[128:135], v2
    v_smfmac_f32_16x16x64_bf16 v[84:87], v[48:51], a[136:143], v2
    s_waitcnt lgkmcnt(2)
    v_smfmac_f32_16x16x64_bf16 v[72:75], v[52:55], a[48:55], v2
    v_smfmac_f32_16x16x64_bf16 v[76:79], v[52:55], a[56:63], v2
    v_smfmac_f32_16x16x64_bf16 v[80:83], v[52:55], a[144:151], v2
    v_smfmac_f32_16x16x64_bf16 v[84:87], v[52:55], a[152:159], v2
    s_waitcnt lgkmcnt(1)
    v_smfmac_f32_16x16x64_bf16 v[72:75], v[56:59], a[64:71], v2
    v_smfmac_f32_16x16x64_bf16 v[76:79], v[56:59], a[72:79], v2
    v_smfmac_f32_16x16x64_bf16 v[80:83], v[56:59], a[160:167], v2
    v_smfmac_f32_16x16x64_bf16 v[84:87], v[56:59], a[168:175], v2
    s_waitcnt lgkmcnt(0)
    v_smfmac_f32_16x16x64_bf16 v[72:75], v[60:63], a[80:87], v2
    v_smfmac_f32_16x16x64_bf16 v[76:79], v[60:63], a[88:95], v2
    v_smfmac_f32_16x16x64_bf16 v[80:83], v[60:63], a[176:183], v2
    v_smfmac_f32_16x16x64_bf16 v[84:87], v[60:63], a[184:191], v2
    v_add_f32 v72, v72, v74
    v_add_f32 v73, v73, v75
    v_add_f32 v76, v76, v78
    v_add_f32 v77, v77, v79
    v_add_f32 v80, v80, v82
    v_add_f32 v81, v81, v83
    v_add_f32 v84, v84, v86
    v_add_f32 v85, v85, v87
    v_cvt_pk_bf16_f32 v20, v72, v76
    v_cvt_pk_bf16_f32 v21, v73, v77
    v_cvt_pk_bf16_f32 v22, v80, v81
    v_cvt_pk_bf16_f32 v23, v84, v85
c_last_28:
    v_min_u32 v20, 0xfffffffe, v20
    v_min_u32 v21, 0xfffffffe, v21
    v_min_u32 v22, 0xfffffffe, v22
    v_min_u32 v23, 0xfffffffe, v23
    buffer_store_dwordx4 v[20:23], v1, s[4:7], s51 offen sc1
    s_branch L_exit
c_f0_32:
    buffer_load_dwordx4 v[96:99], v1, s[4:7], s48 offen offset:0 sc1
    buffer_load_dwordx4 v[100:103], v1, s[4:7], s48 offen offset:1024 sc1
    buffer_load_dwordx4 v[104:107], v1, s[4:7], s48 offen offset:2048 sc1
    buffer_load_dwordx4 v[108:111], v1, s[4:7], s48 offen offset:3072 sc1
    buffer_load_dwordx4 v[112:115], v1, s[4:7], s37 offen offset:0 sc1
    buffer_load_dwordx4 v[116:119], v1, s[4:7], s37 offen offset:1024 sc1
    buffer_load_dwordx4 v[120:123], v1, s[4:7], s37 offen offset:2048 sc1
    buffer_load_dwordx4 v[124:127], v1, s[4:7], s37 offen offset:3072 sc1
    s_nop 3
    s_nop 3
    s_nop 3
    s_nop 3
    s_nop 3
    s_nop 3
c_fa_33:
    v_mov_b64 v[12:13], 0
    buffer_load_dwordx4 v[72:75], v1, s[4:7], s48 offen offset:0 sc1
    buffer_load_dwordx4 v[76:79], v1, s[4:7], s48 offen offset:1024 sc1
    buffer_load_dwordx4 v[80:83], v1, s[4:7], s48 offen offset:2048 sc1
    buffer_load_dwordx4 v[84:87], v1, s[4:7], s48 offen offset:3072 sc1
    buffer_load_dwordx4 v[32:35], v1, s[4:7], s37 offen offset:0 sc1
    buffer_load_dwordx4 v[36:39], v1, s[4:7], s37 offen offset:1024 sc1
    buffer_load_dwordx4 v[64:67], v1, s[4:7], s37 offen offset:2048 sc1
    buffer_load_dwordx4 v[68:71], v1, s[4:7], s37 offen offset:3072 sc1
    s_waitcnt vmcnt(15)
    v_bitop3_b32 v11, v96, v98, s49 bitop3:0x7e
    s_waitcnt vmcnt(14)
    v_smfmac_f32_16x16x64_bf16 v[12:15], v[16:19], v[96:103], v29
    v_bitop3_b32 v11, v11, v100, s49 bitop3:0xf6
    v_bitop3_b32 v11, v11, v102, s49 bitop3:0xf6
    s_waitcnt vmcnt(13)
    v_bitop3_b32 v11, v11, v104, s49 bitop3:0xf6
    v_bitop3_b32 v11, v11, v106, s49 bitop3:0xf6
    s_waitcnt vmcnt(12)
    v_smfmac_f32_16x16x64_bf16 v[12:15], v[16:19], v[104:111], v29
    v_bitop3_b32 v11, v11, v108, s49 bitop3:0xf6
    v_bitop3_b32 v11, v11, v110, s49 bitop3:0xf6
    s_waitcnt vmcnt(11)
    v_bitop3_b32 v11, v11, v112, s49 bitop3:0xf6
    v_bitop3_b32 v11, v11, v114, s49 bitop3:0xf6
    s_waitcnt vmcnt(10)
    v_smfmac_f32_16x16x64_bf16 v[12:15], v[16:19], v[112:119], v29
    v_bitop3_b32 v11, v11, v116, s49 bitop3:0xf6
    v_bitop3_b32 v11, v11, v118, s49 bitop3:0xf6
    s_waitcnt vmcnt(9)
    v_bitop3_b32 v11, v11, v120, s49 bitop3:0xf6
    v_bitop3_b32 v11, v11, v122, s49 bitop3:0xf6
    s_waitcnt vmcnt(8)
    v_smfmac_f32_16x16x64_bf16 v[12:15], v[16:19], v[120:127], v29
    v_bitop3_b32 v11, v11, v124, s49 bitop3:0xf6
    v_bitop3_b32 v11, v11, v126, s49 bitop3:0xf6
    v_and_b32 v11, 1, v11
    v_cmp_ne_u32 vcc, 0, v11
    s_nop 1
    v_cvt_pk_bf16_f32 v14, v12, v13
    v_min_u32 v14, 0xfffffffe, v14
    s_cmp_eq_u64 vcc, 0
    s_cselect_b32 s30, 0x10000000, 0
    buffer_store_dword v14, v9, s[28:31], s42 offen
    s_cbranch_scc0 c_fb_34
    s_branch c_late_35
c_fb_34:
    v_mov_b64 v[12:13], 0
    buffer_load_dwordx4 v[96:99], v1, s[4:7], s48 offen offset:0 sc1
    buffer_load_dwordx4 v[100:103], v1, s[4:7], s48 offen offset:1024 sc1
    buffer_load_dwordx4 v[104:107], v1, s[4:7], s48 offen offset:2048 sc1
    buffer_load_dwordx4 v[108:111], v1, s[4:7], s48 offen offset:3072 sc1
    buffer_load_dwordx4 v[112:115], v1, s[4:7], s37 offen offset:0 sc1
    buffer_load_dwordx4 v[116:119], v1, s[4:7], s37 offen offset:1024 sc1
    buffer_load_dwordx4 v[120:123], v1, s[4:7], s37 offen offset:2048 sc1
    buffer_load_dwordx4 v[124:127], v1, s[4:7], s37 offen offset:3072 sc1
    s_waitcnt vmcnt(15)
    v_bitop3_b32 v11, v72, v74, s49 bitop3:0x7e
    s_waitcnt vmcnt(14)
    v_smfmac_f32_16x16x64_bf16 v[12:15], v[16:19], v[72:79], v29
    v_bitop3_b32 v11, v11, v76, s49 bitop3:0xf6
    v_bitop3_b32 v11, v11, v78, s49 bitop3:0xf6
    s_waitcnt vmcnt(13)
    v_bitop3_b32 v11, v11, v80, s49 bitop3:0xf6
    v_bitop3_b32 v11, v11, v82, s49 bitop3:0xf6
    s_waitcnt vmcnt(12)
    v_smfmac_f32_16x16x64_bf16 v[12:15], v[16:19], v[80:87], v29
    v_bitop3_b32 v11, v11, v84, s49 bitop3:0xf6
    v_bitop3_b32 v11, v11, v86, s49 bitop3:0xf6
    s_waitcnt vmcnt(11)
    v_bitop3_b32 v11, v11, v32, s49 bitop3:0xf6
    v_bitop3_b32 v11, v11, v34, s49 bitop3:0xf6
    s_waitcnt vmcnt(10)
    v_smfmac_f32_16x16x64_bf16 v[12:15], v[16:19], v[32:39], v29
    v_bitop3_b32 v11, v11, v36, s49 bitop3:0xf6
    v_bitop3_b32 v11, v11, v38, s49 bitop3:0xf6
    s_waitcnt vmcnt(9)
    v_bitop3_b32 v11, v11, v64, s49 bitop3:0xf6
    v_bitop3_b32 v11, v11, v66, s49 bitop3:0xf6
    s_waitcnt vmcnt(8)
    v_smfmac_f32_16x16x64_bf16 v[12:15], v[16:19], v[64:71], v29
    v_bitop3_b32 v11, v11, v68, s49 bitop3:0xf6
    v_bitop3_b32 v11, v11, v70, s49 bitop3:0xf6
    v_and_b32 v11, 1, v11
    v_cmp_ne_u32 vcc, 0, v11
    s_nop 1
    v_cvt_pk_bf16_f32 v14, v12, v13
    v_min_u32 v14, 0xfffffffe, v14
    s_cmp_eq_u64 vcc, 0
    s_cselect_b32 s30, 0x10000000, 0
    buffer_store_dword v14, v9, s[28:31], s42 offen
    s_cbranch_scc0 c_chk_37
    s_branch c_late_35
c_chk_37:
    s_add_u32 s35, s35, 1
    s_cmp_lt_u32 s35, 524288
    s_cbranch_scc1 c_fa_33
    v_cvt_pk_bf16_f32 v14, v12, v13
    v_min_u32 v14, 0xfffffffe, v14
    buffer_store_dword v14, v9, s[4:7], s42 offen offset:0
c_late_35:
    s_nop 3
    s_nop 3
    s_barrier
    buffer_load_dwordx4 v[32:35], v1, s[4:7], s41 offen sc1
    buffer_load_dwordx4 v[36:39], v1, s[4:7], s71 offen sc1
    s_waitcnt vmcnt(3)
    v_mov_b64 v[64:65], 0
    v_mov_b64 v[66:67], 0
    v_mov_b64 v[68:69], 0
    v_mov_b64 v[70:71], 0
    v_mov_b64 v[72:73], 0
    v_mov_b64 v[74:75], 0
    v_mov_b64 v[76:77], 0
    v_mov_b64 v[78:79], 0
    v_mov_b64 v[80:81], 0
    v_mov_b64 v[82:83], 0
    v_mov_b64 v[84:85], 0
    v_mov_b64 v[86:87], 0
    s_branch c_pub_36
c_oth_27:
    ds_read_b128 v[40:43], v0 offset:0
    ds_read_b128 v[44:47], v0 offset:1024
    ds_read_b128 v[48:51], v0 offset:2048
    ds_read_b128 v[52:55], v0 offset:3072
    ds_read_b128 v[56:59], v0 offset:4096
    ds_read_b128 v[60:63], v0 offset:5120
    ds_read_b128 v[88:91], v0 offset:6144
    ds_read_b128 v[92:95], v0 offset:7168
    ds_read_b128 v[96:99], v0 offset:8192
    ds_read_b128 v[100:103], v0 offset:9216
    ds_read_b128 v[104:107], v0 offset:10240
    ds_read_b128 v[108:111], v0 offset:11264
    ds_read_b128 v[112:115], v0 offset:12288
    ds_read_b128 v[116:119], v0 offset:13312
    ds_read_b128 v[120:123], v0 offset:14336
    ds_read_b128 v[124:127], v0 offset:15360
    v_mov_b64 v[64:65], 0
    v_mov_b64 v[66:67], 0
    v_mov_b64 v[68:69], 0
    v_mov_b64 v[70:71], 0
    v_mov_b64 v[72:73], 0
    v_mov_b64 v[74:75], 0
    v_mov_b64 v[76:77], 0
    v_mov_b64 v[78:79], 0
    v_mov_b64 v[80:81], 0
    v_mov_b64 v[82:83], 0
    v_mov_b64 v[84:85], 0
    v_mov_b64 v[86:87], 0
    v_xor_b32 v13, 2048, v3
    v_xor_b32 v14, 4096, v3
    v_xor_b32 v15, 6144, v3
    s_xor_b32 s44, s44, 524288
    s_xor_b32 s45, s45, 524288
    s_xor_b32 s46, s46, 524288
    s_xor_b32 s47, s47, 524288
    s_add_u32 s50, s50, 32768
    s_xor_b32 s59, s59, 0x6000
    s_add_u32 s57, s57, s63
    s_add_u32 s38, s60, 24576
    s_and_b32 s38, s38, 0x7fff
    s_add_u32 s43, s38, 11534336
    s_add_u32 s36, s60, 8192
    s_and_b32 s60, s36, 0x7fff
    s_and_b32 s56, s40, 1
    s_add_u32 s40, s40, 1
    s_xor_b32 s48, s48, 524288
    s_xor_b32 s49, s49, s56
    s_add_u32 s42, s60, 11534336
    s_cmp_lg_u32 s32, 1
    s_cbranch_scc1 c_fo_39
    s_add_u32 s36, s40, 1
    s_lshr_b32 s56, s36, 1
    s_add_u32 s56, s56, 1
    s_min_u32 s56, s56, 32
    s_bitcmp1_b32 s36, 0
    s_cselect_b32 s38, 0xf00, 0xf
    s_mov_b32 s39, 0
    s_waitcnt vmcnt(8)
    v_max_u32 v11, v11, v7
    s_add_u32 s36, s56, 1
    s_min_u32 s36, s36, 32
    v_cmp_gt_u32 vcc, s36, v11
    s_nop 0
    s_and_b32 vcc_lo, vcc_lo, 0xf0f
    s_cselect_b32 s26, 256, 0
c_fc_38:
    v_cmp_gt_u32 vcc, s56, v11
    s_nop 0
    s_and_b64 vcc, vcc, s[38:39]
    s_cbranch_scc0 c_fo_39
    buffer_load_dword v11, v1, s[4:7], s57 offen sc1
    s_add_u32 s35, s35, 1
    s_cmp_lt_u32 s35, 524288
    s_waitcnt vmcnt(0)
    s_cbranch_scc1 c_fc_38
c_fo_39:
c_join_29:
    s_barrier
    buffer_load_dwordx4 v[32:35], v1, s[4:7], s41 offen sc1
    buffer_load_dwordx4 v[36:39], v1, s[4:7], s71 offen sc1
    s_nop 3
    s_nop 3
    s_nop 3
    s_nop 3
    s_nop 3
    s_nop 3
    s_nop 3
    s_nop 3
    s_nop 3
    buffer_load_dwordx4 v[32:35], v1, s[4:7], s41 offen sc1
    buffer_load_dwordx4 v[36:39], v1, s[4:7], s71 offen sc1
    s_branch c_top_22
c_r2_25:
    s_mov_b64 exec, vcc
    buffer_load_dwordx4 v[32:35], v1, s[4:7], s41 offen sc1
    buffer_load_dwordx4 v[36:39], v1, s[4:7], s71 offen sc1
    s_mov_b64 exec, -1
    s_add_u32 s35, s35, 1
    s_cmp_lt_u32 s35, 524288
    v_mov_b64 v[64:65], 0
    v_mov_b64 v[66:67], 0
    v_mov_b64 v[68:69], 0
    v_mov_b64 v[70:71], 0
    s_waitcnt vmcnt(2)
    s_cbranch_scc1 c_c2_30
    s_branch c_go2_24
c_r2b_40:
    v_max3_u32 v12, v32, v33, v34
    v_max3_u32 v0, v35, v36, v37
    v_max3_u32 v12, v12, v38, v39
    v_max_u32 v12, v12, v0
    v_cmp_eq_u32 vcc, -1, v12
    s_cbranch_vccz c_p2_23
    s_mov_b64 exec, vcc
    buffer_load_dwordx4 v[32:35], v1, s[4:7], s41 offen sc1
    buffer_load_dwordx4 v[36:39], v1, s[4:7], s71 offen sc1
    s_mov_b64 exec, -1
    s_add_u32 s35, s35, 1
    s_cmp_lt_u32 s35, 524288
    s_waitcnt vmcnt(6)
    s_cbranch_scc1 c_r2b_40
    s_branch c_go2_24
L_chain_slow:
    s_mov_b64 s[28:29], s[4:5]
    s_xor_b32 s59, s59, 0x6000
    s_mov_b32 s40, 0
    s_mov_b32 s60, 0
    s_mov_b32 s49, 1
    s_add_u32 s41, s70, 11534336
    s_add_u32 s71, s41, 1024
    s_mul_i32 s36, s32, 6144
    s_add_u32 s36, s36, s50
    s_add_u32 s36, s36, 16384
    s_cmp_eq_u32 s32, 1
    s_cselect_b32 s57, s53, s36
    s_cselect_b32 s63, 0, 32768
    s_add_u32 s24, s4, s53
    s_addc_u32 s25, s5, 0
    s_cmp_eq_u32 s32, 1
    s_cselect_b32 s26, 256, 0
    v_mov_b32 v11, 0
    v_mov_b64 v[64:65], 0
    v_mov_b64 v[66:67], 0
    v_mov_b64 v[68:69], 0
    v_mov_b64 v[70:71], 0
    v_mov_b64 v[72:73], 0
    v_mov_b64 v[74:75], 0
    v_mov_b64 v[76:77], 0
    v_mov_b64 v[78:79], 0
    v_mov_b64 v[80:81], 0
    v_mov_b64 v[82:83], 0
    v_mov_b64 v[84:85], 0
    v_mov_b64 v[86:87], 0
    v_xor_b32 v13, 2048, v3
    v_xor_b32 v14, 4096, v3
    v_xor_b32 v15, 6144, v3
    s_add_u32 s50, s50, 32768
    s_add_u32 s36, s60, 8192
    s_and_b32 s36, s36, 0x7fff
    s_add_u32 s42, s36, 11534336
    s_add_u32 s38, s60, 24576
    s_and_b32 s38, s38, 0x7fff
    s_add_u32 s43, s38, 11534336
    s_mov_b32 s60, s36
    s_mov_b32 s53, s51
    s_add_u32 s51, s51, 4096
    s_mov_b64 s[68:69], -1
    buffer_load_dwordx4 v[32:35], v1, s[4:7], s41 offen sc1
    buffer_load_dwordx4 v[36:39], v1, s[4:7], s71 offen sc1
    buffer_load_dwordx4 v[32:35], v1, s[4:7], s41 offen sc1
    buffer_load_dwordx4 v[36:39], v1, s[4:7], s71 offen sc1
.p2align 6
    s_nop 0
    s_nop 0
c_top_41:
    s_waitcnt vmcnt(2) lgkmcnt(0)
c_c2_49:
    v_max3_u32 v12, v32, v33, v34
    v_max3_u32 v0, v35, v36, v37
    v_max3_u32 v12, v12, v38, v39
    v_max_u32 v12, v12, v0
    v_cmp_eq_u32 vcc, -1, v12
c_p2_42:
    v_smfmac_f32_16x16x64_bf16 v[64:67], v[32:35], v[40:47], v2
    ds_write_b128 v3, v[32:35]
    s_cmp_lg_u64 vcc, 0
    v_smfmac_f32_16x16x64_bf16 v[68:71], v[32:35], v[48:55], v2
    s_cbranch_scc1 c_r2_44
    ds_write_b128 v3, v[36:39] offset:1024
    v_smfmac_f32_16x16x64_bf16 v[72:75], v[32:35], v[56:63], v2
c_go2_43:
    v_mov_b32 v12, -1
    v_smfmac_f32_16x16x64_bf16 v[76:79], v[32:35], v[88:95], v2
    v_mov_b32 v18, 0
    v_smfmac_f32_16x16x64_bf16 v[80:83], v[32:35], v[96:103], v2
    v_xor_b32 v3, 0x6000, v3
    v_smfmac_f32_16x16x64_bf16 v[84:87], v[32:35], v[104:111], v2
    s_cmp_eq_u32 s40, 63
    s_waitcnt lgkmcnt(0)
    s_barrier
    ds_read_b128 v[40:43], v13 offset:0
    v_smfmac_f32_16x16x64_bf16 v[64:67], v[36:39], v[112:119], v2
    s_cbranch_scc1 c_fin_50
    ds_read_b128 v[44:47], v13 offset:1024
    v_smfmac_f32_16x16x64_bf16 v[68:71], v[36:39], v[120:127], v2
    ds_read_b128 v[48:51], v14 offset:0
    v_smfmac_f32_16x16x64_bf16 v[72:75], v[36:39], v[128:135], v2
    ds_read_b128 v[52:55], v14 offset:1024
    v_smfmac_f32_16x16x64_bf16 v[76:79], v[36:39], v[136:143], v2
    ds_read_b128 v[56:59], v15 offset:0
    v_smfmac_f32_16x16x64_bf16 v[80:83], v[36:39], v[144:151], v2
    ds_read_b128 v[60:63], v15 offset:1024
    v_smfmac_f32_16x16x64_bf16 v[84:87], v[36:39], v[152:159], v2
    buffer_load_dword v7, v1, s[24:27], 0 offen sc1
    s_waitcnt lgkmcnt(4)
    v_smfmac_f32_16x16x64_bf16 v[64:67], v[40:43], v[160:167], v2
    ds_read_b128 v[88:91], v1 offset:0
    v_smfmac_f32_16x16x64_bf16 v[68:71], v[40:43], v[168:175], v2
    ds_read_b128 v[92:95], v1 offset:4096
    v_smfmac_f32_16x16x64_bf16 v[64:67], v[44:47], v[176:183], v2
    buffer_store_dwordx4 v[20:23], v1, s[4:7], s51 offen sc1
    v_smfmac_f32_16x16x64_bf16 v[68:71], v[44:47], v[184:191], v2
    ds_read_b128 v[96:99], v1 offset:1024
    s_waitcnt lgkmcnt(3)
    v_smfmac_f32_16x16x64_bf16 v[64:67], v[48:51], v[192:199], v2
    ds_read_b128 v[100:103], v1 offset:5120
    v_smfmac_f32_16x16x64_bf16 v[68:71], v[48:51], v[200:207], v2
    s_mov_b32 s51, s53
    s_add_u32 s53, s53, 32768
    v_smfmac_f32_16x16x64_bf16 v[64:67], v[52:55], v[208:215], v2
    ds_read_b128 v[104:107], v1 offset:2048
    v_smfmac_f32_16x16x64_bf16 v[68:71], v[52:55], v[216:223], v2
    ds_read_b128 v[108:111], v1 offset:6144
    v_smfmac_f32_16x16x64_bf16 v[64:67], v[56:59], v[224:231], v2
    buffer_store_dword v12, v9, s[4:7], s43 offen sc1
    v_smfmac_f32_16x16x64_bf16 v[64:67], v[60:63], v[240:247], v2
    ds_read_b128 v[112:115], v1 offset:3072
    v_smfmac_f32_16x16x64_bf16 v[68:71], v[56:59], v[232:239], v2
    ds_read_b128 v[116:119], v1 offset:7168
    v_smfmac_f32_16x16x64_bf16 v[68:71], v[60:63], v[248:255], v2
    s_add_u32 s41, s70, s42
    s_add_u32 s71, s41, 1024
    v_add_f32 v64, v64, v66
    v_smfmac_f32_16x16x64_bf16 v[72:75], v[40:43], a[0:7], v2
    v_add_f32 v65, v65, v67
    v_smfmac_f32_16x16x64_bf16 v[76:79], v[40:43], a[8:15], v2
    v_add_f32 v68, v68, v70
    v_smfmac_f32_16x16x64_bf16 v[72:75], v[44:47], a[16:23], v2
    v_cvt_pk_bf16_f32 v66, v64, v68
    v_smfmac_f32_16x16x64_bf16 v[76:79], v[44:47], a[24:31], v2
    ds_write_b32 v4, v66 offset:0
    v_add_f32 v69, v69, v71
    v_smfmac_f32_16x16x64_bf16 v[72:75], v[48:51], a[32:39], v2
    v_cvt_pk_bf16_f32 v67, v65, v69
    v_smfmac_f32_16x16x64_bf16 v[76:79], v[48:51], a[40:47], v2
    ds_write_b32 v4, v67 offset:288
    v_smfmac_f32_16x16x64_bf16 v[72:75], v[52:55], a[48:55], v2
    s_add_u32 s37, s48, 4096
    s_add_u32 s39, s50, 8192
    v_smfmac_f32_16x16x64_bf16 v[76:79], v[52:55], a[56:63], v2
    s_mov_b32 m0, s58
    v_smfmac_f32_16x16x64_bf16 v[72:75], v[56:59], a[64:71], v2
    v_smfmac_f32_16x16x64_bf16 v[72:75], v[60:63], a[80:87], v2
    s_waitcnt vmcnt(3) lgkmcnt(0)
    s_barrier
    v_smfmac_f32_16x16x64_bf16 v[76:79], v[56:59], a[72:79], v2
    ds_read_b128 v[120:123], v5 offset:0
    buffer_load_dwordx4 v1, s[4:7], s50 offen offset:0 sc1 lds
    v_smfmac_f32_16x16x64_bf16 v[76:79], v[60:63], a[88:95], v2
    ds_read_b128 v[124:127], v5 offset:64
    v_add_f32 v72, v72, v74
    v_smfmac_f32_16x16x64_bf16 v[80:83], v[40:43], a[96:103], v2
    ds_read_b128 v[32:35], v5 offset:128
    v_add_f32 v73, v73, v75
    v_smfmac_f32_16x16x64_bf16 v[84:87], v[40:43], a[104:111], v2
    ds_read_b128 v[36:39], v5 offset:192
    buffer_load_dwordx4 v1, s[4:7], s50 offen offset:1024 sc1 lds
    v_add_f32 v76, v76, v78
    v_add_f32 v77, v77, v79
    v_cvt_pk_bf16_f32 v20, v72, v76
    v_cvt_pk_bf16_f32 v21, v73, v77
    v_smfmac_f32_16x16x64_bf16 v[80:83], v[44:47], a[112:119], v2
    ds_write_b32 v4, v20 offset:2304
    ds_write_b32 v4, v21 offset:2592
    v_smfmac_f32_16x16x64_bf16 v[84:87], v[44:47], a[120:127], v2
    s_waitcnt lgkmcnt(2)
    s_mov_b32 m0, s59
    v_mfma_f32_16x16x32_bf16 v[64:67], v[88:91], v[120:123], 0
    v_mov_b64 v[40:41], 0
    v_mov_b64 v[42:43], 0
    v_mfma_f32_16x16x32_bf16 v[68:71], v[92:95], v[120:123], 0
    buffer_load_dwordx4 v1, s[4:7], s39 offen offset:0 sc1 lds
    v_mov_b64 v[44:45], 0
    v_mfma_f32_16x16x32_bf16 v[64:67], v[96:99], v[124:127], v[64:67]
    v_mov_b64 v[46:47], 0
    v_mfma_f32_16x16x32_bf16 v[68:71], v[100:103], v[124:127], v[68:71]
    s_waitcnt lgkmcnt(0)
    s_barrier
    ds_read_b128 v[88:91], v6 offset:0
    v_mfma_f32_16x16x32_bf16 v[64:67], v[104:107], v[32:35], v[64:67]
    ds_read_b128 v[92:95], v6 offset:64
    v_mfma_f32_16x16x32_bf16 v[68:71], v[108:111], v[32:35], v[68:71]
    buffer_load_dwordx4 v1, s[4:7], s39 offen offset:1024 sc1 lds
    ds_read_b128 v[96:99], v6 offset:128
    v_mfma_f32_16x16x32_bf16 v[64:67], v[112:115], v[36:39], v[64:67]
    ds_read_b128 v[100:103], v6 offset:192
    v_mfma_f32_16x16x32_bf16 v[68:71], v[116:119], v[36:39], v[68:71]
    ds_read_b64 v[106:107], v3 offset:0
    ds_read_b64 v[110:111], v3 offset:8
    v_smfmac_f32_16x16x64_bf16 v[80:83], v[48:51], a[128:135], v2
    ds_read_b64 v[114:115], v3 offset:1024
    ds_read_b64 v[118:119], v3 offset:1032
    v_max3_f32 v12, v64, v65, v66
    v_smfmac_f32_16x16x64_bf16 v[84:87], v[48:51], a[136:143], v2
    s_waitcnt lgkmcnt(4)
    v_max3_f32 v13, v68, v69, v70
    v_mfma_f32_16x16x32_bf16 v[72:75], v[88:91], v[120:123], 0
    v_max3_f32 v12, v12, v67, v71
    v_max_f32 v12, v12, v13
    v_mfma_f32_16x16x32_bf16 v[72:75], v[92:95], v[124:127], v[72:75]
    v_mov_b32 v13, v12
    v_cndmask_b32 v76, v64, v68, s[54:55]
    v_mfma_f32_16x16x32_bf16 v[72:75], v[96:99], v[32:35], v[72:75]
    v_cndmask_b32 v77, v65, v69, s[54:55]
    v_permlane32_swap_b32 v12, v13
    v_mfma_f32_16x16x32_bf16 v[72:75], v[100:103], v[36:39], v[72:75]
    v_cndmask_b32 v78, v66, v70, s[54:55]
    v_cndmask_b32 v79, v67, v71, s[54:55]
    v_smfmac_f32_16x16x64_bf16 v[80:83], v[52:55], a[144:151], v2
    ds_read_b128 v[88:91], v10 offset:0
    v_mov_b64 v[64:65], 0
    v_smfmac_f32_16x16x64_bf16 v[84:87], v[52:55], a[152:159], v2
    ds_read_b128 v[92:95], v10 offset:1024
    v_mov_b64 v[66:67], 0
    v_max3_f32 v12, v12, v13, v75
    v_max3_f32 v13, v72, v73, v74
    v_max_f32 v12, v12, v13
    v_mov_b32 v13, v12
    v_smfmac_f32_16x16x64_bf16 v[80:83], v[56:59], a[160:167], v2
    ds_read_b128 v[96:99], v10 offset:2048
    v_permlane16_swap_b32 v12, v13
    v_smfmac_f32_16x16x64_bf16 v[80:83], v[60:63], a[176:183], v2
    ds_read_b128 v[100:103], v10 offset:3072
    v_max_f32 v12, v12, v13
    v_smfmac_f32_16x16x64_bf16 v[84:87], v[56:59], a[168:175], v2
    ds_read_b128 v[120:123], v10 offset:4096
    v_mul_f32 v14, s52, v12
    v_smfmac_f32_16x16x64_bf16 v[84:87], v[60:63], a[184:191], v2
    s_waitcnt lgkmcnt(5)
    v_fma_f32 v15, v12, s52, 1.0
    v_fma_f32 v76, v76, s52, -v14
    v_fma_f32 v77, v77, s52, -v14
    v_fma_f32 v78, v78, s52, -v14
    v_fma_f32 v79, v79, s52, -v14
    v_fma_f32 v72, v72, s52, -v15
    v_fma_f32 v73, v73, s52, -v15
    v_add_f32 v80, v80, v82
    v_add_f32 v81, v81, v83
    v_add_f32 v84, v84, v86
    v_add_f32 v85, v85, v87
    v_cvt_pk_bf16_f32 v104, v80, v81
    v_cvt_pk_bf16_f32 v112, v84, v85
    v_exp_f32 v76, v76
    v_exp_f32 v77, v77
    v_exp_f32 v78, v78
    v_exp_f32 v79, v79
    v_exp_f32 v72, v72
    v_exp_f32 v73, v73
    v_cvt_pk_bf16_f32 v17, v76, v77
    v_cvt_pk_bf16_f32 v19, v78, v79
    v_cvt_pk_bf16_f32 v16, v72, v73
    v_permlane16_swap_b32 v104, v108
    v_permlane16_swap_b32 v112, v116
    v_smfmac_f32_16x16x64_bf16 v[64:67], v[16:19], v[24:31], v2 abid:1
    ds_read_b128 v[124:127], v10 offset:5120
    v_smfmac_f32_16x16x64_bf16 v[40:43], v[16:19], v[104:111], v2 abid:1
    ds_read_b128 v[32:35], v10 offset:6144
    v_smfmac_f32_16x16x64_bf16 v[44:47], v[16:19], v[112:119], v2 abid:1
    ds_read_b128 v[36:39], v10 offset:7168
    v_add_f32 v64, v64, v66
    v_add_f32 v65, v65, v67
    v_rcp_f32 v64, v64
    v_rcp_f32 v65, v65
    v_add_f32 v40, v40, v42
    v_add_f32 v44, v44, v46
    v_mul_f32 v40, v40, v64
    v_mul_f32 v44, v44, v64
    v_cvt_pk_bf16_f32 v42, v40, v44
    ds_write_b32 v4, v42 offset:4608
    v_add_f32 v41, v41, v43
    v_add_f32 v45, v45, v47
    v_mul_f32 v41, v41, v65
    v_mul_f32 v45, v45, v65
    v_cvt_pk_bf16_f32 v43, v41, v45
    ds_write_b32 v4, v43 offset:4896
    v_cvt_pk_bf16_f32 v22, v80, v81
    v_cvt_pk_bf16_f32 v23, v84, v85
    v_mov_b64 v[72:73], 0
    v_mov_b64 v[74:75], 0
    v_mov_b64 v[76:77], 0
    v_mov_b64 v[78:79], 0
    v_mov_b64 v[64:65], 0
    v_mov_b64 v[66:67], 0
    v_mov_b64 v[68:69], 0
    v_mov_b64 v[70:71], 0
    s_waitcnt lgkmcnt(0)
    s_barrier
    ds_read_b128 v[16:19], v5 offset:4608
    v_min_u32 v20, 0xfffffffe, v20
    v_add_u32 v0, 65536, v10
    s_nop 0
    ds_read_b128 v[12:15], v5 offset:4672
    v_min_u32 v21, 0xfffffffe, v21
    s_cmp_lg_u32 s32, 0
    s_nop 0
    ds_read_b128 v[80:83], v5 offset:4736
    v_min_u32 v22, 0xfffffffe, v22
    s_nop 0
    ds_read_b128 v[84:87], v5 offset:4800
    v_min_u32 v23, 0xfffffffe, v23
    s_waitcnt lgkmcnt(3)
    v_smfmac_f32_16x16x64_bf16 v[72:75], v[16:19], a[192:199], v2
    s_waitcnt lgkmcnt(2)
    v_smfmac_f32_16x16x64_bf16 v[72:75], v[12:15], a[200:207], v2
    ds_read_b128 v[48:51], v10 offset:8192
    s_waitcnt lgkmcnt(2)
    v_smfmac_f32_16x16x64_bf16 v[72:75], v[80:83], a[208:215], v2
    ds_read_b128 v[52:55], v10 offset:9216
    s_waitcnt lgkmcnt(2)
    v_smfmac_f32_16x16x64_bf16 v[72:75], v[84:87], a[216:223], v2
    ds_read_b128 v[56:59], v10 offset:10240
    v_smfmac_f32_16x16x64_bf16 v[76:79], v[16:19], a[224:231], v2
    ds_read_b128 v[60:63], v10 offset:11264
    v_smfmac_f32_16x16x64_bf16 v[76:79], v[12:15], a[232:239], v2
    ds_read_b128 v[104:107], v10 offset:12288
    v_cvt_pk_bf16_f32 v72, v72, v73
    v_smfmac_f32_16x16x64_bf16 v[76:79], v[80:83], a[240:247], v2
    ds_read_b128 v[108:111], v10 offset:13312
    v_cvt_pk_bf16_f32 v73, v74, v75
    v_smfmac_f32_16x16x64_bf16 v[76:79], v[84:87], a[248:255], v2
    ds_read_b128 v[112:115], v10 offset:14336
    v_and_or_b32 v72, v72, -2, s49
    v_smfmac_f32_16x16x64_bf16 v[64:67], v[16:19], v[88:95], v2
    buffer_store_dwordx2 v[72:73], v8, s[4:7], s44 offen sc1
    v_smfmac_f32_16x16x64_bf16 v[64:67], v[12:15], v[96:103], v2
    ds_read_b128 v[116:119], v10 offset:15360
    v_cvt_pk_bf16_f32 v76, v76, v77
    v_smfmac_f32_16x16x64_bf16 v[64:67], v[80:83], v[120:127], v2
    v_cvt_pk_bf16_f32 v77, v78, v79
    v_smfmac_f32_16x16x64_bf16 v[64:67], v[84:87], v[32:39], v2
    v_and_or_b32 v76, v76, -2, s49
    s_waitcnt lgkmcnt(0)
    v_smfmac_f32_16x16x64_bf16 v[68:71], v[16:19], v[48:55], v2
    buffer_store_dwordx2 v[76:77], v8, s[4:7], s45 offen sc1
    v_smfmac_f32_16x16x64_bf16 v[68:71], v[12:15], v[56:63], v2
    v_cvt_pk_bf16_f32 v64, v64, v65
    v_smfmac_f32_16x16x64_bf16 v[68:71], v[80:83], v[104:111], v2
    v_cvt_pk_bf16_f32 v65, v66, v67
    v_smfmac_f32_16x16x64_bf16 v[68:71], v[84:87], v[112:119], v2
    v_and_or_b32 v64, v64, -2, s49
    buffer_store_dwordx2 v[64:65], v8, s[4:7], s46 offen sc1
    s_nop 3
    v_cvt_pk_bf16_f32 v68, v68, v69
    v_and_or_b32 v68, v68, -2, s49
    v_cvt_pk_bf16_f32 v69, v70, v71
    buffer_store_dwordx2 v[68:69], v8, s[4:7], s47 offen sc1
    s_cbranch_scc1 c_oth_46
    ds_read_b128 v[40:43], v0 offset:0
    ds_read_b128 v[44:47], v0 offset:1024
    ds_read_b128 v[48:51], v0 offset:2048
    ds_read_b128 v[52:55], v0 offset:3072
    ds_read_b128 v[56:59], v0 offset:4096
    ds_read_b128 v[60:63], v0 offset:5120
    ds_read_b128 v[88:91], v0 offset:6144
    ds_read_b128 v[92:95], v0 offset:7168
    v_cndmask_b32 v16, v25, 0, s[64:65]
    v_cndmask_b32 v17, 0, v25, s[64:65]
    v_mov_b64 v[18:19], v[16:17]
    v_mov_b64 v[12:13], 0
    s_xor_b32 s44, s44, 524288
    s_xor_b32 s45, s45, 524288
    s_xor_b32 s46, s46, 524288
    s_xor_b32 s47, s47, 524288
    s_add_u32 s50, s50, 32768
    s_xor_b32 s59, s59, 0x6000
    s_add_u32 s57, s57, s63
    s_add_u32 s38, s60, 24576
    s_and_b32 s38, s38, 0x7fff
    s_add_u32 s43, s38, 11534336
    s_add_u32 s36, s60, 8192
    s_and_b32 s60, s36, 0x7fff
    s_and_b32 s56, s40, 1
    s_add_u32 s40, s40, 1
    s_nop 3
    s_nop 3
    s_nop 3
    s_nop 3
    s_nop 3
    s_nop 3
    s_nop 3
    buffer_load_dwordx4 v[72:75], v1, s[4:7], s48 offen offset:0 sc1
    buffer_load_dwordx4 v[76:79], v1, s[4:7], s48 offen offset:1024 sc1
    buffer_load_dwordx4 v[80:83], v1, s[4:7], s48 offen offset:2048 sc1
    buffer_load_dwordx4 v[84:87], v1, s[4:7], s48 offen offset:3072 sc1
    buffer_load_dwordx4 v[32:35], v1, s[4:7], s37 offen offset:0 sc1
    buffer_load_dwordx4 v[36:39], v1, s[4:7], s37 offen offset:1024 sc1
    s_nop 3
    s_nop 3
    buffer_load_dwordx4 v[64:67], v1, s[4:7], s37 offen offset:2048 sc1
    buffer_load_dwordx4 v[68:71], v1, s[4:7], s37 offen offset:3072 sc1
    s_nop 3
    s_nop 3
    s_nop 3
    s_nop 3
    s_nop 3
    buffer_load_dwordx4 v[96:99], v1, s[4:7], s48 offen offset:0 sc1
    buffer_load_dwordx4 v[100:103], v1, s[4:7], s48 offen offset:1024 sc1
    buffer_load_dwordx4 v[104:107], v1, s[4:7], s48 offen offset:2048 sc1
    buffer_load_dwordx4 v[108:111], v1, s[4:7], s48 offen offset:3072 sc1
    buffer_load_dwordx4 v[112:115], v1, s[4:7], s37 offen offset:0 sc1
    buffer_load_dwordx4 v[116:119], v1, s[4:7], s37 offen offset:1024 sc1
    buffer_load_dwordx4 v[120:123], v1, s[4:7], s37 offen offset:2048 sc1
    buffer_load_dwordx4 v[124:127], v1, s[4:7], s37 offen offset:3072 sc1
    s_waitcnt vmcnt(15)
    v_bitop3_b32 v11, v72, v74, s49 bitop3:0x7e
    s_waitcnt vmcnt(14)
    v_smfmac_f32_16x16x64_bf16 v[12:15], v[16:19], v[72:79], v29
    v_bitop3_b32 v11, v11, v76, s49 bitop3:0xf6
    v_bitop3_b32 v11, v11, v78, s49 bitop3:0xf6
    s_waitcnt vmcnt(13)
    v_bitop3_b32 v11, v11, v80, s49 bitop3:0xf6
    v_bitop3_b32 v11, v11, v82, s49 bitop3:0xf6
    s_waitcnt vmcnt(12)
    v_smfmac_f32_16x16x64_bf16 v[12:15], v[16:19], v[80:87], v29
    v_bitop3_b32 v11, v11, v84, s49 bitop3:0xf6
    v_bitop3_b32 v11, v11, v86, s49 bitop3:0xf6
    s_waitcnt vmcnt(11)
    v_bitop3_b32 v11, v11, v32, s49 bitop3:0xf6
    v_bitop3_b32 v11, v11, v34, s49 bitop3:0xf6
    s_waitcnt vmcnt(10)
    v_smfmac_f32_16x16x64_bf16 v[12:15], v[16:19], v[32:39], v29
    v_bitop3_b32 v11, v11, v36, s49 bitop3:0xf6
    v_bitop3_b32 v11, v11, v38, s49 bitop3:0xf6
    s_waitcnt vmcnt(9)
    v_bitop3_b32 v11, v11, v64, s49 bitop3:0xf6
    v_bitop3_b32 v11, v11, v66, s49 bitop3:0xf6
    s_waitcnt vmcnt(8)
    v_smfmac_f32_16x16x64_bf16 v[12:15], v[16:19], v[64:71], v29
    v_bitop3_b32 v11, v11, v68, s49 bitop3:0xf6
    v_bitop3_b32 v11, v11, v70, s49 bitop3:0xf6
    v_and_b32 v11, 1, v11
    v_cmp_ne_u32 vcc, 0, v11
    s_nop 1
    v_cvt_pk_bf16_f32 v14, v12, v13
    v_min_u32 v14, 0xfffffffe, v14
    s_cmp_eq_u64 vcc, 0
    s_cselect_b32 s30, 0x10000000, 0
    buffer_store_dword v14, v9, s[28:31], s42 offen sc1
    s_cbranch_scc0 c_fa_52
    v_mov_b64 v[64:65], 0
    v_mov_b64 v[66:67], 0
    v_mov_b64 v[68:69], 0
    v_mov_b64 v[70:71], 0
    v_mov_b64 v[72:73], 0
    v_mov_b64 v[74:75], 0
    v_mov_b64 v[76:77], 0
    v_mov_b64 v[78:79], 0
    v_mov_b64 v[80:81], 0
    v_mov_b64 v[82:83], 0
    v_mov_b64 v[84:85], 0
    v_mov_b64 v[86:87], 0
    s_nop 3
    s_nop 3
    s_nop 3
    s_nop 3
    s_barrier
    buffer_load_dwordx4 v[32:35], v1, s[4:7], s41 offen sc1
    buffer_load_dwordx4 v[36:39], v1, s[4:7], s71 offen sc1
c_pub_55:
    v_xor_b32 v13, 2048, v3
    v_xor_b32 v14, 4096, v3
    v_xor_b32 v15, 6144, v3
    s_xor_b32 s48, s48, 524288
    s_xor_b32 s49, s49, s56
    s_add_u32 s42, s60, 11534336
    s_waitcnt vmcnt(3)
    ds_read_b128 v[96:99], v0 offset:8192
    ds_read_b128 v[100:103], v0 offset:9216
    ds_read_b128 v[104:107], v0 offset:10240
    ds_read_b128 v[108:111], v0 offset:11264
    ds_read_b128 v[112:115], v0 offset:12288
    ds_read_b128 v[116:119], v0 offset:13312
    ds_read_b128 v[120:123], v0 offset:14336
    ds_read_b128 v[124:127], v0 offset:15360
    s_nop 3
    s_nop 3
    s_nop 3
    s_nop 3
    s_nop 3
    buffer_load_dwordx4 v[32:35], v1, s[4:7], s41 offen sc1
    buffer_load_dwordx4 v[36:39], v1, s[4:7], s71 offen sc1
    s_branch c_top_41
c_fin_50:
    buffer_store_dwordx4 v[20:23], v1, s[4:7], s51 offen sc1
    ds_read_b128 v[40:43], v13 offset:0
    ds_read_b128 v[44:47], v13 offset:1024
    ds_read_b128 v[48:51], v14 offset:0
    ds_read_b128 v[52:55], v14 offset:1024
    ds_read_b128 v[56:59], v15 offset:0
    ds_read_b128 v[60:63], v15 offset:1024
    s_mov_b32 s51, s53
    v_smfmac_f32_16x16x64_bf16 v[72:75], v[36:39], v[128:135], v2
    v_smfmac_f32_16x16x64_bf16 v[76:79], v[36:39], v[136:143], v2
    v_smfmac_f32_16x16x64_bf16 v[80:83], v[36:39], v[144:151], v2
    v_smfmac_f32_16x16x64_bf16 v[84:87], v[36:39], v[152:159], v2
    s_waitcnt lgkmcnt(5)
    v_smfmac_f32_16x16x64_bf16 v[72:75], v[40:43], a[0:7], v2
    v_smfmac_f32_16x16x64_bf16 v[76:79], v[40:43], a[8:15], v2
    v_smfmac_f32_16x16x64_bf16 v[80:83], v[40:43], a[96:103], v2
    v_smfmac_f32_16x16x64_bf16 v[84:87], v[40:43], a[104:111], v2
    s_waitcnt lgkmcnt(4)
    v_smfmac_f32_16x16x64_bf16 v[72:75], v[44:47], a[16:23], v2
    v_smfmac_f32_16x16x64_bf16 v[76:79], v[44:47], a[24:31], v2
    v_smfmac_f32_16x16x64_bf16 v[80:83], v[44:47], a[112:119], v2
    v_smfmac_f32_16x16x64_bf16 v[84:87], v[44:47], a[120:127], v2
    s_waitcnt lgkmcnt(3)
    v_smfmac_f32_16x16x64_bf16 v[72:75], v[48:51], a[32:39], v2
    v_smfmac_f32_16x16x64_bf16 v[76:79], v[48:51], a[40:47], v2
    v_smfmac_f32_16x16x64_bf16 v[80:83], v[48:51], a[128:135], v2
    v_smfmac_f32_16x16x64_bf16 v[84:87], v[48:51], a[136:143], v2
    s_waitcnt lgkmcnt(2)
    v_smfmac_f32_16x16x64_bf16 v[72:75], v[52:55], a[48:55], v2
    v_smfmac_f32_16x16x64_bf16 v[76:79], v[52:55], a[56:63], v2
    v_smfmac_f32_16x16x64_bf16 v[80:83], v[52:55], a[144:151], v2
    v_smfmac_f32_16x16x64_bf16 v[84:87], v[52:55], a[152:159], v2
    s_waitcnt lgkmcnt(1)
    v_smfmac_f32_16x16x64_bf16 v[72:75], v[56:59], a[64:71], v2
    v_smfmac_f32_16x16x64_bf16 v[76:79], v[56:59], a[72:79], v2
    v_smfmac_f32_16x16x64_bf16 v[80:83], v[56:59], a[160:167], v2
    v_smfmac_f32_16x16x64_bf16 v[84:87], v[56:59], a[168:175], v2
    s_waitcnt lgkmcnt(0)
    v_smfmac_f32_16x16x64_bf16 v[72:75], v[60:63], a[80:87], v2
    v_smfmac_f32_16x16x64_bf16 v[76:79], v[60:63], a[88:95], v2
    v_smfmac_f32_16x16x64_bf16 v[80:83], v[60:63], a[176:183], v2
    v_smfmac_f32_16x16x64_bf16 v[84:87], v[60:63], a[184:191], v2
    v_add_f32 v72, v72, v74
    v_add_f32 v73, v73, v75
    v_add_f32 v76, v76, v78
    v_add_f32 v77, v77, v79
    v_add_f32 v80, v80, v82
    v_add_f32 v81, v81, v83
    v_add_f32 v84, v84, v86
    v_add_f32 v85, v85, v87
    v_cvt_pk_bf16_f32 v20, v72, v76
    v_cvt_pk_bf16_f32 v21, v73, v77
    v_cvt_pk_bf16_f32 v22, v80, v81
    v_cvt_pk_bf16_f32 v23, v84, v85
c_last_47:
    v_min_u32 v20, 0xfffffffe, v20
    v_min_u32 v21, 0xfffffffe, v21
    v_min_u32 v22, 0xfffffffe, v22
    v_min_u32 v23, 0xfffffffe, v23
    buffer_store_dwordx4 v[20:23], v1, s[4:7], s51 offen sc1
    s_branch L_exit
c_f0_51:
    buffer_load_dwordx4 v[96:99], v1, s[4:7], s48 offen offset:0 sc1
    buffer_load_dwordx4 v[100:103], v1, s[4:7], s48 offen offset:1024 sc1
    buffer_load_dwordx4 v[104:107], v1, s[4:7], s48 offen offset:2048 sc1
    buffer_load_dwordx4 v[108:111], v1, s[4:7], s48 offen offset:3072 sc1
    buffer_load_dwordx4 v[112:115], v1, s[4:7], s37 offen offset:0 sc1
    buffer_load_dwordx4 v[116:119], v1, s[4:7], s37 offen offset:1024 sc1
    buffer_load_dwordx4 v[120:123], v1, s[4:7], s37 offen offset:2048 sc1
    buffer_load_dwordx4 v[124:127], v1, s[4:7], s37 offen offset:3072 sc1
    s_nop 3
    s_nop 3
    s_nop 3
    s_nop 3
    s_nop 3
    s_nop 3
c_fa_52:
    v_mov_b64 v[12:13], 0
    buffer_load_dwordx4 v[72:75], v1, s[4:7], s48 offen offset:0 sc1
    buffer_load_dwordx4 v[76:79], v1, s[4:7], s48 offen offset:1024 sc1
    buffer_load_dwordx4 v[80:83], v1, s[4:7], s48 offen offset:2048 sc1
    buffer_load_dwordx4 v[84:87], v1, s[4:7], s48 offen offset:3072 sc1
    buffer_load_dwordx4 v[32:35], v1, s[4:7], s37 offen offset:0 sc1
    buffer_load_dwordx4 v[36:39], v1, s[4:7], s37 offen offset:1024 sc1
    buffer_load_dwordx4 v[64:67], v1, s[4:7], s37 offen offset:2048 sc1
    buffer_load_dwordx4 v[68:71], v1, s[4:7], s37 offen offset:3072 sc1
    s_waitcnt vmcnt(15)
    v_bitop3_b32 v11, v96, v98, s49 bitop3:0x7e
    s_waitcnt vmcnt(14)
    v_smfmac_f32_16x16x64_bf16 v[12:15], v[16:19], v[96:103], v29
    v_bitop3_b32 v11, v11, v100, s49 bitop3:0xf6
    v_bitop3_b32 v11, v11, v102, s49 bitop3:0xf6
    s_waitcnt vmcnt(13)
    v_bitop3_b32 v11, v11, v104, s49 bitop3:0xf6
    v_bitop3_b32 v11, v11, v106, s49 bitop3:0xf6
    s_waitcnt vmcnt(12)
    v_smfmac_f32_16x16x64_bf16 v[12:15], v[16:19], v[104:111], v29
    v_bitop3_b32 v11, v11, v108, s49 bitop3:0xf6
    v_bitop3_b32 v11, v11, v110, s49 bitop3:0xf6
    s_waitcnt vmcnt(11)
    v_bitop3_b32 v11, v11, v112, s49 bitop3:0xf6
    v_bitop3_b32 v11, v11, v114, s49 bitop3:0xf6
    s_waitcnt vmcnt(10)
    v_smfmac_f32_16x16x64_bf16 v[12:15], v[16:19], v[112:119], v29
    v_bitop3_b32 v11, v11, v116, s49 bitop3:0xf6
    v_bitop3_b32 v11, v11, v118, s49 bitop3:0xf6
    s_waitcnt vmcnt(9)
    v_bitop3_b32 v11, v11, v120, s49 bitop3:0xf6
    v_bitop3_b32 v11, v11, v122, s49 bitop3:0xf6
    s_waitcnt vmcnt(8)
    v_smfmac_f32_16x16x64_bf16 v[12:15], v[16:19], v[120:127], v29
    v_bitop3_b32 v11, v11, v124, s49 bitop3:0xf6
    v_bitop3_b32 v11, v11, v126, s49 bitop3:0xf6
    v_and_b32 v11, 1, v11
    v_cmp_ne_u32 vcc, 0, v11
    s_nop 1
    v_cvt_pk_bf16_f32 v14, v12, v13
    v_min_u32 v14, 0xfffffffe, v14
    s_cmp_eq_u64 vcc, 0
    s_cselect_b32 s30, 0x10000000, 0
    buffer_store_dword v14, v9, s[28:31], s42 offen sc1
    s_cbranch_scc0 c_fb_53
    s_branch c_late_54
c_fb_53:
    v_mov_b64 v[12:13], 0
    buffer_load_dwordx4 v[96:99], v1, s[4:7], s48 offen offset:0 sc1
    buffer_load_dwordx4 v[100:103], v1, s[4:7], s48 offen offset:1024 sc1
    buffer_load_dwordx4 v[104:107], v1, s[4:7], s48 offen offset:2048 sc1
    buffer_load_dwordx4 v[108:111], v1, s[4:7], s48 offen offset:3072 sc1
    buffer_load_dwordx4 v[112:115], v1, s[4:7], s37 offen offset:0 sc1
    buffer_load_dwordx4 v[116:119], v1, s[4:7], s37 offen offset:1024 sc1
    buffer_load_dwordx4 v[120:123], v1, s[4:7], s37 offen offset:2048 sc1
    buffer_load_dwordx4 v[124:127], v1, s[4:7], s37 offen offset:3072 sc1
    s_waitcnt vmcnt(15)
    v_bitop3_b32 v11, v72, v74, s49 bitop3:0x7e
    s_waitcnt vmcnt(14)
    v_smfmac_f32_16x16x64_bf16 v[12:15], v[16:19], v[72:79], v29
    v_bitop3_b32 v11, v11, v76, s49 bitop3:0xf6
    v_bitop3_b32 v11, v11, v78, s49 bitop3:0xf6
    s_waitcnt vmcnt(13)
    v_bitop3_b32 v11, v11, v80, s49 bitop3:0xf6
    v_bitop3_b32 v11, v11, v82, s49 bitop3:0xf6
    s_waitcnt vmcnt(12)
    v_smfmac_f32_16x16x64_bf16 v[12:15], v[16:19], v[80:87], v29
    v_bitop3_b32 v11, v11, v84, s49 bitop3:0xf6
    v_bitop3_b32 v11, v11, v86, s49 bitop3:0xf6
    s_waitcnt vmcnt(11)
    v_bitop3_b32 v11, v11, v32, s49 bitop3:0xf6
    v_bitop3_b32 v11, v11, v34, s49 bitop3:0xf6
    s_waitcnt vmcnt(10)
    v_smfmac_f32_16x16x64_bf16 v[12:15], v[16:19], v[32:39], v29
    v_bitop3_b32 v11, v11, v36, s49 bitop3:0xf6
    v_bitop3_b32 v11, v11, v38, s49 bitop3:0xf6
    s_waitcnt vmcnt(9)
    v_bitop3_b32 v11, v11, v64, s49 bitop3:0xf6
    v_bitop3_b32 v11, v11, v66, s49 bitop3:0xf6
    s_waitcnt vmcnt(8)
    v_smfmac_f32_16x16x64_bf16 v[12:15], v[16:19], v[64:71], v29
    v_bitop3_b32 v11, v11, v68, s49 bitop3:0xf6
    v_bitop3_b32 v11, v11, v70, s49 bitop3:0xf6
    v_and_b32 v11, 1, v11
    v_cmp_ne_u32 vcc, 0, v11
    s_nop 1
    v_cvt_pk_bf16_f32 v14, v12, v13
    v_min_u32 v14, 0xfffffffe, v14
    s_cmp_eq_u64 vcc, 0
    s_cselect_b32 s30, 0x10000000, 0
    buffer_store_dword v14, v9, s[28:31], s42 offen sc1
    s_cbranch_scc0 c_chk_56
    s_branch c_late_54
c_chk_56:
    s_add_u32 s35, s35, 1
    s_cmp_lt_u32 s35, 524288
    s_cbranch_scc1 c_fa_52
    v_cvt_pk_bf16_f32 v14, v12, v13
    v_min_u32 v14, 0xfffffffe, v14
    buffer_store_dword v14, v9, s[4:7], s42 offen offset:0 sc1
c_late_54:
    s_nop 3
    s_nop 3
    s_barrier
    buffer_load_dwordx4 v[32:35], v1, s[4:7], s41 offen sc1
    buffer_load_dwordx4 v[36:39], v1, s[4:7], s71 offen sc1
    s_waitcnt vmcnt(3)
    v_mov_b64 v[64:65], 0
    v_mov_b64 v[66:67], 0
    v_mov_b64 v[68:69], 0
    v_mov_b64 v[70:71], 0
    v_mov_b64 v[72:73], 0
    v_mov_b64 v[74:75], 0
    v_mov_b64 v[76:77], 0
    v_mov_b64 v[78:79], 0
    v_mov_b64 v[80:81], 0
    v_mov_b64 v[82:83], 0
    v_mov_b64 v[84:85], 0
    v_mov_b64 v[86:87], 0
    s_branch c_pub_55
c_oth_46:
    ds_read_b128 v[40:43], v0 offset:0
    ds_read_b128 v[44:47], v0 offset:1024
    ds_read_b128 v[48:51], v0 offset:2048
    ds_read_b128 v[52:55], v0 offset:3072
    ds_read_b128 v[56:59], v0 offset:4096
    ds_read_b128 v[60:63], v0 offset:5120
    ds_read_b128 v[88:91], v0 offset:6144
    ds_read_b128 v[92:95], v0 offset:7168
    ds_read_b128 v[96:99], v0 offset:8192
    ds_read_b128 v[100:103], v0 offset:9216
    ds_read_b128 v[104:107], v0 offset:10240
    ds_read_b128 v[108:111], v0 offset:11264
    ds_read_b128 v[112:115], v0 offset:12288
    ds_read_b128 v[116:119], v0 offset:13312
    ds_read_b128 v[120:123], v0 offset:14336
    ds_read_b128 v[124:127], v0 offset:15360
    v_mov_b64 v[64:65], 0
    v_mov_b64 v[66:67], 0
    v_mov_b64 v[68:69], 0
    v_mov_b64 v[70:71], 0
    v_mov_b64 v[72:73], 0
    v_mov_b64 v[74:75], 0
    v_mov_b64 v[76:77], 0
    v_mov_b64 v[78:79], 0
    v_mov_b64 v[80:81], 0
    v_mov_b64 v[82:83], 0
    v_mov_b64 v[84:85], 0
    v_mov_b64 v[86:87], 0
    v_xor_b32 v13, 2048, v3
    v_xor_b32 v14, 4096, v3
    v_xor_b32 v15, 6144, v3
    s_xor_b32 s44, s44, 524288
    s_xor_b32 s45, s45, 524288
    s_xor_b32 s46, s46, 524288
    s_xor_b32 s47, s47, 524288
    s_add_u32 s50, s50, 32768
    s_xor_b32 s59, s59, 0x6000
    s_add_u32 s57, s57, s63
    s_add_u32 s38, s60, 24576
    s_and_b32 s38, s38, 0x7fff
    s_add_u32 s43, s38, 11534336
    s_add_u32 s36, s60, 8192
    s_and_b32 s60, s36, 0x7fff
    s_and_b32 s56, s40, 1
    s_add_u32 s40, s40, 1
    s_xor_b32 s48, s48, 524288
    s_xor_b32 s49, s49, s56
    s_add_u32 s42, s60, 11534336
    s_cmp_lg_u32 s32, 1
    s_cbranch_scc1 c_fo_58
    s_add_u32 s36, s40, 1
    s_lshr_b32 s56, s36, 1
    s_add_u32 s56, s56, 1
    s_min_u32 s56, s56, 32
    s_bitcmp1_b32 s36, 0
    s_cselect_b32 s38, 0xf00, 0xf
    s_mov_b32 s39, 0
    s_waitcnt vmcnt(8)
    v_max_u32 v11, v11, v7
    s_add_u32 s36, s56, 1
    s_min_u32 s36, s36, 32
    v_cmp_gt_u32 vcc, s36, v11
    s_nop 0
    s_and_b32 vcc_lo, vcc_lo, 0xf0f
    s_cselect_b32 s26, 256, 0
c_fc_57:
    v_cmp_gt_u32 vcc, s56, v11
    s_nop 0
    s_and_b64 vcc, vcc, s[38:39]
    s_cbranch_scc0 c_fo_58
    buffer_load_dword v11, v1, s[4:7], s57 offen sc1
    s_add_u32 s35, s35, 1
    s_cmp_lt_u32 s35, 524288
    s_waitcnt vmcnt(0)
    s_cbranch_scc1 c_fc_57
c_fo_58:
c_join_48:
    s_barrier
    buffer_load_dwordx4 v[32:35], v1, s[4:7], s41 offen sc1
    buffer_load_dwordx4 v[36:39], v1, s[4:7], s71 offen sc1
    s_nop 3
    s_nop 3
    s_nop 3
    s_nop 3
    s_nop 3
    s_nop 3
    s_nop 3
    s_nop 3
    s_nop 3
    buffer_load_dwordx4 v[32:35], v1, s[4:7], s41 offen sc1
    buffer_load_dwordx4 v[36:39], v1, s[4:7], s71 offen sc1
    s_branch c_top_41
c_r2_44:
    s_mov_b64 exec, vcc
    buffer_load_dwordx4 v[32:35], v1, s[4:7], s41 offen sc1
    buffer_load_dwordx4 v[36:39], v1, s[4:7], s71 offen sc1
    s_mov_b64 exec, -1
    s_add_u32 s35, s35, 1
    s_cmp_lt_u32 s35, 524288
    v_mov_b64 v[64:65], 0
    v_mov_b64 v[66:67], 0
    v_mov_b64 v[68:69], 0
    v_mov_b64 v[70:71], 0
    s_waitcnt vmcnt(2)
    s_cbranch_scc1 c_c2_49
    s_branch c_go2_43
c_r2b_59:
    v_max3_u32 v12, v32, v33, v34
    v_max3_u32 v0, v35, v36, v37
    v_max3_u32 v12, v12, v38, v39
    v_max_u32 v12, v12, v0
    v_cmp_eq_u32 vcc, -1, v12
    s_cbranch_vccz c_p2_42
    s_mov_b64 exec, vcc
    buffer_load_dwordx4 v[32:35], v1, s[4:7], s41 offen sc1
    buffer_load_dwordx4 v[36:39], v1, s[4:7], s71 offen sc1
    s_mov_b64 exec, -1
    s_add_u32 s35, s35, 1
    s_cmp_lt_u32 s35, 524288
    s_waitcnt vmcnt(6)
    s_cbranch_scc1 c_r2b_59
    s_branch c_go2_43
L_t1:
    s_load_dwordx2 s[12:13], s[0:1], 24
    s_load_dwordx2 s[16:17], s[0:1], 32
    s_load_dwordx2 s[20:21], s[0:1], 16
    s_waitcnt lgkmcnt(0)
    s_mov_b32 s14, 0x400000
    s_mov_b32 s15, 0x20000
    s_mov_b32 s18, 0x400000
    s_mov_b32 s19, 0x20000
    s_mov_b32 s22, 0x400000
    s_mov_b32 s23, 0x20000
    v_lshlrev_b32 v1, 4, v0
    v_cmp_eq_u32 vcc, 0, v0
    v_mov_b32 v2, 0x80000000
    s_nop 0
    v_cndmask_b32 v2, v2, 0, vcc
    s_sub_u32 s36, s34, 1
    s_lshl_b32 s36, s36, 4
    s_lshr_b32 s37, s33, 1
    s_add_u32 s48, s36, s37
    s_and_b32 s45, s33, 1
    s_lshl_b32 s49, s48, 8
    v_lshrrev_b32 v11, 4, v0
    v_lshlrev_b32 v12, 2, v11
    v_and_b32 v13, 15, v0
    v_xor_b32 v12, v12, v13
    s_lshl_b32 s36, s32, 4
    v_add_u32 v11, s36, v11
    v_mul_u32_u24 v11, 8192, v11
    v_lshl_add_u32 v11, v12, 4, v11
    v_add_u32 v3, s49, v11
    v_bfe_u32 v11, v0, 2, 2
    v_lshrrev_b32 v12, 5, v0
    v_lshl_add_u32 v12, v12, 3, v11
    v_lshlrev_b32 v12, 8, v12
    s_lshl_b32 s36, s32, 1
    v_bfe_u32 v13, v0, 4, 1
    v_and_b32 v6, 3, v0
    v_lshlrev_b32 v6, 3, v6
    v_add_u32 v13, s36, v13
    v_lshlrev_b32 v11, 1, v11
    v_xor_b32 v13, v13, v11
    v_lshl_add_u32 v12, v13, 5, v12
    v_add_u32 v4, v12, v6
    v_add_u32 v5, 65536, v4
    s_cmp_lg_u32 s45, 0
    s_cbranch_scc1 ld1_60
    s_lshl_b32 s46, s32, 12
    s_add_u32 s46, s46, 0
    s_add_u32 m0, s46, 0
    s_mov_b32 s36, 0
    buffer_load_dwordx4 v3, s[12:15], s36 offen lds
    s_add_u32 m0, s46, 1024
    s_mov_b32 s36, 32768
    buffer_load_dwordx4 v3, s[12:15], s36 offen lds
    s_add_u32 m0, s46, 2048
    s_mov_b32 s36, 65536
    buffer_load_dwordx4 v3, s[12:15], s36 offen lds
    s_add_u32 m0, s46, 3072
    s_mov_b32 s36, 98304
    buffer_load_dwordx4 v3, s[12:15], s36 offen lds
    s_add_u32 m0, s46, 16384
    s_mov_b32 s36, 524288
    buffer_load_dwordx4 v3, s[12:15], s36 offen lds
    s_add_u32 m0, s46, 17408
    s_mov_b32 s36, 557056
    buffer_load_dwordx4 v3, s[12:15], s36 offen lds
    s_add_u32 m0, s46, 18432
    s_mov_b32 s36, 589824
    buffer_load_dwordx4 v3, s[12:15], s36 offen lds
    s_add_u32 m0, s46, 19456
    s_mov_b32 s36, 622592
    buffer_load_dwordx4 v3, s[12:15], s36 offen lds
    s_add_u32 m0, s46, 32768
    s_mov_b32 s36, 1048576
    buffer_load_dwordx4 v3, s[12:15], s36 offen lds
    s_add_u32 m0, s46, 33792
    s_mov_b32 s36, 1081344
    buffer_load_dwordx4 v3, s[12:15], s36 offen lds
    s_add_u32 m0, s46, 34816
    s_mov_b32 s36, 1114112
    buffer_load_dwordx4 v3, s[12:15], s36 offen lds
    s_add_u32 m0, s46, 35840
    s_mov_b32 s36, 1146880
    buffer_load_dwordx4 v3, s[12:15], s36 offen lds
    s_add_u32 m0, s46, 49152
    s_mov_b32 s36, 1572864
    buffer_load_dwordx4 v3, s[12:15], s36 offen lds
    s_add_u32 m0, s46, 50176
    s_mov_b32 s36, 1605632
    buffer_load_dwordx4 v3, s[12:15], s36 offen lds
    s_add_u32 m0, s46, 51200
    s_mov_b32 s36, 1638400
    buffer_load_dwordx4 v3, s[12:15], s36 offen lds
    s_add_u32 m0, s46, 52224
    s_mov_b32 s36, 1671168
    buffer_load_dwordx4 v3, s[12:15], s36 offen lds
    s_add_u32 m0, s46, 65536
    s_mov_b32 s36, 2097152
    buffer_load_dwordx4 v3, s[12:15], s36 offen lds
    s_add_u32 m0, s46, 66560
    s_mov_b32 s36, 2129920
    buffer_load_dwordx4 v3, s[12:15], s36 offen lds
    s_add_u32 m0, s46, 67584
    s_mov_b32 s36, 2162688
    buffer_load_dwordx4 v3, s[12:15], s36 offen lds
    s_add_u32 m0, s46, 68608
    s_mov_b32 s36, 2195456
    buffer_load_dwordx4 v3, s[12:15], s36 offen lds
    s_add_u32 m0, s46, 81920
    s_mov_b32 s36, 2621440
    buffer_load_dwordx4 v3, s[12:15], s36 offen lds
    s_add_u32 m0, s46, 82944
    s_mov_b32 s36, 2654208
    buffer_load_dwordx4 v3, s[12:15], s36 offen lds
    s_add_u32 m0, s46, 83968
    s_mov_b32 s36, 2686976
    buffer_load_dwordx4 v3, s[12:15], s36 offen lds
    s_add_u32 m0, s46, 84992
    s_mov_b32 s36, 2719744
    buffer_load_dwordx4 v3, s[12:15], s36 offen lds
    s_add_u32 m0, s46, 98304
    s_mov_b32 s36, 3145728
    buffer_load_dwordx4 v3, s[12:15], s36 offen lds
    s_add_u32 m0, s46, 99328
    s_mov_b32 s36, 3178496
    buffer_load_dwordx4 v3, s[12:15], s36 offen lds
    s_add_u32 m0, s46, 100352
    s_mov_b32 s36, 3211264
    buffer_load_dwordx4 v3, s[12:15], s36 offen lds
    s_add_u32 m0, s46, 101376
    s_mov_b32 s36, 3244032
    buffer_load_dwordx4 v3, s[12:15], s36 offen lds
    s_waitcnt vmcnt(24) lgkmcnt(0)
    s_barrier
    s_add_u32 m0, s46, 114688
    s_mov_b32 s36, 3670016
    buffer_load_dwordx4 v3, s[12:15], s36 offen lds
    s_add_u32 m0, s46, 115712
    s_mov_b32 s36, 3702784
    buffer_load_dwordx4 v3, s[12:15], s36 offen lds
    s_add_u32 m0, s46, 116736
    s_mov_b32 s36, 3735552
    buffer_load_dwordx4 v3, s[12:15], s36 offen lds
    s_add_u32 m0, s46, 117760
    s_mov_b32 s36, 3768320
    buffer_load_dwordx4 v3, s[12:15], s36 offen lds
    ds_read_b64_tr_b16 v[128:129], v4 offset:0
    ds_read_b64_tr_b16 v[130:131], v4 offset:1024
    ds_read_b64_tr_b16 v[132:133], v4 offset:4096
    ds_read_b64_tr_b16 v[134:135], v4 offset:5120
    ds_read_b64_tr_b16 v[136:137], v4 offset:8192
    ds_read_b64_tr_b16 v[138:139], v4 offset:9216
    ds_read_b64_tr_b16 v[140:141], v4 offset:12288
    ds_read_b64_tr_b16 v[142:143], v4 offset:13312
    s_waitcnt vmcnt(24) lgkmcnt(0)
    s_barrier
    s_add_u32 m0, s46, 0
    s_mov_b32 s36, 0
    buffer_load_dwordx4 v3, s[16:19], s36 offen lds
    s_add_u32 m0, s46, 1024
    s_mov_b32 s36, 32768
    buffer_load_dwordx4 v3, s[16:19], s36 offen lds
    s_add_u32 m0, s46, 2048
    s_mov_b32 s36, 65536
    buffer_load_dwordx4 v3, s[16:19], s36 offen lds
    s_add_u32 m0, s46, 3072
    s_mov_b32 s36, 98304
    buffer_load_dwordx4 v3, s[16:19], s36 offen lds
    ds_read_b64_tr_b16 v[144:145], v4 offset:16384
    ds_read_b64_tr_b16 v[146:147], v4 offset:17408
    ds_read_b64_tr_b16 v[148:149], v4 offset:20480
    ds_read_b64_tr_b16 v[150:151], v4 offset:21504
    ds_read_b64_tr_b16 v[152:153], v4 offset:24576
    ds_read_b64_tr_b16 v[154:155], v4 offset:25600
    ds_read_b64_tr_b16 v[156:157], v4 offset:28672
    ds_read_b64_tr_b16 v[158:159], v4 offset:29696
    s_waitcnt vmcnt(24) lgkmcnt(0)
    s_barrier
    s_add_u32 m0, s46, 16384
    s_mov_b32 s36, 524288
    buffer_load_dwordx4 v3, s[16:19], s36 offen lds
    s_add_u32 m0, s46, 17408
    s_mov_b32 s36, 557056
    buffer_load_dwordx4 v3, s[16:19], s36 offen lds
    s_add_u32 m0, s46, 18432
    s_mov_b32 s36, 589824
    buffer_load_dwordx4 v3, s[16:19], s36 offen lds
    s_add_u32 m0, s46, 19456
    s_mov_b32 s36, 622592
    buffer_load_dwordx4 v3, s[16:19], s36 offen lds
    ds_read_b64_tr_b16 v[160:161], v4 offset:32768
    ds_read_b64_tr_b16 v[162:163], v4 offset:33792
    ds_read_b64_tr_b16 v[164:165], v4 offset:36864
    ds_read_b64_tr_b16 v[166:167], v4 offset:37888
    ds_read_b64_tr_b16 v[168:169], v4 offset:40960
    ds_read_b64_tr_b16 v[170:171], v4 offset:41984
    ds_read_b64_tr_b16 v[172:173], v4 offset:45056
    ds_read_b64_tr_b16 v[174:175], v4 offset:46080
    s_waitcnt vmcnt(24) lgkmcnt(0)
    s_barrier
    s_add_u32 m0, s46, 32768
    s_mov_b32 s36, 1048576
    buffer_load_dwordx4 v3, s[16:19], s36 offen lds
    s_add_u32 m0, s46, 33792
    s_mov_b32 s36, 1081344
    buffer_load_dwordx4 v3, s[16:19], s36 offen lds
    s_add_u32 m0, s46, 34816
    s_mov_b32 s36, 1114112
    buffer_load_dwordx4 v3, s[16:19], s36 offen lds
    s_add_u32 m0, s46, 35840
    s_mov_b32 s36, 1146880
    buffer_load_dwordx4 v3, s[16:19], s36 offen lds
    ds_read_b64_tr_b16 v[176:177], v4 offset:49152
    ds_read_b64_tr_b16 v[178:179], v4 offset:50176
    ds_read_b64_tr_b16 v[180:181], v4 offset:53248
    ds_read_b64_tr_b16 v[182:183], v4 offset:54272
    ds_read_b64_tr_b16 v[184:185], v4 offset:57344
    ds_read_b64_tr_b16 v[186:187], v4 offset:58368
    ds_read_b64_tr_b16 v[188:189], v4 offset:61440
    ds_read_b64_tr_b16 v[190:191], v4 offset:62464
    s_waitcnt vmcnt(24) lgkmcnt(0)
    s_barrier
    s_add_u32 m0, s46, 49152
    s_mov_b32 s36, 1572864
    buffer_load_dwordx4 v3, s[16:19], s36 offen lds
    s_add_u32 m0, s46, 50176
    s_mov_b32 s36, 1605632
    buffer_load_dwordx4 v3, s[16:19], s36 offen lds
    s_add_u32 m0, s46, 51200
    s_mov_b32 s36, 1638400
    buffer_load_dwordx4 v3, s[16:19], s36 offen lds
    s_add_u32 m0, s46, 52224
    s_mov_b32 s36, 1671168
    buffer_load_dwordx4 v3, s[16:19], s36 offen lds
    ds_read_b64_tr_b16 v[192:193], v5 offset:0
    ds_read_b64_tr_b16 v[194:195], v5 offset:1024
    ds_read_b64_tr_b16 v[196:197], v5 offset:4096
    ds_read_b64_tr_b16 v[198:199], v5 offset:5120
    ds_read_b64_tr_b16 v[200:201], v5 offset:8192
    ds_read_b64_tr_b16 v[202:203], v5 offset:9216
    ds_read_b64_tr_b16 v[204:205], v5 offset:12288
    ds_read_b64_tr_b16 v[206:207], v5 offset:13312
    s_waitcnt vmcnt(24) lgkmcnt(0)
    s_barrier
    s_add_u32 m0, s46, 65536
    s_mov_b32 s36, 2097152
    buffer_load_dwordx4 v3, s[16:19], s36 offen lds
    s_add_u32 m0, s46, 66560
    s_mov_b32 s36, 2129920
    buffer_load_dwordx4 v3, s[16:19], s36 offen lds
    s_add_u32 m0, s46, 67584
    s_mov_b32 s36, 2162688
    buffer_load_dwordx4 v3, s[16:19], s36 offen lds
    s_add_u32 m0, s46, 68608
    s_mov_b32 s36, 2195456
    buffer_load_dwordx4 v3, s[16:19], s36 offen lds
    ds_read_b64_tr_b16 v[208:209], v5 offset:16384
    ds_read_b64_tr_b16 v[210:211], v5 offset:17408
    ds_read_b64_tr_b16 v[212:213], v5 offset:20480
    ds_read_b64_tr_b16 v[214:215], v5 offset:21504
    ds_read_b64_tr_b16 v[216:217], v5 offset:24576
    ds_read_b64_tr_b16 v[218:219], v5 offset:25600
    ds_read_b64_tr_b16 v[220:221], v5 offset:28672
    ds_read_b64_tr_b16 v[222:223], v5 offset:29696
    s_waitcnt vmcnt(24) lgkmcnt(0)
    s_barrier
    s_add_u32 m0, s46, 81920
    s_mov_b32 s36, 2621440
    buffer_load_dwordx4 v3, s[16:19], s36 offen lds
    s_add_u32 m0, s46, 82944
    s_mov_b32 s36, 2654208
    buffer_load_dwordx4 v3, s[16:19], s36 offen lds
    s_add_u32 m0, s46, 83968
    s_mov_b32 s36, 2686976
    buffer_load_dwordx4 v3, s[16:19], s36 offen lds
    s_add_u32 m0, s46, 84992
    s_mov_b32 s36, 2719744
    buffer_load_dwordx4 v3, s[16:19], s36 offen lds
    ds_read_b64_tr_b16 v[224:225], v5 offset:32768
    ds_read_b64_tr_b16 v[226:227], v5 offset:33792
    ds_read_b64_tr_b16 v[228:229], v5 offset:36864
    ds_read_b64_tr_b16 v[230:231], v5 offset:37888
    ds_read_b64_tr_b16 v[232:233], v5 offset:40960
    ds_read_b64_tr_b16 v[234:235], v5 offset:41984
    ds_read_b64_tr_b16 v[236:237], v5 offset:45056
    ds_read_b64_tr_b16 v[238:239], v5 offset:46080
    s_waitcnt vmcnt(24) lgkmcnt(0)
    s_barrier
    s_add_u32 m0, s46, 98304
    s_mov_b32 s36, 3145728
    buffer_load_dwordx4 v3, s[16:19], s36 offen lds
    s_add_u32 m0, s46, 99328
    s_mov_b32 s36, 3178496
    buffer_load_dwordx4 v3, s[16:19], s36 offen lds
    s_add_u32 m0, s46, 100352
    s_mov_b32 s36, 3211264
    buffer_load_dwordx4 v3, s[16:19], s36 offen lds
    s_add_u32 m0, s46, 101376
    s_mov_b32 s36, 3244032
    buffer_load_dwordx4 v3, s[16:19], s36 offen lds
    ds_read_b64_tr_b16 v[240:241], v5 offset:49152
    ds_read_b64_tr_b16 v[242:243], v5 offset:50176
    ds_read_b64_tr_b16 v[244:245], v5 offset:53248
    ds_read_b64_tr_b16 v[246:247], v5 offset:54272
    ds_read_b64_tr_b16 v[248:249], v5 offset:57344
    ds_read_b64_tr_b16 v[250:251], v5 offset:58368
    ds_read_b64_tr_b16 v[252:253], v5 offset:61440
    ds_read_b64_tr_b16 v[254:255], v5 offset:62464
    s_waitcnt vmcnt(24) lgkmcnt(0)
    s_barrier
    s_add_u32 m0, s46, 114688
    s_mov_b32 s36, 3670016
    buffer_load_dwordx4 v3, s[16:19], s36 offen lds
    s_add_u32 m0, s46, 115712
    s_mov_b32 s36, 3702784
    buffer_load_dwordx4 v3, s[16:19], s36 offen lds
    s_add_u32 m0, s46, 116736
    s_mov_b32 s36, 3735552
    buffer_load_dwordx4 v3, s[16:19], s36 offen lds
    s_add_u32 m0, s46, 117760
    s_mov_b32 s36, 3768320
    buffer_load_dwordx4 v3, s[16:19], s36 offen lds
    ds_read_b64_tr_b16 a[0:1], v4 offset:0
    ds_read_b64_tr_b16 a[2:3], v4 offset:1024
    ds_read_b64_tr_b16 a[4:5], v4 offset:4096
    ds_read_b64_tr_b16 a[6:7], v4 offset:5120
    ds_read_b64_tr_b16 a[8:9], v4 offset:8192
    ds_read_b64_tr_b16 a[10:11], v4 offset:9216
    ds_read_b64_tr_b16 a[12:13], v4 offset:12288
    ds_read_b64_tr_b16 a[14:15], v4 offset:13312
    s_waitcnt vmcnt(24) lgkmcnt(0)
    s_barrier
    s_add_u32 m0, s46, 0
    s_mov_b32 s36, 0
    buffer_load_dwordx4 v3, s[20:23], s36 offen lds
    s_add_u32 m0, s46, 1024
    s_mov_b32 s36, 32768
    buffer_load_dwordx4 v3, s[20:23], s36 offen lds
    s_add_u32 m0, s46, 2048
    s_mov_b32 s36, 65536
    buffer_load_dwordx4 v3, s[20:23], s36 offen lds
    s_add_u32 m0, s46, 3072
    s_mov_b32 s36, 98304
    buffer_load_dwordx4 v3, s[20:23], s36 offen lds
    ds_read_b64_tr_b16 a[16:17], v4 offset:16384
    ds_read_b64_tr_b16 a[18:19], v4 offset:17408
    ds_read_b64_tr_b16 a[20:21], v4 offset:20480
    ds_read_b64_tr_b16 a[22:23], v4 offset:21504
    ds_read_b64_tr_b16 a[24:25], v4 offset:24576
    ds_read_b64_tr_b16 a[26:27], v4 offset:25600
    ds_read_b64_tr_b16 a[28:29], v4 offset:28672
    ds_read_b64_tr_b16 a[30:31], v4 offset:29696
    s_waitcnt vmcnt(24) lgkmcnt(0)
    s_barrier
    s_add_u32 m0, s46, 16384
    s_mov_b32 s36, 524288
    buffer_load_dwordx4 v3, s[20:23], s36 offen lds
    s_add_u32 m0, s46, 17408
    s_mov_b32 s36, 557056
    buffer_load_dwordx4 v3, s[20:23], s36 offen lds
    s_add_u32 m0, s46, 18432
    s_mov_b32 s36, 589824
    buffer_load_dwordx4 v3, s[20:23], s36 offen lds
    s_add_u32 m0, s46, 19456
    s_mov_b32 s36, 622592
    buffer_load_dwordx4 v3, s[20:23], s36 offen lds
    ds_read_b64_tr_b16 a[32:33], v4 offset:32768
    ds_read_b64_tr_b16 a[34:35], v4 offset:33792
    ds_read_b64_tr_b16 a[36:37], v4 offset:36864
    ds_read_b64_tr_b16 a[38:39], v4 offset:37888
    ds_read_b64_tr_b16 a[40:41], v4 offset:40960
    ds_read_b64_tr_b16 a[42:43], v4 offset:41984
    ds_read_b64_tr_b16 a[44:45], v4 offset:45056
    ds_read_b64_tr_b16 a[46:47], v4 offset:46080
    s_waitcnt vmcnt(24) lgkmcnt(0)
    s_barrier
    s_add_u32 m0, s46, 32768
    s_mov_b32 s36, 1048576
    buffer_load_dwordx4 v3, s[20:23], s36 offen lds
    s_add_u32 m0, s46, 33792
    s_mov_b32 s36, 1081344
    buffer_load_dwordx4 v3, s[20:23], s36 offen lds
    s_add_u32 m0, s46, 34816
    s_mov_b32 s36, 1114112
    buffer_load_dwordx4 v3, s[20:23], s36 offen lds
    s_add_u32 m0, s46, 35840
    s_mov_b32 s36, 1146880
    buffer_load_dwordx4 v3, s[20:23], s36 offen lds
    ds_read_b64_tr_b16 a[48:49], v4 offset:49152
    ds_read_b64_tr_b16 a[50:51], v4 offset:50176
    ds_read_b64_tr_b16 a[52:53], v4 offset:53248
    ds_read_b64_tr_b16 a[54:55], v4 offset:54272
    ds_read_b64_tr_b16 a[56:57], v4 offset:57344
    ds_read_b64_tr_b16 a[58:59], v4 offset:58368
    ds_read_b64_tr_b16 a[60:61], v4 offset:61440
    ds_read_b64_tr_b16 a[62:63], v4 offset:62464
    s_waitcnt vmcnt(24) lgkmcnt(0)
    s_barrier
    s_add_u32 m0, s46, 49152
    s_mov_b32 s36, 1572864
    buffer_load_dwordx4 v3, s[20:23], s36 offen lds
    s_add_u32 m0, s46, 50176
    s_mov_b32 s36, 1605632
    buffer_load_dwordx4 v3, s[20:23], s36 offen lds
    s_add_u32 m0, s46, 51200
    s_mov_b32 s36, 1638400
    buffer_load_dwordx4 v3, s[20:23], s36 offen lds
    s_add_u32 m0, s46, 52224
    s_mov_b32 s36, 1671168
    buffer_load_dwordx4 v3, s[20:23], s36 offen lds
    ds_read_b64_tr_b16 a[64:65], v5 offset:0
    ds_read_b64_tr_b16 a[66:67], v5 offset:1024
    ds_read_b64_tr_b16 a[68:69], v5 offset:4096
    ds_read_b64_tr_b16 a[70:71], v5 offset:5120
    ds_read_b64_tr_b16 a[72:73], v5 offset:8192
    ds_read_b64_tr_b16 a[74:75], v5 offset:9216
    ds_read_b64_tr_b16 a[76:77], v5 offset:12288
    ds_read_b64_tr_b16 a[78:79], v5 offset:13312
    s_waitcnt vmcnt(24) lgkmcnt(0)
    s_barrier
    s_add_u32 m0, s46, 65536
    s_mov_b32 s36, 2097152
    buffer_load_dwordx4 v3, s[20:23], s36 offen lds
    s_add_u32 m0, s46, 66560
    s_mov_b32 s36, 2129920
    buffer_load_dwordx4 v3, s[20:23], s36 offen lds
    s_add_u32 m0, s46, 67584
    s_mov_b32 s36, 2162688
    buffer_load_dwordx4 v3, s[20:23], s36 offen lds
    s_add_u32 m0, s46, 68608
    s_mov_b32 s36, 2195456
    buffer_load_dwordx4 v3, s[20:23], s36 offen lds
    ds_read_b64_tr_b16 a[80:81], v5 offset:16384
    ds_read_b64_tr_b16 a[82:83], v5 offset:17408
    ds_read_b64_tr_b16 a[84:85], v5 offset:20480
    ds_read_b64_tr_b16 a[86:87], v5 offset:21504
    ds_read_b64_tr_b16 a[88:89], v5 offset:24576
    ds_read_b64_tr_b16 a[90:91], v5 offset:25600
    ds_read_b64_tr_b16 a[92:93], v5 offset:28672
    ds_read_b64_tr_b16 a[94:95], v5 offset:29696
    s_waitcnt vmcnt(24) lgkmcnt(0)
    s_barrier
    s_add_u32 m0, s46, 81920
    s_mov_b32 s36, 2621440
    buffer_load_dwordx4 v3, s[20:23], s36 offen lds
    s_add_u32 m0, s46, 82944
    s_mov_b32 s36, 2654208
    buffer_load_dwordx4 v3, s[20:23], s36 offen lds
    s_add_u32 m0, s46, 83968
    s_mov_b32 s36, 2686976
    buffer_load_dwordx4 v3, s[20:23], s36 offen lds
    s_add_u32 m0, s46, 84992
    s_mov_b32 s36, 2719744
    buffer_load_dwordx4 v3, s[20:23], s36 offen lds
    ds_read_b64_tr_b16 a[96:97], v5 offset:32768
    ds_read_b64_tr_b16 a[98:99], v5 offset:33792
    ds_read_b64_tr_b16 a[100:101], v5 offset:36864
    ds_read_b64_tr_b16 a[102:103], v5 offset:37888
    ds_read_b64_tr_b16 a[104:105], v5 offset:40960
    ds_read_b64_tr_b16 a[106:107], v5 offset:41984
    ds_read_b64_tr_b16 a[108:109], v5 offset:45056
    ds_read_b64_tr_b16 a[110:111], v5 offset:46080
    s_waitcnt vmcnt(24) lgkmcnt(0)
    s_barrier
    s_add_u32 m0, s46, 98304
    s_mov_b32 s36, 3145728
    buffer_load_dwordx4 v3, s[20:23], s36 offen lds
    s_add_u32 m0, s46, 99328
    s_mov_b32 s36, 3178496
    buffer_load_dwordx4 v3, s[20:23], s36 offen lds
    s_add_u32 m0, s46, 100352
    s_mov_b32 s36, 3211264
    buffer_load_dwordx4 v3, s[20:23], s36 offen lds
    s_add_u32 m0, s46, 101376
    s_mov_b32 s36, 3244032
    buffer_load_dwordx4 v3, s[20:23], s36 offen lds
    ds_read_b64_tr_b16 a[112:113], v5 offset:49152
    ds_read_b64_tr_b16 a[114:115], v5 offset:50176
    ds_read_b64_tr_b16 a[116:117], v5 offset:53248
    ds_read_b64_tr_b16 a[118:119], v5 offset:54272
    ds_read_b64_tr_b16 a[120:121], v5 offset:57344
    ds_read_b64_tr_b16 a[122:123], v5 offset:58368
    ds_read_b64_tr_b16 a[124:125], v5 offset:61440
    ds_read_b64_tr_b16 a[126:127], v5 offset:62464
    s_waitcnt vmcnt(24) lgkmcnt(0)
    s_barrier
    s_add_u32 m0, s46, 114688
    s_mov_b32 s36, 3670016
    buffer_load_dwordx4 v3, s[20:23], s36 offen lds
    s_add_u32 m0, s46, 115712
    s_mov_b32 s36, 3702784
    buffer_load_dwordx4 v3, s[20:23], s36 offen lds
    s_add_u32 m0, s46, 116736
    s_mov_b32 s36, 3735552
    buffer_load_dwordx4 v3, s[20:23], s36 offen lds
    s_add_u32 m0, s46, 117760
    s_mov_b32 s36, 3768320
    buffer_load_dwordx4 v3, s[20:23], s36 offen lds
    ds_read_b64_tr_b16 a[128:129], v4 offset:0
    ds_read_b64_tr_b16 a[130:131], v4 offset:1024
    ds_read_b64_tr_b16 a[132:133], v4 offset:4096
    ds_read_b64_tr_b16 a[134:135], v4 offset:5120
    ds_read_b64_tr_b16 a[136:137], v4 offset:8192
    ds_read_b64_tr_b16 a[138:139], v4 offset:9216
    ds_read_b64_tr_b16 a[140:141], v4 offset:12288
    ds_read_b64_tr_b16 a[142:143], v4 offset:13312
    s_waitcnt vmcnt(24) lgkmcnt(0)
    s_barrier
    v_mbcnt_lo_u32_b32 v12, -1, 0
    v_mbcnt_hi_u32_b32 v12, -1, v12
    v_lshlrev_b32 v12, 5, v12
wt_62:
    buffer_load_dword v11, v12, s[8:11], 0 offen sc1
    s_waitcnt vmcnt(0)
    v_readlane_b32 s36, v11, 0
    v_readlane_b32 s37, v11, 1
    s_nop 0
    s_add_u32 s36, s36, s37
    v_readlane_b32 s37, v11, 2
    s_nop 0
    s_add_u32 s36, s36, s37
    v_readlane_b32 s37, v11, 3
    s_nop 0
    s_add_u32 s36, s36, s37
    v_readlane_b32 s37, v11, 4
    s_nop 0
    s_add_u32 s36, s36, s37
    v_readlane_b32 s37, v11, 5
    s_nop 0
    s_add_u32 s36, s36, s37
    v_readlane_b32 s37, v11, 6
    s_nop 0
    s_add_u32 s36, s36, s37
    v_readlane_b32 s37, v11, 7
    s_nop 0
    s_add_u32 s36, s36, s37
    s_cmp_ge_u32 s36, 256
    s_cbranch_scc1 wtd_63
    s_sleep 2
    s_add_u32 s35, s35, 1
    s_cmp_lt_u32 s35, 524288
    s_cbranch_scc1 wt_62
wtd_63:
    v_readlane_b32 s55, v11, s34
    s_mov_b32 s38, 11829248
    v_lshlrev_b32 v11, 7, v0
    v_add_u32 v12, 8192, v11
wf_64:
    buffer_load_dwordx4 v[16:19], v11, s[4:7], s38 offen sc1
    buffer_load_dwordx4 v[20:23], v12, s[4:7], s38 offen sc1
    s_waitcnt vmcnt(0)
    v_min_u32 v16, v16, v17
    v_min_u32 v16, v16, v18
    v_min_u32 v16, v16, v19
    v_min_u32 v16, v16, v20
    v_min_u32 v16, v16, v21
    v_min_u32 v16, v16, v22
    v_min_u32 v16, v16, v23
    v_cmp_gt_u32 vcc, 1, v16
    s_cbranch_vccz wfd_65
    s_sleep 2
    s_add_u32 s35, s35, 1
    s_cmp_lt_u32 s35, 524288
    s_cbranch_scc1 wf_64
wfd_65:
    s_lshl_b32 s36, s32, 13
    s_add_u32 s42, s36, 131072
    s_lshl_b32 s41, s45, 15
    s_add_u32 s41, s41, s36
    s_add_u32 m0, s42, 0
    s_add_u32 s36, s41, 0
    buffer_load_dwordx4 v1, s[4:7], s36 offen offset:0 sc1 lds
    buffer_load_dwordx4 v1, s[4:7], s36 offen offset:1024 sc1 lds
    buffer_load_dwordx4 v1, s[4:7], s36 offen offset:2048 sc1 lds
    buffer_load_dwordx4 v1, s[4:7], s36 offen offset:3072 sc1 lds
    s_add_u32 m0, s42, 4096
    s_add_u32 s36, s41, 4096
    buffer_load_dwordx4 v1, s[4:7], s36 offen offset:0 sc1 lds
    buffer_load_dwordx4 v1, s[4:7], s36 offen offset:1024 sc1 lds
    buffer_load_dwordx4 v1, s[4:7], s36 offen offset:2048 sc1 lds
    buffer_load_dwordx4 v1, s[4:7], s36 offen offset:3072 sc1 lds
    s_add_u32 s41, s41, 65536
    s_add_u32 s42, s42, 32768
    s_and_b32 s42, s42, 0x1ffff
    ds_read_b64_tr_b16 a[144:145], v4 offset:16384
    ds_read_b64_tr_b16 a[146:147], v4 offset:17408
    ds_read_b64_tr_b16 a[148:149], v4 offset:20480
    ds_read_b64_tr_b16 a[150:151], v4 offset:21504
    ds_read_b64_tr_b16 a[152:153], v4 offset:24576
    ds_read_b64_tr_b16 a[154:155], v4 offset:25600
    ds_read_b64_tr_b16 a[156:157], v4 offset:28672
    ds_read_b64_tr_b16 a[158:159], v4 offset:29696
    s_waitcnt vmcnt(20) lgkmcnt(0)
    s_barrier
    ds_read_b64_tr_b16 a[160:161], v4 offset:32768
    ds_read_b64_tr_b16 a[162:163], v4 offset:33792
    ds_read_b64_tr_b16 a[164:165], v4 offset:36864
    ds_read_b64_tr_b16 a[166:167], v4 offset:37888
    ds_read_b64_tr_b16 a[168:169], v4 offset:40960
    ds_read_b64_tr_b16 a[170:171], v4 offset:41984
    ds_read_b64_tr_b16 a[172:173], v4 offset:45056
    ds_read_b64_tr_b16 a[174:175], v4 offset:46080
    s_waitcnt vmcnt(16) lgkmcnt(0)
    s_barrier
    ds_read_b64_tr_b16 a[176:177], v4 offset:49152
    ds_read_b64_tr_b16 a[178:179], v4 offset:50176
    ds_read_b64_tr_b16 a[180:181], v4 offset:53248
    ds_read_b64_tr_b16 a[182:183], v4 offset:54272
    ds_read_b64_tr_b16 a[184:185], v4 offset:57344
    ds_read_b64_tr_b16 a[186:187], v4 offset:58368
    ds_read_b64_tr_b16 a[188:189], v4 offset:61440
    ds_read_b64_tr_b16 a[190:191], v4 offset:62464
    s_waitcnt vmcnt(12) lgkmcnt(0)
    s_barrier
    ds_read_b64_tr_b16 a[192:193], v5 offset:0
    ds_read_b64_tr_b16 a[194:195], v5 offset:1024
    ds_read_b64_tr_b16 a[196:197], v5 offset:4096
    ds_read_b64_tr_b16 a[198:199], v5 offset:5120
    ds_read_b64_tr_b16 a[200:201], v5 offset:8192
    ds_read_b64_tr_b16 a[202:203], v5 offset:9216
    ds_read_b64_tr_b16 a[204:205], v5 offset:12288
    ds_read_b64_tr_b16 a[206:207], v5 offset:13312
    s_waitcnt vmcnt(8) lgkmcnt(0)
    s_barrier
    ds_read_b64_tr_b16 a[208:209], v5 offset:16384
    ds_read_b64_tr_b16 a[210:211], v5 offset:17408
    ds_read_b64_tr_b16 a[212:213], v5 offset:20480
    ds_read_b64_tr_b16 a[214:215], v5 offset:21504
    ds_read_b64_tr_b16 a[216:217], v5 offset:24576
    ds_read_b64_tr_b16 a[218:219], v5 offset:25600
    ds_read_b64_tr_b16 a[220:221], v5 offset:28672
    ds_read_b64_tr_b16 a[222:223], v5 offset:29696
    s_waitcnt vmcnt(4) lgkmcnt(0)
    s_barrier
    ds_read_b64_tr_b16 a[224:225], v5 offset:32768
    ds_read_b64_tr_b16 a[226:227], v5 offset:33792
    ds_read_b64_tr_b16 a[228:229], v5 offset:36864
    ds_read_b64_tr_b16 a[230:231], v5 offset:37888
    ds_read_b64_tr_b16 a[232:233], v5 offset:40960
    ds_read_b64_tr_b16 a[234:235], v5 offset:41984
    ds_read_b64_tr_b16 a[236:237], v5 offset:45056
    ds_read_b64_tr_b16 a[238:239], v5 offset:46080
    s_waitcnt vmcnt(0) lgkmcnt(0)
    s_barrier
    ds_read_b64_tr_b16 a[240:241], v5 offset:49152
    ds_read_b64_tr_b16 a[242:243], v5 offset:50176
    ds_read_b64_tr_b16 a[244:245], v5 offset:53248
    ds_read_b64_tr_b16 a[246:247], v5 offset:54272
    ds_read_b64_tr_b16 a[248:249], v5 offset:57344
    ds_read_b64_tr_b16 a[250:251], v5 offset:58368
    ds_read_b64_tr_b16 a[252:253], v5 offset:61440
    ds_read_b64_tr_b16 a[254:255], v5 offset:62464
    s_waitcnt lgkmcnt(0)
    s_barrier
    s_branch ld2_61
ld1_60:
    s_lshl_b32 s46, s32, 12
    s_add_u32 s46, s46, 0
    s_add_u32 m0, s46, 0
    s_mov_b32 s36, 1572864
    buffer_load_dwordx4 v3, s[12:15], s36 offen lds
    s_add_u32 m0, s46, 1024
    s_mov_b32 s36, 1605632
    buffer_load_dwordx4 v3, s[12:15], s36 offen lds
    s_add_u32 m0, s46, 2048
    s_mov_b32 s36, 1638400
    buffer_load_dwordx4 v3, s[12:15], s36 offen lds
    s_add_u32 m0, s46, 3072
    s_mov_b32 s36, 1671168
    buffer_load_dwordx4 v3, s[12:15], s36 offen lds
    s_add_u32 m0, s46, 16384
    s_mov_b32 s36, 2097152
    buffer_load_dwordx4 v3, s[12:15], s36 offen lds
    s_add_u32 m0, s46, 17408
    s_mov_b32 s36, 2129920
    buffer_load_dwordx4 v3, s[12:15], s36 offen lds
    s_add_u32 m0, s46, 18432
    s_mov_b32 s36, 2162688
    buffer_load_dwordx4 v3, s[12:15], s36 offen lds
    s_add_u32 m0, s46, 19456
    s_mov_b32 s36, 2195456
    buffer_load_dwordx4 v3, s[12:15], s36 offen lds
    s_add_u32 m0, s46, 32768
    s_mov_b32 s36, 2621440
    buffer_load_dwordx4 v3, s[12:15], s36 offen lds
    s_add_u32 m0, s46, 33792
    s_mov_b32 s36, 2654208
    buffer_load_dwordx4 v3, s[12:15], s36 offen lds
    s_add_u32 m0, s46, 34816
    s_mov_b32 s36, 2686976
    buffer_load_dwordx4 v3, s[12:15], s36 offen lds
    s_add_u32 m0, s46, 35840
    s_mov_b32 s36, 2719744
    buffer_load_dwordx4 v3, s[12:15], s36 offen lds
    s_add_u32 m0, s46, 49152
    s_mov_b32 s36, 0
    buffer_load_dwordx4 v3, s[12:15], s36 offen lds
    s_add_u32 m0, s46, 50176
    s_mov_b32 s36, 32768
    buffer_load_dwordx4 v3, s[12:15], s36 offen lds
    s_add_u32 m0, s46, 51200
    s_mov_b32 s36, 65536
    buffer_load_dwordx4 v3, s[12:15], s36 offen lds
    s_add_u32 m0, s46, 52224
    s_mov_b32 s36, 98304
    buffer_load_dwordx4 v3, s[12:15], s36 offen lds
    s_add_u32 m0, s46, 65536
    s_mov_b32 s36, 524288
    buffer_load_dwordx4 v3, s[12:15], s36 offen lds
    s_add_u32 m0, s46, 66560
    s_mov_b32 s36, 557056
    buffer_load_dwordx4 v3, s[12:15], s36 offen lds
    s_add_u32 m0, s46, 67584
    s_mov_b32 s36, 589824
    buffer_load_dwordx4 v3, s[12:15], s36 offen lds
    s_add_u32 m0, s46, 68608
    s_mov_b32 s36, 622592
    buffer_load_dwordx4 v3, s[12:15], s36 offen lds
    s_add_u32 m0, s46, 81920
    s_mov_b32 s36, 1048576
    buffer_load_dwordx4 v3, s[12:15], s36 offen lds
    s_add_u32 m0, s46, 82944
    s_mov_b32 s36, 1081344
    buffer_load_dwordx4 v3, s[12:15], s36 offen lds
    s_add_u32 m0, s46, 83968
    s_mov_b32 s36, 1114112
    buffer_load_dwordx4 v3, s[12:15], s36 offen lds
    s_add_u32 m0, s46, 84992
    s_mov_b32 s36, 1146880
    buffer_load_dwordx4 v3, s[12:15], s36 offen lds
    s_add_u32 m0, s46, 98304
    s_mov_b32 s36, 524288
    buffer_load_dwordx4 v3, s[16:19], s36 offen lds
    s_add_u32 m0, s46, 99328
    s_mov_b32 s36, 557056
    buffer_load_dwordx4 v3, s[16:19], s36 offen lds
    s_add_u32 m0, s46, 100352
    s_mov_b32 s36, 589824
    buffer_load_dwordx4 v3, s[16:19], s36 offen lds
    s_add_u32 m0, s46, 101376
    s_mov_b32 s36, 622592
    buffer_load_dwordx4 v3, s[16:19], s36 offen lds
    s_waitcnt vmcnt(24) lgkmcnt(0)
    s_barrier
    s_add_u32 m0, s46, 114688
    s_mov_b32 s36, 1048576
    buffer_load_dwordx4 v3, s[16:19], s36 offen lds
    s_add_u32 m0, s46, 115712
    s_mov_b32 s36, 1081344
    buffer_load_dwordx4 v3, s[16:19], s36 offen lds
    s_add_u32 m0, s46, 116736
    s_mov_b32 s36, 1114112
    buffer_load_dwordx4 v3, s[16:19], s36 offen lds
    s_add_u32 m0, s46, 117760
    s_mov_b32 s36, 1146880
    buffer_load_dwordx4 v3, s[16:19], s36 offen lds
    ds_read_b64_tr_b16 v[176:177], v4 offset:0
    ds_read_b64_tr_b16 v[178:179], v4 offset:1024
    ds_read_b64_tr_b16 v[180:181], v4 offset:4096
    ds_read_b64_tr_b16 v[182:183], v4 offset:5120
    ds_read_b64_tr_b16 v[184:185], v4 offset:8192
    ds_read_b64_tr_b16 v[186:187], v4 offset:9216
    ds_read_b64_tr_b16 v[188:189], v4 offset:12288
    ds_read_b64_tr_b16 v[190:191], v4 offset:13312
    s_waitcnt vmcnt(24) lgkmcnt(0)
    s_barrier
    s_add_u32 m0, s46, 0
    s_mov_b32 s36, 1572864
    buffer_load_dwordx4 v3, s[16:19], s36 offen lds
    s_add_u32 m0, s46, 1024
    s_mov_b32 s36, 1605632
    buffer_load_dwordx4 v3, s[16:19], s36 offen lds
    s_add_u32 m0, s46, 2048
    s_mov_b32 s36, 1638400
    buffer_load_dwordx4 v3, s[16:19], s36 offen lds
    s_add_u32 m0, s46, 3072
    s_mov_b32 s36, 1671168
    buffer_load_dwordx4 v3, s[16:19], s36 offen lds
    ds_read_b64_tr_b16 v[192:193], v4 offset:16384
    ds_read_b64_tr_b16 v[194:195], v4 offset:17408
    ds_read_b64_tr_b16 v[196:197], v4 offset:20480
    ds_read_b64_tr_b16 v[198:199], v4 offset:21504
    ds_read_b64_tr_b16 v[200:201], v4 offset:24576
    ds_read_b64_tr_b16 v[202:203], v4 offset:25600
    ds_read_b64_tr_b16 v[204:205], v4 offset:28672
    ds_read_b64_tr_b16 v[206:207], v4 offset:29696
    s_waitcnt vmcnt(24) lgkmcnt(0)
    s_barrier
    s_add_u32 m0, s46, 16384
    s_mov_b32 s36, 3145728
    buffer_load_dwordx4 v3, s[12:15], s36 offen lds
    s_add_u32 m0, s46, 17408
    s_mov_b32 s36, 3178496
    buffer_load_dwordx4 v3, s[12:15], s36 offen lds
    s_add_u32 m0, s46, 18432
    s_mov_b32 s36, 3211264
    buffer_load_dwordx4 v3, s[12:15], s36 offen lds
    s_add_u32 m0, s46, 19456
    s_mov_b32 s36, 3244032
    buffer_load_dwordx4 v3, s[12:15], s36 offen lds
    ds_read_b64_tr_b16 v[208:209], v4 offset:32768
    ds_read_b64_tr_b16 v[210:211], v4 offset:33792
    ds_read_b64_tr_b16 v[212:213], v4 offset:36864
    ds_read_b64_tr_b16 v[214:215], v4 offset:37888
    ds_read_b64_tr_b16 v[216:217], v4 offset:40960
    ds_read_b64_tr_b16 v[218:219], v4 offset:41984
    ds_read_b64_tr_b16 v[220:221], v4 offset:45056
    ds_read_b64_tr_b16 v[222:223], v4 offset:46080
    s_waitcnt vmcnt(24) lgkmcnt(0)
    s_barrier
    s_add_u32 m0, s46, 32768
    s_mov_b32 s36, 3670016
    buffer_load_dwordx4 v3, s[12:15], s36 offen lds
    s_add_u32 m0, s46, 33792
    s_mov_b32 s36, 3702784
    buffer_load_dwordx4 v3, s[12:15], s36 offen lds
    s_add_u32 m0, s46, 34816
    s_mov_b32 s36, 3735552
    buffer_load_dwordx4 v3, s[12:15], s36 offen lds
    s_add_u32 m0, s46, 35840
    s_mov_b32 s36, 3768320
    buffer_load_dwordx4 v3, s[12:15], s36 offen lds
    ds_read_b64_tr_b16 v[128:129], v4 offset:49152
    ds_read_b64_tr_b16 v[130:131], v4 offset:50176
    ds_read_b64_tr_b16 v[132:133], v4 offset:53248
    ds_read_b64_tr_b16 v[134:135], v4 offset:54272
    ds_read_b64_tr_b16 v[136:137], v4 offset:57344
    ds_read_b64_tr_b16 v[138:139], v4 offset:58368
    ds_read_b64_tr_b16 v[140:141], v4 offset:61440
    ds_read_b64_tr_b16 v[142:143], v4 offset:62464
    s_waitcnt vmcnt(24) lgkmcnt(0)
    s_barrier
    s_add_u32 m0, s46, 49152
    s_mov_b32 s36, 0
    buffer_load_dwordx4 v3, s[16:19], s36 offen lds
    s_add_u32 m0, s46, 50176
    s_mov_b32 s36, 32768
    buffer_load_dwordx4 v3, s[16:19], s36 offen lds
    s_add_u32 m0, s46, 51200
    s_mov_b32 s36, 65536
    buffer_load_dwordx4 v3, s[16:19], s36 offen lds
    s_add_u32 m0, s46, 52224
    s_mov_b32 s36, 98304
    buffer_load_dwordx4 v3, s[16:19], s36 offen lds
    ds_read_b64_tr_b16 v[144:145], v5 offset:0
    ds_read_b64_tr_b16 v[146:147], v5 offset:1024
    ds_read_b64_tr_b16 v[148:149], v5 offset:4096
    ds_read_b64_tr_b16 v[150:151], v5 offset:5120
    ds_read_b64_tr_b16 v[152:153], v5 offset:8192
    ds_read_b64_tr_b16 v[154:155], v5 offset:9216
    ds_read_b64_tr_b16 v[156:157], v5 offset:12288
    ds_read_b64_tr_b16 v[158:159], v5 offset:13312
    s_waitcnt vmcnt(24) lgkmcnt(0)
    s_barrier
    s_add_u32 m0, s46, 65536
    s_mov_b32 s36, 3670016
    buffer_load_dwordx4 v3, s[16:19], s36 offen lds
    s_add_u32 m0, s46, 66560
    s_mov_b32 s36, 3702784
    buffer_load_dwordx4 v3, s[16:19], s36 offen lds
    s_add_u32 m0, s46, 67584
    s_mov_b32 s36, 3735552
    buffer_load_dwordx4 v3, s[16:19], s36 offen lds
    s_add_u32 m0, s46, 68608
    s_mov_b32 s36, 3768320
    buffer_load_dwordx4 v3, s[16:19], s36 offen lds
    ds_read_b64_tr_b16 v[160:161], v5 offset:16384
    ds_read_b64_tr_b16 v[162:163], v5 offset:17408
    ds_read_b64_tr_b16 v[164:165], v5 offset:20480
    ds_read_b64_tr_b16 v[166:167], v5 offset:21504
    ds_read_b64_tr_b16 v[168:169], v5 offset:24576
    ds_read_b64_tr_b16 v[170:171], v5 offset:25600
    ds_read_b64_tr_b16 v[172:173], v5 offset:28672
    ds_read_b64_tr_b16 v[174:175], v5 offset:29696
    s_waitcnt vmcnt(24) lgkmcnt(0)
    s_barrier
    s_add_u32 m0, s46, 81920
    s_mov_b32 s36, 0
    buffer_load_dwordx4 v3, s[20:23], s36 offen lds
    s_add_u32 m0, s46, 82944
    s_mov_b32 s36, 32768
    buffer_load_dwordx4 v3, s[20:23], s36 offen lds
    s_add_u32 m0, s46, 83968
    s_mov_b32 s36, 65536
    buffer_load_dwordx4 v3, s[20:23], s36 offen lds
    s_add_u32 m0, s46, 84992
    s_mov_b32 s36, 98304
    buffer_load_dwordx4 v3, s[20:23], s36 offen lds
    ds_read_b64_tr_b16 a[16:17], v5 offset:32768
    ds_read_b64_tr_b16 a[18:19], v5 offset:33792
    ds_read_b64_tr_b16 a[20:21], v5 offset:36864
    ds_read_b64_tr_b16 a[22:23], v5 offset:37888
    ds_read_b64_tr_b16 a[24:25], v5 offset:40960
    ds_read_b64_tr_b16 a[26:27], v5 offset:41984
    ds_read_b64_tr_b16 a[28:29], v5 offset:45056
    ds_read_b64_tr_b16 a[30:31], v5 offset:46080
    s_waitcnt vmcnt(24) lgkmcnt(0)
    s_barrier
    s_add_u32 m0, s46, 98304
    s_mov_b32 s36, 524288
    buffer_load_dwordx4 v3, s[20:23], s36 offen lds
    s_add_u32 m0, s46, 99328
    s_mov_b32 s36, 557056
    buffer_load_dwordx4 v3, s[20:23], s36 offen lds
    s_add_u32 m0, s46, 100352
    s_mov_b32 s36, 589824
    buffer_load_dwordx4 v3, s[20:23], s36 offen lds
    s_add_u32 m0, s46, 101376
    s_mov_b32 s36, 622592
    buffer_load_dwordx4 v3, s[20:23], s36 offen lds
    ds_read_b64_tr_b16 a[32:33], v5 offset:49152
    ds_read_b64_tr_b16 a[34:35], v5 offset:50176
    ds_read_b64_tr_b16 a[36:37], v5 offset:53248
    ds_read_b64_tr_b16 a[38:39], v5 offset:54272
    ds_read_b64_tr_b16 a[40:41], v5 offset:57344
    ds_read_b64_tr_b16 a[42:43], v5 offset:58368
    ds_read_b64_tr_b16 a[44:45], v5 offset:61440
    ds_read_b64_tr_b16 a[46:47], v5 offset:62464
    s_waitcnt vmcnt(24) lgkmcnt(0)
    s_barrier
    s_add_u32 m0, s46, 114688
    s_mov_b32 s36, 2097152
    buffer_load_dwordx4 v3, s[16:19], s36 offen lds
    s_add_u32 m0, s46, 115712
    s_mov_b32 s36, 2129920
    buffer_load_dwordx4 v3, s[16:19], s36 offen lds
    s_add_u32 m0, s46, 116736
    s_mov_b32 s36, 2162688
    buffer_load_dwordx4 v3, s[16:19], s36 offen lds
    s_add_u32 m0, s46, 117760
    s_mov_b32 s36, 2195456
    buffer_load_dwordx4 v3, s[16:19], s36 offen lds
    ds_read_b64_tr_b16 a[48:49], v4 offset:0
    ds_read_b64_tr_b16 a[50:51], v4 offset:1024
    ds_read_b64_tr_b16 a[52:53], v4 offset:4096
    ds_read_b64_tr_b16 a[54:55], v4 offset:5120
    ds_read_b64_tr_b16 a[56:57], v4 offset:8192
    ds_read_b64_tr_b16 a[58:59], v4 offset:9216
    ds_read_b64_tr_b16 a[60:61], v4 offset:12288
    ds_read_b64_tr_b16 a[62:63], v4 offset:13312
    s_waitcnt vmcnt(24) lgkmcnt(0)
    s_barrier
    s_add_u32 m0, s46, 0
    s_mov_b32 s36, 2621440
    buffer_load_dwordx4 v3, s[16:19], s36 offen lds
    s_add_u32 m0, s46, 1024
    s_mov_b32 s36, 2654208
    buffer_load_dwordx4 v3, s[16:19], s36 offen lds
    s_add_u32 m0, s46, 2048
    s_mov_b32 s36, 2686976
    buffer_load_dwordx4 v3, s[16:19], s36 offen lds
    s_add_u32 m0, s46, 3072
    s_mov_b32 s36, 2719744
    buffer_load_dwordx4 v3, s[16:19], s36 offen lds
    ds_read_b64_tr_b16 v[224:225], v4 offset:16384
    ds_read_b64_tr_b16 v[226:227], v4 offset:17408
    ds_read_b64_tr_b16 v[228:229], v4 offset:20480
    ds_read_b64_tr_b16 v[230:231], v4 offset:21504
    ds_read_b64_tr_b16 v[232:233], v4 offset:24576
    ds_read_b64_tr_b16 v[234:235], v4 offset:25600
    ds_read_b64_tr_b16 v[236:237], v4 offset:28672
    ds_read_b64_tr_b16 v[238:239], v4 offset:29696
    s_waitcnt vmcnt(24) lgkmcnt(0)
    s_barrier
    s_add_u32 m0, s46, 16384
    s_mov_b32 s36, 3145728
    buffer_load_dwordx4 v3, s[16:19], s36 offen lds
    s_add_u32 m0, s46, 17408
    s_mov_b32 s36, 3178496
    buffer_load_dwordx4 v3, s[16:19], s36 offen lds
    s_add_u32 m0, s46, 18432
    s_mov_b32 s36, 3211264
    buffer_load_dwordx4 v3, s[16:19], s36 offen lds
    s_add_u32 m0, s46, 19456
    s_mov_b32 s36, 3244032
    buffer_load_dwordx4 v3, s[16:19], s36 offen lds
    ds_read_b64_tr_b16 v[240:241], v4 offset:32768
    ds_read_b64_tr_b16 v[242:243], v4 offset:33792
    ds_read_b64_tr_b16 v[244:245], v4 offset:36864
    ds_read_b64_tr_b16 v[246:247], v4 offset:37888
    ds_read_b64_tr_b16 v[248:249], v4 offset:40960
    ds_read_b64_tr_b16 v[250:251], v4 offset:41984
    ds_read_b64_tr_b16 v[252:253], v4 offset:45056
    ds_read_b64_tr_b16 v[254:255], v4 offset:46080
    s_waitcnt vmcnt(24) lgkmcnt(0)
    s_barrier
    s_add_u32 m0, s46, 32768
    s_mov_b32 s36, 2621440
    buffer_load_dwordx4 v3, s[20:23], s36 offen lds
    s_add_u32 m0, s46, 33792
    s_mov_b32 s36, 2654208
    buffer_load_dwordx4 v3, s[20:23], s36 offen lds
    s_add_u32 m0, s46, 34816
    s_mov_b32 s36, 2686976
    buffer_load_dwordx4 v3, s[20:23], s36 offen lds
    s_add_u32 m0, s46, 35840
    s_mov_b32 s36, 2719744
    buffer_load_dwordx4 v3, s[20:23], s36 offen lds
    ds_read_b64_tr_b16 a[0:1], v4 offset:49152
    ds_read_b64_tr_b16 a[2:3], v4 offset:50176
    ds_read_b64_tr_b16 a[4:5], v4 offset:53248
    ds_read_b64_tr_b16 a[6:7], v4 offset:54272
    ds_read_b64_tr_b16 a[8:9], v4 offset:57344
    ds_read_b64_tr_b16 a[10:11], v4 offset:58368
    ds_read_b64_tr_b16 a[12:13], v4 offset:61440
    ds_read_b64_tr_b16 a[14:15], v4 offset:62464
    s_waitcnt vmcnt(24) lgkmcnt(0)
    s_barrier
    s_add_u32 m0, s46, 49152
    s_mov_b32 s36, 3145728
    buffer_load_dwordx4 v3, s[20:23], s36 offen lds
    s_add_u32 m0, s46, 50176
    s_mov_b32 s36, 3178496
    buffer_load_dwordx4 v3, s[20:23], s36 offen lds
    s_add_u32 m0, s46, 51200
    s_mov_b32 s36, 3211264
    buffer_load_dwordx4 v3, s[20:23], s36 offen lds
    s_add_u32 m0, s46, 52224
    s_mov_b32 s36, 3244032
    buffer_load_dwordx4 v3, s[20:23], s36 offen lds
    ds_read_b64_tr_b16 a[112:113], v5 offset:0
    ds_read_b64_tr_b16 a[114:115], v5 offset:1024
    ds_read_b64_tr_b16 a[116:117], v5 offset:4096
    ds_read_b64_tr_b16 a[118:119], v5 offset:5120
    ds_read_b64_tr_b16 a[120:121], v5 offset:8192
    ds_read_b64_tr_b16 a[122:123], v5 offset:9216
    ds_read_b64_tr_b16 a[124:125], v5 offset:12288
    ds_read_b64_tr_b16 a[126:127], v5 offset:13312
    s_waitcnt vmcnt(24) lgkmcnt(0)
    s_barrier
    s_add_u32 m0, s46, 65536
    s_mov_b32 s36, 3670016
    buffer_load_dwordx4 v3, s[20:23], s36 offen lds
    s_add_u32 m0, s46, 66560
    s_mov_b32 s36, 3702784
    buffer_load_dwordx4 v3, s[20:23], s36 offen lds
    s_add_u32 m0, s46, 67584
    s_mov_b32 s36, 3735552
    buffer_load_dwordx4 v3, s[20:23], s36 offen lds
    s_add_u32 m0, s46, 68608
    s_mov_b32 s36, 3768320
    buffer_load_dwordx4 v3, s[20:23], s36 offen lds
    ds_read_b64_tr_b16 a[128:129], v5 offset:16384
    ds_read_b64_tr_b16 a[130:131], v5 offset:17408
    ds_read_b64_tr_b16 a[132:133], v5 offset:20480
    ds_read_b64_tr_b16 a[134:135], v5 offset:21504
    ds_read_b64_tr_b16 a[136:137], v5 offset:24576
    ds_read_b64_tr_b16 a[138:139], v5 offset:25600
    ds_read_b64_tr_b16 a[140:141], v5 offset:28672
    ds_read_b64_tr_b16 a[142:143], v5 offset:29696
    s_waitcnt vmcnt(24) lgkmcnt(0)
    s_barrier
    s_add_u32 m0, s46, 81920
    s_mov_b32 s36, 1048576
    buffer_load_dwordx4 v3, s[20:23], s36 offen lds
    s_add_u32 m0, s46, 82944
    s_mov_b32 s36, 1081344
    buffer_load_dwordx4 v3, s[20:23], s36 offen lds
    s_add_u32 m0, s46, 83968
    s_mov_b32 s36, 1114112
    buffer_load_dwordx4 v3, s[20:23], s36 offen lds
    s_add_u32 m0, s46, 84992
    s_mov_b32 s36, 1146880
    buffer_load_dwordx4 v3, s[20:23], s36 offen lds
    ds_read_b64_tr_b16 a[144:145], v5 offset:32768
    ds_read_b64_tr_b16 a[146:147], v5 offset:33792
    ds_read_b64_tr_b16 a[148:149], v5 offset:36864
    ds_read_b64_tr_b16 a[150:151], v5 offset:37888
    ds_read_b64_tr_b16 a[152:153], v5 offset:40960
    ds_read_b64_tr_b16 a[154:155], v5 offset:41984
    ds_read_b64_tr_b16 a[156:157], v5 offset:45056
    ds_read_b64_tr_b16 a[158:159], v5 offset:46080
    s_waitcnt vmcnt(24) lgkmcnt(0)
    s_barrier
    s_add_u32 m0, s46, 98304
    s_mov_b32 s36, 1572864
    buffer_load_dwordx4 v3, s[20:23], s36 offen lds
    s_add_u32 m0, s46, 99328
    s_mov_b32 s36, 1605632
    buffer_load_dwordx4 v3, s[20:23], s36 offen lds
    s_add_u32 m0, s46, 100352
    s_mov_b32 s36, 1638400
    buffer_load_dwordx4 v3, s[20:23], s36 offen lds
    s_add_u32 m0, s46, 101376
    s_mov_b32 s36, 1671168
    buffer_load_dwordx4 v3, s[20:23], s36 offen lds
    ds_read_b64_tr_b16 a[64:65], v5 offset:49152
    ds_read_b64_tr_b16 a[66:67], v5 offset:50176
    ds_read_b64_tr_b16 a[68:69], v5 offset:53248
    ds_read_b64_tr_b16 a[70:71], v5 offset:54272
    ds_read_b64_tr_b16 a[72:73], v5 offset:57344
    ds_read_b64_tr_b16 a[74:75], v5 offset:58368
    ds_read_b64_tr_b16 a[76:77], v5 offset:61440
    ds_read_b64_tr_b16 a[78:79], v5 offset:62464
    s_waitcnt vmcnt(24) lgkmcnt(0)
    s_barrier
    s_add_u32 m0, s46, 114688
    s_mov_b32 s36, 2097152
    buffer_load_dwordx4 v3, s[20:23], s36 offen lds
    s_add_u32 m0, s46, 115712
    s_mov_b32 s36, 2129920
    buffer_load_dwordx4 v3, s[20:23], s36 offen lds
    s_add_u32 m0, s46, 116736
    s_mov_b32 s36, 2162688
    buffer_load_dwordx4 v3, s[20:23], s36 offen lds
    s_add_u32 m0, s46, 117760
    s_mov_b32 s36, 2195456
    buffer_load_dwordx4 v3, s[20:23], s36 offen lds
    ds_read_b64_tr_b16 a[80:81], v4 offset:0
    ds_read_b64_tr_b16 a[82:83], v4 offset:1024
    ds_read_b64_tr_b16 a[84:85], v4 offset:4096
    ds_read_b64_tr_b16 a[86:87], v4 offset:5120
    ds_read_b64_tr_b16 a[88:89], v4 offset:8192
    ds_read_b64_tr_b16 a[90:91], v4 offset:9216
    ds_read_b64_tr_b16 a[92:93], v4 offset:12288
    ds_read_b64_tr_b16 a[94:95], v4 offset:13312
    s_waitcnt vmcnt(24) lgkmcnt(0)
    s_barrier
    v_mbcnt_lo_u32_b32 v12, -1, 0
    v_mbcnt_hi_u32_b32 v12, -1, v12
    v_lshlrev_b32 v12, 5, v12
wt_66:
    buffer_load_dword v11, v12, s[8:11], 0 offen sc1
    s_waitcnt vmcnt(0)
    v_readlane_b32 s36, v11, 0
    v_readlane_b32 s37, v11, 1
    s_nop 0
    s_add_u32 s36, s36, s37
    v_readlane_b32 s37, v11, 2
    s_nop 0
    s_add_u32 s36, s36, s37
    v_readlane_b32 s37, v11, 3
    s_nop 0
    s_add_u32 s36, s36, s37
    v_readlane_b32 s37, v11, 4
    s_nop 0
    s_add_u32 s36, s36, s37
    v_readlane_b32 s37, v11, 5
    s_nop 0
    s_add_u32 s36, s36, s37
    v_readlane_b32 s37, v11, 6
    s_nop 0
    s_add_u32 s36, s36, s37
    v_readlane_b32 s37, v11, 7
    s_nop 0
    s_add_u32 s36, s36, s37
    s_cmp_ge_u32 s36, 256
    s_cbranch_scc1 wtd_67
    s_sleep 2
    s_add_u32 s35, s35, 1
    s_cmp_lt_u32 s35, 524288
    s_cbranch_scc1 wt_66
wtd_67:
    v_readlane_b32 s55, v11, s34
    s_mov_b32 s38, 11829248
    v_lshlrev_b32 v11, 7, v0
    v_add_u32 v12, 8192, v11
wf_68:
    buffer_load_dwordx4 v[16:19], v11, s[4:7], s38 offen sc1
    buffer_load_dwordx4 v[20:23], v12, s[4:7], s38 offen sc1
    s_waitcnt vmcnt(0)
    v_min_u32 v16, v16, v17
    v_min_u32 v16, v16, v18
    v_min_u32 v16, v16, v19
    v_min_u32 v16, v16, v20
    v_min_u32 v16, v16, v21
    v_min_u32 v16, v16, v22
    v_min_u32 v16, v16, v23
    v_cmp_gt_u32 vcc, 1, v16
    s_cbranch_vccz wfd_69
    s_sleep 2
    s_add_u32 s35, s35, 1
    s_cmp_lt_u32 s35, 524288
    s_cbranch_scc1 wf_68
wfd_69:
    s_lshl_b32 s36, s32, 13
    s_add_u32 s42, s36, 131072
    s_lshl_b32 s41, s45, 15
    s_add_u32 s41, s41, s36
    s_add_u32 m0, s42, 0
    s_add_u32 s36, s41, 0
    buffer_load_dwordx4 v1, s[4:7], s36 offen offset:0 sc1 lds
    buffer_load_dwordx4 v1, s[4:7], s36 offen offset:1024 sc1 lds
    buffer_load_dwordx4 v1, s[4:7], s36 offen offset:2048 sc1 lds
    buffer_load_dwordx4 v1, s[4:7], s36 offen offset:3072 sc1 lds
    s_add_u32 m0, s42, 4096
    s_add_u32 s36, s41, 4096
    buffer_load_dwordx4 v1, s[4:7], s36 offen offset:0 sc1 lds
    buffer_load_dwordx4 v1, s[4:7], s36 offen offset:1024 sc1 lds
    buffer_load_dwordx4 v1, s[4:7], s36 offen offset:2048 sc1 lds
    buffer_load_dwordx4 v1, s[4:7], s36 offen offset:3072 sc1 lds
    s_add_u32 s41, s41, 65536
    s_add_u32 s42, s42, 32768
    s_and_b32 s42, s42, 0x1ffff
    ds_read_b64_tr_b16 a[96:97], v4 offset:16384
    ds_read_b64_tr_b16 a[98:99], v4 offset:17408
    ds_read_b64_tr_b16 a[100:101], v4 offset:20480
    ds_read_b64_tr_b16 a[102:103], v4 offset:21504
    ds_read_b64_tr_b16 a[104:105], v4 offset:24576
    ds_read_b64_tr_b16 a[106:107], v4 offset:25600
    ds_read_b64_tr_b16 a[108:109], v4 offset:28672
    ds_read_b64_tr_b16 a[110:111], v4 offset:29696
    s_waitcnt vmcnt(20) lgkmcnt(0)
    s_barrier
    ds_read_b64_tr_b16 a[208:209], v4 offset:32768
    ds_read_b64_tr_b16 a[210:211], v4 offset:33792
    ds_read_b64_tr_b16 a[212:213], v4 offset:36864
    ds_read_b64_tr_b16 a[214:215], v4 offset:37888
    ds_read_b64_tr_b16 a[216:217], v4 offset:40960
    ds_read_b64_tr_b16 a[218:219], v4 offset:41984
    ds_read_b64_tr_b16 a[220:221], v4 offset:45056
    ds_read_b64_tr_b16 a[222:223], v4 offset:46080
    s_waitcnt vmcnt(16) lgkmcnt(0)
    s_barrier
    ds_read_b64_tr_b16 a[224:225], v4 offset:49152
    ds_read_b64_tr_b16 a[226:227], v4 offset:50176
    ds_read_b64_tr_b16 a[228:229], v4 offset:53248
    ds_read_b64_tr_b16 a[230:231], v4 offset:54272
    ds_read_b64_tr_b16 a[232:233], v4 offset:57344
    ds_read_b64_tr_b16 a[234:235], v4 offset:58368
    ds_read_b64_tr_b16 a[236:237], v4 offset:61440
    ds_read_b64_tr_b16 a[238:239], v4 offset:62464
    s_waitcnt vmcnt(12) lgkmcnt(0)
    s_barrier
    ds_read_b64_tr_b16 a[240:241], v5 offset:0
    ds_read_b64_tr_b16 a[242:243], v5 offset:1024
    ds_read_b64_tr_b16 a[244:245], v5 offset:4096
    ds_read_b64_tr_b16 a[246:247], v5 offset:5120
    ds_read_b64_tr_b16 a[248:249], v5 offset:8192
    ds_read_b64_tr_b16 a[250:251], v5 offset:9216
    ds_read_b64_tr_b16 a[252:253], v5 offset:12288
    ds_read_b64_tr_b16 a[254:255], v5 offset:13312
    s_waitcnt vmcnt(8) lgkmcnt(0)
    s_barrier
    ds_read_b64_tr_b16 a[160:161], v5 offset:16384
    ds_read_b64_tr_b16 a[162:163], v5 offset:17408
    ds_read_b64_tr_b16 a[164:165], v5 offset:20480
    ds_read_b64_tr_b16 a[166:167], v5 offset:21504
    ds_read_b64_tr_b16 a[168:169], v5 offset:24576
    ds_read_b64_tr_b16 a[170:171], v5 offset:25600
    ds_read_b64_tr_b16 a[172:173], v5 offset:28672
    ds_read_b64_tr_b16 a[174:175], v5 offset:29696
    s_waitcnt vmcnt(4) lgkmcnt(0)
    s_barrier
    ds_read_b64_tr_b16 a[176:177], v5 offset:32768
    ds_read_b64_tr_b16 a[178:179], v5 offset:33792
    ds_read_b64_tr_b16 a[180:181], v5 offset:36864
    ds_read_b64_tr_b16 a[182:183], v5 offset:37888
    ds_read_b64_tr_b16 a[184:185], v5 offset:40960
    ds_read_b64_tr_b16 a[186:187], v5 offset:41984
    ds_read_b64_tr_b16 a[188:189], v5 offset:45056
    ds_read_b64_tr_b16 a[190:191], v5 offset:46080
    s_waitcnt vmcnt(0) lgkmcnt(0)
    s_barrier
    ds_read_b64_tr_b16 a[192:193], v5 offset:49152
    ds_read_b64_tr_b16 a[194:195], v5 offset:50176
    ds_read_b64_tr_b16 a[196:197], v5 offset:53248
    ds_read_b64_tr_b16 a[198:199], v5 offset:54272
    ds_read_b64_tr_b16 a[200:201], v5 offset:57344
    ds_read_b64_tr_b16 a[202:203], v5 offset:58368
    ds_read_b64_tr_b16 a[204:205], v5 offset:61440
    ds_read_b64_tr_b16 a[206:207], v5 offset:62464
    s_waitcnt lgkmcnt(0)
    s_barrier
ld2_61:
    v_bfe_u32 v11, v0, 4, 1
    v_lshrrev_b32 v12, 5, v0
    v_and_b32 v13, 15, v0
    v_lshlrev_b32 v13, 4, v13
    v_lshl_add_u32 v8, v11, 12, v13
    v_lshl_add_u32 v8, v12, 8, v8
    v_lshl_add_u32 v9, v11, 10, v13
    v_lshl_add_u32 v9, v12, 9, v9
    s_mul_i32 s36, s48, 2097152
    s_lshl_b32 s37, s45, 15
    s_add_u32 s36, s36, s37
    s_lshl_b32 s37, s32, 10
    s_add_u32 s36, s36, s37
    s_add_u32 s50, s36, 33554432
    s_add_u32 s52, s36, 33570816
    s_add_u32 s36, s36, s37
    s_add_u32 s51, s36, 33562624
    s_lshl_b32 s36, s48, 1
    s_add_u32 s36, s36, s45
    s_lshl_b32 s36, s36, 7
    s_lshl_b32 s37, s32, 4
    s_add_u32 s36, s36, s37
    s_add_u32 s43, s36, 11804672
    v_mov_b32 v104, -1
    v_mov_b32 v105, -1
    v_mov_b32 v106, -1
    v_mov_b32 v107, -1
    v_and_b32 v10, 31, v0
    v_lshlrev_b32 v10, 7, v10
    s_mul_i32 s36, s32, 3072
    v_add_u32 v10, s36, v10
    s_add_u32 m0, s42, 0
    s_add_u32 s36, s41, 0
    buffer_load_dwordx4 v1, s[4:7], s36 offen offset:0 sc1 lds
    buffer_load_dwordx4 v1, s[4:7], s36 offen offset:1024 sc1 lds
    buffer_load_dwordx4 v1, s[4:7], s36 offen offset:2048 sc1 lds
    buffer_load_dwordx4 v1, s[4:7], s36 offen offset:3072 sc1 lds
    s_add_u32 m0, s42, 4096
    s_add_u32 s36, s41, 4096
    buffer_load_dwordx4 v1, s[4:7], s36 offen offset:0 sc1 lds
    buffer_load_dwordx4 v1, s[4:7], s36 offen offset:1024 sc1 lds
    buffer_load_dwordx4 v1, s[4:7], s36 offen offset:2048 sc1 lds
    buffer_load_dwordx4 v1, s[4:7], s36 offen offset:3072 sc1 lds
    s_add_u32 s41, s41, 65536
    s_add_u32 s42, s42, 32768
    s_and_b32 s42, s42, 0x1ffff
    s_add_u32 m0, s42, 0
    s_add_u32 s36, s41, 0
    buffer_load_dwordx4 v1, s[4:7], s36 offen offset:0 sc1 lds
    buffer_load_dwordx4 v1, s[4:7], s36 offen offset:1024 sc1 lds
    buffer_load_dwordx4 v1, s[4:7], s36 offen offset:2048 sc1 lds
    buffer_load_dwordx4 v1, s[4:7], s36 offen offset:3072 sc1 lds
    s_add_u32 m0, s42, 4096
    s_add_u32 s36, s41, 4096
    buffer_load_dwordx4 v1, s[4:7], s36 offen offset:0 sc1 lds
    buffer_load_dwordx4 v1, s[4:7], s36 offen offset:1024 sc1 lds
    buffer_load_dwordx4 v1, s[4:7], s36 offen offset:2048 sc1 lds
    buffer_load_dwordx4 v1, s[4:7], s36 offen offset:3072 sc1 lds
    s_add_u32 s41, s41, 65536
    s_add_u32 s42, s42, 32768
    s_and_b32 s42, s42, 0x1ffff
    v_add_u32 v7, 131072, v1
    s_mov_b32 s40, 0
    s_waitcnt vmcnt(16)
xgs_70:
xg_71:
    s_barrier
    ds_read_b128 v[16:19], v7 offset:0
    ds_read_b128 v[20:23], v7 offset:1024
    ds_read_b128 v[24:27], v7 offset:2048
    s_waitcnt lgkmcnt(2)
    v_mfma_f32_32x32x16_bf16 v[32:47], v[128:131], v[16:19], 0
    ds_read_b128 v[28:31], v7 offset:3072
    v_mfma_f32_32x32x16_bf16 v[48:63], v[16:19], a[0:3], 0
    s_add_u32 m0, s42, 0
    s_add_u32 s36, s41, 0
    v_mfma_f32_32x32x16_bf16 v[64:79], a[128:131], v[16:19], 0
    buffer_load_dwordx4 v1, s[4:7], s36 offen offset:0 sc1 lds
    s_waitcnt lgkmcnt(2)
    v_mfma_f32_32x32x16_bf16 v[32:47], v[132:135], v[20:23], v[32:47]
    ds_read_b128 v[16:19], v7 offset:4096
    v_mfma_f32_32x32x16_bf16 v[48:63], v[20:23], a[4:7], v[48:63]
    buffer_load_dwordx4 v1, s[4:7], s36 offen offset:1024 sc1 lds
    v_mfma_f32_32x32x16_bf16 v[64:79], a[132:135], v[20:23], v[64:79]
    buffer_load_dwordx4 v1, s[4:7], s36 offen offset:2048 sc1 lds
    s_waitcnt lgkmcnt(2)
    v_mfma_f32_32x32x16_bf16 v[32:47], v[136:139], v[24:27], v[32:47]
    ds_read_b128 v[20:23], v7 offset:5120
    v_mfma_f32_32x32x16_bf16 v[48:63], v[24:27], a[8:11], v[48:63]
    buffer_load_dwordx4 v1, s[4:7], s36 offen offset:3072 sc1 lds
    s_add_u32 m0, s42, 4096
    v_mfma_f32_32x32x16_bf16 v[64:79], a[136:139], v[24:27], v[64:79]
    s_add_u32 s36, s41, 4096
    s_waitcnt lgkmcnt(2)
    v_mfma_f32_32x32x16_bf16 v[32:47], v[140:143], v[28:31], v[32:47]
    ds_read_b128 v[24:27], v7 offset:6144
    v_mfma_f32_32x32x16_bf16 v[48:63], v[28:31], a[12:15], v[48:63]
    buffer_load_dwordx4 v1, s[4:7], s36 offen offset:0 sc1 lds
    v_mfma_f32_32x32x16_bf16 v[64:79], a[140:143], v[28:31], v[64:79]
    buffer_load_dwordx4 v1, s[4:7], s36 offen offset:1024 sc1 lds
    s_waitcnt lgkmcnt(2)
    v_mfma_f32_32x32x16_bf16 v[32:47], v[144:147], v[16:19], v[32:47]
    ds_read_b128 v[28:31], v7 offset:7168
    v_mfma_f32_32x32x16_bf16 v[48:63], v[16:19], a[16:19], v[48:63]
    buffer_load_dwordx4 v1, s[4:7], s36 offen offset:2048 sc1 lds
    v_mfma_f32_32x32x16_bf16 v[64:79], a[144:147], v[16:19], v[64:79]
    buffer_load_dwordx4 v1, s[4:7], s36 offen offset:3072 sc1 lds
    s_add_u32 s41, s41, 65536
    s_waitcnt lgkmcnt(2)
    v_mfma_f32_32x32x16_bf16 v[32:47], v[148:151], v[20:23], v[32:47]
    ds_read_b128 v[16:19], v7 offset:8192
    v_mfma_f32_32x32x16_bf16 v[48:63], v[20:23], a[20:23], v[48:63]
    s_add_u32 s42, s42, 32768
    s_and_b32 s42, s42, 0x1ffff
    v_mfma_f32_32x32x16_bf16 v[64:79], a[148:151], v[20:23], v[64:79]
    s_waitcnt lgkmcnt(2)
    v_mfma_f32_32x32x16_bf16 v[32:47], v[152:155], v[24:27], v[32:47]
    ds_read_b128 v[20:23], v7 offset:9216
    v_mfma_f32_32x32x16_bf16 v[48:63], v[24:27], a[24:27], v[48:63]
    v_mfma_f32_32x32x16_bf16 v[64:79], a[152:155], v[24:27], v[64:79]
    s_waitcnt lgkmcnt(2)
    v_mfma_f32_32x32x16_bf16 v[32:47], v[156:159], v[28:31], v[32:47]
    ds_read_b128 v[24:27], v7 offset:10240
    v_mfma_f32_32x32x16_bf16 v[48:63], v[28:31], a[28:31], v[48:63]
    v_mfma_f32_32x32x16_bf16 v[64:79], a[156:159], v[28:31], v[64:79]
    s_waitcnt lgkmcnt(2)
    v_mfma_f32_32x32x16_bf16 v[32:47], v[160:163], v[16:19], v[32:47]
    ds_read_b128 v[28:31], v7 offset:11264
    v_mfma_f32_32x32x16_bf16 v[48:63], v[16:19], a[32:35], v[48:63]
    v_mfma_f32_32x32x16_bf16 v[64:79], a[160:163], v[16:19], v[64:79]
    s_waitcnt lgkmcnt(2)
    v_mfma_f32_32x32x16_bf16 v[32:47], v[164:167], v[20:23], v[32:47]
    ds_read_b128 v[16:19], v7 offset:12288
    v_mfma_f32_32x32x16_bf16 v[48:63], v[20:23], a[36:39], v[48:63]
    v_mfma_f32_32x32x16_bf16 v[64:79], a[164:167], v[20:23], v[64:79]
    s_waitcnt lgkmcnt(2)
    v_mfma_f32_32x32x16_bf16 v[32:47], v[168:171], v[24:27], v[32:47]
    ds_read_b128 v[20:23], v7 offset:13312
    v_mfma_f32_32x32x16_bf16 v[48:63], v[24:27], a[40:43], v[48:63]
    v_mfma_f32_32x32x16_bf16 v[64:79], a[168:171], v[24:27], v[64:79]
    s_waitcnt lgkmcnt(2)
    v_mfma_f32_32x32x16_bf16 v[32:47], v[172:175], v[28:31], v[32:47]
    ds_read_b128 v[24:27], v7 offset:14336
    v_mfma_f32_32x32x16_bf16 v[48:63], v[28:31], a[44:47], v[48:63]
    v_mfma_f32_32x32x16_bf16 v[64:79], a[172:175], v[28:31], v[64:79]
    s_waitcnt lgkmcnt(2)
    v_mfma_f32_32x32x16_bf16 v[32:47], v[176:179], v[16:19], v[32:47]
    ds_read_b128 v[28:31], v7 offset:15360
    v_mfma_f32_32x32x16_bf16 v[48:63], v[16:19], a[48:51], v[48:63]
    v_mfma_f32_32x32x16_bf16 v[64:79], a[176:179], v[16:19], v[64:79]
    s_waitcnt lgkmcnt(2)
    v_mfma_f32_32x32x16_bf16 v[32:47], v[180:183], v[20:23], v[32:47]
    ds_read_b128 v[16:19], v7 offset:16384
    v_mfma_f32_32x32x16_bf16 v[48:63], v[20:23], a[52:55], v[48:63]
    v_mfma_f32_32x32x16_bf16 v[64:79], a[180:183], v[20:23], v[64:79]
    s_waitcnt lgkmcnt(2)
    v_mfma_f32_32x32x16_bf16 v[32:47], v[184:187], v[24:27], v[32:47]
    ds_read_b128 v[20:23], v7 offset:17408
    v_mfma_f32_32x32x16_bf16 v[48:63], v[24:27], a[56:59], v[48:63]
    v_mfma_f32_32x32x16_bf16 v[64:79], a[184:187], v[24:27], v[64:79]
    s_waitcnt lgkmcnt(2)
    v_mfma_f32_32x32x16_bf16 v[32:47], v[188:191], v[28:31], v[32:47]
    ds_read_b128 v[24:27], v7 offset:18432
    v_mfma_f32_32x32x16_bf16 v[48:63], v[28:31], a[60:63], v[48:63]
    v_mfma_f32_32x32x16_bf16 v[64:79], a[188:191], v[28:31], v[64:79]
    s_waitcnt lgkmcnt(2)
    v_mfma_f32_32x32x16_bf16 v[32:47], v[192:195], v[16:19], v[32:47]
    ds_read_b128 v[28:31], v7 offset:19456
    v_mfma_f32_32x32x16_bf16 v[48:63], v[16:19], a[64:67], v[48:63]
    v_mfma_f32_32x32x16_bf16 v[64:79], a[192:195], v[16:19], v[64:79]
    s_waitcnt lgkmcnt(2)
    v_mfma_f32_32x32x16_bf16 v[32:47], v[196:199], v[20:23], v[32:47]
    ds_read_b128 v[16:19], v7 offset:20480
    v_mfma_f32_32x32x16_bf16 v[48:63], v[20:23], a[68:71], v[48:63]
    v_mfma_f32_32x32x16_bf16 v[64:79], a[196:199], v[20:23], v[64:79]
    s_waitcnt lgkmcnt(2)
    v_mfma_f32_32x32x16_bf16 v[32:47], v[200:203], v[24:27], v[32:47]
    ds_read_b128 v[20:23], v7 offset:21504
    v_mfma_f32_32x32x16_bf16 v[48:63], v[24:27], a[72:75], v[48:63]
    v_mfma_f32_32x32x16_bf16 v[64:79], a[200:203], v[24:27], v[64:79]
    s_waitcnt lgkmcnt(2)
    v_mfma_f32_32x32x16_bf16 v[32:47], v[204:207], v[28:31], v[32:47]
    ds_read_b128 v[24:27], v7 offset:22528
    v_mfma_f32_32x32x16_bf16 v[48:63], v[28:31], a[76:79], v[48:63]
    v_mfma_f32_32x32x16_bf16 v[64:79], a[204:207], v[28:31], v[64:79]
    s_waitcnt lgkmcnt(2)
    v_mfma_f32_32x32x16_bf16 v[32:47], v[208:211], v[16:19], v[32:47]
    ds_read_b128 v[28:31], v7 offset:23552
    v_mfma_f32_32x32x16_bf16 v[48:63], v[16:19], a[80:83], v[48:63]
    v_mfma_f32_32x32x16_bf16 v[64:79], a[208:211], v[16:19], v[64:79]
    s_waitcnt vmcnt(8)
    v_mov_b32 v11, s40
    buffer_store_dword v11, v2, s[4:7], s43 offen sc1
    s_waitcnt lgkmcnt(2)
    v_mfma_f32_32x32x16_bf16 v[32:47], v[212:215], v[20:23], v[32:47]
    ds_read_b128 v[16:19], v7 offset:24576
    v_mfma_f32_32x32x16_bf16 v[48:63], v[20:23], a[84:87], v[48:63]
    v_mfma_f32_32x32x16_bf16 v[64:79], a[212:215], v[20:23], v[64:79]
    s_waitcnt lgkmcnt(2)
    v_mfma_f32_32x32x16_bf16 v[32:47], v[216:219], v[24:27], v[32:47]
    ds_read_b128 v[20:23], v7 offset:25600
    v_mfma_f32_32x32x16_bf16 v[48:63], v[24:27], a[88:91], v[48:63]
    v_mfma_f32_32x32x16_bf16 v[64:79], a[216:219], v[24:27], v[64:79]
    s_waitcnt lgkmcnt(2)
    v_mfma_f32_32x32x16_bf16 v[32:47], v[220:223], v[28:31], v[32:47]
    ds_read_b128 v[24:27], v7 offset:26624
    v_mfma_f32_32x32x16_bf16 v[48:63], v[28:31], a[92:95], v[48:63]
    v_mfma_f32_32x32x16_bf16 v[64:79], a[220:223], v[28:31], v[64:79]
    s_waitcnt lgkmcnt(2)
    v_mfma_f32_32x32x16_bf16 v[32:47], v[224:227], v[16:19], v[32:47]
    ds_read_b128 v[28:31], v7 offset:27648
    v_mfma_f32_32x32x16_bf16 v[48:63], v[16:19], a[96:99], v[48:63]
    v_mfma_f32_32x32x16_bf16 v[64:79], a[224:227], v[16:19], v[64:79]
    s_waitcnt lgkmcnt(2)
    v_mfma_f32_32x32x16_bf16 v[32:47], v[228:231], v[20:23], v[32:47]
    ds_read_b128 v[16:19], v7 offset:28672
    v_mfma_f32_32x32x16_bf16 v[48:63], v[20:23], a[100:103], v[48:63]
    v_mfma_f32_32x32x16_bf16 v[64:79], a[228:231], v[20:23], v[64:79]
    s_waitcnt lgkmcnt(2)
    v_mfma_f32_32x32x16_bf16 v[32:47], v[232:235], v[24:27], v[32:47]
    ds_read_b128 v[20:23], v7 offset:29696
    v_mfma_f32_32x32x16_bf16 v[48:63], v[24:27], a[104:107], v[48:63]
    v_mfma_f32_32x32x16_bf16 v[64:79], a[232:235], v[24:27], v[64:79]
    s_waitcnt lgkmcnt(2)
    v_mfma_f32_32x32x16_bf16 v[32:47], v[236:239], v[28:31], v[32:47]
    ds_read_b128 v[24:27], v7 offset:30720
    v_mfma_f32_32x32x16_bf16 v[48:63], v[28:31], a[108:111], v[48:63]
    v_mfma_f32_32x32x16_bf16 v[64:79], a[236:239], v[28:31], v[64:79]
    s_waitcnt lgkmcnt(2)
    v_mfma_f32_32x32x16_bf16 v[32:47], v[240:243], v[16:19], v[32:47]
    ds_read_b128 v[28:31], v7 offset:31744
    v_mfma_f32_32x32x16_bf16 v[48:63], v[16:19], a[112:115], v[48:63]
    v_mfma_f32_32x32x16_bf16 v[64:79], a[240:243], v[16:19], v[64:79]
    s_waitcnt lgkmcnt(2)
    v_mfma_f32_32x32x16_bf16 v[32:47], v[244:247], v[20:23], v[32:47]
    v_mfma_f32_32x32x16_bf16 v[48:63], v[20:23], a[116:119], v[48:63]
    v_mfma_f32_32x32x16_bf16 v[64:79], a[244:247], v[20:23], v[64:79]
    s_waitcnt lgkmcnt(1)
    v_mfma_f32_32x32x16_bf16 v[32:47], v[248:251], v[24:27], v[32:47]
    v_mfma_f32_32x32x16_bf16 v[48:63], v[24:27], a[120:123], v[48:63]
    v_mfma_f32_32x32x16_bf16 v[64:79], a[248:251], v[24:27], v[64:79]
    s_waitcnt lgkmcnt(0)
    v_mfma_f32_32x32x16_bf16 v[32:47], v[252:255], v[28:31], v[32:47]
    v_mfma_f32_32x32x16_bf16 v[48:63], v[28:31], a[124:127], v[48:63]
    v_mfma_f32_32x32x16_bf16 v[64:79], a[252:255], v[28:31], v[64:79]
    v_add_u32 v7, 32768, v7
    v_and_b32 v7, 0x1ffff, v7
    s_add_u32 s37, s50, 24576
    buffer_store_dwordx4 v[104:107], v1, s[4:7], s37 offen sc1
    v_cvt_pk_bf16_f32 v80, v32, v40
    v_cvt_pk_bf16_f32 v81, v33, v41
    v_cvt_pk_bf16_f32 v82, v34, v42
    v_cvt_pk_bf16_f32 v83, v35, v43
    buffer_store_dwordx4 v[80:83], v8, s[4:7], s50 offen offset:0 sc1
    v_cvt_pk_bf16_f32 v84, v36, v44
    v_cvt_pk_bf16_f32 v85, v37, v45
    v_cvt_pk_bf16_f32 v86, v38, v46
    v_cvt_pk_bf16_f32 v87, v39, v47
    buffer_store_dwordx4 v[84:87], v8, s[4:7], s50 offen offset:512 sc1
    v_cvt_pk_bf16_f32 v96, v48, v49
    v_cvt_pk_bf16_f32 v97, v56, v57
    v_cvt_pk_bf16_f32 v98, v52, v53
    v_cvt_pk_bf16_f32 v99, v60, v61
    buffer_store_dwordx4 v[96:99], v9, s[4:7], s51 offen offset:0 sc1
    v_cvt_pk_bf16_f32 v100, v50, v51
    v_cvt_pk_bf16_f32 v101, v58, v59
    v_cvt_pk_bf16_f32 v102, v54, v55
    v_cvt_pk_bf16_f32 v103, v62, v63
    buffer_store_dwordx4 v[100:103], v9, s[4:7], s51 offen offset:256 sc1
    v_cvt_pk_bf16_f32 v88, v64, v72
    v_cvt_pk_bf16_f32 v89, v65, v73
    v_cvt_pk_bf16_f32 v90, v66, v74
    v_cvt_pk_bf16_f32 v91, v67, v75
    buffer_store_dwordx4 v[88:91], v8, s[4:7], s52 offen offset:0 sc1
    v_cvt_pk_bf16_f32 v92, v68, v76
    v_cvt_pk_bf16_f32 v93, v69, v77
    v_cvt_pk_bf16_f32 v94, v70, v78
    v_cvt_pk_bf16_f32 v95, v71, v79
    buffer_store_dwordx4 v[92:95], v8, s[4:7], s52 offen offset:512 sc1
    s_add_u32 s50, s50, 65536
    s_add_u32 s51, s51, 65536
    s_add_u32 s52, s52, 65536
    s_add_u32 s40, s40, 1
    s_cmp_gt_u32 s40, 1
    s_cbranch_scc1 xgf_72
    s_waitcnt vmcnt(0)
    v_mov_b32 v11, 1
    buffer_store_dword v11, v2, s[4:7], s43 offen sc1
xgf_72:
    s_cmp_lt_u32 s40, 32
    s_cbranch_scc1 xg_71
    s_waitcnt vmcnt(0)
    v_mov_b32 v11, 32
    buffer_store_dword v11, v2, s[4:7], s43 offen sc1
    s_branch L_exit
L_glu:
    s_cmp_ge_u32 s33, 30
    s_cbranch_scc1 L_exit
    v_mbcnt_lo_u32_b32 v2, -1, 0
    v_mbcnt_hi_u32_b32 v2, -1, v2
    v_lshlrev_b32 v2, 5, v2
wt_73:
    buffer_load_dword v1, v2, s[8:11], 0 offen sc1
    s_waitcnt vmcnt(0)
    v_readlane_b32 s36, v1, 0
    v_readlane_b32 s37, v1, 1
    s_nop 0
    s_add_u32 s36, s36, s37
    v_readlane_b32 s37, v1, 2
    s_nop 0
    s_add_u32 s36, s36, s37
    v_readlane_b32 s37, v1, 3
    s_nop 0
    s_add_u32 s36, s36, s37
    v_readlane_b32 s37, v1, 4
    s_nop 0
    s_add_u32 s36, s36, s37
    v_readlane_b32 s37, v1, 5
    s_nop 0
    s_add_u32 s36, s36, s37
    v_readlane_b32 s37, v1, 6
    s_nop 0
    s_add_u32 s36, s36, s37
    v_readlane_b32 s37, v1, 7
    s_nop 0
    s_add_u32 s36, s36, s37
    s_cmp_ge_u32 s36, 256
    s_cbranch_scc1 wtd_74
    s_sleep 2
    s_add_u32 s35, s35, 1
    s_cmp_lt_u32 s35, 524288
    s_cbranch_scc1 wt_73
wtd_74:
    v_mov_b32 v2, 0
    s_mov_b32 s38, 11804672
wf_75:
    buffer_load_dword v1, v2, s[4:7], s38 offen sc1
    s_waitcnt vmcnt(0)
    v_cmp_gt_u32 vcc, 1, v1
    s_cbranch_vccz wfd_76
    s_sleep 16
    s_add_u32 s35, s35, 1
    s_cmp_lt_u32 s35, 524288
    s_cbranch_scc1 wf_75
wfd_76:
    s_cmp_ge_u32 s33, 22
    s_cbranch_scc1 L_t3
    s_load_dwordx2 s[12:13], s[0:1], 64
    s_load_dwordx2 s[16:17], s[0:1], 72
    s_waitcnt lgkmcnt(0)
    s_mov_b32 s14, 0x158000
    s_mov_b32 s15, 0x20000
    s_mov_b32 s18, 0x158000
    s_mov_b32 s19, 0x20000
    v_lshlrev_b32 v1, 4, v0
    v_cmp_eq_u32 vcc, 0, v0
    v_mov_b32 v2, 0x80000000
    s_nop 0
    v_cndmask_b32 v2, v2, 0, vcc
    s_lshr_b32 s48, s33, 1
    s_and_b32 s45, s33, 1
    s_lshl_b32 s49, s48, 8
    v_lshrrev_b32 v11, 4, v0
    v_lshlrev_b32 v12, 2, v11
    v_and_b32 v13, 15, v0
    v_xor_b32 v12, v12, v13
    s_lshl_b32 s36, s32, 4
    v_add_u32 v11, s36, v11
    v_mul_u32_u24 v11, 2752, v11
    v_lshl_add_u32 v11, v12, 4, v11
    v_add_u32 v3, s49, v11
    v_bfe_u32 v11, v0, 2, 2
    v_lshrrev_b32 v12, 5, v0
    v_lshl_add_u32 v12, v12, 3, v11
    v_lshlrev_b32 v12, 8, v12
    s_lshl_b32 s36, s32, 1
    v_bfe_u32 v13, v0, 4, 1
    v_and_b32 v6, 3, v0
    v_lshlrev_b32 v6, 3, v6
    v_add_u32 v13, s36, v13
    v_lshlrev_b32 v11, 1, v11
    v_xor_b32 v13, v13, v11
    v_lshl_add_u32 v12, v13, 5, v12
    v_add_u32 v4, v12, v6
    v_add_u32 v5, 65536, v4
    s_cmp_lg_u32 s45, 0
    s_cbranch_scc1 ld1_77
    s_lshl_b32 s46, s32, 12
    s_add_u32 s46, s46, 0
    s_add_u32 m0, s46, 0
    s_mov_b32 s36, 0
    buffer_load_dwordx4 v3, s[12:15], s36 offen lds
    s_add_u32 m0, s46, 1024
    s_mov_b32 s36, 11008
    buffer_load_dwordx4 v3, s[12:15], s36 offen lds
    s_add_u32 m0, s46, 2048
    s_mov_b32 s36, 22016
    buffer_load_dwordx4 v3, s[12:15], s36 offen lds
    s_add_u32 m0, s46, 3072
    s_mov_b32 s36, 33024
    buffer_load_dwordx4 v3, s[12:15], s36 offen lds
    s_add_u32 m0, s46, 16384
    s_mov_b32 s36, 176128
    buffer_load_dwordx4 v3, s[12:15], s36 offen lds
    s_add_u32 m0, s46, 17408
    s_mov_b32 s36, 187136
    buffer_load_dwordx4 v3, s[12:15], s36 offen lds
    s_add_u32 m0, s46, 18432
    s_mov_b32 s36, 198144
    buffer_load_dwordx4 v3, s[12:15], s36 offen lds
    s_add_u32 m0, s46, 19456
    s_mov_b32 s36, 209152
    buffer_load_dwordx4 v3, s[12:15], s36 offen lds
    s_add_u32 m0, s46, 32768
    s_mov_b32 s36, 352256
    buffer_load_dwordx4 v3, s[12:15], s36 offen lds
    s_add_u32 m0, s46, 33792
    s_mov_b32 s36, 363264
    buffer_load_dwordx4 v3, s[12:15], s36 offen lds
    s_add_u32 m0, s46, 34816
    s_mov_b32 s36, 374272
    buffer_load_dwordx4 v3, s[12:15], s36 offen lds
    s_add_u32 m0, s46, 35840
    s_mov_b32 s36, 385280
    buffer_load_dwordx4 v3, s[12:15], s36 offen lds
    s_add_u32 m0, s46, 49152
    s_mov_b32 s36, 528384
    buffer_load_dwordx4 v3, s[12:15], s36 offen lds
    s_add_u32 m0, s46, 50176
    s_mov_b32 s36, 539392
    buffer_load_dwordx4 v3, s[12:15], s36 offen lds
    s_add_u32 m0, s46, 51200
    s_mov_b32 s36, 550400
    buffer_load_dwordx4 v3, s[12:15], s36 offen lds
    s_add_u32 m0, s46, 52224
    s_mov_b32 s36, 561408
    buffer_load_dwordx4 v3, s[12:15], s36 offen lds
    s_add_u32 m0, s46, 65536
    s_mov_b32 s36, 704512
    buffer_load_dwordx4 v3, s[12:15], s36 offen lds
    s_add_u32 m0, s46, 66560
    s_mov_b32 s36, 715520
    buffer_load_dwordx4 v3, s[12:15], s36 offen lds
    s_add_u32 m0, s46, 67584
    s_mov_b32 s36, 726528
    buffer_load_dwordx4 v3, s[12:15], s36 offen lds
    s_add_u32 m0, s46, 68608
    s_mov_b32 s36, 737536
    buffer_load_dwordx4 v3, s[12:15], s36 offen lds
    s_add_u32 m0, s46, 81920
    s_mov_b32 s36, 880640
    buffer_load_dwordx4 v3, s[12:15], s36 offen lds
    s_add_u32 m0, s46, 82944
    s_mov_b32 s36, 891648
    buffer_load_dwordx4 v3, s[12:15], s36 offen lds
    s_add_u32 m0, s46, 83968
    s_mov_b32 s36, 902656
    buffer_load_dwordx4 v3, s[12:15], s36 offen lds
    s_add_u32 m0, s46, 84992
    s_mov_b32 s36, 913664
    buffer_load_dwordx4 v3, s[12:15], s36 offen lds
    s_add_u32 m0, s46, 98304
    s_mov_b32 s36, 1056768
    buffer_load_dwordx4 v3, s[12:15], s36 offen lds
    s_add_u32 m0, s46, 99328
    s_mov_b32 s36, 1067776
    buffer_load_dwordx4 v3, s[12:15], s36 offen lds
    s_add_u32 m0, s46, 100352
    s_mov_b32 s36, 1078784
    buffer_load_dwordx4 v3, s[12:15], s36 offen lds
    s_add_u32 m0, s46, 101376
    s_mov_b32 s36, 1089792
    buffer_load_dwordx4 v3, s[12:15], s36 offen lds
    s_waitcnt vmcnt(24) lgkmcnt(0)
    s_barrier
    s_add_u32 m0, s46, 114688
    s_mov_b32 s36, 1232896
    buffer_load_dwordx4 v3, s[12:15], s36 offen lds
    s_add_u32 m0, s46, 115712
    s_mov_b32 s36, 1243904
    buffer_load_dwordx4 v3, s[12:15], s36 offen lds
    s_add_u32 m0, s46, 116736
    s_mov_b32 s36, 1254912
    buffer_load_dwordx4 v3, s[12:15], s36 offen lds
    s_add_u32 m0, s46, 117760
    s_mov_b32 s36, 1265920
    buffer_load_dwordx4 v3, s[12:15], s36 offen lds
    ds_read_b64_tr_b16 a[0:1], v4 offset:0
    ds_read_b64_tr_b16 a[2:3], v4 offset:1024
    ds_read_b64_tr_b16 a[4:5], v4 offset:4096
    ds_read_b64_tr_b16 a[6:7], v4 offset:5120
    ds_read_b64_tr_b16 a[8:9], v4 offset:8192
    ds_read_b64_tr_b16 a[10:11], v4 offset:9216
    ds_read_b64_tr_b16 a[12:13], v4 offset:12288
    ds_read_b64_tr_b16 a[14:15], v4 offset:13312
    s_waitcnt vmcnt(24) lgkmcnt(0)
    s_barrier
    s_add_u32 m0, s46, 0
    s_mov_b32 s36, 0
    buffer_load_dwordx4 v3, s[16:19], s36 offen lds
    s_add_u32 m0, s46, 1024
    s_mov_b32 s36, 11008
    buffer_load_dwordx4 v3, s[16:19], s36 offen lds
    s_add_u32 m0, s46, 2048
    s_mov_b32 s36, 22016
    buffer_load_dwordx4 v3, s[16:19], s36 offen lds
    s_add_u32 m0, s46, 3072
    s_mov_b32 s36, 33024
    buffer_load_dwordx4 v3, s[16:19], s36 offen lds
    ds_read_b64_tr_b16 a[16:17], v4 offset:16384
    ds_read_b64_tr_b16 a[18:19], v4 offset:17408
    ds_read_b64_tr_b16 a[20:21], v4 offset:20480
    ds_read_b64_tr_b16 a[22:23], v4 offset:21504
    ds_read_b64_tr_b16 a[24:25], v4 offset:24576
    ds_read_b64_tr_b16 a[26:27], v4 offset:25600
    ds_read_b64_tr_b16 a[28:29], v4 offset:28672
    ds_read_b64_tr_b16 a[30:31], v4 offset:29696
    s_waitcnt vmcnt(24) lgkmcnt(0)
    s_barrier
    s_add_u32 m0, s46, 16384
    s_mov_b32 s36, 176128
    buffer_load_dwordx4 v3, s[16:19], s36 offen lds
    s_add_u32 m0, s46, 17408
    s_mov_b32 s36, 187136
    buffer_load_dwordx4 v3, s[16:19], s36 offen lds
    s_add_u32 m0, s46, 18432
    s_mov_b32 s36, 198144
    buffer_load_dwordx4 v3, s[16:19], s36 offen lds
    s_add_u32 m0, s46, 19456
    s_mov_b32 s36, 209152
    buffer_load_dwordx4 v3, s[16:19], s36 offen lds
    ds_read_b64_tr_b16 a[32:33], v4 offset:32768
    ds_read_b64_tr_b16 a[34:35], v4 offset:33792
    ds_read_b64_tr_b16 a[36:37], v4 offset:36864
    ds_read_b64_tr_b16 a[38:39], v4 offset:37888
    ds_read_b64_tr_b16 a[40:41], v4 offset:40960
    ds_read_b64_tr_b16 a[42:43], v4 offset:41984
    ds_read_b64_tr_b16 a[44:45], v4 offset:45056
    ds_read_b64_tr_b16 a[46:47], v4 offset:46080
    s_waitcnt vmcnt(24) lgkmcnt(0)
    s_barrier
    s_add_u32 m0, s46, 32768
    s_mov_b32 s36, 352256
    buffer_load_dwordx4 v3, s[16:19], s36 offen lds
    s_add_u32 m0, s46, 33792
    s_mov_b32 s36, 363264
    buffer_load_dwordx4 v3, s[16:19], s36 offen lds
    s_add_u32 m0, s46, 34816
    s_mov_b32 s36, 374272
    buffer_load_dwordx4 v3, s[16:19], s36 offen lds
    s_add_u32 m0, s46, 35840
    s_mov_b32 s36, 385280
    buffer_load_dwordx4 v3, s[16:19], s36 offen lds
    ds_read_b64_tr_b16 a[48:49], v4 offset:49152
    ds_read_b64_tr_b16 a[50:51], v4 offset:50176
    ds_read_b64_tr_b16 a[52:53], v4 offset:53248
    ds_read_b64_tr_b16 a[54:55], v4 offset:54272
    ds_read_b64_tr_b16 a[56:57], v4 offset:57344
    ds_read_b64_tr_b16 a[58:59], v4 offset:58368
    ds_read_b64_tr_b16 a[60:61], v4 offset:61440
    ds_read_b64_tr_b16 a[62:63], v4 offset:62464
    s_waitcnt vmcnt(24) lgkmcnt(0)
    s_barrier
    s_add_u32 m0, s46, 49152
    s_mov_b32 s36, 528384
    buffer_load_dwordx4 v3, s[16:19], s36 offen lds
    s_add_u32 m0, s46, 50176
    s_mov_b32 s36, 539392
    buffer_load_dwordx4 v3, s[16:19], s36 offen lds
    s_add_u32 m0, s46, 51200
    s_mov_b32 s36, 550400
    buffer_load_dwordx4 v3, s[16:19], s36 offen lds
    s_add_u32 m0, s46, 52224
    s_mov_b32 s36, 561408
    buffer_load_dwordx4 v3, s[16:19], s36 offen lds
    ds_read_b64_tr_b16 a[64:65], v5 offset:0
    ds_read_b64_tr_b16 a[66:67], v5 offset:1024
    ds_read_b64_tr_b16 a[68:69], v5 offset:4096
    ds_read_b64_tr_b16 a[70:71], v5 offset:5120
    ds_read_b64_tr_b16 a[72:73], v5 offset:8192
    ds_read_b64_tr_b16 a[74:75], v5 offset:9216
    ds_read_b64_tr_b16 a[76:77], v5 offset:12288
    ds_read_b64_tr_b16 a[78:79], v5 offset:13312
    s_waitcnt vmcnt(24) lgkmcnt(0)
    s_barrier
    s_add_u32 m0, s46, 65536
    s_mov_b32 s36, 704512
    buffer_load_dwordx4 v3, s[16:19], s36 offen lds
    s_add_u32 m0, s46, 66560
    s_mov_b32 s36, 715520
    buffer_load_dwordx4 v3, s[16:19], s36 offen lds
    s_add_u32 m0, s46, 67584
    s_mov_b32 s36, 726528
    buffer_load_dwordx4 v3, s[16:19], s36 offen lds
    s_add_u32 m0, s46, 68608
    s_mov_b32 s36, 737536
    buffer_load_dwordx4 v3, s[16:19], s36 offen lds
    ds_read_b64_tr_b16 a[80:81], v5 offset:16384
    ds_read_b64_tr_b16 a[82:83], v5 offset:17408
    ds_read_b64_tr_b16 a[84:85], v5 offset:20480
    ds_read_b64_tr_b16 a[86:87], v5 offset:21504
    ds_read_b64_tr_b16 a[88:89], v5 offset:24576
    ds_read_b64_tr_b16 a[90:91], v5 offset:25600
    ds_read_b64_tr_b16 a[92:93], v5 offset:28672
    ds_read_b64_tr_b16 a[94:95], v5 offset:29696
    s_waitcnt vmcnt(24) lgkmcnt(0)
    s_barrier
    s_add_u32 m0, s46, 81920
    s_mov_b32 s36, 880640
    buffer_load_dwordx4 v3, s[16:19], s36 offen lds
    s_add_u32 m0, s46, 82944
    s_mov_b32 s36, 891648
    buffer_load_dwordx4 v3, s[16:19], s36 offen lds
    s_add_u32 m0, s46, 83968
    s_mov_b32 s36, 902656
    buffer_load_dwordx4 v3, s[16:19], s36 offen lds
    s_add_u32 m0, s46, 84992
    s_mov_b32 s36, 913664
    buffer_load_dwordx4 v3, s[16:19], s36 offen lds
    ds_read_b64_tr_b16 a[96:97], v5 offset:32768
    ds_read_b64_tr_b16 a[98:99], v5 offset:33792
    ds_read_b64_tr_b16 a[100:101], v5 offset:36864
    ds_read_b64_tr_b16 a[102:103], v5 offset:37888
    ds_read_b64_tr_b16 a[104:105], v5 offset:40960
    ds_read_b64_tr_b16 a[106:107], v5 offset:41984
    ds_read_b64_tr_b16 a[108:109], v5 offset:45056
    ds_read_b64_tr_b16 a[110:111], v5 offset:46080
    s_waitcnt vmcnt(24) lgkmcnt(0)
    s_barrier
    s_add_u32 m0, s46, 98304
    s_mov_b32 s36, 1056768
    buffer_load_dwordx4 v3, s[16:19], s36 offen lds
    s_add_u32 m0, s46, 99328
    s_mov_b32 s36, 1067776
    buffer_load_dwordx4 v3, s[16:19], s36 offen lds
    s_add_u32 m0, s46, 100352
    s_mov_b32 s36, 1078784
    buffer_load_dwordx4 v3, s[16:19], s36 offen lds
    s_add_u32 m0, s46, 101376
    s_mov_b32 s36, 1089792
    buffer_load_dwordx4 v3, s[16:19], s36 offen lds
    ds_read_b64_tr_b16 a[112:113], v5 offset:49152
    ds_read_b64_tr_b16 a[114:115], v5 offset:50176
    ds_read_b64_tr_b16 a[116:117], v5 offset:53248
    ds_read_b64_tr_b16 a[118:119], v5 offset:54272
    ds_read_b64_tr_b16 a[120:121], v5 offset:57344
    ds_read_b64_tr_b16 a[122:123], v5 offset:58368
    ds_read_b64_tr_b16 a[124:125], v5 offset:61440
    ds_read_b64_tr_b16 a[126:127], v5 offset:62464
    s_waitcnt vmcnt(24) lgkmcnt(0)
    s_barrier
    s_add_u32 m0, s46, 114688
    s_mov_b32 s36, 1232896
    buffer_load_dwordx4 v3, s[16:19], s36 offen lds
    s_add_u32 m0, s46, 115712
    s_mov_b32 s36, 1243904
    buffer_load_dwordx4 v3, s[16:19], s36 offen lds
    s_add_u32 m0, s46, 116736
    s_mov_b32 s36, 1254912
    buffer_load_dwordx4 v3, s[16:19], s36 offen lds
    s_add_u32 m0, s46, 117760
    s_mov_b32 s36, 1265920
    buffer_load_dwordx4 v3, s[16:19], s36 offen lds
    ds_read_b64_tr_b16 a[128:129], v4 offset:0
    ds_read_b64_tr_b16 a[130:131], v4 offset:1024
    ds_read_b64_tr_b16 a[132:133], v4 offset:4096
    ds_read_b64_tr_b16 a[134:135], v4 offset:5120
    ds_read_b64_tr_b16 a[136:137], v4 offset:8192
    ds_read_b64_tr_b16 a[138:139], v4 offset:9216
    ds_read_b64_tr_b16 a[140:141], v4 offset:12288
    ds_read_b64_tr_b16 a[142:143], v4 offset:13312
    s_waitcnt vmcnt(24) lgkmcnt(0)
    s_barrier
    v_mbcnt_lo_u32_b32 v12, -1, 0
    v_mbcnt_hi_u32_b32 v12, -1, v12
    v_lshlrev_b32 v12, 5, v12
wt_79:
    buffer_load_dword v11, v12, s[8:11], 0 offen sc1
    s_waitcnt vmcnt(0)
    v_readlane_b32 s36, v11, 0
    v_readlane_b32 s37, v11, 1
    s_nop 0
    s_add_u32 s36, s36, s37
    v_readlane_b32 s37, v11, 2
    s_nop 0
    s_add_u32 s36, s36, s37
    v_readlane_b32 s37, v11, 3
    s_nop 0
    s_add_u32 s36, s36, s37
    v_readlane_b32 s37, v11, 4
    s_nop 0
    s_add_u32 s36, s36, s37
    v_readlane_b32 s37, v11, 5
    s_nop 0
    s_add_u32 s36, s36, s37
    v_readlane_b32 s37, v11, 6
    s_nop 0
    s_add_u32 s36, s36, s37
    v_readlane_b32 s37, v11, 7
    s_nop 0
    s_add_u32 s36, s36, s37
    s_cmp_ge_u32 s36, 256
    s_cbranch_scc1 wtd_80
    s_sleep 2
    s_add_u32 s35, s35, 1
    s_cmp_lt_u32 s35, 524288
    s_cbranch_scc1 wt_79
wtd_80:
    v_readlane_b32 s55, v11, s34
    s_mov_b32 s38, 11829248
    v_lshlrev_b32 v11, 7, v0
    v_add_u32 v12, 8192, v11
wf_81:
    buffer_load_dwordx4 v[16:19], v11, s[4:7], s38 offen sc1
    buffer_load_dwordx4 v[20:23], v12, s[4:7], s38 offen sc1
    s_waitcnt vmcnt(0)
    v_min_u32 v16, v16, v17
    v_min_u32 v16, v16, v18
    v_min_u32 v16, v16, v19
    v_min_u32 v16, v16, v20
    v_min_u32 v16, v16, v21
    v_min_u32 v16, v16, v22
    v_min_u32 v16, v16, v23
    v_cmp_gt_u32 vcc, 1, v16
    s_cbranch_vccz wfd_82
    s_sleep 2
    s_add_u32 s35, s35, 1
    s_cmp_lt_u32 s35, 524288
    s_cbranch_scc1 wf_81
wfd_82:
    s_lshl_b32 s36, s32, 13
    s_add_u32 s42, s36, 131072
    s_lshl_b32 s41, s45, 15
    s_add_u32 s41, s41, s36
    s_add_u32 m0, s42, 0
    s_add_u32 s36, s41, 0
    buffer_load_dwordx4 v1, s[4:7], s36 offen offset:0 sc1 lds
    buffer_load_dwordx4 v1, s[4:7], s36 offen offset:1024 sc1 lds
    buffer_load_dwordx4 v1, s[4:7], s36 offen offset:2048 sc1 lds
    buffer_load_dwordx4 v1, s[4:7], s36 offen offset:3072 sc1 lds
    s_add_u32 m0, s42, 4096
    s_add_u32 s36, s41, 4096
    buffer_load_dwordx4 v1, s[4:7], s36 offen offset:0 sc1 lds
    buffer_load_dwordx4 v1, s[4:7], s36 offen offset:1024 sc1 lds
    buffer_load_dwordx4 v1, s[4:7], s36 offen offset:2048 sc1 lds
    buffer_load_dwordx4 v1, s[4:7], s36 offen offset:3072 sc1 lds
    s_add_u32 s41, s41, 65536
    s_add_u32 s42, s42, 32768
    s_and_b32 s42, s42, 0x1ffff
    ds_read_b64_tr_b16 a[144:145], v4 offset:16384
    ds_read_b64_tr_b16 a[146:147], v4 offset:17408
    ds_read_b64_tr_b16 a[148:149], v4 offset:20480
    ds_read_b64_tr_b16 a[150:151], v4 offset:21504
    ds_read_b64_tr_b16 a[152:153], v4 offset:24576
    ds_read_b64_tr_b16 a[154:155], v4 offset:25600
    ds_read_b64_tr_b16 a[156:157], v4 offset:28672
    ds_read_b64_tr_b16 a[158:159], v4 offset:29696
    s_waitcnt vmcnt(20) lgkmcnt(0)
    s_barrier
    ds_read_b64_tr_b16 a[160:161], v4 offset:32768
    ds_read_b64_tr_b16 a[162:163], v4 offset:33792
    ds_read_b64_tr_b16 a[164:165], v4 offset:36864
    ds_read_b64_tr_b16 a[166:167], v4 offset:37888
    ds_read_b64_tr_b16 a[168:169], v4 offset:40960
    ds_read_b64_tr_b16 a[170:171], v4 offset:41984
    ds_read_b64_tr_b16 a[172:173], v4 offset:45056
    ds_read_b64_tr_b16 a[174:175], v4 offset:46080
    s_waitcnt vmcnt(16) lgkmcnt(0)
    s_barrier
    ds_read_b64_tr_b16 a[176:177], v4 offset:49152
    ds_read_b64_tr_b16 a[178:179], v4 offset:50176
    ds_read_b64_tr_b16 a[180:181], v4 offset:53248
    ds_read_b64_tr_b16 a[182:183], v4 offset:54272
    ds_read_b64_tr_b16 a[184:185], v4 offset:57344
    ds_read_b64_tr_b16 a[186:187], v4 offset:58368
    ds_read_b64_tr_b16 a[188:189], v4 offset:61440
    ds_read_b64_tr_b16 a[190:191], v4 offset:62464
    s_waitcnt vmcnt(12) lgkmcnt(0)
    s_barrier
    ds_read_b64_tr_b16 a[192:193], v5 offset:0
    ds_read_b64_tr_b16 a[194:195], v5 offset:1024
    ds_read_b64_tr_b16 a[196:197], v5 offset:4096
    ds_read_b64_tr_b16 a[198:199], v5 offset:5120
    ds_read_b64_tr_b16 a[200:201], v5 offset:8192
    ds_read_b64_tr_b16 a[202:203], v5 offset:9216
    ds_read_b64_tr_b16 a[204:205], v5 offset:12288
    ds_read_b64_tr_b16 a[206:207], v5 offset:13312
    s_waitcnt vmcnt(8) lgkmcnt(0)
    s_barrier
    ds_read_b64_tr_b16 a[208:209], v5 offset:16384
    ds_read_b64_tr_b16 a[210:211], v5 offset:17408
    ds_read_b64_tr_b16 a[212:213], v5 offset:20480
    ds_read_b64_tr_b16 a[214:215], v5 offset:21504
    ds_read_b64_tr_b16 a[216:217], v5 offset:24576
    ds_read_b64_tr_b16 a[218:219], v5 offset:25600
    ds_read_b64_tr_b16 a[220:221], v5 offset:28672
    ds_read_b64_tr_b16 a[222:223], v5 offset:29696
    s_waitcnt vmcnt(4) lgkmcnt(0)
    s_barrier
    ds_read_b64_tr_b16 a[224:225], v5 offset:32768
    ds_read_b64_tr_b16 a[226:227], v5 offset:33792
    ds_read_b64_tr_b16 a[228:229], v5 offset:36864
    ds_read_b64_tr_b16 a[230:231], v5 offset:37888
    ds_read_b64_tr_b16 a[232:233], v5 offset:40960
    ds_read_b64_tr_b16 a[234:235], v5 offset:41984
    ds_read_b64_tr_b16 a[236:237], v5 offset:45056
    ds_read_b64_tr_b16 a[238:239], v5 offset:46080
    s_waitcnt vmcnt(0) lgkmcnt(0)
    s_barrier
    ds_read_b64_tr_b16 a[240:241], v5 offset:49152
    ds_read_b64_tr_b16 a[242:243], v5 offset:50176
    ds_read_b64_tr_b16 a[244:245], v5 offset:53248
    ds_read_b64_tr_b16 a[246:247], v5 offset:54272
    ds_read_b64_tr_b16 a[248:249], v5 offset:57344
    ds_read_b64_tr_b16 a[250:251], v5 offset:58368
    ds_read_b64_tr_b16 a[252:253], v5 offset:61440
    ds_read_b64_tr_b16 a[254:255], v5 offset:62464
    s_waitcnt lgkmcnt(0)
    s_barrier
    s_branch ld2_78
ld1_77:
    s_lshl_b32 s46, s32, 12
    s_add_u32 s46, s46, 0
    s_add_u32 m0, s46, 0
    s_mov_b32 s36, 528384
    buffer_load_dwordx4 v3, s[12:15], s36 offen lds
    s_add_u32 m0, s46, 1024
    s_mov_b32 s36, 539392
    buffer_load_dwordx4 v3, s[12:15], s36 offen lds
    s_add_u32 m0, s46, 2048
    s_mov_b32 s36, 550400
    buffer_load_dwordx4 v3, s[12:15], s36 offen lds
    s_add_u32 m0, s46, 3072
    s_mov_b32 s36, 561408
    buffer_load_dwordx4 v3, s[12:15], s36 offen lds
    s_add_u32 m0, s46, 16384
    s_mov_b32 s36, 704512
    buffer_load_dwordx4 v3, s[12:15], s36 offen lds
    s_add_u32 m0, s46, 17408
    s_mov_b32 s36, 715520
    buffer_load_dwordx4 v3, s[12:15], s36 offen lds
    s_add_u32 m0, s46, 18432
    s_mov_b32 s36, 726528
    buffer_load_dwordx4 v3, s[12:15], s36 offen lds
    s_add_u32 m0, s46, 19456
    s_mov_b32 s36, 737536
    buffer_load_dwordx4 v3, s[12:15], s36 offen lds
    s_add_u32 m0, s46, 32768
    s_mov_b32 s36, 880640
    buffer_load_dwordx4 v3, s[12:15], s36 offen lds
    s_add_u32 m0, s46, 33792
    s_mov_b32 s36, 891648
    buffer_load_dwordx4 v3, s[12:15], s36 offen lds
    s_add_u32 m0, s46, 34816
    s_mov_b32 s36, 902656
    buffer_load_dwordx4 v3, s[12:15], s36 offen lds
    s_add_u32 m0, s46, 35840
    s_mov_b32 s36, 913664
    buffer_load_dwordx4 v3, s[12:15], s36 offen lds
    s_add_u32 m0, s46, 49152
    s_mov_b32 s36, 0
    buffer_load_dwordx4 v3, s[12:15], s36 offen lds
    s_add_u32 m0, s46, 50176
    s_mov_b32 s36, 11008
    buffer_load_dwordx4 v3, s[12:15], s36 offen lds
    s_add_u32 m0, s46, 51200
    s_mov_b32 s36, 22016
    buffer_load_dwordx4 v3, s[12:15], s36 offen lds
    s_add_u32 m0, s46, 52224
    s_mov_b32 s36, 33024
    buffer_load_dwordx4 v3, s[12:15], s36 offen lds
    s_add_u32 m0, s46, 65536
    s_mov_b32 s36, 176128
    buffer_load_dwordx4 v3, s[12:15], s36 offen lds
    s_add_u32 m0, s46, 66560
    s_mov_b32 s36, 187136
    buffer_load_dwordx4 v3, s[12:15], s36 offen lds
    s_add_u32 m0, s46, 67584
    s_mov_b32 s36, 198144
    buffer_load_dwordx4 v3, s[12:15], s36 offen lds
    s_add_u32 m0, s46, 68608
    s_mov_b32 s36, 209152
    buffer_load_dwordx4 v3, s[12:15], s36 offen lds
    s_add_u32 m0, s46, 81920
    s_mov_b32 s36, 352256
    buffer_load_dwordx4 v3, s[12:15], s36 offen lds
    s_add_u32 m0, s46, 82944
    s_mov_b32 s36, 363264
    buffer_load_dwordx4 v3, s[12:15], s36 offen lds
    s_add_u32 m0, s46, 83968
    s_mov_b32 s36, 374272
    buffer_load_dwordx4 v3, s[12:15], s36 offen lds
    s_add_u32 m0, s46, 84992
    s_mov_b32 s36, 385280
    buffer_load_dwordx4 v3, s[12:15], s36 offen lds
    s_add_u32 m0, s46, 98304
    s_mov_b32 s36, 176128
    buffer_load_dwordx4 v3, s[16:19], s36 offen lds
    s_add_u32 m0, s46, 99328
    s_mov_b32 s36, 187136
    buffer_load_dwordx4 v3, s[16:19], s36 offen lds
    s_add_u32 m0, s46, 100352
    s_mov_b32 s36, 198144
    buffer_load_dwordx4 v3, s[16:19], s36 offen lds
    s_add_u32 m0, s46, 101376
    s_mov_b32 s36, 209152
    buffer_load_dwordx4 v3, s[16:19], s36 offen lds
    s_waitcnt vmcnt(24) lgkmcnt(0)
    s_barrier
    s_add_u32 m0, s46, 114688
    s_mov_b32 s36, 352256
    buffer_load_dwordx4 v3, s[16:19], s36 offen lds
    s_add_u32 m0, s46, 115712
    s_mov_b32 s36, 363264
    buffer_load_dwordx4 v3, s[16:19], s36 offen lds
    s_add_u32 m0, s46, 116736
    s_mov_b32 s36, 374272
    buffer_load_dwordx4 v3, s[16:19], s36 offen lds
    s_add_u32 m0, s46, 117760
    s_mov_b32 s36, 385280
    buffer_load_dwordx4 v3, s[16:19], s36 offen lds
    ds_read_b64_tr_b16 a[48:49], v4 offset:0
    ds_read_b64_tr_b16 a[50:51], v4 offset:1024
    ds_read_b64_tr_b16 a[52:53], v4 offset:4096
    ds_read_b64_tr_b16 a[54:55], v4 offset:5120
    ds_read_b64_tr_b16 a[56:57], v4 offset:8192
    ds_read_b64_tr_b16 a[58:59], v4 offset:9216
    ds_read_b64_tr_b16 a[60:61], v4 offset:12288
    ds_read_b64_tr_b16 a[62:63], v4 offset:13312
    s_waitcnt vmcnt(24) lgkmcnt(0)
    s_barrier
    s_add_u32 m0, s46, 0
    s_mov_b32 s36, 528384
    buffer_load_dwordx4 v3, s[16:19], s36 offen lds
    s_add_u32 m0, s46, 1024
    s_mov_b32 s36, 539392
    buffer_load_dwordx4 v3, s[16:19], s36 offen lds
    s_add_u32 m0, s46, 2048
    s_mov_b32 s36, 550400
    buffer_load_dwordx4 v3, s[16:19], s36 offen lds
    s_add_u32 m0, s46, 3072
    s_mov_b32 s36, 561408
    buffer_load_dwordx4 v3, s[16:19], s36 offen lds
    ds_read_b64_tr_b16 a[64:65], v4 offset:16384
    ds_read_b64_tr_b16 a[66:67], v4 offset:17408
    ds_read_b64_tr_b16 a[68:69], v4 offset:20480
    ds_read_b64_tr_b16 a[70:71], v4 offset:21504
    ds_read_b64_tr_b16 a[72:73], v4 offset:24576
    ds_read_b64_tr_b16 a[74:75], v4 offset:25600
    ds_read_b64_tr_b16 a[76:77], v4 offset:28672
    ds_read_b64_tr_b16 a[78:79], v4 offset:29696
    s_waitcnt vmcnt(24) lgkmcnt(0)
    s_barrier
    s_add_u32 m0, s46, 16384
    s_mov_b32 s36, 1056768
    buffer_load_dwordx4 v3, s[12:15], s36 offen lds
    s_add_u32 m0, s46, 17408
    s_mov_b32 s36, 1067776
    buffer_load_dwordx4 v3, s[12:15], s36 offen lds
    s_add_u32 m0, s46, 18432
    s_mov_b32 s36, 1078784
    buffer_load_dwordx4 v3, s[12:15], s36 offen lds
    s_add_u32 m0, s46, 19456
    s_mov_b32 s36, 1089792
    buffer_load_dwordx4 v3, s[12:15], s36 offen lds
    ds_read_b64_tr_b16 a[80:81], v4 offset:32768
    ds_read_b64_tr_b16 a[82:83], v4 offset:33792
    ds_read_b64_tr_b16 a[84:85], v4 offset:36864
    ds_read_b64_tr_b16 a[86:87], v4 offset:37888
    ds_read_b64_tr_b16 a[88:89], v4 offset:40960
    ds_read_b64_tr_b16 a[90:91], v4 offset:41984
    ds_read_b64_tr_b16 a[92:93], v4 offset:45056
    ds_read_b64_tr_b16 a[94:95], v4 offset:46080
    s_waitcnt vmcnt(24) lgkmcnt(0)
    s_barrier
    s_add_u32 m0, s46, 32768
    s_mov_b32 s36, 1232896
    buffer_load_dwordx4 v3, s[12:15], s36 offen lds
    s_add_u32 m0, s46, 33792
    s_mov_b32 s36, 1243904
    buffer_load_dwordx4 v3, s[12:15], s36 offen lds
    s_add_u32 m0, s46, 34816
    s_mov_b32 s36, 1254912
    buffer_load_dwordx4 v3, s[12:15], s36 offen lds
    s_add_u32 m0, s46, 35840
    s_mov_b32 s36, 1265920
    buffer_load_dwordx4 v3, s[12:15], s36 offen lds
    ds_read_b64_tr_b16 a[0:1], v4 offset:49152
    ds_read_b64_tr_b16 a[2:3], v4 offset:50176
    ds_read_b64_tr_b16 a[4:5], v4 offset:53248
    ds_read_b64_tr_b16 a[6:7], v4 offset:54272
    ds_read_b64_tr_b16 a[8:9], v4 offset:57344
    ds_read_b64_tr_b16 a[10:11], v4 offset:58368
    ds_read_b64_tr_b16 a[12:13], v4 offset:61440
    ds_read_b64_tr_b16 a[14:15], v4 offset:62464
    s_waitcnt vmcnt(24) lgkmcnt(0)
    s_barrier
    s_add_u32 m0, s46, 49152
    s_mov_b32 s36, 0
    buffer_load_dwordx4 v3, s[16:19], s36 offen lds
    s_add_u32 m0, s46, 50176
    s_mov_b32 s36, 11008
    buffer_load_dwordx4 v3, s[16:19], s36 offen lds
    s_add_u32 m0, s46, 51200
    s_mov_b32 s36, 22016
    buffer_load_dwordx4 v3, s[16:19], s36 offen lds
    s_add_u32 m0, s46, 52224
    s_mov_b32 s36, 33024
    buffer_load_dwordx4 v3, s[16:19], s36 offen lds
    ds_read_b64_tr_b16 a[16:17], v5 offset:0
    ds_read_b64_tr_b16 a[18:19], v5 offset:1024
    ds_read_b64_tr_b16 a[20:21], v5 offset:4096
    ds_read_b64_tr_b16 a[22:23], v5 offset:5120
    ds_read_b64_tr_b16 a[24:25], v5 offset:8192
    ds_read_b64_tr_b16 a[26:27], v5 offset:9216
    ds_read_b64_tr_b16 a[28:29], v5 offset:12288
    ds_read_b64_tr_b16 a[30:31], v5 offset:13312
    s_waitcnt vmcnt(24) lgkmcnt(0)
    s_barrier
    s_add_u32 m0, s46, 65536
    s_mov_b32 s36, 1056768
    buffer_load_dwordx4 v3, s[16:19], s36 offen lds
    s_add_u32 m0, s46, 66560
    s_mov_b32 s36, 1067776
    buffer_load_dwordx4 v3, s[16:19], s36 offen lds
    s_add_u32 m0, s46, 67584
    s_mov_b32 s36, 1078784
    buffer_load_dwordx4 v3, s[16:19], s36 offen lds
    s_add_u32 m0, s46, 68608
    s_mov_b32 s36, 1089792
    buffer_load_dwordx4 v3, s[16:19], s36 offen lds
    ds_read_b64_tr_b16 a[32:33], v5 offset:16384
    ds_read_b64_tr_b16 a[34:35], v5 offset:17408
    ds_read_b64_tr_b16 a[36:37], v5 offset:20480
    ds_read_b64_tr_b16 a[38:39], v5 offset:21504
    ds_read_b64_tr_b16 a[40:41], v5 offset:24576
    ds_read_b64_tr_b16 a[42:43], v5 offset:25600
    ds_read_b64_tr_b16 a[44:45], v5 offset:28672
    ds_read_b64_tr_b16 a[46:47], v5 offset:29696
    s_waitcnt vmcnt(24) lgkmcnt(0)
    s_barrier
    s_add_u32 m0, s46, 81920
    s_mov_b32 s36, 1232896
    buffer_load_dwordx4 v3, s[16:19], s36 offen lds
    s_add_u32 m0, s46, 82944
    s_mov_b32 s36, 1243904
    buffer_load_dwordx4 v3, s[16:19], s36 offen lds
    s_add_u32 m0, s46, 83968
    s_mov_b32 s36, 1254912
    buffer_load_dwordx4 v3, s[16:19], s36 offen lds
    s_add_u32 m0, s46, 84992
    s_mov_b32 s36, 1265920
    buffer_load_dwordx4 v3, s[16:19], s36 offen lds
    ds_read_b64_tr_b16 a[144:145], v5 offset:32768
    ds_read_b64_tr_b16 a[146:147], v5 offset:33792
    ds_read_b64_tr_b16 a[148:149], v5 offset:36864
    ds_read_b64_tr_b16 a[150:151], v5 offset:37888
    ds_read_b64_tr_b16 a[152:153], v5 offset:40960
    ds_read_b64_tr_b16 a[154:155], v5 offset:41984
    ds_read_b64_tr_b16 a[156:157], v5 offset:45056
    ds_read_b64_tr_b16 a[158:159], v5 offset:46080
    s_waitcnt vmcnt(24) lgkmcnt(0)
    s_barrier
    s_add_u32 m0, s46, 98304
    s_mov_b32 s36, 704512
    buffer_load_dwordx4 v3, s[16:19], s36 offen lds
    s_add_u32 m0, s46, 99328
    s_mov_b32 s36, 715520
    buffer_load_dwordx4 v3, s[16:19], s36 offen lds
    s_add_u32 m0, s46, 100352
    s_mov_b32 s36, 726528
    buffer_load_dwordx4 v3, s[16:19], s36 offen lds
    s_add_u32 m0, s46, 101376
    s_mov_b32 s36, 737536
    buffer_load_dwordx4 v3, s[16:19], s36 offen lds
    ds_read_b64_tr_b16 a[160:161], v5 offset:49152
    ds_read_b64_tr_b16 a[162:163], v5 offset:50176
    ds_read_b64_tr_b16 a[164:165], v5 offset:53248
    ds_read_b64_tr_b16 a[166:167], v5 offset:54272
    ds_read_b64_tr_b16 a[168:169], v5 offset:57344
    ds_read_b64_tr_b16 a[170:171], v5 offset:58368
    ds_read_b64_tr_b16 a[172:173], v5 offset:61440
    ds_read_b64_tr_b16 a[174:175], v5 offset:62464
    s_waitcnt vmcnt(24) lgkmcnt(0)
    s_barrier
    s_add_u32 m0, s46, 114688
    s_mov_b32 s36, 880640
    buffer_load_dwordx4 v3, s[16:19], s36 offen lds
    s_add_u32 m0, s46, 115712
    s_mov_b32 s36, 891648
    buffer_load_dwordx4 v3, s[16:19], s36 offen lds
    s_add_u32 m0, s46, 116736
    s_mov_b32 s36, 902656
    buffer_load_dwordx4 v3, s[16:19], s36 offen lds
    s_add_u32 m0, s46, 117760
    s_mov_b32 s36, 913664
    buffer_load_dwordx4 v3, s[16:19], s36 offen lds
    ds_read_b64_tr_b16 a[176:177], v4 offset:0
    ds_read_b64_tr_b16 a[178:179], v4 offset:1024
    ds_read_b64_tr_b16 a[180:181], v4 offset:4096
    ds_read_b64_tr_b16 a[182:183], v4 offset:5120
    ds_read_b64_tr_b16 a[184:185], v4 offset:8192
    ds_read_b64_tr_b16 a[186:187], v4 offset:9216
    ds_read_b64_tr_b16 a[188:189], v4 offset:12288
    ds_read_b64_tr_b16 a[190:191], v4 offset:13312
    s_waitcnt vmcnt(24) lgkmcnt(0)
    s_barrier
    v_mbcnt_lo_u32_b32 v12, -1, 0
    v_mbcnt_hi_u32_b32 v12, -1, v12
    v_lshlrev_b32 v12, 5, v12
wt_83:
    buffer_load_dword v11, v12, s[8:11], 0 offen sc1
    s_waitcnt vmcnt(0)
    v_readlane_b32 s36, v11, 0
    v_readlane_b32 s37, v11, 1
    s_nop 0
    s_add_u32 s36, s36, s37
    v_readlane_b32 s37, v11, 2
    s_nop 0
    s_add_u32 s36, s36, s37
    v_readlane_b32 s37, v11, 3
    s_nop 0
    s_add_u32 s36, s36, s37
    v_readlane_b32 s37, v11, 4
    s_nop 0
    s_add_u32 s36, s36, s37
    v_readlane_b32 s37, v11, 5
    s_nop 0
    s_add_u32 s36, s36, s37
    v_readlane_b32 s37, v11, 6
    s_nop 0
    s_add_u32 s36, s36, s37
    v_readlane_b32 s37, v11, 7
    s_nop 0
    s_add_u32 s36, s36, s37
    s_cmp_ge_u32 s36, 256
    s_cbranch_scc1 wtd_84
    s_sleep 2
    s_add_u32 s35, s35, 1
    s_cmp_lt_u32 s35, 524288
    s_cbranch_scc1 wt_83
wtd_84:
    v_readlane_b32 s55, v11, s34
    s_mov_b32 s38, 11829248
    v_lshlrev_b32 v11, 7, v0
    v_add_u32 v12, 8192, v11
wf_85:
    buffer_load_dwordx4 v[16:19], v11, s[4:7], s38 offen sc1
    buffer_load_dwordx4 v[20:23], v12, s[4:7], s38 offen sc1
    s_waitcnt vmcnt(0)
    v_min_u32 v16, v16, v17
    v_min_u32 v16, v16, v18
    v_min_u32 v16, v16, v19
    v_min_u32 v16, v16, v20
    v_min_u32 v16, v16, v21
    v_min_u32 v16, v16, v22
    v_min_u32 v16, v16, v23
    v_cmp_gt_u32 vcc, 1, v16
    s_cbranch_vccz wfd_86
    s_sleep 2
    s_add_u32 s35, s35, 1
    s_cmp_lt_u32 s35, 524288
    s_cbranch_scc1 wf_85
wfd_86:
    s_lshl_b32 s36, s32, 13
    s_add_u32 s42, s36, 131072
    s_lshl_b32 s41, s45, 15
    s_add_u32 s41, s41, s36
    s_add_u32 m0, s42, 0
    s_add_u32 s36, s41, 0
    buffer_load_dwordx4 v1, s[4:7], s36 offen offset:0 sc1 lds
    buffer_load_dwordx4 v1, s[4:7], s36 offen offset:1024 sc1 lds
    buffer_load_dwordx4 v1, s[4:7], s36 offen offset:2048 sc1 lds
    buffer_load_dwordx4 v1, s[4:7], s36 offen offset:3072 sc1 lds
    s_add_u32 m0, s42, 4096
    s_add_u32 s36, s41, 4096
    buffer_load_dwordx4 v1, s[4:7], s36 offen offset:0 sc1 lds
    buffer_load_dwordx4 v1, s[4:7], s36 offen offset:1024 sc1 lds
    buffer_load_dwordx4 v1, s[4:7], s36 offen offset:2048 sc1 lds
    buffer_load_dwordx4 v1, s[4:7], s36 offen offset:3072 sc1 lds
    s_add_u32 s41, s41, 65536
    s_add_u32 s42, s42, 32768
    s_and_b32 s42, s42, 0x1ffff
    ds_read_b64_tr_b16 a[96:97], v4 offset:16384
    ds_read_b64_tr_b16 a[98:99], v4 offset:17408
    ds_read_b64_tr_b16 a[100:101], v4 offset:20480
    ds_read_b64_tr_b16 a[102:103], v4 offset:21504
    ds_read_b64_tr_b16 a[104:105], v4 offset:24576
    ds_read_b64_tr_b16 a[106:107], v4 offset:25600
    ds_read_b64_tr_b16 a[108:109], v4 offset:28672
    ds_read_b64_tr_b16 a[110:111], v4 offset:29696
    s_waitcnt vmcnt(20) lgkmcnt(0)
    s_barrier
    ds_read_b64_tr_b16 a[112:113], v4 offset:32768
    ds_read_b64_tr_b16 a[114:115], v4 offset:33792
    ds_read_b64_tr_b16 a[116:117], v4 offset:36864
    ds_read_b64_tr_b16 a[118:119], v4 offset:37888
    ds_read_b64_tr_b16 a[120:121], v4 offset:40960
    ds_read_b64_tr_b16 a[122:123], v4 offset:41984
    ds_read_b64_tr_b16 a[124:125], v4 offset:45056
    ds_read_b64_tr_b16 a[126:127], v4 offset:46080
    s_waitcnt vmcnt(16) lgkmcnt(0)
    s_barrier
    ds_read_b64_tr_b16 a[128:129], v4 offset:49152
    ds_read_b64_tr_b16 a[130:131], v4 offset:50176
    ds_read_b64_tr_b16 a[132:133], v4 offset:53248
    ds_read_b64_tr_b16 a[134:135], v4 offset:54272
    ds_read_b64_tr_b16 a[136:137], v4 offset:57344
    ds_read_b64_tr_b16 a[138:139], v4 offset:58368
    ds_read_b64_tr_b16 a[140:141], v4 offset:61440
    ds_read_b64_tr_b16 a[142:143], v4 offset:62464
    s_waitcnt vmcnt(12) lgkmcnt(0)
    s_barrier
    ds_read_b64_tr_b16 a[224:225], v5 offset:0
    ds_read_b64_tr_b16 a[226:227], v5 offset:1024
    ds_read_b64_tr_b16 a[228:229], v5 offset:4096
    ds_read_b64_tr_b16 a[230:231], v5 offset:5120
    ds_read_b64_tr_b16 a[232:233], v5 offset:8192
    ds_read_b64_tr_b16 a[234:235], v5 offset:9216
    ds_read_b64_tr_b16 a[236:237], v5 offset:12288
    ds_read_b64_tr_b16 a[238:239], v5 offset:13312
    s_waitcnt vmcnt(8) lgkmcnt(0)
    s_barrier
    ds_read_b64_tr_b16 a[240:241], v5 offset:16384
    ds_read_b64_tr_b16 a[242:243], v5 offset:17408
    ds_read_b64_tr_b16 a[244:245], v5 offset:20480
    ds_read_b64_tr_b16 a[246:247], v5 offset:21504
    ds_read_b64_tr_b16 a[248:249], v5 offset:24576
    ds_read_b64_tr_b16 a[250:251], v5 offset:25600
    ds_read_b64_tr_b16 a[252:253], v5 offset:28672
    ds_read_b64_tr_b16 a[254:255], v5 offset:29696
    s_waitcnt vmcnt(4) lgkmcnt(0)
    s_barrier
    ds_read_b64_tr_b16 a[192:193], v5 offset:32768
    ds_read_b64_tr_b16 a[194:195], v5 offset:33792
    ds_read_b64_tr_b16 a[196:197], v5 offset:36864
    ds_read_b64_tr_b16 a[198:199], v5 offset:37888
    ds_read_b64_tr_b16 a[200:201], v5 offset:40960
    ds_read_b64_tr_b16 a[202:203], v5 offset:41984
    ds_read_b64_tr_b16 a[204:205], v5 offset:45056
    ds_read_b64_tr_b16 a[206:207], v5 offset:46080
    s_waitcnt vmcnt(0) lgkmcnt(0)
    s_barrier
    ds_read_b64_tr_b16 a[208:209], v5 offset:49152
    ds_read_b64_tr_b16 a[210:211], v5 offset:50176
    ds_read_b64_tr_b16 a[212:213], v5 offset:53248
    ds_read_b64_tr_b16 a[214:215], v5 offset:54272
    ds_read_b64_tr_b16 a[216:217], v5 offset:57344
    ds_read_b64_tr_b16 a[218:219], v5 offset:58368
    ds_read_b64_tr_b16 a[220:221], v5 offset:61440
    ds_read_b64_tr_b16 a[222:223], v5 offset:62464
    s_waitcnt lgkmcnt(0)
    s_barrier
ld2_78:
    s_lshl_b32 s36, s48, 2
    s_add_u32 s36, s36, s32
    s_cmp_lt_u32 s36, 43
    s_cselect_b32 s37, 0, 0x80000000
    v_add_u32 v8, s37, v1
    s_lshl_b32 s44, s36, 11
    s_mul_i32 s37, s45, 88064
    s_add_u32 s44, s44, s37
    s_add_u32 s44, s44, 4194304
    s_lshl_b32 s36, s48, 7
    s_lshl_b32 s37, s45, 11
    s_add_u32 s36, s36, s37
    s_lshl_b32 s37, s32, 2
    s_add_u32 s36, s36, s37
    s_add_u32 s43, s36, 11812864
    s_add_u32 m0, s42, 0
    s_add_u32 s36, s41, 0
    buffer_load_dwordx4 v1, s[4:7], s36 offen offset:0 sc1 lds
    buffer_load_dwordx4 v1, s[4:7], s36 offen offset:1024 sc1 lds
    buffer_load_dwordx4 v1, s[4:7], s36 offen offset:2048 sc1 lds
    buffer_load_dwordx4 v1, s[4:7], s36 offen offset:3072 sc1 lds
    s_add_u32 m0, s42, 4096
    s_add_u32 s36, s41, 4096
    buffer_load_dwordx4 v1, s[4:7], s36 offen offset:0 sc1 lds
    buffer_load_dwordx4 v1, s[4:7], s36 offen offset:1024 sc1 lds
    buffer_load_dwordx4 v1, s[4:7], s36 offen offset:2048 sc1 lds
    buffer_load_dwordx4 v1, s[4:7], s36 offen offset:3072 sc1 lds
    s_add_u32 s41, s41, 65536
    s_add_u32 s42, s42, 32768
    s_and_b32 s42, s42, 0x1ffff
    s_add_u32 m0, s42, 0
    s_add_u32 s36, s41, 0
    buffer_load_dwordx4 v1, s[4:7], s36 offen offset:0 sc1 lds
    buffer_load_dwordx4 v1, s[4:7], s36 offen offset:1024 sc1 lds
    buffer_load_dwordx4 v1, s[4:7], s36 offen offset:2048 sc1 lds
    buffer_load_dwordx4 v1, s[4:7], s36 offen offset:3072 sc1 lds
    s_add_u32 m0, s42, 4096
    s_add_u32 s36, s41, 4096
    buffer_load_dwordx4 v1, s[4:7], s36 offen offset:0 sc1 lds
    buffer_load_dwordx4 v1, s[4:7], s36 offen offset:1024 sc1 lds
    buffer_load_dwordx4 v1, s[4:7], s36 offen offset:2048 sc1 lds
    buffer_load_dwordx4 v1, s[4:7], s36 offen offset:3072 sc1 lds
    s_add_u32 s41, s41, 65536
    s_add_u32 s42, s42, 32768
    s_and_b32 s42, s42, 0x1ffff
    v_add_u32 v7, 131072, v1
    s_mov_b32 s40, 0
    s_waitcnt vmcnt(16)
    s_cmp_lt_u32 s55, 32
    s_cbranch_scc1 xgs_87
xg_88:
    s_barrier
    ds_read_b128 v[16:19], v7 offset:0
    ds_read_b128 v[20:23], v7 offset:1024
    ds_read_b128 v[24:27], v7 offset:2048
    s_waitcnt lgkmcnt(2)
    v_mfma_f32_32x32x16_bf16 v[32:47], a[0:3], v[16:19], 0
    ds_read_b128 v[28:31], v7 offset:3072
    v_mfma_f32_32x32x16_bf16 v[48:63], a[128:131], v[16:19], 0
    s_add_u32 m0, s42, 0
    s_add_u32 s36, s41, 0
    s_waitcnt lgkmcnt(2)
    v_mfma_f32_32x32x16_bf16 v[32:47], a[4:7], v[20:23], v[32:47]
    ds_read_b128 v[16:19], v7 offset:4096
    v_mfma_f32_32x32x16_bf16 v[48:63], a[132:135], v[20:23], v[48:63]
    buffer_load_dwordx4 v1, s[4:7], s36 offen offset:0 sc1 lds
    s_waitcnt lgkmcnt(2)
    v_mfma_f32_32x32x16_bf16 v[32:47], a[8:11], v[24:27], v[32:47]
    ds_read_b128 v[20:23], v7 offset:5120
    v_mfma_f32_32x32x16_bf16 v[48:63], a[136:139], v[24:27], v[48:63]
    buffer_load_dwordx4 v1, s[4:7], s36 offen offset:1024 sc1 lds
    s_waitcnt lgkmcnt(2)
    v_mfma_f32_32x32x16_bf16 v[32:47], a[12:15], v[28:31], v[32:47]
    ds_read_b128 v[24:27], v7 offset:6144
    v_mfma_f32_32x32x16_bf16 v[48:63], a[140:143], v[28:31], v[48:63]
    buffer_load_dwordx4 v1, s[4:7], s36 offen offset:2048 sc1 lds
    s_waitcnt lgkmcnt(2)
    v_mfma_f32_32x32x16_bf16 v[32:47], a[16:19], v[16:19], v[32:47]
    ds_read_b128 v[28:31], v7 offset:7168
    v_mfma_f32_32x32x16_bf16 v[48:63], a[144:147], v[16:19], v[48:63]
    buffer_load_dwordx4 v1, s[4:7], s36 offen offset:3072 sc1 lds
    s_add_u32 m0, s42, 4096
    s_waitcnt lgkmcnt(2)
    v_mfma_f32_32x32x16_bf16 v[32:47], a[20:23], v[20:23], v[32:47]
    ds_read_b128 v[16:19], v7 offset:8192
    v_mfma_f32_32x32x16_bf16 v[48:63], a[148:151], v[20:23], v[48:63]
    s_add_u32 s36, s41, 4096
    s_waitcnt lgkmcnt(2)
    v_mfma_f32_32x32x16_bf16 v[32:47], a[24:27], v[24:27], v[32:47]
    ds_read_b128 v[20:23], v7 offset:9216
    v_mfma_f32_32x32x16_bf16 v[48:63], a[152:155], v[24:27], v[48:63]
    buffer_load_dwordx4 v1, s[4:7], s36 offen offset:0 sc1 lds
    s_waitcnt lgkmcnt(2)
    v_mfma_f32_32x32x16_bf16 v[32:47], a[28:31], v[28:31], v[32:47]
    ds_read_b128 v[24:27], v7 offset:10240
    v_mfma_f32_32x32x16_bf16 v[48:63], a[156:159], v[28:31], v[48:63]
    buffer_load_dwordx4 v1, s[4:7], s36 offen offset:1024 sc1 lds
    s_waitcnt lgkmcnt(2)
    v_mfma_f32_32x32x16_bf16 v[32:47], a[32:35], v[16:19], v[32:47]
    ds_read_b128 v[28:31], v7 offset:11264
    v_mfma_f32_32x32x16_bf16 v[48:63], a[160:163], v[16:19], v[48:63]
    buffer_load_dwordx4 v1, s[4:7], s36 offen offset:2048 sc1 lds
    s_waitcnt lgkmcnt(2)
    v_mfma_f32_32x32x16_bf16 v[32:47], a[36:39], v[20:23], v[32:47]
    ds_read_b128 v[16:19], v7 offset:12288
    v_mfma_f32_32x32x16_bf16 v[48:63], a[164:167], v[20:23], v[48:63]
    buffer_load_dwordx4 v1, s[4:7], s36 offen offset:3072 sc1 lds
    s_add_u32 s41, s41, 65536
    s_waitcnt lgkmcnt(2)
    v_mfma_f32_32x32x16_bf16 v[32:47], a[40:43], v[24:27], v[32:47]
    ds_read_b128 v[20:23], v7 offset:13312
    v_mfma_f32_32x32x16_bf16 v[48:63], a[168:171], v[24:27], v[48:63]
    s_add_u32 s42, s42, 32768
    s_and_b32 s42, s42, 0x1ffff
    s_waitcnt lgkmcnt(2)
    v_mfma_f32_32x32x16_bf16 v[32:47], a[44:47], v[28:31], v[32:47]
    ds_read_b128 v[24:27], v7 offset:14336
    v_mfma_f32_32x32x16_bf16 v[48:63], a[172:175], v[28:31], v[48:63]
    s_waitcnt lgkmcnt(2)
    v_mfma_f32_32x32x16_bf16 v[32:47], a[48:51], v[16:19], v[32:47]
    ds_read_b128 v[28:31], v7 offset:15360
    v_mfma_f32_32x32x16_bf16 v[48:63], a[176:179], v[16:19], v[48:63]
    s_waitcnt lgkmcnt(2)
    v_mfma_f32_32x32x16_bf16 v[32:47], a[52:55], v[20:23], v[32:47]
    ds_read_b128 v[16:19], v7 offset:16384
    v_mfma_f32_32x32x16_bf16 v[48:63], a[180:183], v[20:23], v[48:63]
    s_waitcnt lgkmcnt(2)
    v_mfma_f32_32x32x16_bf16 v[32:47], a[56:59], v[24:27], v[32:47]
    ds_read_b128 v[20:23], v7 offset:17408
    v_mfma_f32_32x32x16_bf16 v[48:63], a[184:187], v[24:27], v[48:63]
    s_waitcnt lgkmcnt(2)
    v_mfma_f32_32x32x16_bf16 v[32:47], a[60:63], v[28:31], v[32:47]
    ds_read_b128 v[24:27], v7 offset:18432
    v_mfma_f32_32x32x16_bf16 v[48:63], a[188:191], v[28:31], v[48:63]
    s_waitcnt lgkmcnt(2)
    v_mfma_f32_32x32x16_bf16 v[32:47], a[64:67], v[16:19], v[32:47]
    ds_read_b128 v[28:31], v7 offset:19456
    v_mfma_f32_32x32x16_bf16 v[48:63], a[192:195], v[16:19], v[48:63]
    s_waitcnt vmcnt(8)
    v_mov_b32 v11, s40
    buffer_store_dword v11, v2, s[4:7], s43 offen
    s_waitcnt lgkmcnt(2)
    v_mfma_f32_32x32x16_bf16 v[32:47], a[68:71], v[20:23], v[32:47]
    ds_read_b128 v[16:19], v7 offset:20480
    v_mfma_f32_32x32x16_bf16 v[48:63], a[196:199], v[20:23], v[48:63]
    s_waitcnt lgkmcnt(2)
    v_mfma_f32_32x32x16_bf16 v[32:47], a[72:75], v[24:27], v[32:47]
    ds_read_b128 v[20:23], v7 offset:21504
    v_mfma_f32_32x32x16_bf16 v[48:63], a[200:203], v[24:27], v[48:63]
    s_waitcnt lgkmcnt(2)
    v_mfma_f32_32x32x16_bf16 v[32:47], a[76:79], v[28:31], v[32:47]
    ds_read_b128 v[24:27], v7 offset:22528
    v_mfma_f32_32x32x16_bf16 v[48:63], a[204:207], v[28:31], v[48:63]
    s_waitcnt lgkmcnt(2)
    v_mfma_f32_32x32x16_bf16 v[32:47], a[80:83], v[16:19], v[32:47]
    ds_read_b128 v[28:31], v7 offset:23552
    v_mfma_f32_32x32x16_bf16 v[48:63], a[208:211], v[16:19], v[48:63]
    s_waitcnt lgkmcnt(2)
    v_mfma_f32_32x32x16_bf16 v[32:47], a[84:87], v[20:23], v[32:47]
    ds_read_b128 v[16:19], v7 offset:24576
    v_mfma_f32_32x32x16_bf16 v[48:63], a[212:215], v[20:23], v[48:63]
    s_waitcnt lgkmcnt(2)
    v_mfma_f32_32x32x16_bf16 v[32:47], a[88:91], v[24:27], v[32:47]
    ds_read_b128 v[20:23], v7 offset:25600
    v_mfma_f32_32x32x16_bf16 v[48:63], a[216:219], v[24:27], v[48:63]
    s_waitcnt lgkmcnt(2)
    v_mfma_f32_32x32x16_bf16 v[32:47], a[92:95], v[28:31], v[32:47]
    ds_read_b128 v[24:27], v7 offset:26624
    v_mfma_f32_32x32x16_bf16 v[48:63], a[220:223], v[28:31], v[48:63]
    s_waitcnt lgkmcnt(2)
    v_mfma_f32_32x32x16_bf16 v[32:47], a[96:99], v[16:19], v[32:47]
    ds_read_b128 v[28:31], v7 offset:27648
    v_mfma_f32_32x32x16_bf16 v[48:63], a[224:227], v[16:19], v[48:63]
    s_waitcnt lgkmcnt(2)
    v_mfma_f32_32x32x16_bf16 v[32:47], a[100:103], v[20:23], v[32:47]
    ds_read_b128 v[16:19], v7 offset:28672
    v_mfma_f32_32x32x16_bf16 v[48:63], a[228:231], v[20:23], v[48:63]
    s_waitcnt lgkmcnt(2)
    v_mfma_f32_32x32x16_bf16 v[32:47], a[104:107], v[24:27], v[32:47]
    ds_read_b128 v[20:23], v7 offset:29696
    v_mfma_f32_32x32x16_bf16 v[48:63], a[232:235], v[24:27], v[48:63]
    s_waitcnt lgkmcnt(2)
    v_mfma_f32_32x32x16_bf16 v[32:47], a[108:111], v[28:31], v[32:47]
    ds_read_b128 v[24:27], v7 offset:30720
    v_mfma_f32_32x32x16_bf16 v[48:63], a[236:239], v[28:31], v[48:63]
    s_waitcnt lgkmcnt(2)
    v_mfma_f32_32x32x16_bf16 v[32:47], a[112:115], v[16:19], v[32:47]
    ds_read_b128 v[28:31], v7 offset:31744
    v_mfma_f32_32x32x16_bf16 v[48:63], a[240:243], v[16:19], v[48:63]
    s_waitcnt lgkmcnt(2)
    v_mfma_f32_32x32x16_bf16 v[32:47], a[116:119], v[20:23], v[32:47]
    v_mfma_f32_32x32x16_bf16 v[48:63], a[244:247], v[20:23], v[48:63]
    s_waitcnt lgkmcnt(1)
    v_mfma_f32_32x32x16_bf16 v[32:47], a[120:123], v[24:27], v[32:47]
    v_mfma_f32_32x32x16_bf16 v[48:63], a[248:251], v[24:27], v[48:63]
    s_waitcnt lgkmcnt(0)
    v_mfma_f32_32x32x16_bf16 v[32:47], a[124:127], v[28:31], v[32:47]
    v_mfma_f32_32x32x16_bf16 v[48:63], a[252:255], v[28:31], v[48:63]
    v_add_u32 v7, 32768, v7
    v_and_b32 v7, 0x1ffff, v7
    s_nop 8
    v_mul_f32 v96, v32, v48
    v_mul_f32 v97, v33, v49
    v_mul_f32 v98, v34, v50
    v_mul_f32 v99, v35, v51
    v_mul_f32 v100, v36, v52
    v_mul_f32 v101, v37, v53
    v_mul_f32 v102, v38, v54
    v_mul_f32 v103, v39, v55
    v_cvt_pk_bf16_f32 v80, v96, v97
    v_cvt_pk_bf16_f32 v81, v98, v99
    v_cvt_pk_bf16_f32 v82, v100, v101
    v_cvt_pk_bf16_f32 v83, v102, v103
    buffer_store_dwordx4 v[80:83], v8, s[4:7], s44 offen offset:0
    v_mul_f32 v96, v40, v56
    v_mul_f32 v97, v41, v57
    v_mul_f32 v98, v42, v58
    v_mul_f32 v99, v43, v59
    v_mul_f32 v100, v44, v60
    v_mul_f32 v101, v45, v61
    v_mul_f32 v102, v46, v62
    v_mul_f32 v103, v47, v63
    v_cvt_pk_bf16_f32 v84, v96, v97
    v_cvt_pk_bf16_f32 v85, v98, v99
    v_cvt_pk_bf16_f32 v86, v100, v101
    v_cvt_pk_bf16_f32 v87, v102, v103
    buffer_store_dwordx4 v[84:87], v8, s[4:7], s44 offen offset:1024
    s_add_u32 s44, s44, 176128
    s_add_u32 s40, s40, 1
    s_cmp_gt_u32 s40, 1
    s_cbranch_scc1 xgf_89
    s_waitcnt vmcnt(0)
    v_mov_b32 v11, 1
    buffer_store_dword v11, v2, s[4:7], s43 offen
xgf_89:
    s_cmp_lt_u32 s40, 32
    s_cbranch_scc1 xg_88
    s_waitcnt vmcnt(0)
    v_mov_b32 v11, 32
    buffer_store_dword v11, v2, s[4:7], s43 offen
    s_branch L_exit
xgs_87:
xg_90:
    s_barrier
    ds_read_b128 v[16:19], v7 offset:0
    ds_read_b128 v[20:23], v7 offset:1024
    ds_read_b128 v[24:27], v7 offset:2048
    s_waitcnt lgkmcnt(2)
    v_mfma_f32_32x32x16_bf16 v[32:47], a[0:3], v[16:19], 0
    ds_read_b128 v[28:31], v7 offset:3072
    v_mfma_f32_32x32x16_bf16 v[48:63], a[128:131], v[16:19], 0
    s_add_u32 m0, s42, 0
    s_add_u32 s36, s41, 0
    s_waitcnt lgkmcnt(2)
    v_mfma_f32_32x32x16_bf16 v[32:47], a[4:7], v[20:23], v[32:47]
    ds_read_b128 v[16:19], v7 offset:4096
    v_mfma_f32_32x32x16_bf16 v[48:63], a[132:135], v[20:23], v[48:63]
    buffer_load_dwordx4 v1, s[4:7], s36 offen offset:0 sc1 lds
    s_waitcnt lgkmcnt(2)
    v_mfma_f32_32x32x16_bf16 v[32:47], a[8:11], v[24:27], v[32:47]
    ds_read_b128 v[20:23], v7 offset:5120
    v_mfma_f32_32x32x16_bf16 v[48:63], a[136:139], v[24:27], v[48:63]
    buffer_load_dwordx4 v1, s[4:7], s36 offen offset:1024 sc1 lds
    s_waitcnt lgkmcnt(2)
    v_mfma_f32_32x32x16_bf16 v[32:47], a[12:15], v[28:31], v[32:47]
    ds_read_b128 v[24:27], v7 offset:6144
    v_mfma_f32_32x32x16_bf16 v[48:63], a[140:143], v[28:31], v[48:63]
    buffer_load_dwordx4 v1, s[4:7], s36 offen offset:2048 sc1 lds
    s_waitcnt lgkmcnt(2)
    v_mfma_f32_32x32x16_bf16 v[32:47], a[16:19], v[16:19], v[32:47]
    ds_read_b128 v[28:31], v7 offset:7168
    v_mfma_f32_32x32x16_bf16 v[48:63], a[144:147], v[16:19], v[48:63]
    buffer_load_dwordx4 v1, s[4:7], s36 offen offset:3072 sc1 lds
    s_add_u32 m0, s42, 4096
    s_waitcnt lgkmcnt(2)
    v_mfma_f32_32x32x16_bf16 v[32:47], a[20:23], v[20:23], v[32:47]
    ds_read_b128 v[16:19], v7 offset:8192
    v_mfma_f32_32x32x16_bf16 v[48:63], a[148:151], v[20:23], v[48:63]
    s_add_u32 s36, s41, 4096
    s_waitcnt lgkmcnt(2)
    v_mfma_f32_32x32x16_bf16 v[32:47], a[24:27], v[24:27], v[32:47]
    ds_read_b128 v[20:23], v7 offset:9216
    v_mfma_f32_32x32x16_bf16 v[48:63], a[152:155], v[24:27], v[48:63]
    buffer_load_dwordx4 v1, s[4:7], s36 offen offset:0 sc1 lds
    s_waitcnt lgkmcnt(2)
    v_mfma_f32_32x32x16_bf16 v[32:47], a[28:31], v[28:31], v[32:47]
    ds_read_b128 v[24:27], v7 offset:10240
    v_mfma_f32_32x32x16_bf16 v[48:63], a[156:159], v[28:31], v[48:63]
    buffer_load_dwordx4 v1, s[4:7], s36 offen offset:1024 sc1 lds
    s_waitcnt lgkmcnt(2)
    v_mfma_f32_32x32x16_bf16 v[32:47], a[32:35], v[16:19], v[32:47]
    ds_read_b128 v[28:31], v7 offset:11264
    v_mfma_f32_32x32x16_bf16 v[48:63], a[160:163], v[16:19], v[48:63]
    buffer_load_dwordx4 v1, s[4:7], s36 offen offset:2048 sc1 lds
    s_waitcnt lgkmcnt(2)
    v_mfma_f32_32x32x16_bf16 v[32:47], a[36:39], v[20:23], v[32:47]
    ds_read_b128 v[16:19], v7 offset:12288
    v_mfma_f32_32x32x16_bf16 v[48:63], a[164:167], v[20:23], v[48:63]
    buffer_load_dwordx4 v1, s[4:7], s36 offen offset:3072 sc1 lds
    s_add_u32 s41, s41, 65536
    s_waitcnt lgkmcnt(2)
    v_mfma_f32_32x32x16_bf16 v[32:47], a[40:43], v[24:27], v[32:47]
    ds_read_b128 v[20:23], v7 offset:13312
    v_mfma_f32_32x32x16_bf16 v[48:63], a[168:171], v[24:27], v[48:63]
    s_add_u32 s42, s42, 32768
    s_and_b32 s42, s42, 0x1ffff
    s_waitcnt lgkmcnt(2)
    v_mfma_f32_32x32x16_bf16 v[32:47], a[44:47], v[28:31], v[32:47]
    ds_read_b128 v[24:27], v7 offset:14336
    v_mfma_f32_32x32x16_bf16 v[48:63], a[172:175], v[28:31], v[48:63]
    s_waitcnt lgkmcnt(2)
    v_mfma_f32_32x32x16_bf16 v[32:47], a[48:51], v[16:19], v[32:47]
    ds_read_b128 v[28:31], v7 offset:15360
    v_mfma_f32_32x32x16_bf16 v[48:63], a[176:179], v[16:19], v[48:63]
    s_waitcnt lgkmcnt(2)
    v_mfma_f32_32x32x16_bf16 v[32:47], a[52:55], v[20:23], v[32:47]
    ds_read_b128 v[16:19], v7 offset:16384
    v_mfma_f32_32x32x16_bf16 v[48:63], a[180:183], v[20:23], v[48:63]
    s_waitcnt lgkmcnt(2)
    v_mfma_f32_32x32x16_bf16 v[32:47], a[56:59], v[24:27], v[32:47]
    ds_read_b128 v[20:23], v7 offset:17408
    v_mfma_f32_32x32x16_bf16 v[48:63], a[184:187], v[24:27], v[48:63]
    s_waitcnt lgkmcnt(2)
    v_mfma_f32_32x32x16_bf16 v[32:47], a[60:63], v[28:31], v[32:47]
    ds_read_b128 v[24:27], v7 offset:18432
    v_mfma_f32_32x32x16_bf16 v[48:63], a[188:191], v[28:31], v[48:63]
    s_waitcnt lgkmcnt(2)
    v_mfma_f32_32x32x16_bf16 v[32:47], a[64:67], v[16:19], v[32:47]
    ds_read_b128 v[28:31], v7 offset:19456
    v_mfma_f32_32x32x16_bf16 v[48:63], a[192:195], v[16:19], v[48:63]
    s_waitcnt vmcnt(8)
    v_mov_b32 v11, s40
    buffer_store_dword v11, v2, s[4:7], s43 offen sc1
    s_waitcnt lgkmcnt(2)
    v_mfma_f32_32x32x16_bf16 v[32:47], a[68:71], v[20:23], v[32:47]
    ds_read_b128 v[16:19], v7 offset:20480
    v_mfma_f32_32x32x16_bf16 v[48:63], a[196:199], v[20:23], v[48:63]
    s_waitcnt lgkmcnt(2)
    v_mfma_f32_32x32x16_bf16 v[32:47], a[72:75], v[24:27], v[32:47]
    ds_read_b128 v[20:23], v7 offset:21504
    v_mfma_f32_32x32x16_bf16 v[48:63], a[200:203], v[24:27], v[48:63]
    s_waitcnt lgkmcnt(2)
    v_mfma_f32_32x32x16_bf16 v[32:47], a[76:79], v[28:31], v[32:47]
    ds_read_b128 v[24:27], v7 offset:22528
    v_mfma_f32_32x32x16_bf16 v[48:63], a[204:207], v[28:31], v[48:63]
    s_waitcnt lgkmcnt(2)
    v_mfma_f32_32x32x16_bf16 v[32:47], a[80:83], v[16:19], v[32:47]
    ds_read_b128 v[28:31], v7 offset:23552
    v_mfma_f32_32x32x16_bf16 v[48:63], a[208:211], v[16:19], v[48:63]
    s_waitcnt lgkmcnt(2)
    v_mfma_f32_32x32x16_bf16 v[32:47], a[84:87], v[20:23], v[32:47]
    ds_read_b128 v[16:19], v7 offset:24576
    v_mfma_f32_32x32x16_bf16 v[48:63], a[212:215], v[20:23], v[48:63]
    s_waitcnt lgkmcnt(2)
    v_mfma_f32_32x32x16_bf16 v[32:47], a[88:91], v[24:27], v[32:47]
    ds_read_b128 v[20:23], v7 offset:25600
    v_mfma_f32_32x32x16_bf16 v[48:63], a[216:219], v[24:27], v[48:63]
    s_waitcnt lgkmcnt(2)
    v_mfma_f32_32x32x16_bf16 v[32:47], a[92:95], v[28:31], v[32:47]
    ds_read_b128 v[24:27], v7 offset:26624
    v_mfma_f32_32x32x16_bf16 v[48:63], a[220:223], v[28:31], v[48:63]
    s_waitcnt lgkmcnt(2)
    v_mfma_f32_32x32x16_bf16 v[32:47], a[96:99], v[16:19], v[32:47]
    ds_read_b128 v[28:31], v7 offset:27648
    v_mfma_f32_32x32x16_bf16 v[48:63], a[224:227], v[16:19], v[48:63]
    s_waitcnt lgkmcnt(2)
    v_mfma_f32_32x32x16_bf16 v[32:47], a[100:103], v[20:23], v[32:47]
    ds_read_b128 v[16:19], v7 offset:28672
    v_mfma_f32_32x32x16_bf16 v[48:63], a[228:231], v[20:23], v[48:63]
    s_waitcnt lgkmcnt(2)
    v_mfma_f32_32x32x16_bf16 v[32:47], a[104:107], v[24:27], v[32:47]
    ds_read_b128 v[20:23], v7 offset:29696
    v_mfma_f32_32x32x16_bf16 v[48:63], a[232:235], v[24:27], v[48:63]
    s_waitcnt lgkmcnt(2)
    v_mfma_f32_32x32x16_bf16 v[32:47], a[108:111], v[28:31], v[32:47]
    ds_read_b128 v[24:27], v7 offset:30720
    v_mfma_f32_32x32x16_bf16 v[48:63], a[236:239], v[28:31], v[48:63]
    s_waitcnt lgkmcnt(2)
    v_mfma_f32_32x32x16_bf16 v[32:47], a[112:115], v[16:19], v[32:47]
    ds_read_b128 v[28:31], v7 offset:31744
    v_mfma_f32_32x32x16_bf16 v[48:63], a[240:243], v[16:19], v[48:63]
    s_waitcnt lgkmcnt(2)
    v_mfma_f32_32x32x16_bf16 v[32:47], a[116:119], v[20:23], v[32:47]
    v_mfma_f32_32x32x16_bf16 v[48:63], a[244:247], v[20:23], v[48:63]
    s_waitcnt lgkmcnt(1)
    v_mfma_f32_32x32x16_bf16 v[32:47], a[120:123], v[24:27], v[32:47]
    v_mfma_f32_32x32x16_bf16 v[48:63], a[248:251], v[24:27], v[48:63]
    s_waitcnt lgkmcnt(0)
    v_mfma_f32_32x32x16_bf16 v[32:47], a[124:127], v[28:31], v[32:47]
    v_mfma_f32_32x32x16_bf16 v[48:63], a[252:255], v[28:31], v[48:63]
    v_add_u32 v7, 32768, v7
    v_and_b32 v7, 0x1ffff, v7
    s_nop 8
    v_mul_f32 v96, v32, v48
    v_mul_f32 v97, v33, v49
    v_mul_f32 v98, v34, v50
    v_mul_f32 v99, v35, v51
    v_mul_f32 v100, v36, v52
    v_mul_f32 v101, v37, v53
    v_mul_f32 v102, v38, v54
    v_mul_f32 v103, v39, v55
    v_cvt_pk_bf16_f32 v80, v96, v97
    v_cvt_pk_bf16_f32 v81, v98, v99
    v_cvt_pk_bf16_f32 v82, v100, v101
    v_cvt_pk_bf16_f32 v83, v102, v103
    buffer_store_dwordx4 v[80:83], v8, s[4:7], s44 offen offset:0 sc1
    v_mul_f32 v96, v40, v56
    v_mul_f32 v97, v41, v57
    v_mul_f32 v98, v42, v58
    v_mul_f32 v99, v43, v59
    v_mul_f32 v100, v44, v60
    v_mul_f32 v101, v45, v61
    v_mul_f32 v102, v46, v62
    v_mul_f32 v103, v47, v63
    v_cvt_pk_bf16_f32 v84, v96, v97
    v_cvt_pk_bf16_f32 v85, v98, v99
    v_cvt_pk_bf16_f32 v86, v100, v101
    v_cvt_pk_bf16_f32 v87, v102, v103
    buffer_store_dwordx4 v[84:87], v8, s[4:7], s44 offen offset:1024 sc1
    s_add_u32 s44, s44, 176128
    s_add_u32 s40, s40, 1
    s_cmp_gt_u32 s40, 1
    s_cbranch_scc1 xgf_91
    s_waitcnt vmcnt(0)
    v_mov_b32 v11, 1
    buffer_store_dword v11, v2, s[4:7], s43 offen sc1
xgf_91:
    s_cmp_lt_u32 s40, 32
    s_cbranch_scc1 xg_90
    s_waitcnt vmcnt(0)
    v_mov_b32 v11, 32
    buffer_store_dword v11, v2, s[4:7], s43 offen sc1
    s_branch L_exit
L_t3:
    s_load_dwordx2 s[12:13], s[0:1], 80
    s_waitcnt lgkmcnt(0)
    s_mov_b32 s14, 0x158000
    s_mov_b32 s15, 0x20000
    v_lshlrev_b32 v1, 4, v0
    v_cmp_eq_u32 vcc, 0, v0
    v_mov_b32 v2, 0x80000000
    s_nop 0
    v_cndmask_b32 v2, v2, 0, vcc
    s_sub_u32 s48, s33, 22
    s_lshr_b32 s48, s48, 1
    s_and_b32 s45, s33, 1
    s_lshl_b32 s49, s48, 8
    v_min_u32 v8, 42, v0
    v_and_b32 v11, 3, v8
    v_lshrrev_b32 v8, 2, v8
    v_lshlrev_b32 v8, 7, v8
    v_lshl_add_u32 v8, v11, 2, v8
    s_lshl_b32 s50, s45, 11
    s_add_u32 s50, s50, 11812864
    v_lshrrev_b32 v11, 4, v0
    v_lshlrev_b32 v12, 2, v11
    v_and_b32 v13, 15, v0
    v_xor_b32 v12, v12, v13
    s_lshl_b32 s36, s32, 4
    v_add_u32 v11, s36, v11
    v_mul_u32_u24 v11, 1024, v11
    v_lshl_add_u32 v11, v12, 4, v11
    v_add_u32 v3, s49, v11
    v_bfe_u32 v11, v0, 2, 2
    v_lshrrev_b32 v12, 5, v0
    v_lshl_add_u32 v12, v12, 2, v11
    v_lshlrev_b32 v12, 8, v12
    s_lshl_b32 s36, s32, 1
    v_and_b32 v13, 1, v0
    v_bfe_u32 v6, v0, 4, 1
    v_bfe_u32 v5, v0, 1, 1
    v_lshl_add_u32 v6, v6, 1, v5
    v_lshlrev_b32 v6, 3, v6
    v_add_u32 v13, s36, v13
    v_lshlrev_b32 v11, 1, v11
    v_xor_b32 v13, v13, v11
    v_lshl_add_u32 v12, v13, 5, v12
    v_add_u32 v4, v12, v6
    v_add_u32 v5, 65536, v4
    s_cmp_lg_u32 s45, 0
    s_cbranch_scc1 ld1_92
    s_lshl_b32 s46, s32, 12
    s_add_u32 s46, s46, 0
    s_add_u32 m0, s46, 0
    s_mov_b32 s36, 0
    buffer_load_dwordx4 v3, s[12:15], s36 offen lds
    s_add_u32 m0, s46, 1024
    s_mov_b32 s36, 4096
    buffer_load_dwordx4 v3, s[12:15], s36 offen lds
    s_add_u32 m0, s46, 2048
    s_mov_b32 s36, 8192
    buffer_load_dwordx4 v3, s[12:15], s36 offen lds
    s_add_u32 m0, s46, 3072
    s_mov_b32 s36, 12288
    buffer_load_dwordx4 v3, s[12:15], s36 offen lds
    s_add_u32 m0, s46, 16384
    s_mov_b32 s36, 65536
    buffer_load_dwordx4 v3, s[12:15], s36 offen lds
    s_add_u32 m0, s46, 17408
    s_mov_b32 s36, 69632
    buffer_load_dwordx4 v3, s[12:15], s36 offen lds
    s_add_u32 m0, s46, 18432
    s_mov_b32 s36, 73728
    buffer_load_dwordx4 v3, s[12:15], s36 offen lds
    s_add_u32 m0, s46, 19456
    s_mov_b32 s36, 77824
    buffer_load_dwordx4 v3, s[12:15], s36 offen lds
    s_add_u32 m0, s46, 32768
    s_mov_b32 s36, 131072
    buffer_load_dwordx4 v3, s[12:15], s36 offen lds
    s_add_u32 m0, s46, 33792
    s_mov_b32 s36, 135168
    buffer_load_dwordx4 v3, s[12:15], s36 offen lds
    s_add_u32 m0, s46, 34816
    s_mov_b32 s36, 139264
    buffer_load_dwordx4 v3, s[12:15], s36 offen lds
    s_add_u32 m0, s46, 35840
    s_mov_b32 s36, 143360
    buffer_load_dwordx4 v3, s[12:15], s36 offen lds
    s_add_u32 m0, s46, 49152
    s_mov_b32 s36, 196608
    buffer_load_dwordx4 v3, s[12:15], s36 offen lds
    s_add_u32 m0, s46, 50176
    s_mov_b32 s36, 200704
    buffer_load_dwordx4 v3, s[12:15], s36 offen lds
    s_add_u32 m0, s46, 51200
    s_mov_b32 s36, 204800
    buffer_load_dwordx4 v3, s[12:15], s36 offen lds
    s_add_u32 m0, s46, 52224
    s_mov_b32 s36, 208896
    buffer_load_dwordx4 v3, s[12:15], s36 offen lds
    s_add_u32 m0, s46, 65536
    s_mov_b32 s36, 262144
    buffer_load_dwordx4 v3, s[12:15], s36 offen lds
    s_add_u32 m0, s46, 66560
    s_mov_b32 s36, 266240
    buffer_load_dwordx4 v3, s[12:15], s36 offen lds
    s_add_u32 m0, s46, 67584
    s_mov_b32 s36, 270336
    buffer_load_dwordx4 v3, s[12:15], s36 offen lds
    s_add_u32 m0, s46, 68608
    s_mov_b32 s36, 274432
    buffer_load_dwordx4 v3, s[12:15], s36 offen lds
    s_add_u32 m0, s46, 81920
    s_mov_b32 s36, 327680
    buffer_load_dwordx4 v3, s[12:15], s36 offen lds
    s_add_u32 m0, s46, 82944
    s_mov_b32 s36, 331776
    buffer_load_dwordx4 v3, s[12:15], s36 offen lds
    s_add_u32 m0, s46, 83968
    s_mov_b32 s36, 335872
    buffer_load_dwordx4 v3, s[12:15], s36 offen lds
    s_add_u32 m0, s46, 84992
    s_mov_b32 s36, 339968
    buffer_load_dwordx4 v3, s[12:15], s36 offen lds
    s_add_u32 m0, s46, 98304
    s_mov_b32 s36, 393216
    buffer_load_dwordx4 v3, s[12:15], s36 offen lds
    s_add_u32 m0, s46, 99328
    s_mov_b32 s36, 397312
    buffer_load_dwordx4 v3, s[12:15], s36 offen lds
    s_add_u32 m0, s46, 100352
    s_mov_b32 s36, 401408
    buffer_load_dwordx4 v3, s[12:15], s36 offen lds
    s_add_u32 m0, s46, 101376
    s_mov_b32 s36, 405504
    buffer_load_dwordx4 v3, s[12:15], s36 offen lds
    s_waitcnt vmcnt(24) lgkmcnt(0)
    s_barrier
    s_add_u32 m0, s46, 114688
    s_mov_b32 s36, 458752
    buffer_load_dwordx4 v3, s[12:15], s36 offen lds
    s_add_u32 m0, s46, 115712
    s_mov_b32 s36, 462848
    buffer_load_dwordx4 v3, s[12:15], s36 offen lds
    s_add_u32 m0, s46, 116736
    s_mov_b32 s36, 466944
    buffer_load_dwordx4 v3, s[12:15], s36 offen lds
    s_add_u32 m0, s46, 117760
    s_mov_b32 s36, 471040
    buffer_load_dwordx4 v3, s[12:15], s36 offen lds
    ds_read_b64_tr_b16 v[168:169], v4 offset:0
    ds_read_b64_tr_b16 v[170:171], v4 offset:2048
    ds_read_b64_tr_b16 v[172:173], v4 offset:4096
    ds_read_b64_tr_b16 v[174:175], v4 offset:6144
    ds_read_b64_tr_b16 v[176:177], v4 offset:8192
    ds_read_b64_tr_b16 v[178:179], v4 offset:10240
    ds_read_b64_tr_b16 v[180:181], v4 offset:12288
    ds_read_b64_tr_b16 v[182:183], v4 offset:14336
    s_waitcnt vmcnt(24) lgkmcnt(0)
    s_barrier
    s_add_u32 m0, s46, 0
    s_mov_b32 s36, 524288
    buffer_load_dwordx4 v3, s[12:15], s36 offen lds
    s_add_u32 m0, s46, 1024
    s_mov_b32 s36, 528384
    buffer_load_dwordx4 v3, s[12:15], s36 offen lds
    s_add_u32 m0, s46, 2048
    s_mov_b32 s36, 532480
    buffer_load_dwordx4 v3, s[12:15], s36 offen lds
    s_add_u32 m0, s46, 3072
    s_mov_b32 s36, 536576
    buffer_load_dwordx4 v3, s[12:15], s36 offen lds
    ds_read_b64_tr_b16 v[184:185], v4 offset:16384
    ds_read_b64_tr_b16 v[186:187], v4 offset:18432
    ds_read_b64_tr_b16 v[188:189], v4 offset:20480
    ds_read_b64_tr_b16 v[190:191], v4 offset:22528
    ds_read_b64_tr_b16 v[192:193], v4 offset:24576
    ds_read_b64_tr_b16 v[194:195], v4 offset:26624
    ds_read_b64_tr_b16 v[196:197], v4 offset:28672
    ds_read_b64_tr_b16 v[198:199], v4 offset:30720
    s_waitcnt vmcnt(24) lgkmcnt(0)
    s_barrier
    s_add_u32 m0, s46, 16384
    s_mov_b32 s36, 589824
    buffer_load_dwordx4 v3, s[12:15], s36 offen lds
    s_add_u32 m0, s46, 17408
    s_mov_b32 s36, 593920
    buffer_load_dwordx4 v3, s[12:15], s36 offen lds
    s_add_u32 m0, s46, 18432
    s_mov_b32 s36, 598016
    buffer_load_dwordx4 v3, s[12:15], s36 offen lds
    s_add_u32 m0, s46, 19456
    s_mov_b32 s36, 602112
    buffer_load_dwordx4 v3, s[12:15], s36 offen lds
    ds_read_b64_tr_b16 v[200:201], v4 offset:32768
    ds_read_b64_tr_b16 v[202:203], v4 offset:34816
    ds_read_b64_tr_b16 v[204:205], v4 offset:36864
    ds_read_b64_tr_b16 v[206:207], v4 offset:38912
    ds_read_b64_tr_b16 v[208:209], v4 offset:40960
    ds_read_b64_tr_b16 v[210:211], v4 offset:43008
    ds_read_b64_tr_b16 v[212:213], v4 offset:45056
    ds_read_b64_tr_b16 v[214:215], v4 offset:47104
    s_waitcnt vmcnt(24) lgkmcnt(0)
    s_barrier
    s_add_u32 m0, s46, 32768
    s_mov_b32 s36, 655360
    buffer_load_dwordx4 v3, s[12:15], s36 offen lds
    s_add_u32 m0, s46, 33792
    s_mov_b32 s36, 659456
    buffer_load_dwordx4 v3, s[12:15], s36 offen lds
    s_add_u32 m0, s46, 34816
    s_mov_b32 s36, 663552
    buffer_load_dwordx4 v3, s[12:15], s36 offen lds
    s_add_u32 m0, s46, 35840
    s_mov_b32 s36, 667648
    buffer_load_dwordx4 v3, s[12:15], s36 offen lds
    ds_read_b64_tr_b16 v[216:217], v4 offset:49152
    ds_read_b64_tr_b16 v[218:219], v4 offset:51200
    ds_read_b64_tr_b16 v[220:221], v4 offset:53248
    ds_read_b64_tr_b16 v[222:223], v4 offset:55296
    ds_read_b64_tr_b16 v[224:225], v4 offset:57344
    ds_read_b64_tr_b16 v[226:227], v4 offset:59392
    ds_read_b64_tr_b16 v[228:229], v4 offset:61440
    ds_read_b64_tr_b16 v[230:231], v4 offset:63488
    s_waitcnt vmcnt(24) lgkmcnt(0)
    s_barrier
    s_add_u32 m0, s46, 49152
    s_mov_b32 s36, 720896
    buffer_load_dwordx4 v3, s[12:15], s36 offen lds
    s_add_u32 m0, s46, 50176
    s_mov_b32 s36, 724992
    buffer_load_dwordx4 v3, s[12:15], s36 offen lds
    s_add_u32 m0, s46, 51200
    s_mov_b32 s36, 729088
    buffer_load_dwordx4 v3, s[12:15], s36 offen lds
    s_add_u32 m0, s46, 52224
    s_mov_b32 s36, 733184
    buffer_load_dwordx4 v3, s[12:15], s36 offen lds
    ds_read_b64_tr_b16 v[232:233], v5 offset:0
    ds_read_b64_tr_b16 v[234:235], v5 offset:2048
    ds_read_b64_tr_b16 v[236:237], v5 offset:4096
    ds_read_b64_tr_b16 v[238:239], v5 offset:6144
    ds_read_b64_tr_b16 v[240:241], v5 offset:8192
    ds_read_b64_tr_b16 v[242:243], v5 offset:10240
    ds_read_b64_tr_b16 v[244:245], v5 offset:12288
    ds_read_b64_tr_b16 v[246:247], v5 offset:14336
    s_waitcnt vmcnt(24) lgkmcnt(0)
    s_barrier
    s_add_u32 m0, s46, 65536
    s_mov_b32 s36, 786432
    buffer_load_dwordx4 v3, s[12:15], s36 offen lds
    s_add_u32 m0, s46, 66560
    s_mov_b32 s36, 790528
    buffer_load_dwordx4 v3, s[12:15], s36 offen lds
    s_add_u32 m0, s46, 67584
    s_mov_b32 s36, 794624
    buffer_load_dwordx4 v3, s[12:15], s36 offen lds
    s_add_u32 m0, s46, 68608
    s_mov_b32 s36, 798720
    buffer_load_dwordx4 v3, s[12:15], s36 offen lds
    ds_read_b64_tr_b16 v[248:249], v5 offset:16384
    ds_read_b64_tr_b16 v[250:251], v5 offset:18432
    ds_read_b64_tr_b16 v[252:253], v5 offset:20480
    ds_read_b64_tr_b16 v[254:255], v5 offset:22528
    ds_read_b64_tr_b16 a[0:1], v5 offset:24576
    ds_read_b64_tr_b16 a[2:3], v5 offset:26624
    ds_read_b64_tr_b16 a[4:5], v5 offset:28672
    ds_read_b64_tr_b16 a[6:7], v5 offset:30720
    s_waitcnt vmcnt(24) lgkmcnt(0)
    s_barrier
    s_add_u32 m0, s46, 81920
    s_mov_b32 s36, 851968
    buffer_load_dwordx4 v3, s[12:15], s36 offen lds
    s_add_u32 m0, s46, 82944
    s_mov_b32 s36, 856064
    buffer_load_dwordx4 v3, s[12:15], s36 offen lds
    s_add_u32 m0, s46, 83968
    s_mov_b32 s36, 860160
    buffer_load_dwordx4 v3, s[12:15], s36 offen lds
    s_add_u32 m0, s46, 84992
    s_mov_b32 s36, 864256
    buffer_load_dwordx4 v3, s[12:15], s36 offen lds
    ds_read_b64_tr_b16 a[8:9], v5 offset:32768
    ds_read_b64_tr_b16 a[10:11], v5 offset:34816
    ds_read_b64_tr_b16 a[12:13], v5 offset:36864
    ds_read_b64_tr_b16 a[14:15], v5 offset:38912
    ds_read_b64_tr_b16 a[16:17], v5 offset:40960
    ds_read_b64_tr_b16 a[18:19], v5 offset:43008
    ds_read_b64_tr_b16 a[20:21], v5 offset:45056
    ds_read_b64_tr_b16 a[22:23], v5 offset:47104
    s_waitcnt vmcnt(24) lgkmcnt(0)
    s_barrier
    s_add_u32 m0, s46, 98304
    s_mov_b32 s36, 917504
    buffer_load_dwordx4 v3, s[12:15], s36 offen lds
    s_add_u32 m0, s46, 99328
    s_mov_b32 s36, 921600
    buffer_load_dwordx4 v3, s[12:15], s36 offen lds
    s_add_u32 m0, s46, 100352
    s_mov_b32 s36, 925696
    buffer_load_dwordx4 v3, s[12:15], s36 offen lds
    s_add_u32 m0, s46, 101376
    s_mov_b32 s36, 929792
    buffer_load_dwordx4 v3, s[12:15], s36 offen lds
    ds_read_b64_tr_b16 a[24:25], v5 offset:49152
    ds_read_b64_tr_b16 a[26:27], v5 offset:51200
    ds_read_b64_tr_b16 a[28:29], v5 offset:53248
    ds_read_b64_tr_b16 a[30:31], v5 offset:55296
    ds_read_b64_tr_b16 a[32:33], v5 offset:57344
    ds_read_b64_tr_b16 a[34:35], v5 offset:59392
    ds_read_b64_tr_b16 a[36:37], v5 offset:61440
    ds_read_b64_tr_b16 a[38:39], v5 offset:63488
    s_waitcnt vmcnt(24) lgkmcnt(0)
    s_barrier
    s_add_u32 m0, s46, 114688
    s_mov_b32 s36, 983040
    buffer_load_dwordx4 v3, s[12:15], s36 offen lds
    s_add_u32 m0, s46, 115712
    s_mov_b32 s36, 987136
    buffer_load_dwordx4 v3, s[12:15], s36 offen lds
    s_add_u32 m0, s46, 116736
    s_mov_b32 s36, 991232
    buffer_load_dwordx4 v3, s[12:15], s36 offen lds
    s_add_u32 m0, s46, 117760
    s_mov_b32 s36, 995328
    buffer_load_dwordx4 v3, s[12:15], s36 offen lds
    ds_read_b64_tr_b16 a[40:41], v4 offset:0
    ds_read_b64_tr_b16 a[42:43], v4 offset:2048
    ds_read_b64_tr_b16 a[44:45], v4 offset:4096
    ds_read_b64_tr_b16 a[46:47], v4 offset:6144
    ds_read_b64_tr_b16 a[48:49], v4 offset:8192
    ds_read_b64_tr_b16 a[50:51], v4 offset:10240
    ds_read_b64_tr_b16 a[52:53], v4 offset:12288
    ds_read_b64_tr_b16 a[54:55], v4 offset:14336
    s_waitcnt vmcnt(24) lgkmcnt(0)
    s_barrier
    s_add_u32 m0, s46, 0
    s_mov_b32 s36, 1048576
    buffer_load_dwordx4 v3, s[12:15], s36 offen lds
    s_add_u32 m0, s46, 1024
    s_mov_b32 s36, 1052672
    buffer_load_dwordx4 v3, s[12:15], s36 offen lds
    s_add_u32 m0, s46, 2048
    s_mov_b32 s36, 1056768
    buffer_load_dwordx4 v3, s[12:15], s36 offen lds
    s_add_u32 m0, s46, 3072
    s_mov_b32 s36, 1060864
    buffer_load_dwordx4 v3, s[12:15], s36 offen lds
    ds_read_b64_tr_b16 a[56:57], v4 offset:16384
    ds_read_b64_tr_b16 a[58:59], v4 offset:18432
    ds_read_b64_tr_b16 a[60:61], v4 offset:20480
    ds_read_b64_tr_b16 a[62:63], v4 offset:22528
    ds_read_b64_tr_b16 a[64:65], v4 offset:24576
    ds_read_b64_tr_b16 a[66:67], v4 offset:26624
    ds_read_b64_tr_b16 a[68:69], v4 offset:28672
    ds_read_b64_tr_b16 a[70:71], v4 offset:30720
    s_waitcnt vmcnt(24) lgkmcnt(0)
    s_barrier
    s_add_u32 m0, s46, 16384
    s_mov_b32 s36, 1114112
    buffer_load_dwordx4 v3, s[12:15], s36 offen lds
    s_add_u32 m0, s46, 17408
    s_mov_b32 s36, 1118208
    buffer_load_dwordx4 v3, s[12:15], s36 offen lds
    s_add_u32 m0, s46, 18432
    s_mov_b32 s36, 1122304
    buffer_load_dwordx4 v3, s[12:15], s36 offen lds
    s_add_u32 m0, s46, 19456
    s_mov_b32 s36, 1126400
    buffer_load_dwordx4 v3, s[12:15], s36 offen lds
    ds_read_b64_tr_b16 a[72:73], v4 offset:32768
    ds_read_b64_tr_b16 a[74:75], v4 offset:34816
    ds_read_b64_tr_b16 a[76:77], v4 offset:36864
    ds_read_b64_tr_b16 a[78:79], v4 offset:38912
    ds_read_b64_tr_b16 a[80:81], v4 offset:40960
    ds_read_b64_tr_b16 a[82:83], v4 offset:43008
    ds_read_b64_tr_b16 a[84:85], v4 offset:45056
    ds_read_b64_tr_b16 a[86:87], v4 offset:47104
    s_waitcnt vmcnt(24) lgkmcnt(0)
    s_barrier
    s_add_u32 m0, s46, 32768
    s_mov_b32 s36, 1179648
    buffer_load_dwordx4 v3, s[12:15], s36 offen lds
    s_add_u32 m0, s46, 33792
    s_mov_b32 s36, 1183744
    buffer_load_dwordx4 v3, s[12:15], s36 offen lds
    s_add_u32 m0, s46, 34816
    s_mov_b32 s36, 1187840
    buffer_load_dwordx4 v3, s[12:15], s36 offen lds
    s_add_u32 m0, s46, 35840
    s_mov_b32 s36, 1191936
    buffer_load_dwordx4 v3, s[12:15], s36 offen lds
    ds_read_b64_tr_b16 a[88:89], v4 offset:49152
    ds_read_b64_tr_b16 a[90:91], v4 offset:51200
    ds_read_b64_tr_b16 a[92:93], v4 offset:53248
    ds_read_b64_tr_b16 a[94:95], v4 offset:55296
    ds_read_b64_tr_b16 a[96:97], v4 offset:57344
    ds_read_b64_tr_b16 a[98:99], v4 offset:59392
    ds_read_b64_tr_b16 a[100:101], v4 offset:61440
    ds_read_b64_tr_b16 a[102:103], v4 offset:63488
    s_waitcnt vmcnt(24) lgkmcnt(0)
    s_barrier
    s_add_u32 m0, s46, 49152
    s_mov_b32 s36, 1245184
    buffer_load_dwordx4 v3, s[12:15], s36 offen lds
    s_add_u32 m0, s46, 50176
    s_mov_b32 s36, 1249280
    buffer_load_dwordx4 v3, s[12:15], s36 offen lds
    s_add_u32 m0, s46, 51200
    s_mov_b32 s36, 1253376
    buffer_load_dwordx4 v3, s[12:15], s36 offen lds
    s_add_u32 m0, s46, 52224
    s_mov_b32 s36, 1257472
    buffer_load_dwordx4 v3, s[12:15], s36 offen lds
    ds_read_b64_tr_b16 a[104:105], v5 offset:0
    ds_read_b64_tr_b16 a[106:107], v5 offset:2048
    ds_read_b64_tr_b16 a[108:109], v5 offset:4096
    ds_read_b64_tr_b16 a[110:111], v5 offset:6144
    ds_read_b64_tr_b16 a[112:113], v5 offset:8192
    ds_read_b64_tr_b16 a[114:115], v5 offset:10240
    ds_read_b64_tr_b16 a[116:117], v5 offset:12288
    ds_read_b64_tr_b16 a[118:119], v5 offset:14336
    s_waitcnt vmcnt(24) lgkmcnt(0)
    s_barrier
    s_add_u32 m0, s46, 65536
    s_mov_b32 s36, 1310720
    buffer_load_dwordx4 v3, s[12:15], s36 offen lds
    s_add_u32 m0, s46, 66560
    s_mov_b32 s36, 1314816
    buffer_load_dwordx4 v3, s[12:15], s36 offen lds
    s_add_u32 m0, s46, 67584
    s_mov_b32 s36, 1318912
    buffer_load_dwordx4 v3, s[12:15], s36 offen lds
    s_add_u32 m0, s46, 68608
    s_mov_b32 s36, 1323008
    buffer_load_dwordx4 v3, s[12:15], s36 offen lds
    ds_read_b64_tr_b16 a[120:121], v5 offset:16384
    ds_read_b64_tr_b16 a[122:123], v5 offset:18432
    ds_read_b64_tr_b16 a[124:125], v5 offset:20480
    ds_read_b64_tr_b16 a[126:127], v5 offset:22528
    ds_read_b64_tr_b16 a[128:129], v5 offset:24576
    ds_read_b64_tr_b16 a[130:131], v5 offset:26624
    ds_read_b64_tr_b16 a[132:133], v5 offset:28672
    ds_read_b64_tr_b16 a[134:135], v5 offset:30720
    s_waitcnt vmcnt(24) lgkmcnt(0)
    s_barrier
    s_add_u32 m0, s46, 81920
    s_mov_b32 s36, 1376256
    buffer_load_dwordx4 v3, s[12:15], s36 offen lds
    s_add_u32 m0, s46, 82944
    s_mov_b32 s36, 1380352
    buffer_load_dwordx4 v3, s[12:15], s36 offen lds
    s_add_u32 m0, s46, 83968
    s_mov_b32 s36, 1384448
    buffer_load_dwordx4 v3, s[12:15], s36 offen lds
    s_add_u32 m0, s46, 84992
    s_mov_b32 s36, 1388544
    buffer_load_dwordx4 v3, s[12:15], s36 offen lds
    ds_read_b64_tr_b16 a[136:137], v5 offset:32768
    ds_read_b64_tr_b16 a[138:139], v5 offset:34816
    ds_read_b64_tr_b16 a[140:141], v5 offset:36864
    ds_read_b64_tr_b16 a[142:143], v5 offset:38912
    ds_read_b64_tr_b16 a[144:145], v5 offset:40960
    ds_read_b64_tr_b16 a[146:147], v5 offset:43008
    ds_read_b64_tr_b16 a[148:149], v5 offset:45056
    ds_read_b64_tr_b16 a[150:151], v5 offset:47104
    s_waitcnt vmcnt(24) lgkmcnt(0)
    s_barrier
    ds_read_b64_tr_b16 a[152:153], v5 offset:49152
    ds_read_b64_tr_b16 a[154:155], v5 offset:51200
    ds_read_b64_tr_b16 a[156:157], v5 offset:53248
    ds_read_b64_tr_b16 a[158:159], v5 offset:55296
    ds_read_b64_tr_b16 a[160:161], v5 offset:57344
    ds_read_b64_tr_b16 a[162:163], v5 offset:59392
    ds_read_b64_tr_b16 a[164:165], v5 offset:61440
    ds_read_b64_tr_b16 a[166:167], v5 offset:63488
    s_waitcnt vmcnt(20) lgkmcnt(0)
    s_barrier
    ds_read_b64_tr_b16 a[168:169], v4 offset:0
    ds_read_b64_tr_b16 a[170:171], v4 offset:2048
    ds_read_b64_tr_b16 a[172:173], v4 offset:4096
    ds_read_b64_tr_b16 a[174:175], v4 offset:6144
    ds_read_b64_tr_b16 a[176:177], v4 offset:8192
    ds_read_b64_tr_b16 a[178:179], v4 offset:10240
    ds_read_b64_tr_b16 a[180:181], v4 offset:12288
    ds_read_b64_tr_b16 a[182:183], v4 offset:14336
    s_waitcnt vmcnt(16) lgkmcnt(0)
    s_barrier
    ds_read_b64_tr_b16 a[184:185], v4 offset:16384
    ds_read_b64_tr_b16 a[186:187], v4 offset:18432
    ds_read_b64_tr_b16 a[188:189], v4 offset:20480
    ds_read_b64_tr_b16 a[190:191], v4 offset:22528
    ds_read_b64_tr_b16 a[192:193], v4 offset:24576
    ds_read_b64_tr_b16 a[194:195], v4 offset:26624
    ds_read_b64_tr_b16 a[196:197], v4 offset:28672
    ds_read_b64_tr_b16 a[198:199], v4 offset:30720
    s_waitcnt vmcnt(12) lgkmcnt(0)
    s_barrier
    ds_read_b64_tr_b16 a[200:201], v4 offset:32768
    ds_read_b64_tr_b16 a[202:203], v4 offset:34816
    ds_read_b64_tr_b16 a[204:205], v4 offset:36864
    ds_read_b64_tr_b16 a[206:207], v4 offset:38912
    ds_read_b64_tr_b16 a[208:209], v4 offset:40960
    ds_read_b64_tr_b16 a[210:211], v4 offset:43008
    ds_read_b64_tr_b16 a[212:213], v4 offset:45056
    ds_read_b64_tr_b16 a[214:215], v4 offset:47104
    s_waitcnt vmcnt(8) lgkmcnt(0)
    s_barrier
    ds_read_b64_tr_b16 a[216:217], v4 offset:49152
    ds_read_b64_tr_b16 a[218:219], v4 offset:51200
    ds_read_b64_tr_b16 a[220:221], v4 offset:53248
    ds_read_b64_tr_b16 a[222:223], v4 offset:55296
    ds_read_b64_tr_b16 a[224:225], v4 offset:57344
    ds_read_b64_tr_b16 a[226:227], v4 offset:59392
    ds_read_b64_tr_b16 a[228:229], v4 offset:61440
    ds_read_b64_tr_b16 a[230:231], v4 offset:63488
    s_waitcnt vmcnt(4) lgkmcnt(0)
    s_barrier
    ds_read_b64_tr_b16 a[232:233], v5 offset:0
    ds_read_b64_tr_b16 a[234:235], v5 offset:2048
    ds_read_b64_tr_b16 a[236:237], v5 offset:4096
    ds_read_b64_tr_b16 a[238:239], v5 offset:6144
    ds_read_b64_tr_b16 a[240:241], v5 offset:8192
    ds_read_b64_tr_b16 a[242:243], v5 offset:10240
    ds_read_b64_tr_b16 a[244:245], v5 offset:12288
    ds_read_b64_tr_b16 a[246:247], v5 offset:14336
    s_waitcnt vmcnt(0) lgkmcnt(0)
    s_barrier
    ds_read_b64_tr_b16 a[248:249], v5 offset:16384
    ds_read_b64_tr_b16 a[250:251], v5 offset:18432
    ds_read_b64_tr_b16 a[252:253], v5 offset:20480
    ds_read_b64_tr_b16 a[254:255], v5 offset:22528
    s_waitcnt lgkmcnt(0)
    s_barrier
    s_branch ld2_93
ld1_92:
    s_lshl_b32 s46, s32, 12
    s_add_u32 s46, s46, 0
    s_add_u32 m0, s46, 0
    s_mov_b32 s36, 196608
    buffer_load_dwordx4 v3, s[12:15], s36 offen lds
    s_add_u32 m0, s46, 1024
    s_mov_b32 s36, 200704
    buffer_load_dwordx4 v3, s[12:15], s36 offen lds
    s_add_u32 m0, s46, 2048
    s_mov_b32 s36, 204800
    buffer_load_dwordx4 v3, s[12:15], s36 offen lds
    s_add_u32 m0, s46, 3072
    s_mov_b32 s36, 208896
    buffer_load_dwordx4 v3, s[12:15], s36 offen lds
    s_add_u32 m0, s46, 16384
    s_mov_b32 s36, 262144
    buffer_load_dwordx4 v3, s[12:15], s36 offen lds
    s_add_u32 m0, s46, 17408
    s_mov_b32 s36, 266240
    buffer_load_dwordx4 v3, s[12:15], s36 offen lds
    s_add_u32 m0, s46, 18432
    s_mov_b32 s36, 270336
    buffer_load_dwordx4 v3, s[12:15], s36 offen lds
    s_add_u32 m0, s46, 19456
    s_mov_b32 s36, 274432
    buffer_load_dwordx4 v3, s[12:15], s36 offen lds
    s_add_u32 m0, s46, 32768
    s_mov_b32 s36, 327680
    buffer_load_dwordx4 v3, s[12:15], s36 offen lds
    s_add_u32 m0, s46, 33792
    s_mov_b32 s36, 331776
    buffer_load_dwordx4 v3, s[12:15], s36 offen lds
    s_add_u32 m0, s46, 34816
    s_mov_b32 s36, 335872
    buffer_load_dwordx4 v3, s[12:15], s36 offen lds
    s_add_u32 m0, s46, 35840
    s_mov_b32 s36, 339968
    buffer_load_dwordx4 v3, s[12:15], s36 offen lds
    s_add_u32 m0, s46, 49152
    s_mov_b32 s36, 0
    buffer_load_dwordx4 v3, s[12:15], s36 offen lds
    s_add_u32 m0, s46, 50176
    s_mov_b32 s36, 4096
    buffer_load_dwordx4 v3, s[12:15], s36 offen lds
    s_add_u32 m0, s46, 51200
    s_mov_b32 s36, 8192
    buffer_load_dwordx4 v3, s[12:15], s36 offen lds
    s_add_u32 m0, s46, 52224
    s_mov_b32 s36, 12288
    buffer_load_dwordx4 v3, s[12:15], s36 offen lds
    s_add_u32 m0, s46, 65536
    s_mov_b32 s36, 65536
    buffer_load_dwordx4 v3, s[12:15], s36 offen lds
    s_add_u32 m0, s46, 66560
    s_mov_b32 s36, 69632
    buffer_load_dwordx4 v3, s[12:15], s36 offen lds
    s_add_u32 m0, s46, 67584
    s_mov_b32 s36, 73728
    buffer_load_dwordx4 v3, s[12:15], s36 offen lds
    s_add_u32 m0, s46, 68608
    s_mov_b32 s36, 77824
    buffer_load_dwordx4 v3, s[12:15], s36 offen lds
    s_add_u32 m0, s46, 81920
    s_mov_b32 s36, 131072
    buffer_load_dwordx4 v3, s[12:15], s36 offen lds
    s_add_u32 m0, s46, 82944
    s_mov_b32 s36, 135168
    buffer_load_dwordx4 v3, s[12:15], s36 offen lds
    s_add_u32 m0, s46, 83968
    s_mov_b32 s36, 139264
    buffer_load_dwordx4 v3, s[12:15], s36 offen lds
    s_add_u32 m0, s46, 84992
    s_mov_b32 s36, 143360
    buffer_load_dwordx4 v3, s[12:15], s36 offen lds
    s_add_u32 m0, s46, 98304
    s_mov_b32 s36, 589824
    buffer_load_dwordx4 v3, s[12:15], s36 offen lds
    s_add_u32 m0, s46, 99328
    s_mov_b32 s36, 593920
    buffer_load_dwordx4 v3, s[12:15], s36 offen lds
    s_add_u32 m0, s46, 100352
    s_mov_b32 s36, 598016
    buffer_load_dwordx4 v3, s[12:15], s36 offen lds
    s_add_u32 m0, s46, 101376
    s_mov_b32 s36, 602112
    buffer_load_dwordx4 v3, s[12:15], s36 offen lds
    s_waitcnt vmcnt(24) lgkmcnt(0)
    s_barrier
    s_add_u32 m0, s46, 114688
    s_mov_b32 s36, 655360
    buffer_load_dwordx4 v3, s[12:15], s36 offen lds
    s_add_u32 m0, s46, 115712
    s_mov_b32 s36, 659456
    buffer_load_dwordx4 v3, s[12:15], s36 offen lds
    s_add_u32 m0, s46, 116736
    s_mov_b32 s36, 663552
    buffer_load_dwordx4 v3, s[12:15], s36 offen lds
    s_add_u32 m0, s46, 117760
    s_mov_b32 s36, 667648
    buffer_load_dwordx4 v3, s[12:15], s36 offen lds
    ds_read_b64_tr_b16 v[216:217], v4 offset:0
    ds_read_b64_tr_b16 v[218:219], v4 offset:2048
    ds_read_b64_tr_b16 v[220:221], v4 offset:4096
    ds_read_b64_tr_b16 v[222:223], v4 offset:6144
    ds_read_b64_tr_b16 v[224:225], v4 offset:8192
    ds_read_b64_tr_b16 v[226:227], v4 offset:10240
    ds_read_b64_tr_b16 v[228:229], v4 offset:12288
    ds_read_b64_tr_b16 v[230:231], v4 offset:14336
    s_waitcnt vmcnt(24) lgkmcnt(0)
    s_barrier
    s_add_u32 m0, s46, 0
    s_mov_b32 s36, 720896
    buffer_load_dwordx4 v3, s[12:15], s36 offen lds
    s_add_u32 m0, s46, 1024
    s_mov_b32 s36, 724992
    buffer_load_dwordx4 v3, s[12:15], s36 offen lds
    s_add_u32 m0, s46, 2048
    s_mov_b32 s36, 729088
    buffer_load_dwordx4 v3, s[12:15], s36 offen lds
    s_add_u32 m0, s46, 3072
    s_mov_b32 s36, 733184
    buffer_load_dwordx4 v3, s[12:15], s36 offen lds
    ds_read_b64_tr_b16 v[232:233], v4 offset:16384
    ds_read_b64_tr_b16 v[234:235], v4 offset:18432
    ds_read_b64_tr_b16 v[236:237], v4 offset:20480
    ds_read_b64_tr_b16 v[238:239], v4 offset:22528
    ds_read_b64_tr_b16 v[240:241], v4 offset:24576
    ds_read_b64_tr_b16 v[242:243], v4 offset:26624
    ds_read_b64_tr_b16 v[244:245], v4 offset:28672
    ds_read_b64_tr_b16 v[246:247], v4 offset:30720
    s_waitcnt vmcnt(24) lgkmcnt(0)
    s_barrier
    s_add_u32 m0, s46, 16384
    s_mov_b32 s36, 393216
    buffer_load_dwordx4 v3, s[12:15], s36 offen lds
    s_add_u32 m0, s46, 17408
    s_mov_b32 s36, 397312
    buffer_load_dwordx4 v3, s[12:15], s36 offen lds
    s_add_u32 m0, s46, 18432
    s_mov_b32 s36, 401408
    buffer_load_dwordx4 v3, s[12:15], s36 offen lds
    s_add_u32 m0, s46, 19456
    s_mov_b32 s36, 405504
    buffer_load_dwordx4 v3, s[12:15], s36 offen lds
    ds_read_b64_tr_b16 v[248:249], v4 offset:32768
    ds_read_b64_tr_b16 v[250:251], v4 offset:34816
    ds_read_b64_tr_b16 v[252:253], v4 offset:36864
    ds_read_b64_tr_b16 v[254:255], v4 offset:38912
    ds_read_b64_tr_b16 a[0:1], v4 offset:40960
    ds_read_b64_tr_b16 a[2:3], v4 offset:43008
    ds_read_b64_tr_b16 a[4:5], v4 offset:45056
    ds_read_b64_tr_b16 a[6:7], v4 offset:47104
    s_waitcnt vmcnt(24) lgkmcnt(0)
    s_barrier
    s_add_u32 m0, s46, 32768
    s_mov_b32 s36, 458752
    buffer_load_dwordx4 v3, s[12:15], s36 offen lds
    s_add_u32 m0, s46, 33792
    s_mov_b32 s36, 462848
    buffer_load_dwordx4 v3, s[12:15], s36 offen lds
    s_add_u32 m0, s46, 34816
    s_mov_b32 s36, 466944
    buffer_load_dwordx4 v3, s[12:15], s36 offen lds
    s_add_u32 m0, s46, 35840
    s_mov_b32 s36, 471040
    buffer_load_dwordx4 v3, s[12:15], s36 offen lds
    ds_read_b64_tr_b16 v[168:169], v4 offset:49152
    ds_read_b64_tr_b16 v[170:171], v4 offset:51200
    ds_read_b64_tr_b16 v[172:173], v4 offset:53248
    ds_read_b64_tr_b16 v[174:175], v4 offset:55296
    ds_read_b64_tr_b16 v[176:177], v4 offset:57344
    ds_read_b64_tr_b16 v[178:179], v4 offset:59392
    ds_read_b64_tr_b16 v[180:181], v4 offset:61440
    ds_read_b64_tr_b16 v[182:183], v4 offset:63488
    s_waitcnt vmcnt(24) lgkmcnt(0)
    s_barrier
    s_add_u32 m0, s46, 49152
    s_mov_b32 s36, 524288
    buffer_load_dwordx4 v3, s[12:15], s36 offen lds
    s_add_u32 m0, s46, 50176
    s_mov_b32 s36, 528384
    buffer_load_dwordx4 v3, s[12:15], s36 offen lds
    s_add_u32 m0, s46, 51200
    s_mov_b32 s36, 532480
    buffer_load_dwordx4 v3, s[12:15], s36 offen lds
    s_add_u32 m0, s46, 52224
    s_mov_b32 s36, 536576
    buffer_load_dwordx4 v3, s[12:15], s36 offen lds
    ds_read_b64_tr_b16 v[184:185], v5 offset:0
    ds_read_b64_tr_b16 v[186:187], v5 offset:2048
    ds_read_b64_tr_b16 v[188:189], v5 offset:4096
    ds_read_b64_tr_b16 v[190:191], v5 offset:6144
    ds_read_b64_tr_b16 v[192:193], v5 offset:8192
    ds_read_b64_tr_b16 v[194:195], v5 offset:10240
    ds_read_b64_tr_b16 v[196:197], v5 offset:12288
    ds_read_b64_tr_b16 v[198:199], v5 offset:14336
    s_waitcnt vmcnt(24) lgkmcnt(0)
    s_barrier
    s_add_u32 m0, s46, 65536
    s_mov_b32 s36, 983040
    buffer_load_dwordx4 v3, s[12:15], s36 offen lds
    s_add_u32 m0, s46, 66560
    s_mov_b32 s36, 987136
    buffer_load_dwordx4 v3, s[12:15], s36 offen lds
    s_add_u32 m0, s46, 67584
    s_mov_b32 s36, 991232
    buffer_load_dwordx4 v3, s[12:15], s36 offen lds
    s_add_u32 m0, s46, 68608
    s_mov_b32 s36, 995328
    buffer_load_dwordx4 v3, s[12:15], s36 offen lds
    ds_read_b64_tr_b16 v[200:201], v5 offset:16384
    ds_read_b64_tr_b16 v[202:203], v5 offset:18432
    ds_read_b64_tr_b16 v[204:205], v5 offset:20480
    ds_read_b64_tr_b16 v[206:207], v5 offset:22528
    ds_read_b64_tr_b16 v[208:209], v5 offset:24576
    ds_read_b64_tr_b16 v[210:211], v5 offset:26624
    ds_read_b64_tr_b16 v[212:213], v5 offset:28672
    ds_read_b64_tr_b16 v[214:215], v5 offset:30720
    s_waitcnt vmcnt(24) lgkmcnt(0)
    s_barrier
    s_add_u32 m0, s46, 81920
    s_mov_b32 s36, 1048576
    buffer_load_dwordx4 v3, s[12:15], s36 offen lds
    s_add_u32 m0, s46, 82944
    s_mov_b32 s36, 1052672
    buffer_load_dwordx4 v3, s[12:15], s36 offen lds
    s_add_u32 m0, s46, 83968
    s_mov_b32 s36, 1056768
    buffer_load_dwordx4 v3, s[12:15], s36 offen lds
    s_add_u32 m0, s46, 84992
    s_mov_b32 s36, 1060864
    buffer_load_dwordx4 v3, s[12:15], s36 offen lds
    ds_read_b64_tr_b16 a[56:57], v5 offset:32768
    ds_read_b64_tr_b16 a[58:59], v5 offset:34816
    ds_read_b64_tr_b16 a[60:61], v5 offset:36864
    ds_read_b64_tr_b16 a[62:63], v5 offset:38912
    ds_read_b64_tr_b16 a[64:65], v5 offset:40960
    ds_read_b64_tr_b16 a[66:67], v5 offset:43008
    ds_read_b64_tr_b16 a[68:69], v5 offset:45056
    ds_read_b64_tr_b16 a[70:71], v5 offset:47104
    s_waitcnt vmcnt(24) lgkmcnt(0)
    s_barrier
    s_add_u32 m0, s46, 98304
    s_mov_b32 s36, 1114112
    buffer_load_dwordx4 v3, s[12:15], s36 offen lds
    s_add_u32 m0, s46, 99328
    s_mov_b32 s36, 1118208
    buffer_load_dwordx4 v3, s[12:15], s36 offen lds
    s_add_u32 m0, s46, 100352
    s_mov_b32 s36, 1122304
    buffer_load_dwordx4 v3, s[12:15], s36 offen lds
    s_add_u32 m0, s46, 101376
    s_mov_b32 s36, 1126400
    buffer_load_dwordx4 v3, s[12:15], s36 offen lds
    ds_read_b64_tr_b16 a[72:73], v5 offset:49152
    ds_read_b64_tr_b16 a[74:75], v5 offset:51200
    ds_read_b64_tr_b16 a[76:77], v5 offset:53248
    ds_read_b64_tr_b16 a[78:79], v5 offset:55296
    ds_read_b64_tr_b16 a[80:81], v5 offset:57344
    ds_read_b64_tr_b16 a[82:83], v5 offset:59392
    ds_read_b64_tr_b16 a[84:85], v5 offset:61440
    ds_read_b64_tr_b16 a[86:87], v5 offset:63488
    s_waitcnt vmcnt(24) lgkmcnt(0)
    s_barrier
    s_add_u32 m0, s46, 114688
    s_mov_b32 s36, 786432
    buffer_load_dwordx4 v3, s[12:15], s36 offen lds
    s_add_u32 m0, s46, 115712
    s_mov_b32 s36, 790528
    buffer_load_dwordx4 v3, s[12:15], s36 offen lds
    s_add_u32 m0, s46, 116736
    s_mov_b32 s36, 794624
    buffer_load_dwordx4 v3, s[12:15], s36 offen lds
    s_add_u32 m0, s46, 117760
    s_mov_b32 s36, 798720
    buffer_load_dwordx4 v3, s[12:15], s36 offen lds
    ds_read_b64_tr_b16 a[88:89], v4 offset:0
    ds_read_b64_tr_b16 a[90:91], v4 offset:2048
    ds_read_b64_tr_b16 a[92:93], v4 offset:4096
    ds_read_b64_tr_b16 a[94:95], v4 offset:6144
    ds_read_b64_tr_b16 a[96:97], v4 offset:8192
    ds_read_b64_tr_b16 a[98:99], v4 offset:10240
    ds_read_b64_tr_b16 a[100:101], v4 offset:12288
    ds_read_b64_tr_b16 a[102:103], v4 offset:14336
    s_waitcnt vmcnt(24) lgkmcnt(0)
    s_barrier
    s_add_u32 m0, s46, 0
    s_mov_b32 s36, 851968
    buffer_load_dwordx4 v3, s[12:15], s36 offen lds
    s_add_u32 m0, s46, 1024
    s_mov_b32 s36, 856064
    buffer_load_dwordx4 v3, s[12:15], s36 offen lds
    s_add_u32 m0, s46, 2048
    s_mov_b32 s36, 860160
    buffer_load_dwordx4 v3, s[12:15], s36 offen lds
    s_add_u32 m0, s46, 3072
    s_mov_b32 s36, 864256
    buffer_load_dwordx4 v3, s[12:15], s36 offen lds
    ds_read_b64_tr_b16 a[8:9], v4 offset:16384
    ds_read_b64_tr_b16 a[10:11], v4 offset:18432
    ds_read_b64_tr_b16 a[12:13], v4 offset:20480
    ds_read_b64_tr_b16 a[14:15], v4 offset:22528
    ds_read_b64_tr_b16 a[16:17], v4 offset:24576
    ds_read_b64_tr_b16 a[18:19], v4 offset:26624
    ds_read_b64_tr_b16 a[20:21], v4 offset:28672
    ds_read_b64_tr_b16 a[22:23], v4 offset:30720
    s_waitcnt vmcnt(24) lgkmcnt(0)
    s_barrier
    s_add_u32 m0, s46, 16384
    s_mov_b32 s36, 917504
    buffer_load_dwordx4 v3, s[12:15], s36 offen lds
    s_add_u32 m0, s46, 17408
    s_mov_b32 s36, 921600
    buffer_load_dwordx4 v3, s[12:15], s36 offen lds
    s_add_u32 m0, s46, 18432
    s_mov_b32 s36, 925696
    buffer_load_dwordx4 v3, s[12:15], s36 offen lds
    s_add_u32 m0, s46, 19456
    s_mov_b32 s36, 929792
    buffer_load_dwordx4 v3, s[12:15], s36 offen lds
    ds_read_b64_tr_b16 a[24:25], v4 offset:32768
    ds_read_b64_tr_b16 a[26:27], v4 offset:34816
    ds_read_b64_tr_b16 a[28:29], v4 offset:36864
    ds_read_b64_tr_b16 a[30:31], v4 offset:38912
    ds_read_b64_tr_b16 a[32:33], v4 offset:40960
    ds_read_b64_tr_b16 a[34:35], v4 offset:43008
    ds_read_b64_tr_b16 a[36:37], v4 offset:45056
    ds_read_b64_tr_b16 a[38:39], v4 offset:47104
    s_waitcnt vmcnt(24) lgkmcnt(0)
    s_barrier
    s_add_u32 m0, s46, 32768
    s_mov_b32 s36, 1310720
    buffer_load_dwordx4 v3, s[12:15], s36 offen lds
    s_add_u32 m0, s46, 33792
    s_mov_b32 s36, 1314816
    buffer_load_dwordx4 v3, s[12:15], s36 offen lds
    s_add_u32 m0, s46, 34816
    s_mov_b32 s36, 1318912
    buffer_load_dwordx4 v3, s[12:15], s36 offen lds
    s_add_u32 m0, s46, 35840
    s_mov_b32 s36, 1323008
    buffer_load_dwordx4 v3, s[12:15], s36 offen lds
    ds_read_b64_tr_b16 a[40:41], v4 offset:49152
    ds_read_b64_tr_b16 a[42:43], v4 offset:51200
    ds_read_b64_tr_b16 a[44:45], v4 offset:53248
    ds_read_b64_tr_b16 a[46:47], v4 offset:55296
    ds_read_b64_tr_b16 a[48:49], v4 offset:57344
    ds_read_b64_tr_b16 a[50:51], v4 offset:59392
    ds_read_b64_tr_b16 a[52:53], v4 offset:61440
    ds_read_b64_tr_b16 a[54:55], v4 offset:63488
    s_waitcnt vmcnt(24) lgkmcnt(0)
    s_barrier
    s_add_u32 m0, s46, 49152
    s_mov_b32 s36, 1376256
    buffer_load_dwordx4 v3, s[12:15], s36 offen lds
    s_add_u32 m0, s46, 50176
    s_mov_b32 s36, 1380352
    buffer_load_dwordx4 v3, s[12:15], s36 offen lds
    s_add_u32 m0, s46, 51200
    s_mov_b32 s36, 1384448
    buffer_load_dwordx4 v3, s[12:15], s36 offen lds
    s_add_u32 m0, s46, 52224
    s_mov_b32 s36, 1388544
    buffer_load_dwordx4 v3, s[12:15], s36 offen lds
    ds_read_b64_tr_b16 a[152:153], v5 offset:0
    ds_read_b64_tr_b16 a[154:155], v5 offset:2048
    ds_read_b64_tr_b16 a[156:157], v5 offset:4096
    ds_read_b64_tr_b16 a[158:159], v5 offset:6144
    ds_read_b64_tr_b16 a[160:161], v5 offset:8192
    ds_read_b64_tr_b16 a[162:163], v5 offset:10240
    ds_read_b64_tr_b16 a[164:165], v5 offset:12288
    ds_read_b64_tr_b16 a[166:167], v5 offset:14336
    s_waitcnt vmcnt(24) lgkmcnt(0)
    s_barrier
    s_add_u32 m0, s46, 65536
    s_mov_b32 s36, 1179648
    buffer_load_dwordx4 v3, s[12:15], s36 offen lds
    s_add_u32 m0, s46, 66560
    s_mov_b32 s36, 1183744
    buffer_load_dwordx4 v3, s[12:15], s36 offen lds
    s_add_u32 m0, s46, 67584
    s_mov_b32 s36, 1187840
    buffer_load_dwordx4 v3, s[12:15], s36 offen lds
    s_add_u32 m0, s46, 68608
    s_mov_b32 s36, 1191936
    buffer_load_dwordx4 v3, s[12:15], s36 offen lds
    ds_read_b64_tr_b16 a[168:169], v5 offset:16384
    ds_read_b64_tr_b16 a[170:171], v5 offset:18432
    ds_read_b64_tr_b16 a[172:173], v5 offset:20480
    ds_read_b64_tr_b16 a[174:175], v5 offset:22528
    ds_read_b64_tr_b16 a[176:177], v5 offset:24576
    ds_read_b64_tr_b16 a[178:179], v5 offset:26624
    ds_read_b64_tr_b16 a[180:181], v5 offset:28672
    ds_read_b64_tr_b16 a[182:183], v5 offset:30720
    s_waitcnt vmcnt(24) lgkmcnt(0)
    s_barrier
    s_add_u32 m0, s46, 81920
    s_mov_b32 s36, 1245184
    buffer_load_dwordx4 v3, s[12:15], s36 offen lds
    s_add_u32 m0, s46, 82944
    s_mov_b32 s36, 1249280
    buffer_load_dwordx4 v3, s[12:15], s36 offen lds
    s_add_u32 m0, s46, 83968
    s_mov_b32 s36, 1253376
    buffer_load_dwordx4 v3, s[12:15], s36 offen lds
    s_add_u32 m0, s46, 84992
    s_mov_b32 s36, 1257472
    buffer_load_dwordx4 v3, s[12:15], s36 offen lds
    ds_read_b64_tr_b16 a[184:185], v5 offset:32768
    ds_read_b64_tr_b16 a[186:187], v5 offset:34816
    ds_read_b64_tr_b16 a[188:189], v5 offset:36864
    ds_read_b64_tr_b16 a[190:191], v5 offset:38912
    ds_read_b64_tr_b16 a[192:193], v5 offset:40960
    ds_read_b64_tr_b16 a[194:195], v5 offset:43008
    ds_read_b64_tr_b16 a[196:197], v5 offset:45056
    ds_read_b64_tr_b16 a[198:199], v5 offset:47104
    s_waitcnt vmcnt(24) lgkmcnt(0)
    s_barrier
    ds_read_b64_tr_b16 a[104:105], v5 offset:49152
    ds_read_b64_tr_b16 a[106:107], v5 offset:51200
    ds_read_b64_tr_b16 a[108:109], v5 offset:53248
    ds_read_b64_tr_b16 a[110:111], v5 offset:55296
    ds_read_b64_tr_b16 a[112:113], v5 offset:57344
    ds_read_b64_tr_b16 a[114:115], v5 offset:59392
    ds_read_b64_tr_b16 a[116:117], v5 offset:61440
    ds_read_b64_tr_b16 a[118:119], v5 offset:63488
    s_waitcnt vmcnt(20) lgkmcnt(0)
    s_barrier
    ds_read_b64_tr_b16 a[120:121], v4 offset:0
    ds_read_b64_tr_b16 a[122:123], v4 offset:2048
    ds_read_b64_tr_b16 a[124:125], v4 offset:4096
    ds_read_b64_tr_b16 a[126:127], v4 offset:6144
    ds_read_b64_tr_b16 a[128:129], v4 offset:8192
    ds_read_b64_tr_b16 a[130:131], v4 offset:10240
    ds_read_b64_tr_b16 a[132:133], v4 offset:12288
    ds_read_b64_tr_b16 a[134:135], v4 offset:14336
    s_waitcnt vmcnt(16) lgkmcnt(0)
    s_barrier
    ds_read_b64_tr_b16 a[136:137], v4 offset:16384
    ds_read_b64_tr_b16 a[138:139], v4 offset:18432
    ds_read_b64_tr_b16 a[140:141], v4 offset:20480
    ds_read_b64_tr_b16 a[142:143], v4 offset:22528
    ds_read_b64_tr_b16 a[144:145], v4 offset:24576
    ds_read_b64_tr_b16 a[146:147], v4 offset:26624
    ds_read_b64_tr_b16 a[148:149], v4 offset:28672
    ds_read_b64_tr_b16 a[150:151], v4 offset:30720
    s_waitcnt vmcnt(12) lgkmcnt(0)
    s_barrier
    ds_read_b64_tr_b16 a[232:233], v4 offset:32768
    ds_read_b64_tr_b16 a[234:235], v4 offset:34816
    ds_read_b64_tr_b16 a[236:237], v4 offset:36864
    ds_read_b64_tr_b16 a[238:239], v4 offset:38912
    ds_read_b64_tr_b16 a[240:241], v4 offset:40960
    ds_read_b64_tr_b16 a[242:243], v4 offset:43008
    ds_read_b64_tr_b16 a[244:245], v4 offset:45056
    ds_read_b64_tr_b16 a[246:247], v4 offset:47104
    s_waitcnt vmcnt(8) lgkmcnt(0)
    s_barrier
    ds_read_b64_tr_b16 a[248:249], v4 offset:49152
    ds_read_b64_tr_b16 a[250:251], v4 offset:51200
    ds_read_b64_tr_b16 a[252:253], v4 offset:53248
    ds_read_b64_tr_b16 a[254:255], v4 offset:55296
    s_waitcnt vmcnt(4) lgkmcnt(0)
    s_barrier
    ds_read_b64_tr_b16 a[200:201], v5 offset:0
    ds_read_b64_tr_b16 a[202:203], v5 offset:2048
    ds_read_b64_tr_b16 a[204:205], v5 offset:4096
    ds_read_b64_tr_b16 a[206:207], v5 offset:6144
    ds_read_b64_tr_b16 a[208:209], v5 offset:8192
    ds_read_b64_tr_b16 a[210:211], v5 offset:10240
    ds_read_b64_tr_b16 a[212:213], v5 offset:12288
    ds_read_b64_tr_b16 a[214:215], v5 offset:14336
    s_waitcnt vmcnt(0) lgkmcnt(0)
    s_barrier
    ds_read_b64_tr_b16 a[216:217], v5 offset:16384
    ds_read_b64_tr_b16 a[218:219], v5 offset:18432
    ds_read_b64_tr_b16 a[220:221], v5 offset:20480
    ds_read_b64_tr_b16 a[222:223], v5 offset:22528
    ds_read_b64_tr_b16 a[224:225], v5 offset:24576
    ds_read_b64_tr_b16 a[226:227], v5 offset:26624
    ds_read_b64_tr_b16 a[228:229], v5 offset:28672
    ds_read_b64_tr_b16 a[230:231], v5 offset:30720
    s_waitcnt lgkmcnt(0)
    s_barrier
ld2_93:
    v_mbcnt_lo_u32_b32 v12, -1, 0
    v_mbcnt_hi_u32_b32 v12, -1, v12
    v_lshlrev_b32 v12, 5, v12
wt_94:
    buffer_load_dword v11, v12, s[8:11], 0 offen sc1
    s_waitcnt vmcnt(0)
    v_readlane_b32 s36, v11, 0
    v_readlane_b32 s37, v11, 1
    s_nop 0
    s_add_u32 s36, s36, s37
    v_readlane_b32 s37, v11, 2
    s_nop 0
    s_add_u32 s36, s36, s37
    v_readlane_b32 s37, v11, 3
    s_nop 0
    s_add_u32 s36, s36, s37
    v_readlane_b32 s37, v11, 4
    s_nop 0
    s_add_u32 s36, s36, s37
    v_readlane_b32 s37, v11, 5
    s_nop 0
    s_add_u32 s36, s36, s37
    v_readlane_b32 s37, v11, 6
    s_nop 0
    s_add_u32 s36, s36, s37
    v_readlane_b32 s37, v11, 7
    s_nop 0
    s_add_u32 s36, s36, s37
    s_cmp_ge_u32 s36, 256
    s_cbranch_scc1 wtd_95
    s_sleep 2
    s_add_u32 s35, s35, 1
    s_cmp_lt_u32 s35, 524288
    s_cbranch_scc1 wt_94
wtd_95:
wf_96:
    buffer_load_dword v11, v8, s[4:7], s50 offen sc1
    s_waitcnt vmcnt(0)
    v_cmp_gt_u32 vcc, 1, v11
    s_cbranch_vccz wfd_97
    s_sleep 8
    s_add_u32 s35, s35, 1
    s_cmp_lt_u32 s35, 524288
    s_cbranch_scc1 wf_96
wfd_97:
    v_mov_b32 v9, 0x80000000
    v_mov_b32 v10, 0
    s_lshl_b32 s36, s48, 2
    s_add_u32 s36, s36, s32
    s_lshl_b32 s44, s36, 11
    s_lshl_b32 s37, s45, 15
    s_add_u32 s44, s44, s37
    s_add_u32 s44, s44, 2031616
    s_lshl_b32 s36, s48, 7
    s_lshl_b32 s37, s45, 9
    s_add_u32 s36, s36, s37
    s_lshl_b32 s37, s32, 2
    s_add_u32 s36, s36, s37
    s_add_u32 s43, s36, 11816960
    s_mul_i32 s52, s32, 11264
    s_mul_i32 s41, s45, 88064
    s_add_u32 s41, s41, s52
    s_add_u32 s41, s41, 4194304
    s_mov_b32 s42, 0
    s_mov_b32 s51, 0
    s_mov_b32 s53, 0xbfb8aa3b
    s_add_u32 s37, s42, s52
    s_add_u32 m0, s37, 0
    s_add_u32 s36, s41, 0
    buffer_load_dwordx4 v1, s[4:7], s36 offen offset:0 sc1 lds
    buffer_load_dwordx4 v1, s[4:7], s36 offen offset:1024 sc1 lds
    buffer_load_dwordx4 v1, s[4:7], s36 offen offset:2048 sc1 lds
    buffer_load_dwordx4 v1, s[4:7], s36 offen offset:3072 sc1 lds
    s_add_u32 m0, s37, 4096
    s_add_u32 s36, s41, 4096
    buffer_load_dwordx4 v1, s[4:7], s36 offen offset:0 sc1 lds
    buffer_load_dwordx4 v1, s[4:7], s36 offen offset:1024 sc1 lds
    buffer_load_dwordx4 v1, s[4:7], s36 offen offset:2048 sc1 lds
    buffer_load_dwordx4 v1, s[4:7], s36 offen offset:3072 sc1 lds
    s_add_u32 m0, s37, 8192
    s_add_u32 s36, s41, 8192
    buffer_load_dwordx4 v1, s[4:7], s36 offen offset:0 sc1 lds
    buffer_load_dwordx4 v1, s[4:7], s36 offen offset:1024 sc1 lds
    buffer_load_dwordx4 v1, s[4:7], s36 offen offset:2048 sc1 lds
    s_add_u32 s41, s41, 44032
    s_add_u32 s42, s42, 45056
    s_cmp_ge_u32 s42, 135168
    s_cselect_b32 s42, 0, s42
    s_add_u32 s37, s42, s52
    s_add_u32 m0, s37, 0
    s_add_u32 s36, s41, 0
    buffer_load_dwordx4 v1, s[4:7], s36 offen offset:0 sc1 lds
    buffer_load_dwordx4 v1, s[4:7], s36 offen offset:1024 sc1 lds
    buffer_load_dwordx4 v1, s[4:7], s36 offen offset:2048 sc1 lds
    buffer_load_dwordx4 v1, s[4:7], s36 offen offset:3072 sc1 lds
    s_add_u32 m0, s37, 4096
    s_add_u32 s36, s41, 4096
    buffer_load_dwordx4 v1, s[4:7], s36 offen offset:0 sc1 lds
    buffer_load_dwordx4 v1, s[4:7], s36 offen offset:1024 sc1 lds
    buffer_load_dwordx4 v1, s[4:7], s36 offen offset:2048 sc1 lds
    buffer_load_dwordx4 v1, s[4:7], s36 offen offset:3072 sc1 lds
    s_add_u32 m0, s37, 8192
    s_add_u32 s36, s41, 8192
    buffer_load_dwordx4 v1, s[4:7], s36 offen offset:0 sc1 lds
    buffer_load_dwordx4 v1, s[4:7], s36 offen offset:1024 sc1 lds
    buffer_load_dwordx4 v1, s[4:7], s36 offen offset:2048 sc1 lds
    s_add_u32 s41, s41, 132096
    s_add_u32 s42, s42, 45056
    s_cmp_ge_u32 s42, 135168
    s_cselect_b32 s42, 0, s42
    s_mov_b32 s40, 0
    s_waitcnt vmcnt(0)
t3_98:
    s_waitcnt vmcnt(12)
    s_barrier
    v_add_u32 v7, s51, v1
    ds_read_b128 v[16:19], v7 offset:0
    ds_read_b128 v[20:23], v7 offset:1024
    ds_read_b128 v[24:27], v7 offset:2048
    ds_read_b128 v[28:31], v7 offset:3072
    ds_read_b128 v[32:35], v7 offset:4096
    s_add_u32 s51, s51, 45056
    s_cmp_ge_u32 s51, 135168
    s_cselect_b32 s51, 0, s51
    s_add_u32 s47, s40, 2
    s_min_u32 s47, s47, 32
    v_cmp_gt_u32 vcc, s47, v10
    s_cbranch_vccz t3ok_99
wf_100:
    buffer_load_dword v10, v8, s[4:7], s50 offen sc1
    s_waitcnt vmcnt(0)
    v_cmp_gt_u32 vcc, s47, v10
    s_cbranch_vccz wfd_101
    s_sleep 2
    s_add_u32 s35, s35, 1
    s_cmp_lt_u32 s35, 524288
    s_cbranch_scc1 wf_100
wfd_101:
t3ok_99:
    s_waitcnt lgkmcnt(4)
    v_mfma_f32_32x32x16_bf16 v[40:55], v[168:171], v[16:19], 0
    ds_read_b128 v[36:39], v7 offset:5120
    s_add_u32 s37, s42, s52
    v_cvt_pk_bf16_f32 v73, v80, v81
    v_lshlrev_b32 v72, 16, v73
    v_and_b32 v73, 0xffff0000, v73
    v_mul_f32 v74, s53, v72
    s_waitcnt lgkmcnt(4)
    v_mfma_f32_32x32x16_bf16 v[40:55], v[172:175], v[20:23], v[40:55]
    ds_read_b128 v[16:19], v7 offset:6144
    s_add_u32 m0, s37, 0
    s_add_u32 s36, s41, 0
    v_mul_f32 v75, s53, v73
    v_exp_f32 v74, v74
    v_exp_f32 v75, v75
    v_add_f32 v74, 1.0, v74
    s_waitcnt lgkmcnt(4)
    v_mfma_f32_32x32x16_bf16 v[40:55], v[176:179], v[24:27], v[40:55]
    ds_read_b128 v[20:23], v7 offset:7168
    v_add_f32 v75, 1.0, v75
    v_rcp_f32 v74, v74
    v_rcp_f32 v75, v75
    v_mul_f32 v72, v72, v74
    s_waitcnt lgkmcnt(4)
    v_mfma_f32_32x32x16_bf16 v[40:55], v[180:183], v[28:31], v[40:55]
    ds_read_b128 v[24:27], v7 offset:8192
    buffer_load_dwordx4 v1, s[4:7], s36 offen offset:0 sc1 lds
    v_mul_f32 v73, v73, v75
    v_cvt_pk_bf16_f32 v56, v72, v73
    v_cvt_pk_bf16_f32 v77, v82, v83
    v_lshlrev_b32 v76, 16, v77
    s_waitcnt lgkmcnt(4)
    v_mfma_f32_32x32x16_bf16 v[40:55], v[184:187], v[32:35], v[40:55]
    ds_read_b128 v[28:31], v7 offset:9216
    v_and_b32 v77, 0xffff0000, v77
    v_mul_f32 v78, s53, v76
    v_mul_f32 v79, s53, v77
    v_exp_f32 v78, v78
    s_waitcnt lgkmcnt(4)
    v_mfma_f32_32x32x16_bf16 v[40:55], v[188:191], v[36:39], v[40:55]
    ds_read_b128 v[32:35], v7 offset:10240
    buffer_load_dwordx4 v1, s[4:7], s36 offen offset:1024 sc1 lds
    v_exp_f32 v79, v79
    v_add_f32 v78, 1.0, v78
    v_add_f32 v79, 1.0, v79
    v_rcp_f32 v78, v78
    s_waitcnt lgkmcnt(4)
    v_mfma_f32_32x32x16_bf16 v[40:55], v[192:195], v[16:19], v[40:55]
    ds_read_b128 v[36:39], v7 offset:11264
    v_rcp_f32 v79, v79
    v_mul_f32 v76, v76, v78
    v_mul_f32 v77, v77, v79
    v_cvt_pk_bf16_f32 v57, v76, v77
    s_waitcnt lgkmcnt(4)
    v_mfma_f32_32x32x16_bf16 v[40:55], v[196:199], v[20:23], v[40:55]
    ds_read_b128 v[16:19], v7 offset:12288
    buffer_load_dwordx4 v1, s[4:7], s36 offen offset:2048 sc1 lds
    v_cvt_pk_bf16_f32 v73, v84, v85
    v_lshlrev_b32 v72, 16, v73
    v_and_b32 v73, 0xffff0000, v73
    v_mul_f32 v74, s53, v72
    s_waitcnt lgkmcnt(4)
    v_mfma_f32_32x32x16_bf16 v[40:55], v[200:203], v[24:27], v[40:55]
    ds_read_b128 v[20:23], v7 offset:13312
    v_mul_f32 v75, s53, v73
    v_exp_f32 v74, v74
    v_exp_f32 v75, v75
    v_add_f32 v74, 1.0, v74
    s_waitcnt lgkmcnt(4)
    v_mfma_f32_32x32x16_bf16 v[40:55], v[204:207], v[28:31], v[40:55]
    ds_read_b128 v[24:27], v7 offset:14336
    buffer_load_dwordx4 v1, s[4:7], s36 offen offset:3072 sc1 lds
    v_add_f32 v75, 1.0, v75
    v_rcp_f32 v74, v74
    v_rcp_f32 v75, v75
    v_mul_f32 v72, v72, v74
    s_waitcnt lgkmcnt(4)
    v_mfma_f32_32x32x16_bf16 v[40:55], v[208:211], v[32:35], v[40:55]
    ds_read_b128 v[28:31], v7 offset:15360
    s_add_u32 m0, s37, 4096
    s_add_u32 s36, s41, 4096
    v_mul_f32 v73, v73, v75
    v_cvt_pk_bf16_f32 v58, v72, v73
    v_cvt_pk_bf16_f32 v77, v86, v87
    v_lshlrev_b32 v76, 16, v77
    s_waitcnt lgkmcnt(4)
    v_mfma_f32_32x32x16_bf16 v[40:55], v[212:215], v[36:39], v[40:55]
    ds_read_b128 v[32:35], v7 offset:16384
    buffer_load_dwordx4 v1, s[4:7], s36 offen offset:0 sc1 lds
    v_and_b32 v77, 0xffff0000, v77
    v_mul_f32 v78, s53, v76
    v_mul_f32 v79, s53, v77
    v_exp_f32 v78, v78
    s_waitcnt lgkmcnt(4)
    v_mfma_f32_32x32x16_bf16 v[40:55], v[216:219], v[16:19], v[40:55]
    ds_read_b128 v[36:39], v7 offset:17408
    v_exp_f32 v79, v79
    v_add_f32 v78, 1.0, v78
    v_add_f32 v79, 1.0, v79
    v_rcp_f32 v78, v78
    s_waitcnt lgkmcnt(4)
    v_mfma_f32_32x32x16_bf16 v[40:55], v[220:223], v[20:23], v[40:55]
    ds_read_b128 v[16:19], v7 offset:18432
    buffer_load_dwordx4 v1, s[4:7], s36 offen offset:1024 sc1 lds
    v_rcp_f32 v79, v79
    v_mul_f32 v76, v76, v78
    v_mul_f32 v77, v77, v79
    v_cvt_pk_bf16_f32 v59, v76, v77
    s_waitcnt lgkmcnt(4)
    v_mfma_f32_32x32x16_bf16 v[40:55], v[224:227], v[24:27], v[40:55]
    ds_read_b128 v[20:23], v7 offset:19456
    v_cvt_pk_bf16_f32 v73, v88, v89
    v_lshlrev_b32 v72, 16, v73
    v_and_b32 v73, 0xffff0000, v73
    v_mul_f32 v74, s53, v72
    s_waitcnt lgkmcnt(4)
    v_mfma_f32_32x32x16_bf16 v[40:55], v[228:231], v[28:31], v[40:55]
    ds_read_b128 v[24:27], v7 offset:20480
    buffer_load_dwordx4 v1, s[4:7], s36 offen offset:2048 sc1 lds
    v_mul_f32 v75, s53, v73
    v_exp_f32 v74, v74
    v_exp_f32 v75, v75
    v_add_f32 v74, 1.0, v74
    s_waitcnt lgkmcnt(4)
    v_mfma_f32_32x32x16_bf16 v[40:55], v[232:235], v[32:35], v[40:55]
    ds_read_b128 v[28:31], v7 offset:21504
    v_add_f32 v75, 1.0, v75
    v_rcp_f32 v74, v74
    v_rcp_f32 v75, v75
    v_mul_f32 v72, v72, v74
    s_waitcnt lgkmcnt(4)
    v_mfma_f32_32x32x16_bf16 v[40:55], v[236:239], v[36:39], v[40:55]
    ds_read_b128 v[32:35], v7 offset:22528
    buffer_load_dwordx4 v1, s[4:7], s36 offen offset:3072 sc1 lds
    v_mul_f32 v73, v73, v75
    v_cvt_pk_bf16_f32 v60, v72, v73
    v_cvt_pk_bf16_f32 v77, v90, v91
    v_lshlrev_b32 v76, 16, v77
    s_waitcnt lgkmcnt(4)
    v_mfma_f32_32x32x16_bf16 v[40:55], v[240:243], v[16:19], v[40:55]
    ds_read_b128 v[36:39], v7 offset:23552
    s_add_u32 m0, s37, 8192
    s_add_u32 s36, s41, 8192
    v_and_b32 v77, 0xffff0000, v77
    v_mul_f32 v78, s53, v76
    v_mul_f32 v79, s53, v77
    v_exp_f32 v78, v78
    s_waitcnt lgkmcnt(4)
    v_mfma_f32_32x32x16_bf16 v[40:55], v[244:247], v[20:23], v[40:55]
    ds_read_b128 v[16:19], v7 offset:24576
    buffer_load_dwordx4 v1, s[4:7], s36 offen offset:0 sc1 lds
    v_exp_f32 v79, v79
    v_add_f32 v78, 1.0, v78
    v_add_f32 v79, 1.0, v79
    v_rcp_f32 v78, v78
    s_waitcnt lgkmcnt(4)
    v_mfma_f32_32x32x16_bf16 v[40:55], v[248:251], v[24:27], v[40:55]
    ds_read_b128 v[20:23], v7 offset:25600
    v_rcp_f32 v79, v79
    v_mul_f32 v76, v76, v78
    v_mul_f32 v77, v77, v79
    v_cvt_pk_bf16_f32 v61, v76, v77
    s_waitcnt lgkmcnt(4)
    v_mfma_f32_32x32x16_bf16 v[40:55], v[252:255], v[28:31], v[40:55]
    ds_read_b128 v[24:27], v7 offset:26624
    buffer_load_dwordx4 v1, s[4:7], s36 offen offset:1024 sc1 lds
    v_cvt_pk_bf16_f32 v73, v92, v93
    v_lshlrev_b32 v72, 16, v73
    v_and_b32 v73, 0xffff0000, v73
    v_mul_f32 v74, s53, v72
    s_waitcnt lgkmcnt(4)
    v_mfma_f32_32x32x16_bf16 v[40:55], a[0:3], v[32:35], v[40:55]
    ds_read_b128 v[28:31], v7 offset:27648
    v_mul_f32 v75, s53, v73
    v_exp_f32 v74, v74
    v_exp_f32 v75, v75
    v_add_f32 v74, 1.0, v74
    s_waitcnt lgkmcnt(4)
    v_mfma_f32_32x32x16_bf16 v[40:55], a[4:7], v[36:39], v[40:55]
    ds_read_b128 v[32:35], v7 offset:28672
    buffer_load_dwordx4 v1, s[4:7], s36 offen offset:2048 sc1 lds
    v_add_f32 v75, 1.0, v75
    v_rcp_f32 v74, v74
    v_rcp_f32 v75, v75
    v_mul_f32 v72, v72, v74
    s_waitcnt lgkmcnt(4)
    v_mfma_f32_32x32x16_bf16 v[40:55], a[8:11], v[16:19], v[40:55]
    ds_read_b128 v[36:39], v7 offset:29696
    s_add_u32 s41, s41, 44032
    v_mul_f32 v73, v73, v75
    v_cvt_pk_bf16_f32 v62, v72, v73
    v_cvt_pk_bf16_f32 v77, v94, v95
    v_lshlrev_b32 v76, 16, v77
    s_waitcnt lgkmcnt(4)
    v_mfma_f32_32x32x16_bf16 v[40:55], a[12:15], v[20:23], v[40:55]
    ds_read_b128 v[16:19], v7 offset:30720
    s_add_u32 s42, s42, 45056
    v_and_b32 v77, 0xffff0000, v77
    v_mul_f32 v78, s53, v76
    v_mul_f32 v79, s53, v77
    v_exp_f32 v78, v78
    s_waitcnt lgkmcnt(4)
    v_mfma_f32_32x32x16_bf16 v[40:55], a[16:19], v[24:27], v[40:55]
    ds_read_b128 v[20:23], v7 offset:31744
    s_cmp_ge_u32 s42, 135168
    s_cselect_b32 s42, 0, s42
    v_exp_f32 v79, v79
    v_add_f32 v78, 1.0, v78
    v_add_f32 v79, 1.0, v79
    v_rcp_f32 v78, v78
    s_waitcnt lgkmcnt(4)
    v_mfma_f32_32x32x16_bf16 v[40:55], a[20:23], v[28:31], v[40:55]
    ds_read_b128 v[24:27], v7 offset:32768
    v_rcp_f32 v79, v79
    v_mul_f32 v76, v76, v78
    v_mul_f32 v77, v77, v79
    v_cvt_pk_bf16_f32 v63, v76, v77
    s_waitcnt lgkmcnt(4)
    v_mfma_f32_32x32x16_bf16 v[40:55], a[24:27], v[32:35], v[40:55]
    ds_read_b128 v[28:31], v7 offset:33792
    buffer_store_dwordx4 v[56:59], v9, s[4:7], s44 offen sc1
    buffer_store_dwordx4 v[60:63], v9, s[4:7], s44 offen offset:1024 sc1
    s_add_u32 s44, s44, 65536
    v_mov_b32 v9, v1
    s_waitcnt lgkmcnt(4)
    v_mfma_f32_32x32x16_bf16 v[40:55], a[28:31], v[36:39], v[40:55]
    ds_read_b128 v[32:35], v7 offset:34816
    s_waitcnt lgkmcnt(4)
    v_mfma_f32_32x32x16_bf16 v[40:55], a[32:35], v[16:19], v[40:55]
    ds_read_b128 v[36:39], v7 offset:35840
    s_waitcnt lgkmcnt(4)
    v_mfma_f32_32x32x16_bf16 v[40:55], a[36:39], v[20:23], v[40:55]
    ds_read_b128 v[16:19], v7 offset:36864
    s_waitcnt lgkmcnt(4)
    v_mfma_f32_32x32x16_bf16 v[40:55], a[40:43], v[24:27], v[40:55]
    ds_read_b128 v[20:23], v7 offset:37888
    s_waitcnt lgkmcnt(4)
    v_mfma_f32_32x32x16_bf16 v[40:55], a[44:47], v[28:31], v[40:55]
    ds_read_b128 v[24:27], v7 offset:38912
    s_waitcnt lgkmcnt(4)
    v_mfma_f32_32x32x16_bf16 v[40:55], a[48:51], v[32:35], v[40:55]
    ds_read_b128 v[28:31], v7 offset:39936
    s_waitcnt lgkmcnt(4)
    v_mfma_f32_32x32x16_bf16 v[40:55], a[52:55], v[36:39], v[40:55]
    ds_read_b128 v[32:35], v7 offset:40960
    s_waitcnt lgkmcnt(4)
    v_mfma_f32_32x32x16_bf16 v[40:55], a[56:59], v[16:19], v[40:55]
    ds_read_b128 v[36:39], v7 offset:41984
    s_waitcnt lgkmcnt(4)
    v_mfma_f32_32x32x16_bf16 v[40:55], a[60:63], v[20:23], v[40:55]
    ds_read_b128 v[16:19], v7 offset:43008
    s_waitcnt lgkmcnt(4)
    v_mfma_f32_32x32x16_bf16 v[40:55], a[64:67], v[24:27], v[40:55]
    s_waitcnt lgkmcnt(3)
    v_mfma_f32_32x32x16_bf16 v[40:55], a[68:71], v[28:31], v[40:55]
    s_waitcnt lgkmcnt(2)
    v_mfma_f32_32x32x16_bf16 v[40:55], a[72:75], v[32:35], v[40:55]
    s_waitcnt lgkmcnt(1)
    v_mfma_f32_32x32x16_bf16 v[40:55], a[76:79], v[36:39], v[40:55]
    s_waitcnt lgkmcnt(0)
    v_mfma_f32_32x32x16_bf16 v[40:55], a[80:83], v[16:19], v[40:55]
    s_waitcnt vmcnt(14)
    s_barrier
    v_add_u32 v7, s51, v1
    ds_read_b128 v[16:19], v7 offset:0
    ds_read_b128 v[20:23], v7 offset:1024
    ds_read_b128 v[24:27], v7 offset:2048
    ds_read_b128 v[28:31], v7 offset:3072
    ds_read_b128 v[32:35], v7 offset:4096
    s_add_u32 s51, s51, 45056
    s_cmp_ge_u32 s51, 135168
    s_cselect_b32 s51, 0, s51
    buffer_load_dword v10, v8, s[4:7], s50 offen sc1
    s_waitcnt lgkmcnt(4)
    v_mfma_f32_32x32x16_bf16 v[40:55], a[84:87], v[16:19], v[40:55]
    ds_read_b128 v[36:39], v7 offset:5120
    s_add_u32 s37, s42, s52
    s_waitcnt lgkmcnt(4)
    v_mfma_f32_32x32x16_bf16 v[40:55], a[88:91], v[20:23], v[40:55]
    ds_read_b128 v[16:19], v7 offset:6144
    s_add_u32 m0, s37, 0
    s_add_u32 s36, s41, 0
    s_waitcnt lgkmcnt(4)
    v_mfma_f32_32x32x16_bf16 v[40:55], a[92:95], v[24:27], v[40:55]
    ds_read_b128 v[20:23], v7 offset:7168
    s_waitcnt lgkmcnt(4)
    v_mfma_f32_32x32x16_bf16 v[40:55], a[96:99], v[28:31], v[40:55]
    ds_read_b128 v[24:27], v7 offset:8192
    buffer_load_dwordx4 v1, s[4:7], s36 offen offset:0 sc1 lds
    s_waitcnt lgkmcnt(4)
    v_mfma_f32_32x32x16_bf16 v[40:55], a[100:103], v[32:35], v[40:55]
    ds_read_b128 v[28:31], v7 offset:9216
    s_waitcnt lgkmcnt(4)
    v_mfma_f32_32x32x16_bf16 v[40:55], a[104:107], v[36:39], v[40:55]
    ds_read_b128 v[32:35], v7 offset:10240
    buffer_load_dwordx4 v1, s[4:7], s36 offen offset:1024 sc1 lds
    s_waitcnt lgkmcnt(4)
    v_mfma_f32_32x32x16_bf16 v[40:55], a[108:111], v[16:19], v[40:55]
    ds_read_b128 v[36:39], v7 offset:11264
    s_waitcnt lgkmcnt(4)
    v_mfma_f32_32x32x16_bf16 v[40:55], a[112:115], v[20:23], v[40:55]
    ds_read_b128 v[16:19], v7 offset:12288
    buffer_load_dwordx4 v1, s[4:7], s36 offen offset:2048 sc1 lds
    s_waitcnt lgkmcnt(4)
    v_mfma_f32_32x32x16_bf16 v[40:55], a[116:119], v[24:27], v[40:55]
    ds_read_b128 v[20:23], v7 offset:13312
    s_waitcnt lgkmcnt(4)
    v_mfma_f32_32x32x16_bf16 v[40:55], a[120:123], v[28:31], v[40:55]
    ds_read_b128 v[24:27], v7 offset:14336
    buffer_load_dwordx4 v1, s[4:7], s36 offen offset:3072 sc1 lds
    s_waitcnt lgkmcnt(4)
    v_mfma_f32_32x32x16_bf16 v[40:55], a[124:127], v[32:35], v[40:55]
    ds_read_b128 v[28:31], v7 offset:15360
    s_add_u32 m0, s37, 4096
    s_add_u32 s36, s41, 4096
    s_waitcnt lgkmcnt(4)
    v_mfma_f32_32x32x16_bf16 v[40:55], a[128:131], v[36:39], v[40:55]
    ds_read_b128 v[32:35], v7 offset:16384
    buffer_load_dwordx4 v1, s[4:7], s36 offen offset:0 sc1 lds
    s_waitcnt lgkmcnt(4)
    v_mfma_f32_32x32x16_bf16 v[40:55], a[132:135], v[16:19], v[40:55]
    ds_read_b128 v[36:39], v7 offset:17408
    s_waitcnt lgkmcnt(4)
    v_mfma_f32_32x32x16_bf16 v[40:55], a[136:139], v[20:23], v[40:55]
    ds_read_b128 v[16:19], v7 offset:18432
    buffer_load_dwordx4 v1, s[4:7], s36 offen offset:1024 sc1 lds
    s_waitcnt lgkmcnt(4)
    v_mfma_f32_32x32x16_bf16 v[40:55], a[140:143], v[24:27], v[40:55]
    ds_read_b128 v[20:23], v7 offset:19456
    s_waitcnt lgkmcnt(4)
    v_mfma_f32_32x32x16_bf16 v[40:55], a[144:147], v[28:31], v[40:55]
    ds_read_b128 v[24:27], v7 offset:20480
    buffer_load_dwordx4 v1, s[4:7], s36 offen offset:2048 sc1 lds
    s_waitcnt lgkmcnt(4)
    v_mfma_f32_32x32x16_bf16 v[40:55], a[148:151], v[32:35], v[40:55]
    ds_read_b128 v[28:31], v7 offset:21504
    s_waitcnt lgkmcnt(4)
    v_mfma_f32_32x32x16_bf16 v[40:55], a[152:155], v[36:39], v[40:55]
    ds_read_b128 v[32:35], v7 offset:22528
    buffer_load_dwordx4 v1, s[4:7], s36 offen offset:3072 sc1 lds
    s_waitcnt lgkmcnt(4)
    v_mfma_f32_32x32x16_bf16 v[40:55], a[156:159], v[16:19], v[40:55]
    ds_read_b128 v[36:39], v7 offset:23552
    s_add_u32 m0, s37, 8192
    s_add_u32 s36, s41, 8192
    s_waitcnt lgkmcnt(4)
    v_mfma_f32_32x32x16_bf16 v[40:55], a[160:163], v[20:23], v[40:55]
    ds_read_b128 v[16:19], v7 offset:24576
    buffer_load_dwordx4 v1, s[4:7], s36 offen offset:0 sc1 lds
    s_waitcnt lgkmcnt(4)
    v_mfma_f32_32x32x16_bf16 v[40:55], a[164:167], v[24:27], v[40:55]
    ds_read_b128 v[20:23], v7 offset:25600
    s_waitcnt lgkmcnt(4)
    v_mfma_f32_32x32x16_bf16 v[40:55], a[168:171], v[28:31], v[40:55]
    ds_read_b128 v[24:27], v7 offset:26624
    buffer_load_dwordx4 v1, s[4:7], s36 offen offset:1024 sc1 lds
    s_waitcnt lgkmcnt(4)
    v_mfma_f32_32x32x16_bf16 v[40:55], a[172:175], v[32:35], v[40:55]
    ds_read_b128 v[28:31], v7 offset:27648
    s_waitcnt lgkmcnt(4)
    v_mfma_f32_32x32x16_bf16 v[40:55], a[176:179], v[36:39], v[40:55]
    ds_read_b128 v[32:35], v7 offset:28672
    buffer_load_dwordx4 v1, s[4:7], s36 offen offset:2048 sc1 lds
    s_waitcnt lgkmcnt(4)
    v_mfma_f32_32x32x16_bf16 v[40:55], a[180:183], v[16:19], v[40:55]
    ds_read_b128 v[36:39], v7 offset:29696
    s_add_u32 s41, s41, 132096
    s_waitcnt lgkmcnt(4)
    v_mfma_f32_32x32x16_bf16 v[40:55], a[184:187], v[20:23], v[40:55]
    ds_read_b128 v[16:19], v7 offset:30720
    s_add_u32 s42, s42, 45056
    s_waitcnt lgkmcnt(4)
    v_mfma_f32_32x32x16_bf16 v[40:55], a[188:191], v[24:27], v[40:55]
    ds_read_b128 v[20:23], v7 offset:31744
    s_cmp_ge_u32 s42, 135168
    s_cselect_b32 s42, 0, s42
    s_waitcnt lgkmcnt(4)
    v_mfma_f32_32x32x16_bf16 v[40:55], a[192:195], v[28:31], v[40:55]
    ds_read_b128 v[24:27], v7 offset:32768
    s_waitcnt lgkmcnt(4)
    v_mfma_f32_32x32x16_bf16 v[40:55], a[196:199], v[32:35], v[40:55]
    ds_read_b128 v[28:31], v7 offset:33792
    s_waitcnt lgkmcnt(4)
    v_mfma_f32_32x32x16_bf16 v[40:55], a[200:203], v[36:39], v[40:55]
    ds_read_b128 v[32:35], v7 offset:34816
    s_waitcnt lgkmcnt(4)
    v_mfma_f32_32x32x16_bf16 v[40:55], a[204:207], v[16:19], v[40:55]
    ds_read_b128 v[36:39], v7 offset:35840
    s_waitcnt vmcnt(12)
    v_mov_b32 v12, s40
    buffer_store_dword v12, v2, s[4:7], s43 offen sc1
    s_waitcnt lgkmcnt(4)
    v_mfma_f32_32x32x16_bf16 v[40:55], a[208:211], v[20:23], v[40:55]
    ds_read_b128 v[16:19], v7 offset:36864
    s_waitcnt lgkmcnt(4)
    v_mfma_f32_32x32x16_bf16 v[40:55], a[212:215], v[24:27], v[40:55]
    ds_read_b128 v[20:23], v7 offset:37888
    s_waitcnt lgkmcnt(4)
    v_mfma_f32_32x32x16_bf16 v[40:55], a[216:219], v[28:31], v[40:55]
    ds_read_b128 v[24:27], v7 offset:38912
    s_waitcnt lgkmcnt(4)
    v_mfma_f32_32x32x16_bf16 v[40:55], a[220:223], v[32:35], v[40:55]
    ds_read_b128 v[28:31], v7 offset:39936
    s_waitcnt lgkmcnt(4)
    v_mfma_f32_32x32x16_bf16 v[40:55], a[224:227], v[36:39], v[40:55]
    ds_read_b128 v[32:35], v7 offset:40960
    s_waitcnt lgkmcnt(4)
    v_mfma_f32_32x32x16_bf16 v[40:55], a[228:231], v[16:19], v[40:55]
    ds_read_b128 v[36:39], v7 offset:41984
    s_waitcnt lgkmcnt(4)
    v_mfma_f32_32x32x16_bf16 v[40:55], a[232:235], v[20:23], v[40:55]
    ds_read_b128 v[16:19], v7 offset:43008
    s_waitcnt lgkmcnt(4)
    v_mfma_f32_32x32x16_bf16 v[40:55], a[236:239], v[24:27], v[40:55]
    s_waitcnt lgkmcnt(3)
    v_mfma_f32_32x32x16_bf16 v[40:55], a[240:243], v[28:31], v[40:55]
    s_waitcnt lgkmcnt(2)
    v_mfma_f32_32x32x16_bf16 v[40:55], a[244:247], v[32:35], v[40:55]
    s_waitcnt lgkmcnt(1)
    v_mfma_f32_32x32x16_bf16 v[40:55], a[248:251], v[36:39], v[40:55]
    s_waitcnt lgkmcnt(0)
    v_mfma_f32_32x32x16_bf16 v[40:55], a[252:255], v[16:19], v[40:55]
    s_nop 11
    v_mov_b64 v[80:81], v[40:41]
    v_mov_b64 v[82:83], v[42:43]
    v_mov_b64 v[84:85], v[44:45]
    v_mov_b64 v[86:87], v[46:47]
    v_mov_b64 v[88:89], v[48:49]
    v_mov_b64 v[90:91], v[50:51]
    v_mov_b64 v[92:93], v[52:53]
    v_mov_b64 v[94:95], v[54:55]
    s_add_u32 s40, s40, 1
    s_cmp_lt_u32 s40, 32
    s_cbranch_scc1 t3_98
    v_cvt_pk_bf16_f32 v73, v80, v81
    v_lshlrev_b32 v72, 16, v73
    v_and_b32 v73, 0xffff0000, v73
    v_mul_f32 v74, s53, v72
    v_mul_f32 v75, s53, v73
    v_exp_f32 v74, v74
    v_exp_f32 v75, v75
    v_add_f32 v74, 1.0, v74
    v_add_f32 v75, 1.0, v75
    v_rcp_f32 v74, v74
    v_rcp_f32 v75, v75
    v_mul_f32 v72, v72, v74
    v_mul_f32 v73, v73, v75
    v_cvt_pk_bf16_f32 v56, v72, v73
    v_cvt_pk_bf16_f32 v77, v82, v83
    v_lshlrev_b32 v76, 16, v77
    v_and_b32 v77, 0xffff0000, v77
    v_mul_f32 v78, s53, v76
    v_mul_f32 v79, s53, v77
    v_exp_f32 v78, v78
    v_exp_f32 v79, v79
    v_add_f32 v78, 1.0, v78
    v_add_f32 v79, 1.0, v79
    v_rcp_f32 v78, v78
    v_rcp_f32 v79, v79
    v_mul_f32 v76, v76, v78
    v_mul_f32 v77, v77, v79
    v_cvt_pk_bf16_f32 v57, v76, v77
    v_cvt_pk_bf16_f32 v73, v84, v85
    v_lshlrev_b32 v72, 16, v73
    v_and_b32 v73, 0xffff0000, v73
    v_mul_f32 v74, s53, v72
    v_mul_f32 v75, s53, v73
    v_exp_f32 v74, v74
    v_exp_f32 v75, v75
    v_add_f32 v74, 1.0, v74
    v_add_f32 v75, 1.0, v75
    v_rcp_f32 v74, v74
    v_rcp_f32 v75, v75
    v_mul_f32 v72, v72, v74
    v_mul_f32 v73, v73, v75
    v_cvt_pk_bf16_f32 v58, v72, v73
    v_cvt_pk_bf16_f32 v77, v86, v87
    v_lshlrev_b32 v76, 16, v77
    v_and_b32 v77, 0xffff0000, v77
    v_mul_f32 v78, s53, v76
    v_mul_f32 v79, s53, v77
    v_exp_f32 v78, v78
    v_exp_f32 v79, v79
    v_add_f32 v78, 1.0, v78
    v_add_f32 v79, 1.0, v79
    v_rcp_f32 v78, v78
    v_rcp_f32 v79, v79
    v_mul_f32 v76, v76, v78
    v_mul_f32 v77, v77, v79
    v_cvt_pk_bf16_f32 v59, v76, v77
    v_cvt_pk_bf16_f32 v73, v88, v89
    v_lshlrev_b32 v72, 16, v73
    v_and_b32 v73, 0xffff0000, v73
    v_mul_f32 v74, s53, v72
    v_mul_f32 v75, s53, v73
    v_exp_f32 v74, v74
    v_exp_f32 v75, v75
    v_add_f32 v74, 1.0, v74
    v_add_f32 v75, 1.0, v75
    v_rcp_f32 v74, v74
    v_rcp_f32 v75, v75
    v_mul_f32 v72, v72, v74
    v_mul_f32 v73, v73, v75
    v_cvt_pk_bf16_f32 v60, v72, v73
    v_cvt_pk_bf16_f32 v77, v90, v91
    v_lshlrev_b32 v76, 16, v77
    v_and_b32 v77, 0xffff0000, v77
    v_mul_f32 v78, s53, v76
    v_mul_f32 v79, s53, v77
    v_exp_f32 v78, v78
    v_exp_f32 v79, v79
    v_add_f32 v78, 1.0, v78
    v_add_f32 v79, 1.0, v79
    v_rcp_f32 v78, v78
    v_rcp_f32 v79, v79
    v_mul_f32 v76, v76, v78
    v_mul_f32 v77, v77, v79
    v_cvt_pk_bf16_f32 v61, v76, v77
    v_cvt_pk_bf16_f32 v73, v92, v93
    v_lshlrev_b32 v72, 16, v73
    v_and_b32 v73, 0xffff0000, v73
    v_mul_f32 v74, s53, v72
    v_mul_f32 v75, s53, v73
    v_exp_f32 v74, v74
    v_exp_f32 v75, v75
    v_add_f32 v74, 1.0, v74
    v_add_f32 v75, 1.0, v75
    v_rcp_f32 v74, v74
    v_rcp_f32 v75, v75
    v_mul_f32 v72, v72, v74
    v_mul_f32 v73, v73, v75
    v_cvt_pk_bf16_f32 v62, v72, v73
    v_cvt_pk_bf16_f32 v77, v94, v95
    v_lshlrev_b32 v76, 16, v77
    v_and_b32 v77, 0xffff0000, v77
    v_mul_f32 v78, s53, v76
    v_mul_f32 v79, s53, v77
    v_exp_f32 v78, v78
    v_exp_f32 v79, v79
    v_add_f32 v78, 1.0, v78
    v_add_f32 v79, 1.0, v79
    v_rcp_f32 v78, v78
    v_rcp_f32 v79, v79
    v_mul_f32 v76, v76, v78
    v_mul_f32 v77, v77, v79
    v_cvt_pk_bf16_f32 v63, v76, v77
    buffer_store_dwordx4 v[56:59], v9, s[4:7], s44 offen sc1
    buffer_store_dwordx4 v[60:63], v9, s[4:7], s44 offen offset:1024 sc1
    s_add_u32 s44, s44, 65536
    v_mov_b32 v9, v1
    s_waitcnt vmcnt(0)
    v_mov_b32 v12, 32
    buffer_store_dword v12, v2, s[4:7], s43 offen sc1
    s_branch L_exit
L_p3:
    s_load_dwordx2 s[12:13], s[0:1], 0
    s_load_dwordx2 s[16:17], s[0:1], 40
    s_load_dwordx2 s[20:21], s[0:1], 88
    s_load_dwordx2 s[24:25], s[0:1], 16
    s_load_dwordx2 s[28:29], s[0:1], 32
    s_load_dwordx2 s[56:57], s[0:1], 24
    s_load_dwordx2 s[60:61], s[0:1], 80
    s_waitcnt lgkmcnt(0)
    s_mov_b32 s14, 0x200000
    s_mov_b32 s15, 0x20000
    s_mov_b32 s18, 0x400000
    s_mov_b32 s19, 0x20000
    s_mov_b32 s22, 0x200000
    s_mov_b32 s23, 0x20000
    s_mov_b32 s26, 0x400000
    s_mov_b32 s27, 0x20000
    s_mov_b32 s30, 0x400000
    s_mov_b32 s31, 0x20000
    s_mov_b32 s58, 0x400000
    s_mov_b32 s59, 0x20000
    s_mov_b32 s62, 0x158000
    s_mov_b32 s63, 0x20000
    v_lshlrev_b32 v1, 4, v0
    v_cmp_eq_u32 vcc, 0, v0
    v_mov_b32 v2, 0x80000000
    s_nop 0
    v_cndmask_b32 v2, v2, 0, vcc
    s_sub_u32 s48, s34, 4
    s_lshl_b32 s48, s48, 5
    s_add_u32 s48, s48, s33
    s_lshl_b32 s36, s48, 14
    s_lshl_b32 s37, s32, 12
    s_add_u32 s36, s36, s37
    buffer_load_dwordx4 v[32:35], v1, s[12:15], s36 offen offset:0
    buffer_load_dwordx4 v[36:39], v1, s[12:15], s36 offen offset:1024
    buffer_load_dwordx4 v[40:43], v1, s[12:15], s36 offen offset:2048
    buffer_load_dwordx4 v[44:47], v1, s[12:15], s36 offen offset:3072
    s_waitcnt vmcnt(3)
    v_lshlrev_b32 v64, 16, v32
    v_and_b32 v65, 0xffff0000, v32
    v_lshlrev_b32 v66, 16, v33
    v_and_b32 v67, 0xffff0000, v33
    v_lshlrev_b32 v68, 16, v34
    v_and_b32 v69, 0xffff0000, v34
    v_lshlrev_b32 v70, 16, v35
    v_and_b32 v71, 0xffff0000, v35
    v_add_f32 v16, v64, v65
    v_add_f32 v16, v16, v66
    v_add_f32 v16, v16, v67
    v_add_f32 v16, v16, v68
    v_add_f32 v16, v16, v69
    v_add_f32 v16, v16, v70
    v_add_f32 v16, v16, v71
    s_waitcnt vmcnt(2)
    v_lshlrev_b32 v72, 16, v36
    v_and_b32 v73, 0xffff0000, v36
    v_lshlrev_b32 v74, 16, v37
    v_and_b32 v75, 0xffff0000, v37
    v_lshlrev_b32 v76, 16, v38
    v_and_b32 v77, 0xffff0000, v38
    v_lshlrev_b32 v78, 16, v39
    v_and_b32 v79, 0xffff0000, v39
    v_add_f32 v17, v72, v73
    v_add_f32 v17, v17, v74
    v_add_f32 v17, v17, v75
    v_add_f32 v17, v17, v76
    v_add_f32 v17, v17, v77
    v_add_f32 v17, v17, v78
    v_add_f32 v17, v17, v79
    s_waitcnt vmcnt(1)
    v_lshlrev_b32 v80, 16, v40
    v_and_b32 v81, 0xffff0000, v40
    v_lshlrev_b32 v82, 16, v41
    v_and_b32 v83, 0xffff0000, v41
    v_lshlrev_b32 v84, 16, v42
    v_and_b32 v85, 0xffff0000, v42
    v_lshlrev_b32 v86, 16, v43
    v_and_b32 v87, 0xffff0000, v43
    v_add_f32 v18, v80, v81
    v_add_f32 v18, v18, v82
    v_add_f32 v18, v18, v83
    v_add_f32 v18, v18, v84
    v_add_f32 v18, v18, v85
    v_add_f32 v18, v18, v86
    v_add_f32 v18, v18, v87
    s_waitcnt vmcnt(0)
    v_lshlrev_b32 v88, 16, v44
    v_and_b32 v89, 0xffff0000, v44
    v_lshlrev_b32 v90, 16, v45
    v_and_b32 v91, 0xffff0000, v45
    v_lshlrev_b32 v92, 16, v46
    v_and_b32 v93, 0xffff0000, v46
    v_lshlrev_b32 v94, 16, v47
    v_and_b32 v95, 0xffff0000, v47
    v_add_f32 v19, v88, v89
    v_add_f32 v19, v19, v90
    v_add_f32 v19, v19, v91
    v_add_f32 v19, v19, v92
    v_add_f32 v19, v19, v93
    v_add_f32 v19, v19, v94
    v_add_f32 v19, v19, v95
    v_add_f32_dpp v16, v16, v16 row_ror:8 row_mask:0xf bank_mask:0xf
    v_add_f32_dpp v17, v17, v17 row_ror:8 row_mask:0xf bank_mask:0xf
    v_add_f32_dpp v18, v18, v18 row_ror:8 row_mask:0xf bank_mask:0xf
    v_add_f32_dpp v19, v19, v19 row_ror:8 row_mask:0xf bank_mask:0xf
    v_add_f32_dpp v16, v16, v16 row_ror:4 row_mask:0xf bank_mask:0xf
    v_add_f32_dpp v17, v17, v17 row_ror:4 row_mask:0xf bank_mask:0xf
    v_add_f32_dpp v18, v18, v18 row_ror:4 row_mask:0xf bank_mask:0xf
    v_add_f32_dpp v19, v19, v19 row_ror:4 row_mask:0xf bank_mask:0xf
    v_add_f32_dpp v16, v16, v16 row_ror:2 row_mask:0xf bank_mask:0xf
    v_add_f32_dpp v17, v17, v17 row_ror:2 row_mask:0xf bank_mask:0xf
    v_add_f32_dpp v18, v18, v18 row_ror:2 row_mask:0xf bank_mask:0xf
    v_add_f32_dpp v19, v19, v19 row_ror:2 row_mask:0xf bank_mask:0xf
    v_add_f32_dpp v16, v16, v16 row_ror:1 row_mask:0xf bank_mask:0xf
    v_add_f32_dpp v17, v17, v17 row_ror:1 row_mask:0xf bank_mask:0xf
    v_add_f32_dpp v18, v18, v18 row_ror:1 row_mask:0xf bank_mask:0xf
    v_add_f32_dpp v19, v19, v19 row_ror:1 row_mask:0xf bank_mask:0xf
    v_mov_b32 v20, v16
    v_mov_b32 v21, v17
    v_mov_b32 v22, v18
    v_mov_b32 v23, v19
    v_permlane16_swap_b32 v16, v20
    v_permlane16_swap_b32 v17, v21
    v_permlane16_swap_b32 v18, v22
    v_permlane16_swap_b32 v19, v23
    v_add_f32 v16, v16, v20
    v_add_f32 v17, v17, v21
    v_add_f32 v18, v18, v22
    v_add_f32 v19, v19, v23
    v_mov_b32 v20, v16
    v_mov_b32 v21, v17
    v_mov_b32 v22, v18
    v_mov_b32 v23, v19
    v_permlane32_swap_b32 v16, v20
    v_permlane32_swap_b32 v17, v21
    v_permlane32_swap_b32 v18, v22
    v_permlane32_swap_b32 v19, v23
    v_add_f32 v16, v16, v20
    v_add_f32 v17, v17, v21
    v_add_f32 v18, v18, v22
    v_add_f32 v19, v19, v23
    s_mov_b32 s38, 0x3b000000
    v_mul_f32 v16, s38, v16
    v_cvt_pk_bf16_f32 v24, v16, v16
    v_lshlrev_b32 v24, 16, v24
    v_mul_f32 v17, s38, v17
    v_cvt_pk_bf16_f32 v25, v17, v17
    v_lshlrev_b32 v25, 16, v25
    v_mul_f32 v18, s38, v18
    v_cvt_pk_bf16_f32 v26, v18, v18
    v_lshlrev_b32 v26, 16, v26
    v_mul_f32 v19, s38, v19
    v_cvt_pk_bf16_f32 v27, v19, v19
    v_lshlrev_b32 v27, 16, v27
    v_sub_f32 v20, v64, v16
    v_mul_f32 v28, v20, v20
    v_sub_f32 v20, v65, v16
    v_fmac_f32 v28, v20, v20
    v_sub_f32 v20, v66, v16
    v_fmac_f32 v28, v20, v20
    v_sub_f32 v20, v67, v16
    v_fmac_f32 v28, v20, v20
    v_sub_f32 v20, v68, v16
    v_fmac_f32 v28, v20, v20
    v_sub_f32 v20, v69, v16
    v_fmac_f32 v28, v20, v20
    v_sub_f32 v20, v70, v16
    v_fmac_f32 v28, v20, v20
    v_sub_f32 v20, v71, v16
    v_fmac_f32 v28, v20, v20
    v_sub_f32 v21, v72, v17
    v_mul_f32 v29, v21, v21
    v_sub_f32 v21, v73, v17
    v_fmac_f32 v29, v21, v21
    v_sub_f32 v21, v74, v17
    v_fmac_f32 v29, v21, v21
    v_sub_f32 v21, v75, v17
    v_fmac_f32 v29, v21, v21
    v_sub_f32 v21, v76, v17
    v_fmac_f32 v29, v21, v21
    v_sub_f32 v21, v77, v17
    v_fmac_f32 v29, v21, v21
    v_sub_f32 v21, v78, v17
    v_fmac_f32 v29, v21, v21
    v_sub_f32 v21, v79, v17
    v_fmac_f32 v29, v21, v21
    v_sub_f32 v22, v80, v18
    v_mul_f32 v30, v22, v22
    v_sub_f32 v22, v81, v18
    v_fmac_f32 v30, v22, v22
    v_sub_f32 v22, v82, v18
    v_fmac_f32 v30, v22, v22
    v_sub_f32 v22, v83, v18
    v_fmac_f32 v30, v22, v22
    v_sub_f32 v22, v84, v18
    v_fmac_f32 v30, v22, v22
    v_sub_f32 v22, v85, v18
    v_fmac_f32 v30, v22, v22
    v_sub_f32 v22, v86, v18
    v_fmac_f32 v30, v22, v22
    v_sub_f32 v22, v87, v18
    v_fmac_f32 v30, v22, v22
    v_sub_f32 v23, v88, v19
    v_mul_f32 v31, v23, v23
    v_sub_f32 v23, v89, v19
    v_fmac_f32 v31, v23, v23
    v_sub_f32 v23, v90, v19
    v_fmac_f32 v31, v23, v23
    v_sub_f32 v23, v91, v19
    v_fmac_f32 v31, v23, v23
    v_sub_f32 v23, v92, v19
    v_fmac_f32 v31, v23, v23
    v_sub_f32 v23, v93, v19
    v_fmac_f32 v31, v23, v23
    v_sub_f32 v23, v94, v19
    v_fmac_f32 v31, v23, v23
    v_sub_f32 v23, v95, v19
    v_fmac_f32 v31, v23, v23
    v_add_f32_dpp v28, v28, v28 row_ror:8 row_mask:0xf bank_mask:0xf
    v_add_f32_dpp v29, v29, v29 row_ror:8 row_mask:0xf bank_mask:0xf
    v_add_f32_dpp v30, v30, v30 row_ror:8 row_mask:0xf bank_mask:0xf
    v_add_f32_dpp v31, v31, v31 row_ror:8 row_mask:0xf bank_mask:0xf
    v_add_f32_dpp v28, v28, v28 row_ror:4 row_mask:0xf bank_mask:0xf
    v_add_f32_dpp v29, v29, v29 row_ror:4 row_mask:0xf bank_mask:0xf
    v_add_f32_dpp v30, v30, v30 row_ror:4 row_mask:0xf bank_mask:0xf
    v_add_f32_dpp v31, v31, v31 row_ror:4 row_mask:0xf bank_mask:0xf
    v_add_f32_dpp v28, v28, v28 row_ror:2 row_mask:0xf bank_mask:0xf
    v_add_f32_dpp v29, v29, v29 row_ror:2 row_mask:0xf bank_mask:0xf
    v_add_f32_dpp v30, v30, v30 row_ror:2 row_mask:0xf bank_mask:0xf
    v_add_f32_dpp v31, v31, v31 row_ror:2 row_mask:0xf bank_mask:0xf
    v_add_f32_dpp v28, v28, v28 row_ror:1 row_mask:0xf bank_mask:0xf
    v_add_f32_dpp v29, v29, v29 row_ror:1 row_mask:0xf bank_mask:0xf
    v_add_f32_dpp v30, v30, v30 row_ror:1 row_mask:0xf bank_mask:0xf
    v_add_f32_dpp v31, v31, v31 row_ror:1 row_mask:0xf bank_mask:0xf
    v_mov_b32 v20, v28
    v_mov_b32 v21, v29
    v_mov_b32 v22, v30
    v_mov_b32 v23, v31
    v_permlane16_swap_b32 v28, v20
    v_permlane16_swap_b32 v29, v21
    v_permlane16_swap_b32 v30, v22
    v_permlane16_swap_b32 v31, v23
    v_add_f32 v28, v28, v20
    v_add_f32 v29, v29, v21
    v_add_f32 v30, v30, v22
    v_add_f32 v31, v31, v23
    v_mov_b32 v20, v28
    v_mov_b32 v21, v29
    v_mov_b32 v22, v30
    v_mov_b32 v23, v31
    v_permlane32_swap_b32 v28, v20
    v_permlane32_swap_b32 v29, v21
    v_permlane32_swap_b32 v30, v22
    v_permlane32_swap_b32 v31, v23
    v_add_f32 v28, v28, v20
    v_add_f32 v29, v29, v21
    v_add_f32 v30, v30, v22
    v_add_f32 v31, v31, v23
    v_mul_f32 v28, s38, v28
    v_cvt_pk_bf16_f32 v28, v28, v28
    v_lshlrev_b32 v28, 16, v28
    v_add_f32 v28, 0x3727c5ac, v28
    v_cvt_pk_bf16_f32 v28, v28, v28
    v_lshlrev_b32 v28, 16, v28
    v_sqrt_f32 v28, v28
    s_nop 0
    v_cvt_pk_bf16_f32 v28, v28, v28
    v_lshlrev_b32 v28, 16, v28
    v_rcp_f32 v28, v28
    v_mul_f32 v29, s38, v29
    v_cvt_pk_bf16_f32 v29, v29, v29
    v_lshlrev_b32 v29, 16, v29
    v_add_f32 v29, 0x3727c5ac, v29
    v_cvt_pk_bf16_f32 v29, v29, v29
    v_lshlrev_b32 v29, 16, v29
    v_sqrt_f32 v29, v29
    s_nop 0
    v_cvt_pk_bf16_f32 v29, v29, v29
    v_lshlrev_b32 v29, 16, v29
    v_rcp_f32 v29, v29
    v_mul_f32 v30, s38, v30
    v_cvt_pk_bf16_f32 v30, v30, v30
    v_lshlrev_b32 v30, 16, v30
    v_add_f32 v30, 0x3727c5ac, v30
    v_cvt_pk_bf16_f32 v30, v30, v30
    v_lshlrev_b32 v30, 16, v30
    v_sqrt_f32 v30, v30
    s_nop 0
    v_cvt_pk_bf16_f32 v30, v30, v30
    v_lshlrev_b32 v30, 16, v30
    v_rcp_f32 v30, v30
    v_mul_f32 v31, s38, v31
    v_cvt_pk_bf16_f32 v31, v31, v31
    v_lshlrev_b32 v31, 16, v31
    v_add_f32 v31, 0x3727c5ac, v31
    v_cvt_pk_bf16_f32 v31, v31, v31
    v_lshlrev_b32 v31, 16, v31
    v_sqrt_f32 v31, v31
    s_nop 0
    v_cvt_pk_bf16_f32 v31, v31, v31
    v_lshlrev_b32 v31, 16, v31
    v_rcp_f32 v31, v31
    s_lshl_b32 s37, s32, 6
    v_lshlrev_b32 v11, 8, v0
    v_add_u32 v11, s37, v11
    v_sub_f32 v64, v64, v24
    v_sub_f32 v65, v65, v24
    v_cvt_pk_bf16_f32 v65, v64, v65
    v_lshlrev_b32 v64, 16, v65
    v_and_b32 v65, 0xffff0000, v65
    v_mul_f32 v64, v64, v28
    v_mul_f32 v65, v65, v28
    v_cvt_pk_bf16_f32 v32, v64, v65
    v_sub_f32 v66, v66, v24
    v_sub_f32 v67, v67, v24
    v_cvt_pk_bf16_f32 v67, v66, v67
    v_lshlrev_b32 v66, 16, v67
    v_and_b32 v67, 0xffff0000, v67
    v_mul_f32 v66, v66, v28
    v_mul_f32 v67, v67, v28
    v_cvt_pk_bf16_f32 v33, v66, v67
    v_sub_f32 v68, v68, v24
    v_sub_f32 v69, v69, v24
    v_cvt_pk_bf16_f32 v69, v68, v69
    v_lshlrev_b32 v68, 16, v69
    v_and_b32 v69, 0xffff0000, v69
    v_mul_f32 v68, v68, v28
    v_mul_f32 v69, v69, v28
    v_cvt_pk_bf16_f32 v34, v68, v69
    v_sub_f32 v70, v70, v24
    v_sub_f32 v71, v71, v24
    v_cvt_pk_bf16_f32 v71, v70, v71
    v_lshlrev_b32 v70, 16, v71
    v_and_b32 v71, 0xffff0000, v71
    v_mul_f32 v70, v70, v28
    v_mul_f32 v71, v71, v28
    v_cvt_pk_bf16_f32 v35, v70, v71
    ds_write_b128 v11, v[32:35] offset:0
    v_sub_f32 v72, v72, v25
    v_sub_f32 v73, v73, v25
    v_cvt_pk_bf16_f32 v73, v72, v73
    v_lshlrev_b32 v72, 16, v73
    v_and_b32 v73, 0xffff0000, v73
    v_mul_f32 v72, v72, v29
    v_mul_f32 v73, v73, v29
    v_cvt_pk_bf16_f32 v36, v72, v73
    v_sub_f32 v74, v74, v25
    v_sub_f32 v75, v75, v25
    v_cvt_pk_bf16_f32 v75, v74, v75
    v_lshlrev_b32 v74, 16, v75
    v_and_b32 v75, 0xffff0000, v75
    v_mul_f32 v74, v74, v29
    v_mul_f32 v75, v75, v29
    v_cvt_pk_bf16_f32 v37, v74, v75
    v_sub_f32 v76, v76, v25
    v_sub_f32 v77, v77, v25
    v_cvt_pk_bf16_f32 v77, v76, v77
    v_lshlrev_b32 v76, 16, v77
    v_and_b32 v77, 0xffff0000, v77
    v_mul_f32 v76, v76, v29
    v_mul_f32 v77, v77, v29
    v_cvt_pk_bf16_f32 v38, v76, v77
    v_sub_f32 v78, v78, v25
    v_sub_f32 v79, v79, v25
    v_cvt_pk_bf16_f32 v79, v78, v79
    v_lshlrev_b32 v78, 16, v79
    v_and_b32 v79, 0xffff0000, v79
    v_mul_f32 v78, v78, v29
    v_mul_f32 v79, v79, v29
    v_cvt_pk_bf16_f32 v39, v78, v79
    ds_write_b128 v11, v[36:39] offset:16
    v_sub_f32 v80, v80, v26
    v_sub_f32 v81, v81, v26
    v_cvt_pk_bf16_f32 v81, v80, v81
    v_lshlrev_b32 v80, 16, v81
    v_and_b32 v81, 0xffff0000, v81
    v_mul_f32 v80, v80, v30
    v_mul_f32 v81, v81, v30
    v_cvt_pk_bf16_f32 v40, v80, v81
    v_sub_f32 v82, v82, v26
    v_sub_f32 v83, v83, v26
    v_cvt_pk_bf16_f32 v83, v82, v83
    v_lshlrev_b32 v82, 16, v83
    v_and_b32 v83, 0xffff0000, v83
    v_mul_f32 v82, v82, v30
    v_mul_f32 v83, v83, v30
    v_cvt_pk_bf16_f32 v41, v82, v83
    v_sub_f32 v84, v84, v26
    v_sub_f32 v85, v85, v26
    v_cvt_pk_bf16_f32 v85, v84, v85
    v_lshlrev_b32 v84, 16, v85
    v_and_b32 v85, 0xffff0000, v85
    v_mul_f32 v84, v84, v30
    v_mul_f32 v85, v85, v30
    v_cvt_pk_bf16_f32 v42, v84, v85
    v_sub_f32 v86, v86, v26
    v_sub_f32 v87, v87, v26
    v_cvt_pk_bf16_f32 v87, v86, v87
    v_lshlrev_b32 v86, 16, v87
    v_and_b32 v87, 0xffff0000, v87
    v_mul_f32 v86, v86, v30
    v_mul_f32 v87, v87, v30
    v_cvt_pk_bf16_f32 v43, v86, v87
    ds_write_b128 v11, v[40:43] offset:32
    v_sub_f32 v88, v88, v27
    v_sub_f32 v89, v89, v27
    v_cvt_pk_bf16_f32 v89, v88, v89
    v_lshlrev_b32 v88, 16, v89
    v_and_b32 v89, 0xffff0000, v89
    v_mul_f32 v88, v88, v31
    v_mul_f32 v89, v89, v31
    v_cvt_pk_bf16_f32 v44, v88, v89
    v_sub_f32 v90, v90, v27
    v_sub_f32 v91, v91, v27
    v_cvt_pk_bf16_f32 v91, v90, v91
    v_lshlrev_b32 v90, 16, v91
    v_and_b32 v91, 0xffff0000, v91
    v_mul_f32 v90, v90, v31
    v_mul_f32 v91, v91, v31
    v_cvt_pk_bf16_f32 v45, v90, v91
    v_sub_f32 v92, v92, v27
    v_sub_f32 v93, v93, v27
    v_cvt_pk_bf16_f32 v93, v92, v93
    v_lshlrev_b32 v92, 16, v93
    v_and_b32 v93, 0xffff0000, v93
    v_mul_f32 v92, v92, v31
    v_mul_f32 v93, v93, v31
    v_cvt_pk_bf16_f32 v46, v92, v93
    v_sub_f32 v94, v94, v27
    v_sub_f32 v95, v95, v27
    v_cvt_pk_bf16_f32 v95, v94, v95
    v_lshlrev_b32 v94, 16, v95
    v_and_b32 v95, 0xffff0000, v95
    v_mul_f32 v94, v94, v31
    v_mul_f32 v95, v95, v31
    v_cvt_pk_bf16_f32 v47, v94, v95
    ds_write_b128 v11, v[44:47] offset:48
    s_waitcnt lgkmcnt(0)
    s_barrier
    s_lshl_b32 s37, s32, 12
    v_add_u32 v11, s37, v1
    ds_read_b128 v[32:35], v11 offset:0
    ds_read_b128 v[36:39], v11 offset:1024
    ds_read_b128 v[40:43], v11 offset:2048
    ds_read_b128 v[44:47], v11 offset:3072
    v_lshrrev_b32 v12, 4, v0
    v_and_b32 v13, 15, v0
    v_lshlrev_b32 v12, 9, v12
    v_lshl_add_u32 v12, v13, 4, v12
    s_lshr_b32 s36, s48, 1
    s_lshl_b32 s36, s36, 15
    s_and_b32 s37, s48, 1
    s_lshl_b32 s37, s37, 8
    s_add_u32 s36, s36, s37
    s_lshl_b32 s37, s32, 13
    s_add_u32 s36, s36, s37
    s_add_u32 s37, s36, 4096
    s_waitcnt lgkmcnt(3)
    buffer_store_dwordx4 v[32:35], v12, s[4:7], s36 offen offset:0 sc1
    s_waitcnt lgkmcnt(2)
    buffer_store_dwordx4 v[36:39], v12, s[4:7], s36 offen offset:2048 sc1
    s_waitcnt lgkmcnt(1)
    buffer_store_dwordx4 v[40:43], v12, s[4:7], s37 offen offset:0 sc1
    s_waitcnt lgkmcnt(0)
    buffer_store_dwordx4 v[44:47], v12, s[4:7], s37 offen offset:2048 sc1
    v_mbcnt_lo_u32_b32 v15, -1, 0
    v_mbcnt_hi_u32_b32 v15, -1, v15
    v_lshlrev_b32 v15, 5, v15
wt_102:
    buffer_load_dword v14, v15, s[8:11], 0 offen sc1
    s_waitcnt vmcnt(0)
    v_readlane_b32 s36, v14, 0
    v_readlane_b32 s37, v14, 1
    s_nop 0
    s_add_u32 s36, s36, s37
    v_readlane_b32 s37, v14, 2
    s_nop 0
    s_add_u32 s36, s36, s37
    v_readlane_b32 s37, v14, 3
    s_nop 0
    s_add_u32 s36, s36, s37
    v_readlane_b32 s37, v14, 4
    s_nop 0
    s_add_u32 s36, s36, s37
    v_readlane_b32 s37, v14, 5
    s_nop 0
    s_add_u32 s36, s36, s37
    v_readlane_b32 s37, v14, 6
    s_nop 0
    s_add_u32 s36, s36, s37
    v_readlane_b32 s37, v14, 7
    s_nop 0
    s_add_u32 s36, s36, s37
    s_cmp_ge_u32 s36, 256
    s_cbranch_scc1 wtd_103
    s_sleep 2
    s_add_u32 s35, s35, 1
    s_cmp_lt_u32 s35, 524288
    s_cbranch_scc1 wt_102
wtd_103:
    s_lshl_b32 s36, s48, 5
    s_add_u32 s36, s36, s32
    s_lshl_b32 s36, s36, 2
    s_add_u32 s36, s36, 11829248
    v_mov_b32 v11, 1
    buffer_store_dword v11, v2, s[4:7], s36 offen sc1
    s_barrier
    s_cmp_lg_u32 s34, 7
    s_cbranch_scc1 p3n7_104
    s_lshl_b32 s36, s33, 2
    s_add_u32 s36, s36, s32
    s_lshl_b32 s36, s36, 15
    v_lshlrev_b32 v11, 7, v0
    s_waitcnt vmcnt(0)
    s_branch L_exit
p3n7_104:
    v_readlane_b32 s55, v14, s34
    s_sub_u32 s38, s34, 4
    s_mul_i32 s36, s33, 2097152
    s_lshl_b32 s37, s38, 15
    s_add_u32 s36, s36, s37
    s_mul_i32 s37, s32, 6144
    s_add_u32 s41, s36, s37
    s_add_u32 s41, s41, 33554432
    s_lshl_b32 s37, s32, 10
    s_add_u32 s36, s36, s37
    s_add_u32 s49, s36, 33579008
    s_lshl_b32 s36, s33, 2
    s_add_u32 s36, s36, s32
    s_mul_i32 s36, s36, 8448
    s_lshl_b32 s37, s38, 22
    s_add_u32 s36, s36, s37
    s_add_u32 s50, s36, 109051904
    s_cmp_lt_u32 s34, 4
    s_cbranch_scc1 p3w_105
    s_lshl_b32 s38, s33, 7
    s_add_u32 s38, s38, 11800576
    v_mov_b32 v12, 0
wf_106:
    buffer_load_dword v11, v12, s[4:7], s38 offen sc1
    s_waitcnt vmcnt(0)
    v_cmp_gt_u32 vcc, 1, v11
    s_cbranch_vccz wfd_107
    s_sleep 16
    s_add_u32 s35, s35, 1
    s_cmp_lt_u32 s35, 524288
    s_cbranch_scc1 wf_106
wfd_107:
p3w_105:
    v_lshrrev_b32 v11, 4, v0
    v_lshlrev_b32 v12, 1, v11
    v_and_b32 v13, 15, v0
    v_xor_b32 v12, v12, v13
    s_lshl_b32 s36, s32, 14
    s_lshl_b32 s37, s33, 17
    s_add_u32 s36, s36, s37
    v_lshlrev_b32 v11, 10, v11
    v_lshl_add_u32 v11, v12, 4, v11
    v_add_u32 v3, s36, v11
    v_xor_b32 v4, 128, v3
    v_lshrrev_b32 v11, 2, v0
    v_and_b32 v12, 7, v11
    v_bfe_u32 v13, v0, 1, 1
    s_and_b32 s36, s32, 2
    s_lshl_b32 s36, s36, 1
    v_add_u32 v13, s36, v13
    v_xor_b32 v12, v12, v13
    v_lshlrev_b32 v11, 8, v11
    v_lshl_add_u32 v11, v12, 5, v11
    v_and_b32 v12, 1, v0
    v_lshl_add_u32 v7, v12, 4, v11
    v_xor_b32 v8, 64, v7
    v_add_u32 v9, 65536, v7
    v_add_u32 v10, 65536, v8
    s_lshl_b32 s46, s32, 12
    s_add_u32 s46, s46, 0
    s_add_u32 m0, s46, 0
    s_mov_b32 s36, 0
    buffer_load_dwordx4 v3, s[16:19], s36 offen lds
    s_add_u32 m0, s46, 1024
    s_mov_b32 s36, 4096
    buffer_load_dwordx4 v4, s[16:19], s36 offen lds
    s_add_u32 m0, s46, 2048
    s_mov_b32 s36, 8192
    buffer_load_dwordx4 v3, s[16:19], s36 offen lds
    s_add_u32 m0, s46, 3072
    s_mov_b32 s36, 12288
    buffer_load_dwordx4 v4, s[16:19], s36 offen lds
    s_add_u32 m0, s46, 16384
    s_mov_b32 s36, 65536
    buffer_load_dwordx4 v3, s[16:19], s36 offen lds
    s_add_u32 m0, s46, 17408
    s_mov_b32 s36, 69632
    buffer_load_dwordx4 v4, s[16:19], s36 offen lds
    s_add_u32 m0, s46, 18432
    s_mov_b32 s36, 73728
    buffer_load_dwordx4 v3, s[16:19], s36 offen lds
    s_add_u32 m0, s46, 19456
    s_mov_b32 s36, 77824
    buffer_load_dwordx4 v4, s[16:19], s36 offen lds
    s_add_u32 m0, s46, 32768
    s_mov_b32 s36, 256
    buffer_load_dwordx4 v3, s[16:19], s36 offen lds
    s_add_u32 m0, s46, 33792
    s_mov_b32 s36, 4352
    buffer_load_dwordx4 v4, s[16:19], s36 offen lds
    s_add_u32 m0, s46, 34816
    s_mov_b32 s36, 8448
    buffer_load_dwordx4 v3, s[16:19], s36 offen lds
    s_add_u32 m0, s46, 35840
    s_mov_b32 s36, 12544
    buffer_load_dwordx4 v4, s[16:19], s36 offen lds
    s_add_u32 m0, s46, 49152
    s_mov_b32 s36, 65792
    buffer_load_dwordx4 v3, s[16:19], s36 offen lds
    s_add_u32 m0, s46, 50176
    s_mov_b32 s36, 69888
    buffer_load_dwordx4 v4, s[16:19], s36 offen lds
    s_add_u32 m0, s46, 51200
    s_mov_b32 s36, 73984
    buffer_load_dwordx4 v3, s[16:19], s36 offen lds
    s_add_u32 m0, s46, 52224
    s_mov_b32 s36, 78080
    buffer_load_dwordx4 v4, s[16:19], s36 offen lds
    s_add_u32 m0, s46, 65536
    s_mov_b32 s36, 512
    buffer_load_dwordx4 v3, s[16:19], s36 offen lds
    s_add_u32 m0, s46, 66560
    s_mov_b32 s36, 4608
    buffer_load_dwordx4 v4, s[16:19], s36 offen lds
    s_add_u32 m0, s46, 67584
    s_mov_b32 s36, 8704
    buffer_load_dwordx4 v3, s[16:19], s36 offen lds
    s_add_u32 m0, s46, 68608
    s_mov_b32 s36, 12800
    buffer_load_dwordx4 v4, s[16:19], s36 offen lds
    s_add_u32 m0, s46, 81920
    s_mov_b32 s36, 66048
    buffer_load_dwordx4 v3, s[16:19], s36 offen lds
    s_add_u32 m0, s46, 82944
    s_mov_b32 s36, 70144
    buffer_load_dwordx4 v4, s[16:19], s36 offen lds
    s_add_u32 m0, s46, 83968
    s_mov_b32 s36, 74240
    buffer_load_dwordx4 v3, s[16:19], s36 offen lds
    s_add_u32 m0, s46, 84992
    s_mov_b32 s36, 78336
    buffer_load_dwordx4 v4, s[16:19], s36 offen lds
    s_add_u32 m0, s46, 98304
    s_mov_b32 s36, 768
    buffer_load_dwordx4 v3, s[16:19], s36 offen lds
    s_add_u32 m0, s46, 99328
    s_mov_b32 s36, 4864
    buffer_load_dwordx4 v4, s[16:19], s36 offen lds
    s_add_u32 m0, s46, 100352
    s_mov_b32 s36, 8960
    buffer_load_dwordx4 v3, s[16:19], s36 offen lds
    s_add_u32 m0, s46, 101376
    s_mov_b32 s36, 13056
    buffer_load_dwordx4 v4, s[16:19], s36 offen lds
    s_waitcnt vmcnt(24) lgkmcnt(0)
    s_barrier
    s_add_u32 m0, s46, 114688
    s_mov_b32 s36, 66304
    buffer_load_dwordx4 v3, s[16:19], s36 offen lds
    s_add_u32 m0, s46, 115712
    s_mov_b32 s36, 70400
    buffer_load_dwordx4 v4, s[16:19], s36 offen lds
    s_add_u32 m0, s46, 116736
    s_mov_b32 s36, 74496
    buffer_load_dwordx4 v3, s[16:19], s36 offen lds
    s_add_u32 m0, s46, 117760
    s_mov_b32 s36, 78592
    buffer_load_dwordx4 v4, s[16:19], s36 offen lds
    ds_read_b64_tr_b16 a[0:1], v7 offset:0
    ds_read_b64_tr_b16 a[2:3], v7 offset:4096
    ds_read_b64_tr_b16 a[4:5], v7 offset:8192
    ds_read_b64_tr_b16 a[6:7], v7 offset:12288
    ds_read_b64_tr_b16 a[16:17], v7 offset:8
    ds_read_b64_tr_b16 a[18:19], v7 offset:4104
    ds_read_b64_tr_b16 a[20:21], v7 offset:8200
    ds_read_b64_tr_b16 a[22:23], v7 offset:12296
    ds_read_b64_tr_b16 a[32:33], v8 offset:0
    ds_read_b64_tr_b16 a[34:35], v8 offset:4096
    ds_read_b64_tr_b16 a[36:37], v8 offset:8192
    ds_read_b64_tr_b16 a[38:39], v8 offset:12288
    ds_read_b64_tr_b16 a[48:49], v8 offset:8
    ds_read_b64_tr_b16 a[50:51], v8 offset:4104
    ds_read_b64_tr_b16 a[52:53], v8 offset:8200
    ds_read_b64_tr_b16 a[54:55], v8 offset:12296
    s_waitcnt vmcnt(24) lgkmcnt(0)
    s_barrier
    ds_read_b64_tr_b16 a[8:9], v7 offset:16384
    ds_read_b64_tr_b16 a[10:11], v7 offset:20480
    ds_read_b64_tr_b16 a[12:13], v7 offset:24576
    ds_read_b64_tr_b16 a[14:15], v7 offset:28672
    ds_read_b64_tr_b16 a[24:25], v7 offset:16392
    ds_read_b64_tr_b16 a[26:27], v7 offset:20488
    ds_read_b64_tr_b16 a[28:29], v7 offset:24584
    ds_read_b64_tr_b16 a[30:31], v7 offset:28680
    ds_read_b64_tr_b16 a[40:41], v8 offset:16384
    ds_read_b64_tr_b16 a[42:43], v8 offset:20480
    ds_read_b64_tr_b16 a[44:45], v8 offset:24576
    ds_read_b64_tr_b16 a[46:47], v8 offset:28672
    ds_read_b64_tr_b16 a[56:57], v8 offset:16392
    ds_read_b64_tr_b16 a[58:59], v8 offset:20488
    ds_read_b64_tr_b16 a[60:61], v8 offset:24584
    ds_read_b64_tr_b16 a[62:63], v8 offset:28680
    s_waitcnt vmcnt(20) lgkmcnt(0)
    s_barrier
    ds_read_b64_tr_b16 a[64:65], v7 offset:32768
    ds_read_b64_tr_b16 a[66:67], v7 offset:36864
    ds_read_b64_tr_b16 a[68:69], v7 offset:40960
    ds_read_b64_tr_b16 a[70:71], v7 offset:45056
    ds_read_b64_tr_b16 a[80:81], v7 offset:32776
    ds_read_b64_tr_b16 a[82:83], v7 offset:36872
    ds_read_b64_tr_b16 a[84:85], v7 offset:40968
    ds_read_b64_tr_b16 a[86:87], v7 offset:45064
    ds_read_b64_tr_b16 a[96:97], v8 offset:32768
    ds_read_b64_tr_b16 a[98:99], v8 offset:36864
    ds_read_b64_tr_b16 a[100:101], v8 offset:40960
    ds_read_b64_tr_b16 a[102:103], v8 offset:45056
    ds_read_b64_tr_b16 a[112:113], v8 offset:32776
    ds_read_b64_tr_b16 a[114:115], v8 offset:36872
    ds_read_b64_tr_b16 a[116:117], v8 offset:40968
    ds_read_b64_tr_b16 a[118:119], v8 offset:45064
    s_waitcnt vmcnt(16) lgkmcnt(0)
    s_barrier
    ds_read_b64_tr_b16 a[72:73], v7 offset:49152
    ds_read_b64_tr_b16 a[74:75], v7 offset:53248
    ds_read_b64_tr_b16 a[76:77], v7 offset:57344
    ds_read_b64_tr_b16 a[78:79], v7 offset:61440
    ds_read_b64_tr_b16 a[88:89], v7 offset:49160
    ds_read_b64_tr_b16 a[90:91], v7 offset:53256
    ds_read_b64_tr_b16 a[92:93], v7 offset:57352
    ds_read_b64_tr_b16 a[94:95], v7 offset:61448
    ds_read_b64_tr_b16 a[104:105], v8 offset:49152
    ds_read_b64_tr_b16 a[106:107], v8 offset:53248
    ds_read_b64_tr_b16 a[108:109], v8 offset:57344
    ds_read_b64_tr_b16 a[110:111], v8 offset:61440
    ds_read_b64_tr_b16 a[120:121], v8 offset:49160
    ds_read_b64_tr_b16 a[122:123], v8 offset:53256
    ds_read_b64_tr_b16 a[124:125], v8 offset:57352
    ds_read_b64_tr_b16 a[126:127], v8 offset:61448
    s_waitcnt vmcnt(12) lgkmcnt(0)
    s_barrier
    ds_read_b64_tr_b16 a[128:129], v9 offset:0
    ds_read_b64_tr_b16 a[130:131], v9 offset:4096
    ds_read_b64_tr_b16 a[132:133], v9 offset:8192
    ds_read_b64_tr_b16 a[134:135], v9 offset:12288
    ds_read_b64_tr_b16 a[144:145], v9 offset:8
    ds_read_b64_tr_b16 a[146:147], v9 offset:4104
    ds_read_b64_tr_b16 a[148:149], v9 offset:8200
    ds_read_b64_tr_b16 a[150:151], v9 offset:12296
    ds_read_b64_tr_b16 a[160:161], v10 offset:0
    ds_read_b64_tr_b16 a[162:163], v10 offset:4096
    ds_read_b64_tr_b16 a[164:165], v10 offset:8192
    ds_read_b64_tr_b16 a[166:167], v10 offset:12288
    ds_read_b64_tr_b16 a[176:177], v10 offset:8
    ds_read_b64_tr_b16 a[178:179], v10 offset:4104
    ds_read_b64_tr_b16 a[180:181], v10 offset:8200
    ds_read_b64_tr_b16 a[182:183], v10 offset:12296
    s_waitcnt vmcnt(8) lgkmcnt(0)
    s_barrier
    ds_read_b64_tr_b16 a[136:137], v9 offset:16384
    ds_read_b64_tr_b16 a[138:139], v9 offset:20480
    ds_read_b64_tr_b16 a[140:141], v9 offset:24576
    ds_read_b64_tr_b16 a[142:143], v9 offset:28672
    ds_read_b64_tr_b16 a[152:153], v9 offset:16392
    ds_read_b64_tr_b16 a[154:155], v9 offset:20488
    ds_read_b64_tr_b16 a[156:157], v9 offset:24584
    ds_read_b64_tr_b16 a[158:159], v9 offset:28680
    ds_read_b64_tr_b16 a[168:169], v10 offset:16384
    ds_read_b64_tr_b16 a[170:171], v10 offset:20480
    ds_read_b64_tr_b16 a[172:173], v10 offset:24576
    ds_read_b64_tr_b16 a[174:175], v10 offset:28672
    ds_read_b64_tr_b16 a[184:185], v10 offset:16392
    ds_read_b64_tr_b16 a[186:187], v10 offset:20488
    ds_read_b64_tr_b16 a[188:189], v10 offset:24584
    ds_read_b64_tr_b16 a[190:191], v10 offset:28680
    s_waitcnt vmcnt(4) lgkmcnt(0)
    s_barrier
    ds_read_b64_tr_b16 a[192:193], v9 offset:32768
    ds_read_b64_tr_b16 a[194:195], v9 offset:36864
    ds_read_b64_tr_b16 a[196:197], v9 offset:40960
    ds_read_b64_tr_b16 a[198:199], v9 offset:45056
    ds_read_b64_tr_b16 a[208:209], v9 offset:32776
    ds_read_b64_tr_b16 a[210:211], v9 offset:36872
    ds_read_b64_tr_b16 a[212:213], v9 offset:40968
    ds_read_b64_tr_b16 a[214:215], v9 offset:45064
    ds_read_b64_tr_b16 a[224:225], v10 offset:32768
    ds_read_b64_tr_b16 a[226:227], v10 offset:36864
    ds_read_b64_tr_b16 a[228:229], v10 offset:40960
    ds_read_b64_tr_b16 a[230:231], v10 offset:45056
    ds_read_b64_tr_b16 a[240:241], v10 offset:32776
    ds_read_b64_tr_b16 a[242:243], v10 offset:36872
    ds_read_b64_tr_b16 a[244:245], v10 offset:40968
    ds_read_b64_tr_b16 a[246:247], v10 offset:45064
    s_waitcnt vmcnt(0) lgkmcnt(0)
    s_barrier
    ds_read_b64_tr_b16 a[200:201], v9 offset:49152
    ds_read_b64_tr_b16 a[202:203], v9 offset:53248
    ds_read_b64_tr_b16 a[204:205], v9 offset:57344
    ds_read_b64_tr_b16 a[206:207], v9 offset:61440
    ds_read_b64_tr_b16 a[216:217], v9 offset:49160
    ds_read_b64_tr_b16 a[218:219], v9 offset:53256
    ds_read_b64_tr_b16 a[220:221], v9 offset:57352
    ds_read_b64_tr_b16 a[222:223], v9 offset:61448
    ds_read_b64_tr_b16 a[232:233], v10 offset:49152
    ds_read_b64_tr_b16 a[234:235], v10 offset:53248
    ds_read_b64_tr_b16 a[236:237], v10 offset:57344
    ds_read_b64_tr_b16 a[238:239], v10 offset:61440
    ds_read_b64_tr_b16 a[248:249], v10 offset:49160
    ds_read_b64_tr_b16 a[250:251], v10 offset:53256
    ds_read_b64_tr_b16 a[252:253], v10 offset:57352
    ds_read_b64_tr_b16 a[254:255], v10 offset:61448
    s_waitcnt lgkmcnt(0)
    s_barrier
    s_lshl_b32 s38, s33, 7
    s_add_u32 s38, s38, 11800576
    v_mov_b32 v12, 0
wf_108:
    buffer_load_dword v11, v12, s[4:7], s38 offen sc1
    s_waitcnt vmcnt(0)
    v_cmp_gt_u32 vcc, 1, v11
    s_cbranch_vccz wfd_109
    s_sleep 16
    s_add_u32 s35, s35, 1
    s_cmp_lt_u32 s35, 524288
    s_cbranch_scc1 wf_108
wfd_109:
    v_mov_b32 v36, 0
    v_mov_b32 v37, 0
    v_mov_b32 v38, 0
    v_mov_b32 v39, 0
    s_cmp_lt_u32 s55, 32
    s_cbranch_scc1 p3cs_110
    s_add_u32 s36, s50, 0
    buffer_store_dwordx4 v[36:39], v1, s[4:7], s36 offen offset:0
    buffer_store_dwordx4 v[36:39], v1, s[4:7], s36 offen offset:1024
    buffer_store_dwordx4 v[36:39], v1, s[4:7], s36 offen offset:2048
    buffer_store_dwordx4 v[36:39], v1, s[4:7], s36 offen offset:3072
    s_add_u32 s36, s50, 4096
    buffer_store_dwordx4 v[36:39], v1, s[4:7], s36 offen offset:0
    buffer_store_dwordx4 v[36:39], v1, s[4:7], s36 offen offset:1024
    buffer_store_dwordx4 v[36:39], v1, s[4:7], s36 offen offset:2048
    buffer_store_dwordx4 v[36:39], v1, s[4:7], s36 offen offset:3072
    s_add_u32 s36, s50, 2097152
    buffer_store_dwordx4 v[36:39], v1, s[4:7], s36 offen offset:0
    buffer_store_dwordx4 v[36:39], v1, s[4:7], s36 offen offset:1024
    buffer_store_dwordx4 v[36:39], v1, s[4:7], s36 offen offset:2048
    buffer_store_dwordx4 v[36:39], v1, s[4:7], s36 offen offset:3072
    s_add_u32 s36, s50, 2101248
    buffer_store_dwordx4 v[36:39], v1, s[4:7], s36 offen offset:0
    buffer_store_dwordx4 v[36:39], v1, s[4:7], s36 offen offset:1024
    buffer_store_dwordx4 v[36:39], v1, s[4:7], s36 offen offset:2048
    buffer_store_dwordx4 v[36:39], v1, s[4:7], s36 offen offset:3072
    s_branch p3ce_111
p3cs_110:
    s_add_u32 s36, s50, 0
    buffer_store_dwordx4 v[36:39], v1, s[4:7], s36 offen offset:0 sc1
    buffer_store_dwordx4 v[36:39], v1, s[4:7], s36 offen offset:1024 sc1
    buffer_store_dwordx4 v[36:39], v1, s[4:7], s36 offen offset:2048 sc1
    buffer_store_dwordx4 v[36:39], v1, s[4:7], s36 offen offset:3072 sc1
    s_add_u32 s36, s50, 4096
    buffer_store_dwordx4 v[36:39], v1, s[4:7], s36 offen offset:0 sc1
    buffer_store_dwordx4 v[36:39], v1, s[4:7], s36 offen offset:1024 sc1
    buffer_store_dwordx4 v[36:39], v1, s[4:7], s36 offen offset:2048 sc1
    buffer_store_dwordx4 v[36:39], v1, s[4:7], s36 offen offset:3072 sc1
    s_add_u32 s36, s50, 2097152
    buffer_store_dwordx4 v[36:39], v1, s[4:7], s36 offen offset:0 sc1
    buffer_store_dwordx4 v[36:39], v1, s[4:7], s36 offen offset:1024 sc1
    buffer_store_dwordx4 v[36:39], v1, s[4:7], s36 offen offset:2048 sc1
    buffer_store_dwordx4 v[36:39], v1, s[4:7], s36 offen offset:3072 sc1
    s_add_u32 s36, s50, 2101248
    buffer_store_dwordx4 v[36:39], v1, s[4:7], s36 offen offset:0 sc1
    buffer_store_dwordx4 v[36:39], v1, s[4:7], s36 offen offset:1024 sc1
    buffer_store_dwordx4 v[36:39], v1, s[4:7], s36 offen offset:2048 sc1
    buffer_store_dwordx4 v[36:39], v1, s[4:7], s36 offen offset:3072 sc1
p3ce_111:
    s_waitcnt vmcnt(0)
    s_barrier
    s_lshl_b32 s36, s34, 5
    s_add_u32 s36, s36, s33
    s_lshl_b32 s36, s36, 2
    s_add_u32 s36, s36, 11796480
    s_cmp_lg_u32 s32, 0
    s_cbranch_scc1 p3q_112
    v_mov_b32 v11, 1
    buffer_store_dword v11, v2, s[4:7], s36 offen sc1
p3q_112:
    v_lshrrev_b32 v32, 4, v0
    v_and_b32 v33, 15, v0
    s_and_b32 s38, s32, 1
    s_lshl_b32 s36, s38, 12
    v_add_u32 v3, s36, v1
    v_lshrrev_b32 v34, 2, v33
    v_and_b32 v35, 1, v33
    v_lshl_add_u32 v34, v34, 1, v35
    v_bfe_u32 v35, v33, 1, 1
    v_lshlrev_b32 v35, 12, v35
    v_lshl_add_u32 v35, v32, 8, v35
    v_lshl_add_u32 v4, v34, 4, v35
    v_mul_u32_u24 v34, 288, v34
    v_lshl_add_u32 v6, v32, 4, v34
    s_lshl_b32 s36, s32, 6
    v_mul_u32_u24 v34, 576, v32
    v_lshl_add_u32 v34, v33, 2, v34
    v_add_u32 v5, s36, v34
    v_lshlrev_b32 v15, 3, v0
    s_lshl_b32 s36, s32, 9
    v_add_u32 v7, s36, v15
    v_mul_u32_u24 v34, 8448, v32
    v_lshl_add_u32 v8, v33, 4, v34
    v_and_b32 v10, 3, v0
    v_lshlrev_b32 v10, 4, v10
    s_lshl_b32 s36, s38, 4
    v_add_u32 v34, s36, v33
    v_lshlrev_b32 v35, 1, v32
    v_sub_u32 v34, v34, v35
    v_mov_b32 v35, 0xf149f2ca
    v_cmp_gt_i32 vcc, 0, v34
    s_nop 1
    v_cndmask_b32 v20, 0, v35, vcc
    v_cmp_gt_i32 vcc, 1, v34
    s_nop 1
    v_cndmask_b32 v21, 0, v35, vcc
    v_cmp_gt_i32 vcc, 16, v34
    s_nop 1
    v_cndmask_b32 v22, 0, v35, vcc
    v_cmp_gt_i32 vcc, 17, v34
    s_nop 1
    v_cndmask_b32 v23, 0, v35, vcc
    v_cmp_gt_i32 vcc, 8, v34
    s_nop 1
    v_cndmask_b32 v24, 0, v35, vcc
    v_cmp_gt_i32 vcc, 9, v34
    s_nop 1
    v_cndmask_b32 v25, 0, v35, vcc
    v_cmp_gt_i32 vcc, 24, v34
    s_nop 1
    v_cndmask_b32 v26, 0, v35, vcc
    v_cmp_gt_i32 vcc, 25, v34
    s_nop 1
    v_cndmask_b32 v27, 0, v35, vcc
    v_and_b32 v34, 1, v33
    v_lshlrev_b32 v34, 4, v34
    v_mov_b32 v35, 0x3f80
    v_lshlrev_b32 v35, v34, v35
    v_bfe_u32 v34, v33, 1, 2
    v_cmp_eq_u32 vcc, 0, v34
    s_nop 1
    v_cndmask_b32 v16, 0, v35, vcc
    v_cmp_eq_u32 vcc, 1, v34
    s_nop 1
    v_cndmask_b32 v17, 0, v35, vcc
    v_cmp_eq_u32 vcc, 2, v34
    s_nop 1
    v_cndmask_b32 v18, 0, v35, vcc
    v_cmp_eq_u32 vcc, 3, v34
    s_nop 1
    v_cndmask_b32 v19, 0, v35, vcc
    v_mov_b32 v125, 0
    v_mov_b32 v126, 0
    s_bfe_u32 s36, s33, 0x10003
    s_lshl_b32 s36, s36, 14
    s_bfe_u32 s37, s33, 0x20001
    s_lshl_b32 s37, s37, 8
    s_add_u32 s36, s36, s37
    s_lshr_b32 s37, s33, 4
    s_lshl_b32 s37, s37, 7
    s_add_u32 s36, s36, s37
    s_and_b32 s37, s33, 1
    s_lshl_b32 s37, s37, 6
    s_add_u32 s36, s36, s37
    s_lshl_b32 s37, s32, 4
    s_add_u32 s36, s36, s37
    v_lshlrev_b32 v34, 10, v33
    v_lshl_add_u32 v34, v32, 3, v34
    v_add_u32 v34, s36, v34
    v_mov_b32 v35, 0x80000000
    v_cmp_gt_u32 vcc, 2, v32
    s_nop 1
    v_cndmask_b32 v9, v35, v34, vcc
    s_bfe_u32 s36, s33, 0x20001
    s_lshl_b32 s36, s36, 13
    s_lshr_b32 s37, s33, 4
    s_lshl_b32 s37, s37, 12
    s_add_u32 s36, s36, s37
    s_and_b32 s37, s33, 1
    s_lshl_b32 s37, s37, 11
    s_add_u32 s36, s36, s37
    s_and_b32 s37, s32, 1
    s_lshl_b32 s37, s37, 10
    s_add_u32 s36, s36, s37
    s_lshr_b32 s37, s32, 1
    s_lshl_b32 s37, s37, 9
    s_add_u32 s36, s36, s37
    s_bfe_u32 s37, s33, 0x10003
    s_lshl_b32 s37, s37, 8
    s_add_u32 s36, s36, s37
    v_and_b32 v34, 1, v32
    v_lshlrev_b32 v34, 3, v34
    v_lshl_add_u32 v34, v33, 4, v34
    v_add_u32 v254, s36, v34
    s_sub_u32 s38, s34, 4
    s_mul_i32 s36, s32, 270336
    s_lshl_b32 s37, s33, 8
    s_add_u32 s36, s36, s37
    s_lshl_b32 s37, s38, 22
    s_add_u32 s36, s36, s37
    s_add_u32 s51, s36, 109051904
    s_mov_b32 s45, s38
    s_lshl_b32 s36, s33, 8
    s_add_u32 s52, s36, 11804672
    s_bfe_u32 s36, s33, 0x20001
    s_lshl_b32 s36, s36, 5
    s_lshr_b32 s37, s33, 4
    s_lshl_b32 s37, s37, 1
    s_add_u32 s36, s36, s37
    s_and_b32 s37, s33, 1
    s_add_u32 s36, s36, s37
    s_lshl_b32 s36, s36, 2
    s_add_u32 s53, s36, 11816960
    s_lshl_b32 s54, s38, 15
    s_mov_b32 s40, 0
    s_mov_b32 s43, 1
    s_mov_b32 s44, 0x3e0293ee
    v_and_b32 v34, 31, v0
    v_lshlrev_b32 v34, 2, v34
    s_lshl_b32 s38, s34, 7
    s_add_u32 s38, s38, 11796480
wf_113:
    buffer_load_dword v35, v34, s[4:7], s38 offen sc1
    s_waitcnt vmcnt(0)
    v_cmp_gt_u32 vcc, 1, v35
    s_cbranch_vccz wfd_114
    s_sleep 8
    s_add_u32 s35, s35, 1
    s_cmp_lt_u32 s35, 524288
    s_cbranch_scc1 wf_113
wfd_114:
    s_cmp_lt_u32 s55, 32
    s_cbranch_scc1 L_p3_slow
p3_115:
    s_lshr_b32 s47, s45, 1
    s_add_u32 s47, s47, 1
    s_and_b32 s39, s45, 1
    s_lshl_b32 s38, s39, 7
    s_add_u32 s38, s38, s52
    s_lshl_b32 s39, s39, 9
    s_add_u32 s39, s39, s53
wf_116:
    buffer_load_dword v11, v10, s[4:7], s38 offen sc1
    s_waitcnt vmcnt(0)
    v_cmp_gt_u32 vcc, s47, v11
    s_cbranch_vccz wfd_117
    s_sleep 2
    s_add_u32 s35, s35, 1
    s_cmp_lt_u32 s35, 524288
    s_cbranch_scc1 wf_116
wfd_117:
    s_barrier
    s_mul_i32 s37, s32, 6144
    s_mov_b32 m0, s37
    s_nop 0
    buffer_load_dwordx4 v1, s[4:7], s41 offen offset:0 sc1 lds
    buffer_load_dwordx4 v1, s[4:7], s41 offen offset:1024 sc1 lds
    buffer_load_dwordx4 v1, s[4:7], s41 offen offset:2048 sc1 lds
    s_add_u32 m0, s37, 3072
    s_add_u32 s36, s41, 3072
    buffer_load_dwordx4 v1, s[4:7], s36 offen offset:0 sc1 lds
    buffer_load_dwordx4 v1, s[4:7], s36 offen offset:1024 sc1 lds
    buffer_load_dwordx4 v1, s[4:7], s36 offen offset:2048 sc1 lds
    buffer_load_dwordx2 v[248:249], v9, s[12:15], s54 offen
    v_mov_b32 v12, 0
wf_118:
    buffer_load_dword v11, v12, s[4:7], s39 offen sc1
    s_waitcnt vmcnt(0)
    v_cmp_gt_u32 vcc, s47, v11
    s_cbranch_vccz wfd_119
    s_sleep 2
    s_add_u32 s35, s35, 1
    s_cmp_lt_u32 s35, 524288
    s_cbranch_scc1 wf_118
wfd_119:
    s_add_u32 s36, s54, 2097152
    buffer_load_dwordx2 v[250:251], v254, s[4:7], s36 offen sc1
    s_barrier
    ds_read_b128 v[28:31], v3 offset:16384
    ds_read_b128 v[32:35], v3 offset:17408
    ds_read_b128 v[36:39], v3 offset:18432
    ds_read_b128 v[40:43], v3 offset:19456
    ds_read_b128 v[44:47], v4 offset:0
    ds_read_b128 v[48:51], v4 offset:128
    ds_read_b128 v[52:55], v4 offset:1024
    ds_read_b128 v[56:59], v4 offset:1152
    ds_read_b128 v[60:63], v4 offset:2048
    ds_read_b128 v[64:67], v4 offset:2176
    ds_read_b128 v[68:71], v4 offset:3072
    ds_read_b128 v[72:75], v4 offset:3200
    s_waitcnt lgkmcnt(0)
    v_mfma_f32_16x16x32_bf16 v[108:111], v[44:47], v[28:31], v[20:23]
    ds_read_b128 v[76:79], v1 offset:8192
    v_mfma_f32_16x16x32_bf16 v[112:115], v[48:51], v[28:31], v[24:27]
    ds_read_b128 v[80:83], v1 offset:9216
    v_mfma_f32_16x16x32_bf16 v[108:111], v[52:55], v[32:35], v[108:111]
    ds_read_b128 v[84:87], v1 offset:10240
    v_mfma_f32_16x16x32_bf16 v[112:115], v[56:59], v[32:35], v[112:115]
    ds_read_b128 v[88:91], v1 offset:11264
    v_mfma_f32_16x16x32_bf16 v[108:111], v[60:63], v[36:39], v[108:111]
    ds_read_b128 v[92:95], v1 offset:12288
    v_mfma_f32_16x16x32_bf16 v[112:115], v[64:67], v[36:39], v[112:115]
    ds_read_b128 v[96:99], v1 offset:13312
    v_mfma_f32_16x16x32_bf16 v[108:111], v[68:71], v[40:43], v[108:111]
    ds_read_b128 v[100:103], v1 offset:14336
    v_mfma_f32_16x16x32_bf16 v[112:115], v[72:75], v[40:43], v[112:115]
    ds_read_b128 v[104:107], v1 offset:15360
    s_nop 2
    v_max3_f32 v11, v108, v109, v110
    s_nop 2
    v_max3_f32 v12, v112, v113, v114
    v_max3_f32 v11, v11, v111, v115
    v_max_f32 v11, v11, v12
p3k_120:
    buffer_load_dwordx4 v[216:219], v1, s[4:7], s49 offen sc1
    s_add_u32 s35, s35, 1
    s_cmp_ge_u32 s35, 524288
    s_waitcnt vmcnt(0)
    s_cbranch_scc1 p3g_121
    v_max3_u32 v12, v216, v217, v218
    v_max_u32 v12, v12, v219
    v_cmp_eq_u32 vcc, -1, v12
    s_cbranch_vccz p3g_121
    s_sleep 1
    s_branch p3k_120
p3g_121:
    ds_write_b32 v5, v216 offset:24576
    ds_write_b32 v5, v217 offset:24864
    ds_write_b64 v7, v[218:219] offset:28672
    s_waitcnt lgkmcnt(0)
    s_barrier
    ds_read_b128 v[128:131], v6 offset:24576
    ds_read_b128 v[132:135], v6 offset:24640
    ds_read_b128 v[136:139], v6 offset:24704
    ds_read_b128 v[140:143], v6 offset:24768
    ds_read_b64 v[144:145], v15 offset:28672
    ds_read_b64 v[146:147], v15 offset:29184
    ds_read_b64 v[148:149], v15 offset:29696
    ds_read_b64 v[150:151], v15 offset:30208
    s_waitcnt lgkmcnt(7)
    v_mfma_f32_16x16x32_bf16 v[116:119], v[128:131], v[28:31], 0
    s_waitcnt lgkmcnt(6)
    v_mfma_f32_16x16x32_bf16 v[116:119], v[132:135], v[32:35], v[116:119]
    s_waitcnt lgkmcnt(5)
    v_mfma_f32_16x16x32_bf16 v[116:119], v[136:139], v[36:39], v[116:119]
    s_waitcnt lgkmcnt(4)
    v_mfma_f32_16x16x32_bf16 v[116:119], v[140:143], v[40:43], v[116:119]
    s_nop 7
    v_max3_f32 v11, v11, v116, v117
    v_mov_b32 v12, v11
    s_nop 1
    v_permlane16_swap_b32 v11, v12
    v_max_f32 v11, v11, v12
    v_mov_b32 v12, v11
    s_nop 1
    v_permlane32_swap_b32 v11, v12
    v_max_f32 v11, v11, v12
    v_mul_f32 v13, s44, v11
    v_fma_f32 v108, v108, s44, -v13
    v_fma_f32 v109, v109, s44, -v13
    v_fma_f32 v110, v110, s44, -v13
    v_fma_f32 v111, v111, s44, -v13
    v_fma_f32 v112, v112, s44, -v13
    v_fma_f32 v113, v113, s44, -v13
    v_fma_f32 v114, v114, s44, -v13
    v_fma_f32 v115, v115, s44, -v13
    v_fma_f32 v116, v116, s44, -v13
    v_fma_f32 v117, v117, s44, -v13
    v_exp_f32 v108, v108
    v_exp_f32 v109, v109
    v_exp_f32 v110, v110
    v_exp_f32 v111, v111
    v_exp_f32 v112, v112
    v_exp_f32 v113, v113
    v_exp_f32 v114, v114
    v_exp_f32 v115, v115
    v_exp_f32 v116, v116
    v_exp_f32 v117, v117
    v_add_f32 v14, v108, v109
    v_add_f32 v12, v110, v111
    v_add_f32 v14, v14, v112
    v_add_f32 v12, v12, v113
    v_add_f32 v14, v14, v114
    v_add_f32 v12, v12, v115
    v_add_f32 v14, v14, v116
    v_add_f32 v12, v12, v117
    v_add_f32 v14, v14, v12
    v_mov_b32 v12, v14
    s_nop 1
    v_permlane16_swap_b32 v14, v12
    v_add_f32 v14, v14, v12
    v_mov_b32 v12, v14
    s_nop 1
    v_permlane32_swap_b32 v14, v12
    v_add_f32 v14, v14, v12
    v_rcp_f32 v14, v14
    s_nop 0
    v_mul_f32 v108, v108, v14
    v_mul_f32 v109, v109, v14
    v_mul_f32 v110, v110, v14
    v_mul_f32 v111, v111, v14
    v_mul_f32 v112, v112, v14
    v_mul_f32 v113, v113, v14
    v_mul_f32 v114, v114, v14
    v_mul_f32 v115, v115, v14
    v_mul_f32 v116, v116, v14
    v_mul_f32 v117, v117, v14
    v_cvt_pk_bf16_f32 v120, v108, v109
    v_cvt_pk_bf16_f32 v121, v110, v111
    v_cvt_pk_bf16_f32 v122, v112, v113
    v_cvt_pk_bf16_f32 v123, v114, v115
    v_cvt_pk_bf16_f32 v124, v116, v117
    v_cvt_pk_bf16_f32 v127, v116, v117
    s_waitcnt lgkmcnt(0)
    v_mfma_f32_16x16x32_bf16 v[152:155], v[76:79], v[120:123], 0
    v_mfma_f32_16x16x32_bf16 v[156:159], v[80:83], v[120:123], 0
    v_mfma_f32_16x16x32_bf16 v[160:163], v[84:87], v[120:123], 0
    v_mfma_f32_16x16x32_bf16 v[164:167], v[88:91], v[120:123], 0
    v_mfma_f32_16x16x32_bf16 v[168:171], v[92:95], v[120:123], 0
    v_mfma_f32_16x16x32_bf16 v[172:175], v[96:99], v[120:123], 0
    v_mfma_f32_16x16x32_bf16 v[176:179], v[100:103], v[120:123], 0
    v_mfma_f32_16x16x32_bf16 v[180:183], v[104:107], v[120:123], 0
    v_mfma_f32_16x16x16_bf16 v[152:155], v[144:145], v[124:125], v[152:155]
    v_mfma_f32_16x16x16_bf16 v[156:159], v[144:145], v[126:127], v[156:159]
    v_mfma_f32_16x16x16_bf16 v[160:163], v[146:147], v[124:125], v[160:163]
    v_mfma_f32_16x16x16_bf16 v[164:167], v[146:147], v[126:127], v[164:167]
    v_cvt_pk_bf16_f32 v184, v152, v153
    v_cvt_pk_bf16_f32 v185, v154, v155
    v_mfma_f32_16x16x16_bf16 v[168:171], v[148:149], v[124:125], v[168:171]
    v_cvt_pk_bf16_f32 v186, v156, v157
    v_cvt_pk_bf16_f32 v187, v158, v159
    v_mfma_f32_16x16x16_bf16 v[172:175], v[148:149], v[126:127], v[172:175]
    v_cvt_pk_bf16_f32 v188, v160, v161
    v_cvt_pk_bf16_f32 v189, v162, v163
    v_mfma_f32_16x16x16_bf16 v[176:179], v[150:151], v[124:125], v[176:179]
    v_cvt_pk_bf16_f32 v190, v164, v165
    v_cvt_pk_bf16_f32 v191, v166, v167
    v_mfma_f32_16x16x16_bf16 v[180:183], v[150:151], v[126:127], v[180:183]
    v_cvt_pk_bf16_f32 v192, v168, v169
    v_cvt_pk_bf16_f32 v193, v170, v171
    v_cvt_pk_bf16_f32 v194, v172, v173
    v_cvt_pk_bf16_f32 v195, v174, v175
    v_cvt_pk_bf16_f32 v196, v176, v177
    v_cvt_pk_bf16_f32 v197, v178, v179
    s_nop 0
    v_cvt_pk_bf16_f32 v198, v180, v181
    v_cvt_pk_bf16_f32 v199, v182, v183
    s_mov_b32 s36, s51
    v_mfma_f32_16x16x32_bf16 v[200:203], a[0:3], v[184:187], 0
    v_mfma_f32_16x16x32_bf16 v[204:207], a[16:19], v[184:187], 0
    v_mfma_f32_16x16x32_bf16 v[200:203], a[4:7], v[188:191], v[200:203]
    v_mfma_f32_16x16x32_bf16 v[204:207], a[20:23], v[188:191], v[204:207]
    v_mfma_f32_16x16x32_bf16 v[200:203], a[8:11], v[192:195], v[200:203]
    v_mfma_f32_16x16x32_bf16 v[204:207], a[24:27], v[192:195], v[204:207]
    v_mfma_f32_16x16x32_bf16 v[200:203], a[12:15], v[196:199], v[200:203]
    v_mfma_f32_16x16x32_bf16 v[204:207], a[28:31], v[196:199], v[204:207]
    v_mfma_f32_16x16x32_bf16 v[208:211], a[32:35], v[184:187], 0
    v_mfma_f32_16x16x32_bf16 v[212:215], a[48:51], v[184:187], 0
    v_mfma_f32_16x16x32_bf16 v[208:211], a[36:39], v[188:191], v[208:211]
    v_cvt_pk_bf16_f32 v152, v200, v201
    v_cvt_pk_bf16_f32 v153, v202, v203
    v_mfma_f32_16x16x32_bf16 v[212:215], a[52:55], v[188:191], v[212:215]
    v_cvt_pk_bf16_f32 v154, v204, v205
    v_cvt_pk_bf16_f32 v155, v206, v207
    v_mfma_f32_16x16x32_bf16 v[208:211], a[40:43], v[192:195], v[208:211]
    v_and_or_b32 v152, v152, -2, s43
    v_and_or_b32 v154, v154, -2, s43
    v_mfma_f32_16x16x32_bf16 v[212:215], a[56:59], v[192:195], v[212:215]
    buffer_store_dwordx4 v[152:155], v8, s[4:7], s36 offen
    s_add_u32 s36, s36, 33792
    v_mfma_f32_16x16x32_bf16 v[208:211], a[44:47], v[196:199], v[208:211]
    v_mfma_f32_16x16x32_bf16 v[212:215], a[60:63], v[196:199], v[212:215]
    v_mfma_f32_16x16x32_bf16 v[200:203], a[64:67], v[184:187], 0
    v_mfma_f32_16x16x32_bf16 v[204:207], a[80:83], v[184:187], 0
    v_mfma_f32_16x16x32_bf16 v[200:203], a[68:71], v[188:191], v[200:203]
    v_cvt_pk_bf16_f32 v156, v208, v209
    v_cvt_pk_bf16_f32 v157, v210, v211
    v_mfma_f32_16x16x32_bf16 v[204:207], a[84:87], v[188:191], v[204:207]
    v_cvt_pk_bf16_f32 v158, v212, v213
    v_cvt_pk_bf16_f32 v159, v214, v215
    v_mfma_f32_16x16x32_bf16 v[200:203], a[72:75], v[192:195], v[200:203]
    v_and_or_b32 v156, v156, -2, s43
    v_and_or_b32 v158, v158, -2, s43
    v_mfma_f32_16x16x32_bf16 v[204:207], a[88:91], v[192:195], v[204:207]
    buffer_store_dwordx4 v[156:159], v8, s[4:7], s36 offen
    s_add_u32 s36, s36, 33792
    v_mfma_f32_16x16x32_bf16 v[200:203], a[76:79], v[196:199], v[200:203]
    v_mfma_f32_16x16x32_bf16 v[204:207], a[92:95], v[196:199], v[204:207]
    v_mfma_f32_16x16x32_bf16 v[208:211], a[96:99], v[184:187], 0
    v_mfma_f32_16x16x32_bf16 v[212:215], a[112:115], v[184:187], 0
    v_mfma_f32_16x16x32_bf16 v[208:211], a[100:103], v[188:191], v[208:211]
    v_cvt_pk_bf16_f32 v160, v200, v201
    v_cvt_pk_bf16_f32 v161, v202, v203
    v_mfma_f32_16x16x32_bf16 v[212:215], a[116:119], v[188:191], v[212:215]
    v_cvt_pk_bf16_f32 v162, v204, v205
    v_cvt_pk_bf16_f32 v163, v206, v207
    v_mfma_f32_16x16x32_bf16 v[208:211], a[104:107], v[192:195], v[208:211]
    v_and_or_b32 v160, v160, -2, s43
    v_and_or_b32 v162, v162, -2, s43
    v_mfma_f32_16x16x32_bf16 v[212:215], a[120:123], v[192:195], v[212:215]
    buffer_store_dwordx4 v[160:163], v8, s[4:7], s36 offen
    s_add_u32 s36, s36, 33792
    v_mfma_f32_16x16x32_bf16 v[208:211], a[108:111], v[196:199], v[208:211]
    v_mfma_f32_16x16x32_bf16 v[212:215], a[124:127], v[196:199], v[212:215]
    v_mfma_f32_16x16x32_bf16 v[200:203], a[128:131], v[184:187], 0
    v_mfma_f32_16x16x32_bf16 v[204:207], a[144:147], v[184:187], 0
    v_mfma_f32_16x16x32_bf16 v[200:203], a[132:135], v[188:191], v[200:203]
    v_cvt_pk_bf16_f32 v164, v208, v209
    v_cvt_pk_bf16_f32 v165, v210, v211
    v_mfma_f32_16x16x32_bf16 v[204:207], a[148:151], v[188:191], v[204:207]
    v_cvt_pk_bf16_f32 v166, v212, v213
    v_cvt_pk_bf16_f32 v167, v214, v215
    v_mfma_f32_16x16x32_bf16 v[200:203], a[136:139], v[192:195], v[200:203]
    v_and_or_b32 v164, v164, -2, s43
    v_and_or_b32 v166, v166, -2, s43
    v_mfma_f32_16x16x32_bf16 v[204:207], a[152:155], v[192:195], v[204:207]
    buffer_store_dwordx4 v[164:167], v8, s[4:7], s36 offen
    s_add_u32 s36, s36, 33792
    v_mfma_f32_16x16x32_bf16 v[200:203], a[140:143], v[196:199], v[200:203]
    v_mfma_f32_16x16x32_bf16 v[204:207], a[156:159], v[196:199], v[204:207]
    v_mfma_f32_16x16x32_bf16 v[208:211], a[160:163], v[184:187], 0
    v_mfma_f32_16x16x32_bf16 v[212:215], a[176:179], v[184:187], 0
    v_mfma_f32_16x16x32_bf16 v[208:211], a[164:167], v[188:191], v[208:211]
    v_cvt_pk_bf16_f32 v168, v200, v201
    v_cvt_pk_bf16_f32 v169, v202, v203
    v_mfma_f32_16x16x32_bf16 v[212:215], a[180:183], v[188:191], v[212:215]
    v_cvt_pk_bf16_f32 v170, v204, v205
    v_cvt_pk_bf16_f32 v171, v206, v207
    v_mfma_f32_16x16x32_bf16 v[208:211], a[168:171], v[192:195], v[208:211]
    v_and_or_b32 v168, v168, -2, s43
    v_and_or_b32 v170, v170, -2, s43
    v_mfma_f32_16x16x32_bf16 v[212:215], a[184:187], v[192:195], v[212:215]
    buffer_store_dwordx4 v[168:171], v8, s[4:7], s36 offen
    s_add_u32 s36, s36, 33792
    v_mfma_f32_16x16x32_bf16 v[208:211], a[172:175], v[196:199], v[208:211]
    v_mfma_f32_16x16x32_bf16 v[212:215], a[188:191], v[196:199], v[212:215]
    v_mfma_f32_16x16x32_bf16 v[200:203], a[192:195], v[184:187], 0
    v_mfma_f32_16x16x32_bf16 v[204:207], a[208:211], v[184:187], 0
    v_mfma_f32_16x16x32_bf16 v[200:203], a[196:199], v[188:191], v[200:203]
    v_cvt_pk_bf16_f32 v172, v208, v209
    v_cvt_pk_bf16_f32 v173, v210, v211
    v_mfma_f32_16x16x32_bf16 v[204:207], a[212:215], v[188:191], v[204:207]
    v_cvt_pk_bf16_f32 v174, v212, v213
    v_cvt_pk_bf16_f32 v175, v214, v215
    v_mfma_f32_16x16x32_bf16 v[200:203], a[200:203], v[192:195], v[200:203]
    v_and_or_b32 v172, v172, -2, s43
    v_and_or_b32 v174, v174, -2, s43
    v_mfma_f32_16x16x32_bf16 v[204:207], a[216:219], v[192:195], v[204:207]
    buffer_store_dwordx4 v[172:175], v8, s[4:7], s36 offen
    s_add_u32 s36, s36, 33792
    v_mfma_f32_16x16x32_bf16 v[200:203], a[204:207], v[196:199], v[200:203]
    v_mfma_f32_16x16x32_bf16 v[204:207], a[220:223], v[196:199], v[204:207]
    v_mfma_f32_16x16x32_bf16 v[208:211], a[224:227], v[184:187], 0
    v_mfma_f32_16x16x32_bf16 v[212:215], a[240:243], v[184:187], 0
    v_mfma_f32_16x16x32_bf16 v[208:211], a[228:231], v[188:191], v[208:211]
    v_cvt_pk_bf16_f32 v176, v200, v201
    v_cvt_pk_bf16_f32 v177, v202, v203
    v_mfma_f32_16x16x32_bf16 v[212:215], a[244:247], v[188:191], v[212:215]
    v_cvt_pk_bf16_f32 v178, v204, v205
    v_cvt_pk_bf16_f32 v179, v206, v207
    v_mfma_f32_16x16x32_bf16 v[208:211], a[232:235], v[192:195], v[208:211]
    v_and_or_b32 v176, v176, -2, s43
    v_and_or_b32 v178, v178, -2, s43
    v_mfma_f32_16x16x32_bf16 v[212:215], a[248:251], v[192:195], v[212:215]
    buffer_store_dwordx4 v[176:179], v8, s[4:7], s36 offen
    s_add_u32 s36, s36, 33792
    v_mfma_f32_16x16x32_bf16 v[208:211], a[236:239], v[196:199], v[208:211]
    v_mfma_f32_16x16x32_bf16 v[212:215], a[252:255], v[196:199], v[212:215]
    s_nop 3
    v_cvt_pk_bf16_f32 v180, v208, v209
    v_cvt_pk_bf16_f32 v181, v210, v211
    s_nop 1
    v_cvt_pk_bf16_f32 v182, v212, v213
    v_cvt_pk_bf16_f32 v183, v214, v215
    v_and_or_b32 v180, v180, -2, s43
    v_and_or_b32 v182, v182, -2, s43
    buffer_store_dwordx4 v[180:183], v8, s[4:7], s36 offen
    s_add_u32 s36, s36, 33792
    s_add_u32 s37, s50, 4096
    s_waitcnt vmcnt(0)
p3r_122:
    buffer_load_dwordx4 v[216:219], v1, s[4:7], s50 offen offset:0 sc1
    buffer_load_dwordx4 v[220:223], v1, s[4:7], s50 offen offset:1024 sc1
    buffer_load_dwordx4 v[224:227], v1, s[4:7], s50 offen offset:2048 sc1
    buffer_load_dwordx4 v[228:231], v1, s[4:7], s50 offen offset:3072 sc1
    buffer_load_dwordx4 v[232:235], v1, s[4:7], s37 offen offset:0 sc1
    buffer_load_dwordx4 v[236:239], v1, s[4:7], s37 offen offset:1024 sc1
    buffer_load_dwordx4 v[240:243], v1, s[4:7], s37 offen offset:2048 sc1
    buffer_load_dwordx4 v[244:247], v1, s[4:7], s37 offen offset:3072 sc1
    s_add_u32 s35, s35, 1
    s_cmp_ge_u32 s35, 524288
    s_waitcnt vmcnt(7)
    v_mfma_f32_16x16x32_bf16 v[108:111], v[16:19], v[216:219], 0
    v_bitop3_b32 v44, v216, v218, s43 bitop3:0x7e
    s_waitcnt vmcnt(6)
    v_mfma_f32_16x16x32_bf16 v[108:111], v[16:19], v[220:223], v[108:111]
    v_bitop3_b32 v45, v220, v222, s43 bitop3:0x7e
    v_or_b32 v44, v44, v45
    s_waitcnt vmcnt(5)
    v_mfma_f32_16x16x32_bf16 v[108:111], v[16:19], v[224:227], v[108:111]
    v_bitop3_b32 v45, v224, v226, s43 bitop3:0x7e
    v_or_b32 v44, v44, v45
    s_waitcnt vmcnt(4)
    v_mfma_f32_16x16x32_bf16 v[108:111], v[16:19], v[228:231], v[108:111]
    v_bitop3_b32 v45, v228, v230, s43 bitop3:0x7e
    v_or_b32 v44, v44, v45
    s_waitcnt vmcnt(3)
    v_mfma_f32_16x16x32_bf16 v[108:111], v[16:19], v[232:235], v[108:111]
    v_bitop3_b32 v45, v232, v234, s43 bitop3:0x7e
    v_or_b32 v44, v44, v45
    s_waitcnt vmcnt(2)
    v_mfma_f32_16x16x32_bf16 v[108:111], v[16:19], v[236:239], v[108:111]
    v_bitop3_b32 v45, v236, v238, s43 bitop3:0x7e
    v_or_b32 v44, v44, v45
    s_waitcnt vmcnt(1)
    v_mfma_f32_16x16x32_bf16 v[108:111], v[16:19], v[240:243], v[108:111]
    v_bitop3_b32 v45, v240, v242, s43 bitop3:0x7e
    v_or_b32 v44, v44, v45
    s_waitcnt vmcnt(0)
    v_mfma_f32_16x16x32_bf16 v[108:111], v[16:19], v[244:247], v[108:111]
    v_bitop3_b32 v45, v244, v246, s43 bitop3:0x7e
    v_or_b32 v44, v44, v45
    s_cbranch_scc1 p3f_123
    v_and_b32 v44, 1, v44
    v_cmp_ne_u32 vcc, 0, v44
    s_cbranch_vccnz p3r_122
p3f_123:
    s_nop 4
    v_cvt_pk_bf16_f32 v49, v108, v109
    v_lshlrev_b32 v48, 16, v49
    v_and_b32 v49, 0xffff0000, v49
    v_lshlrev_b32 v50, 16, v250
    v_and_b32 v51, 0xffff0000, v250
    v_mul_f32 v48, v48, v50
    v_mul_f32 v49, v49, v51
    v_cvt_pk_bf16_f32 v49, v48, v49
    v_lshlrev_b32 v48, 16, v49
    v_and_b32 v49, 0xffff0000, v49
    v_lshlrev_b32 v50, 16, v248
    v_and_b32 v51, 0xffff0000, v248
    v_add_f32 v48, v48, v50
    v_add_f32 v49, v49, v51
    v_cvt_pk_bf16_f32 v252, v48, v49
    v_cvt_pk_bf16_f32 v49, v110, v111
    v_lshlrev_b32 v48, 16, v49
    v_and_b32 v49, 0xffff0000, v49
    v_lshlrev_b32 v50, 16, v251
    v_and_b32 v51, 0xffff0000, v251
    v_mul_f32 v48, v48, v50
    v_mul_f32 v49, v49, v51
    v_cvt_pk_bf16_f32 v49, v48, v49
    v_lshlrev_b32 v48, 16, v49
    v_and_b32 v49, 0xffff0000, v49
    v_lshlrev_b32 v50, 16, v249
    v_and_b32 v51, 0xffff0000, v249
    v_add_f32 v48, v48, v50
    v_add_f32 v49, v49, v51
    v_cvt_pk_bf16_f32 v253, v48, v49
    buffer_store_dwordx2 v[252:253], v9, s[20:23], s54 offen
    s_xor_b32 s51, s51, 2097152
    s_xor_b32 s50, s50, 2097152
    s_and_b32 s36, s40, 1
    s_xor_b32 s43, s43, s36
    s_add_u32 s49, s49, 98304
    s_add_u32 s41, s41, 98304
    s_add_u32 s54, s54, 98304
    s_add_u32 s45, s45, 3
    s_add_u32 s40, s40, 1
    s_cmp_lt_u32 s45, 64
    s_cbranch_scc1 p3_115
    s_branch L_exit
L_p3_slow:
p3_124:
    s_lshr_b32 s47, s45, 1
    s_add_u32 s47, s47, 1
    s_and_b32 s39, s45, 1
    s_lshl_b32 s38, s39, 7
    s_add_u32 s38, s38, s52
    s_lshl_b32 s39, s39, 9
    s_add_u32 s39, s39, s53
wf_125:
    buffer_load_dword v11, v10, s[4:7], s38 offen sc1
    s_waitcnt vmcnt(0)
    v_cmp_gt_u32 vcc, s47, v11
    s_cbranch_vccz wfd_126
    s_sleep 2
    s_add_u32 s35, s35, 1
    s_cmp_lt_u32 s35, 524288
    s_cbranch_scc1 wf_125
wfd_126:
    s_barrier
    s_mul_i32 s37, s32, 6144
    s_mov_b32 m0, s37
    s_nop 0
    buffer_load_dwordx4 v1, s[4:7], s41 offen offset:0 sc1 lds
    buffer_load_dwordx4 v1, s[4:7], s41 offen offset:1024 sc1 lds
    buffer_load_dwordx4 v1, s[4:7], s41 offen offset:2048 sc1 lds
    s_add_u32 m0, s37, 3072
    s_add_u32 s36, s41, 3072
    buffer_load_dwordx4 v1, s[4:7], s36 offen offset:0 sc1 lds
    buffer_load_dwordx4 v1, s[4:7], s36 offen offset:1024 sc1 lds
    buffer_load_dwordx4 v1, s[4:7], s36 offen offset:2048 sc1 lds
    buffer_load_dwordx2 v[248:249], v9, s[12:15], s54 offen
    v_mov_b32 v12, 0
wf_127:
    buffer_load_dword v11, v12, s[4:7], s39 offen sc1
    s_waitcnt vmcnt(0)
    v_cmp_gt_u32 vcc, s47, v11
    s_cbranch_vccz wfd_128
    s_sleep 2
    s_add_u32 s35, s35, 1
    s_cmp_lt_u32 s35, 524288
    s_cbranch_scc1 wf_127
wfd_128:
    s_add_u32 s36, s54, 2097152
    buffer_load_dwordx2 v[250:251], v254, s[4:7], s36 offen sc1
    s_barrier
    ds_read_b128 v[28:31], v3 offset:16384
    ds_read_b128 v[32:35], v3 offset:17408
    ds_read_b128 v[36:39], v3 offset:18432
    ds_read_b128 v[40:43], v3 offset:19456
    ds_read_b128 v[44:47], v4 offset:0
    ds_read_b128 v[48:51], v4 offset:128
    ds_read_b128 v[52:55], v4 offset:1024
    ds_read_b128 v[56:59], v4 offset:1152
    ds_read_b128 v[60:63], v4 offset:2048
    ds_read_b128 v[64:67], v4 offset:2176
    ds_read_b128 v[68:71], v4 offset:3072
    ds_read_b128 v[72:75], v4 offset:3200
    s_waitcnt lgkmcnt(0)
    v_mfma_f32_16x16x32_bf16 v[108:111], v[44:47], v[28:31], v[20:23]
    ds_read_b128 v[76:79], v1 offset:8192
    v_mfma_f32_16x16x32_bf16 v[112:115], v[48:51], v[28:31], v[24:27]
    ds_read_b128 v[80:83], v1 offset:9216
    v_mfma_f32_16x16x32_bf16 v[108:111], v[52:55], v[32:35], v[108:111]
    ds_read_b128 v[84:87], v1 offset:10240
    v_mfma_f32_16x16x32_bf16 v[112:115], v[56:59], v[32:35], v[112:115]
    ds_read_b128 v[88:91], v1 offset:11264
    v_mfma_f32_16x16x32_bf16 v[108:111], v[60:63], v[36:39], v[108:111]
    ds_read_b128 v[92:95], v1 offset:12288
    v_mfma_f32_16x16x32_bf16 v[112:115], v[64:67], v[36:39], v[112:115]
    ds_read_b128 v[96:99], v1 offset:13312
    v_mfma_f32_16x16x32_bf16 v[108:111], v[68:71], v[40:43], v[108:111]
    ds_read_b128 v[100:103], v1 offset:14336
    v_mfma_f32_16x16x32_bf16 v[112:115], v[72:75], v[40:43], v[112:115]
    ds_read_b128 v[104:107], v1 offset:15360
    s_nop 2
    v_max3_f32 v11, v108, v109, v110
    s_nop 2
    v_max3_f32 v12, v112, v113, v114
    v_max3_f32 v11, v11, v111, v115
    v_max_f32 v11, v11, v12
p3k_129:
    buffer_load_dwordx4 v[216:219], v1, s[4:7], s49 offen sc1
    s_add_u32 s35, s35, 1
    s_cmp_ge_u32 s35, 524288
    s_waitcnt vmcnt(0)
    s_cbranch_scc1 p3g_130
    v_max3_u32 v12, v216, v217, v218
    v_max_u32 v12, v12, v219
    v_cmp_eq_u32 vcc, -1, v12
    s_cbranch_vccz p3g_130
    s_sleep 1
    s_branch p3k_129
p3g_130:
    ds_write_b32 v5, v216 offset:24576
    ds_write_b32 v5, v217 offset:24864
    ds_write_b64 v7, v[218:219] offset:28672
    s_waitcnt lgkmcnt(0)
    s_barrier
    ds_read_b128 v[128:131], v6 offset:24576
    ds_read_b128 v[132:135], v6 offset:24640
    ds_read_b128 v[136:139], v6 offset:24704
    ds_read_b128 v[140:143], v6 offset:24768
    ds_read_b64 v[144:145], v15 offset:28672
    ds_read_b64 v[146:147], v15 offset:29184
    ds_read_b64 v[148:149], v15 offset:29696
    ds_read_b64 v[150:151], v15 offset:30208
    s_waitcnt lgkmcnt(7)
    v_mfma_f32_16x16x32_bf16 v[116:119], v[128:131], v[28:31], 0
    s_waitcnt lgkmcnt(6)
    v_mfma_f32_16x16x32_bf16 v[116:119], v[132:135], v[32:35], v[116:119]
    s_waitcnt lgkmcnt(5)
    v_mfma_f32_16x16x32_bf16 v[116:119], v[136:139], v[36:39], v[116:119]
    s_waitcnt lgkmcnt(4)
    v_mfma_f32_16x16x32_bf16 v[116:119], v[140:143], v[40:43], v[116:119]
    s_nop 7
    v_max3_f32 v11, v11, v116, v117
    v_mov_b32 v12, v11
    s_nop 1
    v_permlane16_swap_b32 v11, v12
    v_max_f32 v11, v11, v12
    v_mov_b32 v12, v11
    s_nop 1
    v_permlane32_swap_b32 v11, v12
    v_max_f32 v11, v11, v12
    v_mul_f32 v13, s44, v11
    v_fma_f32 v108, v108, s44, -v13
    v_fma_f32 v109, v109, s44, -v13
    v_fma_f32 v110, v110, s44, -v13
    v_fma_f32 v111, v111, s44, -v13
    v_fma_f32 v112, v112, s44, -v13
    v_fma_f32 v113, v113, s44, -v13
    v_fma_f32 v114, v114, s44, -v13
    v_fma_f32 v115, v115, s44, -v13
    v_fma_f32 v116, v116, s44, -v13
    v_fma_f32 v117, v117, s44, -v13
    v_exp_f32 v108, v108
    v_exp_f32 v109, v109
    v_exp_f32 v110, v110
    v_exp_f32 v111, v111
    v_exp_f32 v112, v112
    v_exp_f32 v113, v113
    v_exp_f32 v114, v114
    v_exp_f32 v115, v115
    v_exp_f32 v116, v116
    v_exp_f32 v117, v117
    v_add_f32 v14, v108, v109
    v_add_f32 v12, v110, v111
    v_add_f32 v14, v14, v112
    v_add_f32 v12, v12, v113
    v_add_f32 v14, v14, v114
    v_add_f32 v12, v12, v115
    v_add_f32 v14, v14, v116
    v_add_f32 v12, v12, v117
    v_add_f32 v14, v14, v12
    v_mov_b32 v12, v14
    s_nop 1
    v_permlane16_swap_b32 v14, v12
    v_add_f32 v14, v14, v12
    v_mov_b32 v12, v14
    s_nop 1
    v_permlane32_swap_b32 v14, v12
    v_add_f32 v14, v14, v12
    v_rcp_f32 v14, v14
    s_nop 0
    v_mul_f32 v108, v108, v14
    v_mul_f32 v109, v109, v14
    v_mul_f32 v110, v110, v14
    v_mul_f32 v111, v111, v14
    v_mul_f32 v112, v112, v14
    v_mul_f32 v113, v113, v14
    v_mul_f32 v114, v114, v14
    v_mul_f32 v115, v115, v14
    v_mul_f32 v116, v116, v14
    v_mul_f32 v117, v117, v14
    v_cvt_pk_bf16_f32 v120, v108, v109
    v_cvt_pk_bf16_f32 v121, v110, v111
    v_cvt_pk_bf16_f32 v122, v112, v113
    v_cvt_pk_bf16_f32 v123, v114, v115
    v_cvt_pk_bf16_f32 v124, v116, v117
    v_cvt_pk_bf16_f32 v127, v116, v117
    s_waitcnt lgkmcnt(0)
    v_mfma_f32_16x16x32_bf16 v[152:155], v[76:79], v[120:123], 0
    v_mfma_f32_16x16x32_bf16 v[156:159], v[80:83], v[120:123], 0
    v_mfma_f32_16x16x32_bf16 v[160:163], v[84:87], v[120:123], 0
    v_mfma_f32_16x16x32_bf16 v[164:167], v[88:91], v[120:123], 0
    v_mfma_f32_16x16x32_bf16 v[168:171], v[92:95], v[120:123], 0
    v_mfma_f32_16x16x32_bf16 v[172:175], v[96:99], v[120:123], 0
    v_mfma_f32_16x16x32_bf16 v[176:179], v[100:103], v[120:123], 0
    v_mfma_f32_16x16x32_bf16 v[180:183], v[104:107], v[120:123], 0
    v_mfma_f32_16x16x16_bf16 v[152:155], v[144:145], v[124:125], v[152:155]
    v_mfma_f32_16x16x16_bf16 v[156:159], v[144:145], v[126:127], v[156:159]
    v_mfma_f32_16x16x16_bf16 v[160:163], v[146:147], v[124:125], v[160:163]
    v_mfma_f32_16x16x16_bf16 v[164:167], v[146:147], v[126:127], v[164:167]
    v_cvt_pk_bf16_f32 v184, v152, v153
    v_cvt_pk_bf16_f32 v185, v154, v155
    v_mfma_f32_16x16x16_bf16 v[168:171], v[148:149], v[124:125], v[168:171]
    v_cvt_pk_bf16_f32 v186, v156, v157
    v_cvt_pk_bf16_f32 v187, v158, v159
    v_mfma_f32_16x16x16_bf16 v[172:175], v[148:149], v[126:127], v[172:175]
    v_cvt_pk_bf16_f32 v188, v160, v161
    v_cvt_pk_bf16_f32 v189, v162, v163
    v_mfma_f32_16x16x16_bf16 v[176:179], v[150:151], v[124:125], v[176:179]
    v_cvt_pk_bf16_f32 v190, v164, v165
    v_cvt_pk_bf16_f32 v191, v166, v167
    v_mfma_f32_16x16x16_bf16 v[180:183], v[150:151], v[126:127], v[180:183]
    v_cvt_pk_bf16_f32 v192, v168, v169
    v_cvt_pk_bf16_f32 v193, v170, v171
    v_cvt_pk_bf16_f32 v194, v172, v173
    v_cvt_pk_bf16_f32 v195, v174, v175
    v_cvt_pk_bf16_f32 v196, v176, v177
    v_cvt_pk_bf16_f32 v197, v178, v179
    s_nop 0
    v_cvt_pk_bf16_f32 v198, v180, v181
    v_cvt_pk_bf16_f32 v199, v182, v183
    s_mov_b32 s36, s51
    v_mfma_f32_16x16x32_bf16 v[200:203], a[0:3], v[184:187], 0
    v_mfma_f32_16x16x32_bf16 v[204:207], a[16:19], v[184:187], 0
    v_mfma_f32_16x16x32_bf16 v[200:203], a[4:7], v[188:191], v[200:203]
    v_mfma_f32_16x16x32_bf16 v[204:207], a[20:23], v[188:191], v[204:207]
    v_mfma_f32_16x16x32_bf16 v[200:203], a[8:11], v[192:195], v[200:203]
    v_mfma_f32_16x16x32_bf16 v[204:207], a[24:27], v[192:195], v[204:207]
    v_mfma_f32_16x16x32_bf16 v[200:203], a[12:15], v[196:199], v[200:203]
    v_mfma_f32_16x16x32_bf16 v[204:207], a[28:31], v[196:199], v[204:207]
    v_mfma_f32_16x16x32_bf16 v[208:211], a[32:35], v[184:187], 0
    v_mfma_f32_16x16x32_bf16 v[212:215], a[48:51], v[184:187], 0
    v_mfma_f32_16x16x32_bf16 v[208:211], a[36:39], v[188:191], v[208:211]
    v_cvt_pk_bf16_f32 v152, v200, v201
    v_cvt_pk_bf16_f32 v153, v202, v203
    v_mfma_f32_16x16x32_bf16 v[212:215], a[52:55], v[188:191], v[212:215]
    v_cvt_pk_bf16_f32 v154, v204, v205
    v_cvt_pk_bf16_f32 v155, v206, v207
    v_mfma_f32_16x16x32_bf16 v[208:211], a[40:43], v[192:195], v[208:211]
    v_and_or_b32 v152, v152, -2, s43
    v_and_or_b32 v154, v154, -2, s43
    v_mfma_f32_16x16x32_bf16 v[212:215], a[56:59], v[192:195], v[212:215]
    buffer_store_dwordx4 v[152:155], v8, s[4:7], s36 offen sc1
    s_add_u32 s36, s36, 33792
    v_mfma_f32_16x16x32_bf16 v[208:211], a[44:47], v[196:199], v[208:211]
    v_mfma_f32_16x16x32_bf16 v[212:215], a[60:63], v[196:199], v[212:215]
    v_mfma_f32_16x16x32_bf16 v[200:203], a[64:67], v[184:187], 0
    v_mfma_f32_16x16x32_bf16 v[204:207], a[80:83], v[184:187], 0
    v_mfma_f32_16x16x32_bf16 v[200:203], a[68:71], v[188:191], v[200:203]
    v_cvt_pk_bf16_f32 v156, v208, v209
    v_cvt_pk_bf16_f32 v157, v210, v211
    v_mfma_f32_16x16x32_bf16 v[204:207], a[84:87], v[188:191], v[204:207]
    v_cvt_pk_bf16_f32 v158, v212, v213
    v_cvt_pk_bf16_f32 v159, v214, v215
    v_mfma_f32_16x16x32_bf16 v[200:203], a[72:75], v[192:195], v[200:203]
    v_and_or_b32 v156, v156, -2, s43
    v_and_or_b32 v158, v158, -2, s43
    v_mfma_f32_16x16x32_bf16 v[204:207], a[88:91], v[192:195], v[204:207]
    buffer_store_dwordx4 v[156:159], v8, s[4:7], s36 offen sc1
    s_add_u32 s36, s36, 33792
    v_mfma_f32_16x16x32_bf16 v[200:203], a[76:79], v[196:199], v[200:203]
    v_mfma_f32_16x16x32_bf16 v[204:207], a[92:95], v[196:199], v[204:207]
    v_mfma_f32_16x16x32_bf16 v[208:211], a[96:99], v[184:187], 0
    v_mfma_f32_16x16x32_bf16 v[212:215], a[112:115], v[184:187], 0
    v_mfma_f32_16x16x32_bf16 v[208:211], a[100:103], v[188:191], v[208:211]
    v_cvt_pk_bf16_f32 v160, v200, v201
    v_cvt_pk_bf16_f32 v161, v202, v203
    v_mfma_f32_16x16x32_bf16 v[212:215], a[116:119], v[188:191], v[212:215]
    v_cvt_pk_bf16_f32 v162, v204, v205
    v_cvt_pk_bf16_f32 v163, v206, v207
    v_mfma_f32_16x16x32_bf16 v[208:211], a[104:107], v[192:195], v[208:211]
    v_and_or_b32 v160, v160, -2, s43
    v_and_or_b32 v162, v162, -2, s43
    v_mfma_f32_16x16x32_bf16 v[212:215], a[120:123], v[192:195], v[212:215]
    buffer_store_dwordx4 v[160:163], v8, s[4:7], s36 offen sc1
    s_add_u32 s36, s36, 33792
    v_mfma_f32_16x16x32_bf16 v[208:211], a[108:111], v[196:199], v[208:211]
    v_mfma_f32_16x16x32_bf16 v[212:215], a[124:127], v[196:199], v[212:215]
    v_mfma_f32_16x16x32_bf16 v[200:203], a[128:131], v[184:187], 0
    v_mfma_f32_16x16x32_bf16 v[204:207], a[144:147], v[184:187], 0
    v_mfma_f32_16x16x32_bf16 v[200:203], a[132:135], v[188:191], v[200:203]
    v_cvt_pk_bf16_f32 v164, v208, v209
    v_cvt_pk_bf16_f32 v165, v210, v211
    v_mfma_f32_16x16x32_bf16 v[204:207], a[148:151], v[188:191], v[204:207]
    v_cvt_pk_bf16_f32 v166, v212, v213
    v_cvt_pk_bf16_f32 v167, v214, v215
    v_mfma_f32_16x16x32_bf16 v[200:203], a[136:139], v[192:195], v[200:203]
    v_and_or_b32 v164, v164, -2, s43
    v_and_or_b32 v166, v166, -2, s43
    v_mfma_f32_16x16x32_bf16 v[204:207], a[152:155], v[192:195], v[204:207]
    buffer_store_dwordx4 v[164:167], v8, s[4:7], s36 offen sc1
    s_add_u32 s36, s36, 33792
    v_mfma_f32_16x16x32_bf16 v[200:203], a[140:143], v[196:199], v[200:203]
    v_mfma_f32_16x16x32_bf16 v[204:207], a[156:159], v[196:199], v[204:207]
    v_mfma_f32_16x16x32_bf16 v[208:211], a[160:163], v[184:187], 0
    v_mfma_f32_16x16x32_bf16 v[212:215], a[176:179], v[184:187], 0
    v_mfma_f32_16x16x32_bf16 v[208:211], a[164:167], v[188:191], v[208:211]
    v_cvt_pk_bf16_f32 v168, v200, v201
    v_cvt_pk_bf16_f32 v169, v202, v203
    v_mfma_f32_16x16x32_bf16 v[212:215], a[180:183], v[188:191], v[212:215]
    v_cvt_pk_bf16_f32 v170, v204, v205
    v_cvt_pk_bf16_f32 v171, v206, v207
    v_mfma_f32_16x16x32_bf16 v[208:211], a[168:171], v[192:195], v[208:211]
    v_and_or_b32 v168, v168, -2, s43
    v_and_or_b32 v170, v170, -2, s43
    v_mfma_f32_16x16x32_bf16 v[212:215], a[184:187], v[192:195], v[212:215]
    buffer_store_dwordx4 v[168:171], v8, s[4:7], s36 offen sc1
    s_add_u32 s36, s36, 33792
    v_mfma_f32_16x16x32_bf16 v[208:211], a[172:175], v[196:199], v[208:211]
    v_mfma_f32_16x16x32_bf16 v[212:215], a[188:191], v[196:199], v[212:215]
    v_mfma_f32_16x16x32_bf16 v[200:203], a[192:195], v[184:187], 0
    v_mfma_f32_16x16x32_bf16 v[204:207], a[208:211], v[184:187], 0
    v_mfma_f32_16x16x32_bf16 v[200:203], a[196:199], v[188:191], v[200:203]
    v_cvt_pk_bf16_f32 v172, v208, v209
    v_cvt_pk_bf16_f32 v173, v210, v211
    v_mfma_f32_16x16x32_bf16 v[204:207], a[212:215], v[188:191], v[204:207]
    v_cvt_pk_bf16_f32 v174, v212, v213
    v_cvt_pk_bf16_f32 v175, v214, v215
    v_mfma_f32_16x16x32_bf16 v[200:203], a[200:203], v[192:195], v[200:203]
    v_and_or_b32 v172, v172, -2, s43
    v_and_or_b32 v174, v174, -2, s43
    v_mfma_f32_16x16x32_bf16 v[204:207], a[216:219], v[192:195], v[204:207]
    buffer_store_dwordx4 v[172:175], v8, s[4:7], s36 offen sc1
    s_add_u32 s36, s36, 33792
    v_mfma_f32_16x16x32_bf16 v[200:203], a[204:207], v[196:199], v[200:203]
    v_mfma_f32_16x16x32_bf16 v[204:207], a[220:223], v[196:199], v[204:207]
    v_mfma_f32_16x16x32_bf16 v[208:211], a[224:227], v[184:187], 0
    v_mfma_f32_16x16x32_bf16 v[212:215], a[240:243], v[184:187], 0
    v_mfma_f32_16x16x32_bf16 v[208:211], a[228:231], v[188:191], v[208:211]
    v_cvt_pk_bf16_f32 v176, v200, v201
    v_cvt_pk_bf16_f32 v177, v202, v203
    v_mfma_f32_16x16x32_bf16 v[212:215], a[244:247], v[188:191], v[212:215]
    v_cvt_pk_bf16_f32 v178, v204, v205
    v_cvt_pk_bf16_f32 v179, v206, v207
    v_mfma_f32_16x16x32_bf16 v[208:211], a[232:235], v[192:195], v[208:211]
    v_and_or_b32 v176, v176, -2, s43
    v_and_or_b32 v178, v178, -2, s43
    v_mfma_f32_16x16x32_bf16 v[212:215], a[248:251], v[192:195], v[212:215]
    buffer_store_dwordx4 v[176:179], v8, s[4:7], s36 offen sc1
    s_add_u32 s36, s36, 33792
    v_mfma_f32_16x16x32_bf16 v[208:211], a[236:239], v[196:199], v[208:211]
    v_mfma_f32_16x16x32_bf16 v[212:215], a[252:255], v[196:199], v[212:215]
    s_nop 3
    v_cvt_pk_bf16_f32 v180, v208, v209
    v_cvt_pk_bf16_f32 v181, v210, v211
    s_nop 1
    v_cvt_pk_bf16_f32 v182, v212, v213
    v_cvt_pk_bf16_f32 v183, v214, v215
    v_and_or_b32 v180, v180, -2, s43
    v_and_or_b32 v182, v182, -2, s43
    buffer_store_dwordx4 v[180:183], v8, s[4:7], s36 offen sc1
    s_add_u32 s36, s36, 33792
    s_add_u32 s37, s50, 4096
    s_waitcnt vmcnt(0)
p3r_131:
    buffer_load_dwordx4 v[216:219], v1, s[4:7], s50 offen offset:0 sc1
    buffer_load_dwordx4 v[220:223], v1, s[4:7], s50 offen offset:1024 sc1
    buffer_load_dwordx4 v[224:227], v1, s[4:7], s50 offen offset:2048 sc1
    buffer_load_dwordx4 v[228:231], v1, s[4:7], s50 offen offset:3072 sc1
    buffer_load_dwordx4 v[232:235], v1, s[4:7], s37 offen offset:0 sc1
    buffer_load_dwordx4 v[236:239], v1, s[4:7], s37 offen offset:1024 sc1
    buffer_load_dwordx4 v[240:243], v1, s[4:7], s37 offen offset:2048 sc1
    buffer_load_dwordx4 v[244:247], v1, s[4:7], s37 offen offset:3072 sc1
    s_add_u32 s35, s35, 1
    s_cmp_ge_u32 s35, 524288
    s_waitcnt vmcnt(7)
    v_mfma_f32_16x16x32_bf16 v[108:111], v[16:19], v[216:219], 0
    v_bitop3_b32 v44, v216, v218, s43 bitop3:0x7e
    s_waitcnt vmcnt(6)
    v_mfma_f32_16x16x32_bf16 v[108:111], v[16:19], v[220:223], v[108:111]
    v_bitop3_b32 v45, v220, v222, s43 bitop3:0x7e
    v_or_b32 v44, v44, v45
    s_waitcnt vmcnt(5)
    v_mfma_f32_16x16x32_bf16 v[108:111], v[16:19], v[224:227], v[108:111]
    v_bitop3_b32 v45, v224, v226, s43 bitop3:0x7e
    v_or_b32 v44, v44, v45
    s_waitcnt vmcnt(4)
    v_mfma_f32_16x16x32_bf16 v[108:111], v[16:19], v[228:231], v[108:111]
    v_bitop3_b32 v45, v228, v230, s43 bitop3:0x7e
    v_or_b32 v44, v44, v45
    s_waitcnt vmcnt(3)
    v_mfma_f32_16x16x32_bf16 v[108:111], v[16:19], v[232:235], v[108:111]
    v_bitop3_b32 v45, v232, v234, s43 bitop3:0x7e
    v_or_b32 v44, v44, v45
    s_waitcnt vmcnt(2)
    v_mfma_f32_16x16x32_bf16 v[108:111], v[16:19], v[236:239], v[108:111]
    v_bitop3_b32 v45, v236, v238, s43 bitop3:0x7e
    v_or_b32 v44, v44, v45
    s_waitcnt vmcnt(1)
    v_mfma_f32_16x16x32_bf16 v[108:111], v[16:19], v[240:243], v[108:111]
    v_bitop3_b32 v45, v240, v242, s43 bitop3:0x7e
    v_or_b32 v44, v44, v45
    s_waitcnt vmcnt(0)
    v_mfma_f32_16x16x32_bf16 v[108:111], v[16:19], v[244:247], v[108:111]
    v_bitop3_b32 v45, v244, v246, s43 bitop3:0x7e
    v_or_b32 v44, v44, v45
    s_cbranch_scc1 p3f_132
    v_and_b32 v44, 1, v44
    v_cmp_ne_u32 vcc, 0, v44
    s_cbranch_vccnz p3r_131
p3f_132:
    s_nop 4
    v_cvt_pk_bf16_f32 v49, v108, v109
    v_lshlrev_b32 v48, 16, v49
    v_and_b32 v49, 0xffff0000, v49
    v_lshlrev_b32 v50, 16, v250
    v_and_b32 v51, 0xffff0000, v250
    v_mul_f32 v48, v48, v50
    v_mul_f32 v49, v49, v51
    v_cvt_pk_bf16_f32 v49, v48, v49
    v_lshlrev_b32 v48, 16, v49
    v_and_b32 v49, 0xffff0000, v49
    v_lshlrev_b32 v50, 16, v248
    v_and_b32 v51, 0xffff0000, v248
    v_add_f32 v48, v48, v50
    v_add_f32 v49, v49, v51
    v_cvt_pk_bf16_f32 v252, v48, v49
    v_cvt_pk_bf16_f32 v49, v110, v111
    v_lshlrev_b32 v48, 16, v49
    v_and_b32 v49, 0xffff0000, v49
    v_lshlrev_b32 v50, 16, v251
    v_and_b32 v51, 0xffff0000, v251
    v_mul_f32 v48, v48, v50
    v_mul_f32 v49, v49, v51
    v_cvt_pk_bf16_f32 v49, v48, v49
    v_lshlrev_b32 v48, 16, v49
    v_and_b32 v49, 0xffff0000, v49
    v_lshlrev_b32 v50, 16, v249
    v_and_b32 v51, 0xffff0000, v249
    v_add_f32 v48, v48, v50
    v_add_f32 v49, v49, v51
    v_cvt_pk_bf16_f32 v253, v48, v49
    buffer_store_dwordx2 v[252:253], v9, s[20:23], s54 offen
    s_xor_b32 s51, s51, 2097152
    s_xor_b32 s50, s50, 2097152
    s_and_b32 s36, s40, 1
    s_xor_b32 s43, s43, s36
    s_add_u32 s49, s49, 98304
    s_add_u32 s41, s41, 98304
    s_add_u32 s54, s54, 98304
    s_add_u32 s45, s45, 3
    s_add_u32 s40, s40, 1
    s_cmp_lt_u32 s45, 64
    s_cbranch_scc1 p3_124
    s_branch L_exit
L_exit:
    s_endpgm
L_end:
.section .rodata,"a"
.p2align 6
.amdhsa_kernel recurrent_scan__memory_aug_recurrent_mem_tr__glu_gated_bilinear__prompt_kernel
  .amdhsa_next_free_vgpr 512
  .amdhsa_next_free_sgpr 102
  .amdhsa_accum_offset 256
  .amdhsa_group_segment_fixed_size 0
  .amdhsa_kernarg_size 112
  .amdhsa_user_sgpr_count 2
  .amdhsa_user_sgpr_kernarg_segment_ptr 1
  .amdhsa_system_sgpr_workgroup_id_x 1
.end_amdhsa_kernel
```
